```python
import torch

def _softmax(x, axis=-1):
    return torch.softmax(x, dim=axis)
def _gelu(x):
    return torch.nn.functional.gelu(x, approximate="tanh")
def _silu(x):
    return torch.nn.functional.silu(x)
def _sigmoid(x):
    return torch.sigmoid(x)
def _layernorm(x, axis=-1, eps=1e-5):
    m = x.mean(dim=axis, keepdim=True)
    v = x.var(dim=axis, keepdim=True, unbiased=False)
    return (x - m) / torch.sqrt(v + eps)
def _scatter_add(tgt, idx, src, axis=0):
    return tgt.clone().index_add_(axis, idx, src)
def _segment_sum(src, seg, n):
    out = torch.zeros((n,) + src.shape[1:], dtype=src.dtype)
    return out.index_add_(0, seg, src)
def _pad(x, pw):
    flat = tuple(v for pair in reversed(pw) for v in pair)
    return torch.nn.functional.pad(x, flat)

kernel_name = 'recurrent_scan__sliding_block_cached__dense_activation_gelu__prompt'

def setup_inputs():

    _w = (lambda a: (lambda t: t.to(torch.bfloat16) if t.is_floating_point() else t)(torch.as_tensor(a)))
    def _A_setup():
        B, Sq, D = 1, 2048, 448
        Hq, Hkv, Sk, Dh = 16, 8, 2048, 256
        assert Hq % Hkv == 0, (Hq, Hkv)
        return {
            "x": _w((lambda *s: torch.randn(*s, dtype=torch.bfloat16) * 0.05)(B, Sq, D)),
            "k_cache": _w((lambda *s: torch.randn(*s, dtype=torch.bfloat16) * 3.2)(B, Hkv, Sk, Dh)),
            "v_cache": _w((lambda *s: torch.randn(*s, dtype=torch.bfloat16) * 3.2)(B, Hkv, Sk, Dh)),
            "wq": _w((lambda *s: torch.randn(*s, dtype=torch.bfloat16) * 3.2)(D, Hq * Dh) * (D ** -0.5)),
            "wo": _w((lambda *s: torch.randn(*s, dtype=torch.bfloat16) * 3.2)(Hq * Dh, D) * ((Hq * Dh) ** -0.5)),
        }
    _A_in = _A_setup()

    def _B_setup():
        B, S, D, F = 1, 2048, 448, 1792
        return {
            "x": _w((lambda *s: torch.randn(*s, dtype=torch.bfloat16) * 0.05)(B, S, D)),
            "w1": _w((lambda *s: torch.randn(*s, dtype=torch.bfloat16) * 3.2)(D, F) * (D ** -0.5)),
            "b1": _w((lambda *s: torch.randn(*s, dtype=torch.bfloat16) * 3.2)(F) * 0.01),
            "w2": _w((lambda *s: torch.randn(*s, dtype=torch.bfloat16) * 0.4)(F, D) * (F ** -0.5)),
            "b2": _w((lambda *s: torch.randn(*s, dtype=torch.bfloat16) * 0.4)(D) * 0.01),
        }
    _B_in = _B_setup()

    return {
        "A_x": _A_in["x"],
        "A_k_cache": _A_in["k_cache"],
        "A_v_cache": _A_in["v_cache"],
        "A_wq": _A_in["wq"],
        "A_wo": _A_in["wo"],
        "B_x": _B_in["x"],
        "B_w1": _B_in["w1"],
        "B_b1": _B_in["b1"],
        "B_w2": _B_in["w2"],
        "B_b2": _B_in["b2"],
    }

def reference(A_x, A_k_cache, A_v_cache, A_wq, A_wo, B_x, B_w1, B_b1, B_w2, B_b2):
    def _A_ref(x, k_cache, v_cache, wq, wo):
        B, Sq, D = x.shape
        Hq, Dh = 16, 256
        Hkv, Sk = k_cache.shape[1], k_cache.shape[2]
        W = min(4096, max(256, Sk // 4))
        rep = Hq // Hkv
        q = (lambda x, *d: x.permute(*d))((x @ wq).reshape(B, Sq, Hq, Dh), 0, 2, 1, 3)
        k = (lambda x, n, axis: torch.repeat_interleave(x, n, dim=axis))(k_cache[:, :, Sk - W:, :], rep, axis=1)
        v = (lambda x, n, axis: torch.repeat_interleave(x, n, dim=axis))(v_cache[:, :, Sk - W:, :], rep, axis=1)
        scores = torch.einsum("bhqd,bhkd->bhqk", q, k) * (Dh ** -0.5)
        p = _softmax(scores, axis=-1)
        o = torch.einsum("bhqk,bhkd->bhqd", p, v)
        return (lambda x, *d: x.permute(*d))(o, 0, 2, 1, 3).reshape(B, Sq, Hq * Dh) @ wo

    def _B_ref(x, w1, b1, w2, b2):
        h = torch.einsum("bsd,df->bsf", x, w1) + b1
        h = _gelu(h)
        return torch.einsum("bsf,fd->bsd", h, w2) + b2

    x = A_x
    xn = _layernorm(x, axis=-1)
    s = _A_ref(xn, A_k_cache, A_v_cache, A_wq, A_wo)
    g = _silu(_B_ref(xn, B_w1, B_b1, B_w2, B_b2))
    return x + s * g
```

```asm
; @launch grid=(256,1,1) block=(256,1,1) lds=163840
.amdgcn_target "amdgcn-amd-amdhsa--gfx950"
.text
.globl recurrent_scan__sliding_block_cached__dense_activation_gelu__prompt_kernel
.p2align 8
.type recurrent_scan__sliding_block_cached__dense_activation_gelu__prompt_kernel,@function
recurrent_scan__sliding_block_cached__dense_activation_gelu__prompt_kernel:
  s_cmp_ge_u32 s2, 256
  s_cbranch_scc1 L_end
  s_load_dwordx16 s[4:19], s[0:1], 0
  s_load_dwordx8 s[20:27], s[0:1], 64
  s_load_dwordx2 s[28:29], s[0:1], 96
  s_memrealtime s[92:93]
  s_getpc_b64 s[36:37]
L_pc:
  s_mov_b32 s38, L_code_end-L_pc
  s_mov_b32 s39, 0x00020000
  s_bfe_u32 s99, s2, 0x40003
  s_lshl_b32 s99, s99, 13
  v_and_b32 v144, 48, v0
  v_lshlrev_b32 v144, 24, v144
  v_lshrrev_b32 v145, 2, v0
  v_and_b32 v145, 48, v145
  v_and_or_b32 v145, v0, 15, v145
  v_lshl_add_u32 v144, v145, 7, v144
  buffer_load_dword a252, v144, s[36:39], s99 offen offset:0
  v_lshrrev_b32 v135, 6, v0
  v_bfe_u32 v130, v0, 5, 1
  v_readfirstlane_b32 s3, v135
  v_bfe_u32 v132, v0, 2, 2
  v_and_b32 v133, 3, v0
  v_bfe_u32 v139, v0, 4, 1
  s_lshr_b32 s97, s2, 5
  s_bfe_u32 s99, s2, 0x10002
  s_lshl1_add_u32 s97, s97, s99
  s_lshl_b32 s31, s3, 12
  s_lshl2_add_u32 s99, s97, s3
  s_lshl_b32 s99, s99, 5
  v_lshl_add_u32 v140, v130, 2, v132
  v_add_u32 v136, s99, v140
  v_mul_u32_u24 v136, 896, v136
  v_lshl_add_u32 v136, v139, 6, v136
  v_xor_b32 v141, v130, v133
  v_lshl_add_u32 v136, v141, 4, v136
  s_bfe_u32 s100, s2, 0x20003
  s_add_u32 s99, s100, 0
  s_and_b32 s99, s99, 3
  s_lshl_b32 s64, s99, 10
  s_mul_i32 s101, s99, 7168
  s_and_b32 s99, s99, 1
  s_lshl_b32 s99, s99, 5
  v_xor_b32 v148, s99, v136
  v_add_u32 v148, s101, v148
  s_add_u32 s64, s64, s31
  s_lshr_b32 s99, s2, 5
  s_sub_u32 s101, s99, 7
  s_min_u32 s98, s99, s101
  s_mov_b32 s34, 0x001c0000
  s_mov_b32 s35, 0x00020000
  s_waitcnt lgkmcnt(0)
  s_mov_b32 s14, s98
  s_mov_b64 s[32:33], s[4:5]
  s_add_u32 m0, s64, 49152
  s_lshl_b32 s1, s98, 7
  s_mov_b32 s0, 7
  L_x1:
  buffer_load_dwordx4 v148, s[32:35], s1 offen offset:0 lds
  s_add_u32 m0, m0, 16384
  s_add_u32 s1, s1, 128
  s_cmp_eq_u32 s1, 896
  s_cselect_b32 s1, 0, s1
  s_sub_u32 s0, s0, 1
  s_cmp_lg_u32 s0, 0
  s_cbranch_scc1 L_x1
  s_and_b32 s96, s2, 3
  s_bfe_u32 s99, s2, 0x20003
  s_lshl2_add_u32 s96, s96, s99
  v_and_b32 v128, 63, v0
  v_lshrrev_b32 v131, 4, v128
  v_and_b32 v129, 31, v128
  v_lshlrev_b32 v137, 6, v131
  v_lshl_add_u32 v137, v133, 4, v137
  s_lshl_b32 s100, s3, 2
  v_add_u32 v138, s100, v132
  v_lshl_add_u32 v1, v138, 13, v137
  s_lshl_b32 s99, s96, 9
  s_mov_b32 s36, s10
  s_mov_b32 s37, s11
  s_add_u32 s36, s36, s99
  s_addc_u32 s37, s37, 0
  s_mov_b32 s38, 0x00380000
  s_sub_u32 s38, s38, s99
  s_mov_b32 s39, 0x00020000
  s_sub_u32 s40, s36, 0x00000300
  s_subb_u32 s41, s37, 0
  s_add_u32 s42, s38, 0x00000300
  s_mov_b32 s43, 0x00020000
  s_lshl_b32 s15, s14, 19
  s_add_u32 m0, s31, 0
  s_add_u32 s99, s15, 0
  buffer_load_dwordx4 v1, s[36:39], s99 offen offset:0 lds
  buffer_load_dwordx4 v1, s[40:43], s99 offen offset:1024 lds
  s_add_u32 s99, s15, 129024
  buffer_load_dwordx4 v1, s[36:39], s99 offen offset:2048 lds
  buffer_load_dwordx4 v1, s[40:43], s99 offen offset:3072 lds
  s_bfe_u32 s100, s2, 0x20003
  s_add_u32 s99, s100, 1
  s_and_b32 s99, s99, 3
  s_lshl_b32 s65, s99, 10
  s_mul_i32 s101, s99, 7168
  s_and_b32 s99, s99, 1
  s_lshl_b32 s99, s99, 5
  v_xor_b32 v149, s99, v136
  v_add_u32 v149, s101, v149
  s_add_u32 s65, s65, s31
  s_add_u32 s99, s100, 2
  s_and_b32 s99, s99, 3
  s_lshl_b32 s66, s99, 10
  s_mul_i32 s101, s99, 7168
  s_and_b32 s99, s99, 1
  s_lshl_b32 s99, s99, 5
  v_xor_b32 v150, s99, v136
  v_add_u32 v150, s101, v150
  s_add_u32 s66, s66, s31
  s_add_u32 s99, s100, 3
  s_and_b32 s99, s99, 3
  s_lshl_b32 s67, s99, 10
  s_mul_i32 s101, s99, 7168
  s_and_b32 s99, s99, 1
  s_lshl_b32 s99, s99, 5
  v_xor_b32 v151, s99, v136
  v_add_u32 v151, s101, v151
  s_add_u32 s67, s67, s31
  v_mul_u32_u24 v2, 3584, v138
  v_add_u32 v2, v2, v137
  s_lshr_b32 s99, s96, 1
  s_lshl_b32 s99, s99, 20
  s_add_u32 s99, s99, 786432
  s_add_u32 s6, s6, s99
  s_addc_u32 s7, s7, 0
  s_add_u32 s68, s8, s99
  s_addc_u32 s69, s9, 0
  s_mul_i32 s99, s96, 229376
  s_add_u32 s12, s12, s99
  s_addc_u32 s13, s13, 0
  s_and_b32 s15, s96, 1
  s_lshl_b32 s99, s97, 1
  s_lshr_b32 s99, 0x5f5f5f5f, s99
  s_and_b32 s99, s99, 3
  s_lshl2_add_u32 s99, s99, 2
  s_sub_u32 s100, s96, s99
  s_sub_u32 s101, s96, 2
  s_cmp_lt_u32 s96, s99
  s_cselect_b32 s101, s96, s101
  s_add_u32 s99, s100, 14
  s_cmp_lt_u32 s100, 2
  s_cselect_b32 s96, s99, s101
  s_cmp_lt_u32 s96, 14
  s_cselect_b32 s98, s96, 0
  s_lshl_b32 s99, s98, 8
  s_mov_b32 s44, s16
  s_mov_b32 s45, s17
  s_add_u32 s44, s44, s99
  s_addc_u32 s45, s45, 0
  s_sub_u32 s44, s44, 0x00000c00
  s_subb_u32 s45, s45, 0
  s_mov_b32 s46, 0x00188c00
  s_sub_u32 s46, s46, s99
  s_mov_b32 s47, 0x00020000
  s_cmp_lt_u32 s96, 14
  s_cselect_b32 s46, s46, 0
  v_mov_b32 v159, 0x7f000000
  s_lshr_b32 s100, s97, 1
  s_lshl2_add_u32 s100, s100, s3
  s_mul_i32 s101, s100, 56
  v_add_u32 v146, s101, v128
  v_lshlrev_b32 v146, 7, v146
  v_cmp_gt_u32 vcc, 28, v128
  s_nop 1
  v_cndmask_b32 v146, v159, v146, vcc
  v_accvgpr_write_b32 a250, v146
  s_lshr_b32 s101, s97, 3
  s_lshl2_add_u32 s101, s101, s3
  s_mul_i32 s101, s101, 112
  v_add_u32 v146, s101, v128
  v_lshlrev_b32 v146, 7, v146
  v_cndmask_b32 v146, v159, v146, vcc
  v_accvgpr_write_b32 a249, v146
  s_andn2_b32 s92, s92, 6
  s_or_b32 s92, s92, 1
  v_mov_b32 v152, s92
  v_accvgpr_write_b32 a251, s92
  s_mov_b32 s48, s6
  s_mov_b32 s49, s7
  s_mov_b32 s50, 0x00040000
  s_mov_b32 s51, 0x00020000
  s_sub_u32 s52, s48, 0x00000380
  s_subb_u32 s53, s49, 0
  s_add_u32 s54, s50, 0x00000380
  s_mov_b32 s55, 0x00020000
  s_sub_u32 s56, s48, 0x00000700
  s_subb_u32 s57, s49, 0
  s_add_u32 s58, s50, 0x00000700
  s_mov_b32 s59, 0x00020000
  s_sub_u32 s60, s48, 0x00000a80
  s_subb_u32 s61, s49, 0
  s_add_u32 s62, s50, 0x00000a80
  s_mov_b32 s63, 0x00020000
  s_mul_i32 s99, s98, 114688
  s_mov_b32 s72, s20
  s_mov_b32 s73, s21
  s_add_u32 s72, s72, s99
  s_addc_u32 s73, s73, 0
  s_mov_b32 s74, 0x00188000
  s_sub_u32 s74, s74, s99
  s_mov_b32 s75, 0x00020000
  s_add_u32 s76, s72, 0x00001800
  s_addc_u32 s77, s73, 0
  s_sub_u32 s78, s74, 0x00001800
  s_mov_b32 s79, 0x00020000
  s_add_u32 s80, s72, 0x00003000
  s_addc_u32 s81, s73, 0
  s_sub_u32 s82, s74, 0x00003000
  s_mov_b32 s83, 0x00020000
  s_add_u32 s84, s72, 0x00004800
  s_addc_u32 s85, s73, 0
  s_sub_u32 s86, s74, 0x00004800
  s_mov_b32 s87, 0x00020000
  s_cmp_lt_u32 s96, 14
  s_cselect_b32 s74, s74, 0
  s_cmp_lt_u32 s96, 14
  s_cselect_b32 s78, s78, 0
  s_cmp_lt_u32 s96, 14
  s_cselect_b32 s82, s82, 0
  s_cmp_lt_u32 s96, 14
  s_cselect_b32 s86, s86, 0
  s_mov_b32 s88, s28
  s_mov_b32 s89, s29
  s_mov_b32 s90, 0x10000000
  s_mov_b32 s91, 0x00020000
  s_mov_b32 s92, s18
  s_mov_b32 s93, s19
  s_mov_b32 s94, 0x00000e00
  s_mov_b32 s95, 0x00020000
  v_lshlrev_b32 v134, 6, v132
  v_lshl_add_u32 v134, v139, 5, v134
  v_and_b32 v142, 1, v133
  v_lshl_add_u32 v134, v142, 4, v134
  v_lshrrev_b32 v142, 1, v133
  v_lshl_add_u32 v134, v142, 3, v134
  v_lshl_add_u32 v3, v130, 13, v134
  v_lshl_add_u32 v142, v130, 11, v134
  v_accvgpr_write_b32 a240, v142
  v_lshl_add_u32 v142, v130, 10, v134
  v_accvgpr_write_b32 a241, v142
  s_lshl_b32 s100, s3, 3
  v_add_u32 v142, s100, v132
  v_lshl_add_u32 v142, v142, 9, v137
  v_accvgpr_write_b32 a242, v142
  s_lshl_b32 s100, s3, 5
  v_add_u32 v142, s100, v140
  v_mul_u32_u24 v142, 896, v142
  s_and_b32 s101, s96, 1
  s_xor_b32 s101, s101, 1
  v_xor_b32 v143, s101, v139
  v_lshl_add_u32 v142, v143, 6, v142
  v_lshl_add_u32 v142, v133, 4, v142
  v_accvgpr_write_b32 a243, v142
  s_lshl_b32 s100, s3, 3
  v_add_u32 v142, s100, v140
  v_lshlrev_b32 v4, 9, v142
  v_lshl_add_u32 v4, v139, 6, v4
  s_and_b32 s100, s3, 1
  s_lshl_b32 s100, s100, 1
  v_xor_b32 v142, s100, v141
  v_lshl_add_u32 v4, v142, 4, v4
  v_lshlrev_b32 v142, 6, v133
  v_and_b32 v143, 1, v132
  v_lshl_add_u32 v142, v143, 9, v142
  v_xor_b32 v143, v130, v132
  v_lshl_add_u32 v142, v143, 4, v142
  v_lshrrev_b32 v143, 3, v129
  v_lshl_add_u32 v144, v143, 12, v142
  v_accvgpr_write_b32 a244, v144
  v_xor_b32 v144, 32, v144
  v_accvgpr_write_b32 a245, v144
  v_lshl_add_u32 v155, v143, 10, v142
  v_add_u32 v155, s31, v155
  v_add_u32 v155, 49152, v155
  v_xor_b32 v156, 32, v155
  v_add_u32 v157, 65536, v155
  v_add_u32 v158, 65536, v156
  v_lshlrev_b32 v143, 4, v128
  v_accvgpr_write_b32 a246, v143
  v_and_b32 v143, 19, v129
  v_bfe_u32 v144, v129, 2, 1
  v_lshl_add_u32 v143, v144, 3, v143
  v_bfe_u32 v144, v129, 3, 1
  v_lshl_add_u32 v143, v144, 2, v143
  v_accvgpr_write_b32 a247, v143
  s_lshl_b32 s100, s98, 7
  v_add_u32 v143, s100, v143
  v_lshlrev_b32 v143, 1, v143
  v_lshl_add_u32 v143, v130, 20, v143
  v_accvgpr_write_b32 a225, 0
  v_accvgpr_write_b32 a226, 0
  v_accvgpr_write_b32 a227, 0
  v_accvgpr_write_b32 a229, 0
  v_accvgpr_write_b32 a230, 0
  v_accvgpr_write_b32 a231, 0
  v_accvgpr_write_b32 a233, 0
  v_accvgpr_write_b32 a234, 0
  v_accvgpr_write_b32 a235, 0
  v_accvgpr_write_b32 a237, 0
  v_accvgpr_write_b32 a238, 0
  v_accvgpr_write_b32 a239, 0
  s_mov_b64 s[70:71], s[26:27]
  s_mov_b32 s26, s14
  s_lshr_b32 s100, s96, 1
  s_add_u32 s100, s100, 1
  s_sub_u32 s99, s100, 7
  s_min_u32 s100, s100, s99
  s_lshl_b32 s14, s100, 7
  s_add_u32 s100, s100, 1
  s_sub_u32 s99, s100, 7
  s_min_u32 s100, s100, s99
  s_lshl_b32 s15, s100, 7
  s_add_u32 s100, s100, 1
  s_sub_u32 s99, s100, 7
  s_min_u32 s100, s100, s99
  s_lshl_b32 s16, s100, 7
  s_add_u32 s100, s100, 1
  s_sub_u32 s99, s100, 7
  s_min_u32 s100, s100, s99
  s_lshl_b32 s17, s100, 7
  s_add_u32 s100, s100, 1
  s_sub_u32 s99, s100, 7
  s_min_u32 s100, s100, s99
  s_lshl_b32 s18, s100, 7
  s_add_u32 s100, s100, 1
  s_sub_u32 s99, s100, 7
  s_min_u32 s100, s100, s99
  s_lshl_b32 s19, s100, 7
  s_add_u32 s100, s100, 1
  s_sub_u32 s99, s100, 7
  s_min_u32 s100, s100, s99
  s_lshl_b32 s20, s100, 7
  s_lshl_b32 s100, s3, 11
  s_and_b32 s9, s97, 1
  s_lshl_b32 s9, s9, 21
  s_lshr_b32 s99, s97, 1
  s_lshl_b32 s99, s99, 18
  s_add_u32 s9, s9, s99
  s_add_u32 s9, s9, 0
  s_mul_i32 s99, s96, 16384
  s_add_u32 s9, s9, s99
  s_add_u32 s9, s9, s100
  s_add_u32 s9, s9, 0x00000000
  s_xor_b32 s99, s101, 1
  s_mul_i32 s99, s99, 4194304
  s_add_u32 s10, s9, s99
  s_mul_i32 s99, s101, 4194304
  s_add_u32 s9, s9, s99
  s_and_b32 s21, s97, 1
  s_lshl_b32 s21, s21, 21
  s_lshr_b32 s99, s97, 1
  s_lshl_b32 s99, s99, 18
  s_add_u32 s21, s21, s99
  s_add_u32 s21, s21, 0
  s_mul_i32 s99, s98, 16384
  s_add_u32 s21, s21, s99
  s_add_u32 s21, s21, s100
  s_add_u32 s21, s21, 0x04000000
  s_cmp_lt_u32 s96, 14
  s_cselect_b32 s21, s21, 0x7f000000
  s_xor_b32 s99, s101, 1
  s_mul_i32 s99, s99, 4194304
  s_add_u32 s27, s21, s99
  s_mul_i32 s99, s101, 4194304
  s_add_u32 s21, s21, s99
  s_mov_b32 s11, 0x3c0a3963
  s_and_b32 s28, s97, 1
  s_lshl_b32 s28, s28, 21
  s_lshr_b32 s99, s97, 1
  s_lshl_b32 s99, s99, 18
  s_add_u32 s28, s28, s99
  s_add_u32 s28, s28, 0
  s_lshl_b32 s99, s3, 8
  s_add_u32 s28, s28, s99
  s_add_u32 s28, s28, 0x00404000
  s_and_b32 s29, s97, 1
  s_lshl_b32 s29, s29, 21
  s_lshr_b32 s99, s97, 1
  s_lshl_b32 s99, s99, 18
  s_add_u32 s29, s29, s99
  s_add_u32 s29, s29, 0
  s_add_u32 s29, s29, s100
  s_min_u32 s99, s96, 13
  s_mul_i32 s30, s99, 4194304
  s_add_u32 s30, s30, s29
  s_add_u32 s30, s30, 0x04000000
  s_mul_i32 s99, s99, 4194304
  s_add_u32 s29, s29, s99
  s_add_u32 s29, s29, 0x00000000
  v_mov_b32 v8, 0x3f803f80
  v_mov_b32 v9, 0x3f803f80
  v_mov_b32 v10, 0x3f803f80
  v_mov_b32 v11, 0x3f803f80
  v_mov_b32 v6, 0
  v_mov_b32 v7, 0
  s_mov_b64 exec, 0
  s_cmp_lt_u32 s96, 14
  s_cbranch_scc0 L_walk_l
  s_cmp_eq_u32 s3, 0
  s_cbranch_scc1 L_padh0
  s_cmp_eq_u32 s3, 1
  s_cbranch_scc1 L_padh1
  s_cmp_eq_u32 s3, 2
  s_cbranch_scc1 L_padh2
  s_branch L_padh3
  L_walk_l:
  s_cmp_eq_u32 s3, 0
  s_cbranch_scc1 L_padl0
  s_cmp_eq_u32 s3, 1
  s_cbranch_scc1 L_padl1
  s_cmp_eq_u32 s3, 2
  s_cbranch_scc1 L_padl2
  s_branch L_padl3
  L_walk_done:
  s_mov_b64 exec, -1
  s_add_u32 m0, s65, 49152
  s_nop 0
  buffer_load_dwordx4 v149, s[32:35], s1 offen offset:0 lds
  s_add_u32 m0, s66, 49152
  s_nop 0
  buffer_load_dwordx4 v150, s[32:35], s1 offen offset:0 lds
  s_add_u32 m0, s67, 49152
  s_nop 0
  buffer_load_dwordx4 v151, s[32:35], s1 offen offset:0 lds
  s_add_u32 s1, s1, 128
  s_cmp_eq_u32 s1, 896
  s_cselect_b32 s1, 0, s1
  s_add_u32 m0, s65, 65536
  s_nop 0
  buffer_load_dwordx4 v149, s[32:35], s1 offen offset:0 lds
  s_add_u32 m0, s66, 65536
  s_nop 0
  buffer_load_dwordx4 v150, s[32:35], s1 offen offset:0 lds
  s_add_u32 m0, s67, 65536
  s_nop 0
  buffer_load_dwordx4 v151, s[32:35], s1 offen offset:0 lds
  s_add_u32 s1, s1, 128
  s_cmp_eq_u32 s1, 896
  s_cselect_b32 s1, 0, s1
  s_add_u32 m0, s65, 81920
  s_nop 0
  buffer_load_dwordx4 v149, s[32:35], s1 offen offset:0 lds
  s_add_u32 m0, s66, 81920
  s_nop 0
  buffer_load_dwordx4 v150, s[32:35], s1 offen offset:0 lds
  s_add_u32 m0, s67, 81920
  s_nop 0
  buffer_load_dwordx4 v151, s[32:35], s1 offen offset:0 lds
  s_add_u32 s1, s1, 128
  s_cmp_eq_u32 s1, 896
  s_cselect_b32 s1, 0, s1
  s_add_u32 m0, s65, 98304
  s_nop 0
  buffer_load_dwordx4 v149, s[32:35], s1 offen offset:0 lds
  s_add_u32 m0, s66, 98304
  s_nop 0
  buffer_load_dwordx4 v150, s[32:35], s1 offen offset:0 lds
  s_add_u32 m0, s67, 98304
  s_nop 0
  buffer_load_dwordx4 v151, s[32:35], s1 offen offset:0 lds
  s_add_u32 s1, s1, 128
  s_cmp_eq_u32 s1, 896
  s_cselect_b32 s1, 0, s1
  s_add_u32 m0, s65, 114688
  s_nop 0
  buffer_load_dwordx4 v149, s[32:35], s1 offen offset:0 lds
  s_add_u32 m0, s66, 114688
  s_nop 0
  buffer_load_dwordx4 v150, s[32:35], s1 offen offset:0 lds
  s_add_u32 m0, s67, 114688
  s_nop 0
  buffer_load_dwordx4 v151, s[32:35], s1 offen offset:0 lds
  s_add_u32 s1, s1, 128
  s_cmp_eq_u32 s1, 896
  s_cselect_b32 s1, 0, s1
  s_waitcnt vmcnt(12)
  ds_read_b128 v[16:19], v155 offset:0
  ds_read_b128 v[20:23], v156 offset:0
  ds_read_b128 v[24:27], v155 offset:256
  ds_read_b128 v[28:31], v156 offset:256
  s_add_u32 m0, s65, 131072
  s_nop 0
  buffer_load_dwordx4 v149, s[32:35], s1 offen offset:0 lds
  s_add_u32 m0, s66, 131072
  s_nop 0
  buffer_load_dwordx4 v150, s[32:35], s1 offen offset:0 lds
  s_add_u32 m0, s67, 131072
  s_nop 0
  buffer_load_dwordx4 v151, s[32:35], s1 offen offset:0 lds
  s_add_u32 s1, s1, 128
  s_cmp_eq_u32 s1, 896
  s_cselect_b32 s1, 0, s1
  s_waitcnt vmcnt(12)
  ds_read_b128 v[32:35], v155 offset:16384
  ds_read_b128 v[36:39], v156 offset:16384
  ds_read_b128 v[40:43], v155 offset:16640
  ds_read_b128 v[44:47], v156 offset:16640
  s_waitcnt lgkmcnt(7)
  v_mfma_f32_32x32x16_bf16 a[192:207], v[8:11], v[16:19], 0
  s_waitcnt lgkmcnt(6)
  v_mfma_f32_32x32x16_bf16 a[192:207], v[8:11], v[20:23], a[192:207]
  s_waitcnt lgkmcnt(5)
  v_mfma_f32_32x32x16_bf16 a[192:207], v[8:11], v[24:27], a[192:207]
  s_waitcnt lgkmcnt(0)
  v_mfma_f32_32x32x16_bf16 a[192:207], v[8:11], v[28:31], a[192:207]
  s_add_u32 m0, s65, 147456
  s_nop 0
  buffer_load_dwordx4 v149, s[32:35], s1 offen offset:0 lds
  s_add_u32 m0, s66, 147456
  s_nop 0
  buffer_load_dwordx4 v150, s[32:35], s1 offen offset:0 lds
  s_add_u32 m0, s67, 147456
  s_nop 0
  buffer_load_dwordx4 v151, s[32:35], s1 offen offset:0 lds
  s_waitcnt vmcnt(12)
  ds_read_b128 v[48:51], v155 offset:32768
  ds_read_b128 v[52:55], v156 offset:32768
  ds_read_b128 v[56:59], v155 offset:33024
  ds_read_b128 v[60:63], v156 offset:33024
  v_mfma_f32_32x32x16_bf16 a[192:207], v[8:11], v[32:35], a[192:207]
  v_mfma_f32_32x32x16_bf16 a[192:207], v[8:11], v[36:39], a[192:207]
  v_mfma_f32_32x32x16_bf16 a[192:207], v[8:11], v[40:43], a[192:207]
  v_mfma_f32_32x32x16_bf16 a[192:207], v[8:11], v[44:47], a[192:207]
  s_lshl_b32 s7, s26, 19
  s_mul_i32 s8, s26, 229376
  s_add_u32 m0, s31, 16384
  s_add_u32 s0, s7, 262144
  buffer_load_dwordx4 v1, s[36:39], s0 offen offset:0 lds
  buffer_load_dwordx4 v1, s[40:43], s0 offen offset:1024 lds
  s_add_u32 s0, s7, 391168
  buffer_load_dwordx4 v1, s[36:39], s0 offen offset:2048 lds
  buffer_load_dwordx4 v1, s[40:43], s0 offen offset:3072 lds
  s_add_u32 m0, s31, 32768
  s_add_u32 s1, s8, 3072
  buffer_load_dwordx4 v2, s[44:47], s1 offen offset:0 lds
  s_add_u32 s1, s8, 59392
  buffer_load_dwordx4 v2, s[44:47], s1 offen offset:1024 lds
  s_add_u32 s1, s8, 115712
  buffer_load_dwordx4 v2, s[44:47], s1 offen offset:2048 lds
  s_add_u32 s1, s8, 172032
  buffer_load_dwordx4 v2, s[44:47], s1 offen offset:3072 lds
  buffer_load_ushort a224, v143, s[92:95], 0 offen offset:0
  buffer_load_ushort a228, v143, s[92:95], 0 offen offset:64
  buffer_load_ushort a232, v143, s[92:95], 0 offen offset:128
  buffer_load_ushort a236, v143, s[92:95], 0 offen offset:192
  s_mov_b32 s92, s70
  s_mov_b32 s93, s71
  s_mov_b32 s94, 0x00000100
  s_mov_b32 s95, 0x00020000
  s_lshl_b32 s99, s97, 4
  s_lshl2_add_u32 s100, s96, s3
  s_cmp_eq_u32 s100, 56
  s_cselect_b32 s100, s99, 4096
  buffer_store_dword v152, off, s[92:95], s100 sc1
  s_mov_b32 s64, s68
  s_mov_b32 s65, s69
  s_mov_b32 s66, 0x00040000
  s_mov_b32 s67, 0x00020000
  s_sub_u32 s68, s64, 0x00000300
  s_subb_u32 s69, s65, 0
  s_add_u32 s70, s66, 0x00000300
  s_mov_b32 s71, 0x00020000
  s_waitcnt vmcnt(22)
  ds_read_b128 v[64:67], v155 offset:49152
  ds_read_b128 v[68:71], v156 offset:49152
  ds_read_b128 v[72:75], v155 offset:49408
  ds_read_b128 v[76:79], v156 offset:49408
  s_waitcnt lgkmcnt(4)
  v_mfma_f32_32x32x16_bf16 a[192:207], v[8:11], v[48:51], a[192:207]
  v_mfma_f32_32x32x16_bf16 a[192:207], v[8:11], v[52:55], a[192:207]
  v_mfma_f32_32x32x16_bf16 a[192:207], v[8:11], v[56:59], a[192:207]
  v_mfma_f32_32x32x16_bf16 a[192:207], v[8:11], v[60:63], a[192:207]
  s_waitcnt vmcnt(19)
  ds_read_b128 v[80:83], v157 offset:0
  ds_read_b128 v[84:87], v158 offset:0
  ds_read_b128 v[88:91], v157 offset:256
  ds_read_b128 v[92:95], v158 offset:256
  s_waitcnt lgkmcnt(4)
  v_mfma_f32_32x32x16_bf16 a[192:207], v[8:11], v[64:67], a[192:207]
  v_mfma_f32_32x32x16_bf16 a[192:207], v[8:11], v[68:71], a[192:207]
  v_mfma_f32_32x32x16_bf16 a[192:207], v[8:11], v[72:75], a[192:207]
  v_mfma_f32_32x32x16_bf16 a[192:207], v[8:11], v[76:79], a[192:207]
  s_waitcnt vmcnt(16)
  ds_read_b128 v[96:99], v157 offset:16384
  ds_read_b128 v[100:103], v158 offset:16384
  ds_read_b128 v[104:107], v157 offset:16640
  ds_read_b128 v[108:111], v158 offset:16640
  s_waitcnt lgkmcnt(4)
  v_mfma_f32_32x32x16_bf16 a[192:207], v[8:11], v[80:83], a[192:207]
  v_mfma_f32_32x32x16_bf16 a[192:207], v[8:11], v[84:87], a[192:207]
  v_mfma_f32_32x32x16_bf16 a[192:207], v[8:11], v[88:91], a[192:207]
  v_mfma_f32_32x32x16_bf16 a[192:207], v[8:11], v[92:95], a[192:207]
  s_waitcnt vmcnt(13)
  ds_read_b128 v[112:115], v157 offset:32768
  ds_read_b128 v[116:119], v158 offset:32768
  ds_read_b128 v[120:123], v157 offset:33024
  ds_read_b128 v[124:127], v158 offset:33024
  s_waitcnt lgkmcnt(4)
  v_mfma_f32_32x32x16_bf16 a[192:207], v[8:11], v[96:99], a[192:207]
  v_mfma_f32_32x32x16_bf16 a[192:207], v[8:11], v[100:103], a[192:207]
  v_mfma_f32_32x32x16_bf16 a[192:207], v[8:11], v[104:107], a[192:207]
  v_mfma_f32_32x32x16_bf16 a[192:207], v[8:11], v[108:111], a[192:207]
  s_waitcnt lgkmcnt(0)
  v_mfma_f32_32x32x16_bf16 a[192:207], v[8:11], v[112:115], a[192:207]
  v_mfma_f32_32x32x16_bf16 a[192:207], v[8:11], v[116:119], a[192:207]
  v_mfma_f32_32x32x16_bf16 a[192:207], v[8:11], v[120:123], a[192:207]
  v_mfma_f32_32x32x16_bf16 a[192:207], v[8:11], v[124:127], a[192:207]
  s_and_b32 s100, s97, 14
  s_bfe_u32 s99, s2, 0x10003
  s_add_u32 s100, s100, s99
  s_lshl_b32 s2, s100, 14
  s_mov_b32 s32, s12
  s_mov_b32 s33, s13
  s_mov_b32 s34, 0x00038000
  s_mov_b32 s35, 0x00020000
  s_nop 3
  v_accvgpr_read_b32 v5, a192
  v_mul_f32 v5, 0x3b124925, v5
  v_cvt_pk_bf16_f32 v5, v5, v5
  v_and_b32 v5, 0xffff0000, v5
  s_barrier
  ds_read_b64_tr_b16 a[0:1], v3 offset:0
  ds_read_b64_tr_b16 a[2:3], v3 offset:4096
  ds_read_b64_tr_b16 a[4:5], v3 offset:256
  ds_read_b64_tr_b16 a[6:7], v3 offset:4352
  ds_read_b64_tr_b16 a[8:9], v3 offset:512
  ds_read_b64_tr_b16 a[10:11], v3 offset:4608
  ds_read_b64_tr_b16 a[12:13], v3 offset:768
  ds_read_b64_tr_b16 a[14:15], v3 offset:4864
  ds_read_b64_tr_b16 a[16:17], v3 offset:1024
  ds_read_b64_tr_b16 a[18:19], v3 offset:5120
  ds_read_b64_tr_b16 a[20:21], v3 offset:1280
  ds_read_b64_tr_b16 a[22:23], v3 offset:5376
  ds_read_b64_tr_b16 a[24:25], v3 offset:1536
  ds_read_b64_tr_b16 a[26:27], v3 offset:5632
  v_lshlrev_b32 v8, 16, v16
  v_and_b32 v9, 0xffff0000, v16
  v_sub_f32 v8, v8, v5
  v_sub_f32 v9, v9, v5
  v_cvt_pk_bf16_f32 v16, v8, v9
  v_fmac_f32 v6, v8, v8
  v_fmac_f32 v7, v9, v9
  v_lshlrev_b32 v10, 16, v17
  v_and_b32 v11, 0xffff0000, v17
  v_sub_f32 v10, v10, v5
  v_sub_f32 v11, v11, v5
  v_cvt_pk_bf16_f32 v17, v10, v11
  v_fmac_f32 v6, v10, v10
  v_fmac_f32 v7, v11, v11
  v_lshlrev_b32 v12, 16, v18
  v_and_b32 v13, 0xffff0000, v18
  v_sub_f32 v12, v12, v5
  v_sub_f32 v13, v13, v5
  v_cvt_pk_bf16_f32 v18, v12, v13
  v_fmac_f32 v6, v12, v12
  v_fmac_f32 v7, v13, v13
  v_lshlrev_b32 v14, 16, v19
  v_and_b32 v15, 0xffff0000, v19
  v_sub_f32 v14, v14, v5
  v_sub_f32 v15, v15, v5
  v_cvt_pk_bf16_f32 v19, v14, v15
  v_fmac_f32 v6, v14, v14
  v_fmac_f32 v7, v15, v15
  s_cmp_lt_u32 s96, 14
  s_cbranch_scc0 L_light
  s_branch L_heavy
L_end:
  s_endpgm
.p2align 12
L_heavy:
L_padh0:
  s_cbranch_execz L_padh4
  s_waitcnt lgkmcnt(12)
  v_mfma_f32_32x32x16_bf16 v[128:143], a[0:3], v[16:19], 0
  s_add_u32 s26, s26, 1
  s_cmp_eq_u32 s26, 7
  s_cselect_b32 s26, 0, s26
  s_lshl_b32 s7, s26, 19
  s_mul_i32 s8, s26, 229376
  s_add_u32 m0, s31, 49152
  s_add_u32 s0, s7, 0
  ds_read_b64_tr_b16 a[28:29], v3 offset:1792
  ds_read_b64_tr_b16 a[30:31], v3 offset:5888
  buffer_load_dwordx4 v1, s[36:39], s0 offen offset:0 lds
  s_waitcnt lgkmcnt(12)
  v_mfma_f32_32x32x16_bf16 v[144:159], a[4:7], v[16:19], 0
  ds_read_b64_tr_b16 a[0:1], v3 offset:2048
  ds_read_b64_tr_b16 a[2:3], v3 offset:6144
  v_lshlrev_b32 v8, 16, v20
  v_and_b32 v9, 0xffff0000, v20
  v_sub_f32 v8, v8, v5
  v_sub_f32 v9, v9, v5
  s_waitcnt lgkmcnt(12)
  v_mfma_f32_32x32x16_bf16 v[160:175], a[8:11], v[16:19], 0
  ds_read_b64_tr_b16 a[4:5], v3 offset:2304
  ds_read_b64_tr_b16 a[6:7], v3 offset:6400
  buffer_load_dwordx4 v1, s[40:43], s0 offen offset:1024 lds
  v_cvt_pk_bf16_f32 v20, v8, v9
  s_waitcnt lgkmcnt(6)
  v_mfma_f32_32x32x16_bf16 v[176:191], a[12:15], v[16:19], 0
  ds_read_b64_tr_b16 a[8:9], v3 offset:2560
  ds_read_b64_tr_b16 a[10:11], v3 offset:6656
  v_fmac_f32 v6, v8, v8
  v_fmac_f32 v7, v9, v9
  v_lshlrev_b32 v10, 16, v21
  v_and_b32 v11, 0xffff0000, v21
  v_mfma_f32_32x32x16_bf16 v[192:207], a[16:19], v[16:19], 0
  s_add_u32 s0, s7, 129024
  ds_read_b64_tr_b16 a[12:13], v3 offset:2816
  ds_read_b64_tr_b16 a[14:15], v3 offset:6912
  buffer_load_dwordx4 v1, s[36:39], s0 offen offset:2048 lds
  v_mfma_f32_32x32x16_bf16 v[208:223], a[20:23], v[16:19], 0
  ds_read_b64_tr_b16 a[16:17], v3 offset:3072
  ds_read_b64_tr_b16 a[18:19], v3 offset:7168
  v_sub_f32 v10, v10, v5
  v_sub_f32 v11, v11, v5
  v_cvt_pk_bf16_f32 v21, v10, v11
  v_fmac_f32 v6, v10, v10
  v_mfma_f32_32x32x16_bf16 v[224:239], a[24:27], v[16:19], 0
  ds_read_b64_tr_b16 a[20:21], v3 offset:3328
  ds_read_b64_tr_b16 a[22:23], v3 offset:7424
  buffer_load_dwordx4 v1, s[40:43], s0 offen offset:3072 lds
  v_fmac_f32 v7, v11, v11
  s_waitcnt lgkmcnt(6)
  v_mfma_f32_32x32x16_bf16 v[240:255], a[28:31], v[16:19], 0
  ds_read_b64_tr_b16 a[24:25], v3 offset:3584
  ds_read_b64_tr_b16 a[26:27], v3 offset:7680
  v_lshlrev_b32 v12, 16, v22
  v_and_b32 v13, 0xffff0000, v22
  v_sub_f32 v12, v12, v5
  v_sub_f32 v13, v13, v5
  v_cvt_pk_bf16_f32 v22, v12, v13
  v_fmac_f32 v6, v12, v12
  v_fmac_f32 v7, v13, v13
  v_lshlrev_b32 v14, 16, v23
  v_and_b32 v15, 0xffff0000, v23
  v_sub_f32 v14, v14, v5
  v_sub_f32 v15, v15, v5
  v_cvt_pk_bf16_f32 v23, v14, v15
  v_fmac_f32 v6, v14, v14
  v_fmac_f32 v7, v15, v15
  v_mfma_f32_32x32x16_bf16 v[128:143], a[0:3], v[20:23], v[128:143]
  s_add_u32 m0, s31, 65536
  s_add_u32 s0, s7, 262144
  ds_read_b64_tr_b16 a[28:29], v3 offset:3840
  ds_read_b64_tr_b16 a[30:31], v3 offset:7936
  buffer_load_dwordx4 v1, s[36:39], s0 offen offset:0 lds
  v_mfma_f32_32x32x16_bf16 v[144:159], a[4:7], v[20:23], v[144:159]
  s_waitcnt vmcnt(14)
  s_barrier
  ds_read_b64_tr_b16 a[0:1], v3 offset:16384
  ds_read_b64_tr_b16 a[2:3], v3 offset:20480
  v_lshlrev_b32 v8, 16, v24
  v_and_b32 v9, 0xffff0000, v24
  v_mfma_f32_32x32x16_bf16 v[160:175], a[8:11], v[20:23], v[160:175]
  ds_read_b64_tr_b16 a[4:5], v3 offset:16640
  ds_read_b64_tr_b16 a[6:7], v3 offset:20736
  buffer_load_dwordx4 v1, s[40:43], s0 offen offset:1024 lds
  v_sub_f32 v8, v8, v5
  s_waitcnt lgkmcnt(6)
  v_mfma_f32_32x32x16_bf16 v[176:191], a[12:15], v[20:23], v[176:191]
  ds_read_b64_tr_b16 a[8:9], v3 offset:16896
  ds_read_b64_tr_b16 a[10:11], v3 offset:20992
  v_sub_f32 v9, v9, v5
  v_cvt_pk_bf16_f32 v24, v8, v9
  v_fmac_f32 v6, v8, v8
  v_fmac_f32 v7, v9, v9
  v_mfma_f32_32x32x16_bf16 v[192:207], a[16:19], v[20:23], v[192:207]
  s_add_u32 s0, s7, 391168
  ds_read_b64_tr_b16 a[12:13], v3 offset:17152
  ds_read_b64_tr_b16 a[14:15], v3 offset:21248
  buffer_load_dwordx4 v1, s[36:39], s0 offen offset:2048 lds
  v_mfma_f32_32x32x16_bf16 v[208:223], a[20:23], v[20:23], v[208:223]
  ds_read_b64_tr_b16 a[16:17], v3 offset:17408
  ds_read_b64_tr_b16 a[18:19], v3 offset:21504
  v_lshlrev_b32 v10, 16, v25
  v_and_b32 v11, 0xffff0000, v25
  v_sub_f32 v10, v10, v5
  v_sub_f32 v11, v11, v5
  v_mfma_f32_32x32x16_bf16 v[224:239], a[24:27], v[20:23], v[224:239]
  ds_read_b64_tr_b16 a[20:21], v3 offset:17664
  ds_read_b64_tr_b16 a[22:23], v3 offset:21760
  buffer_load_dwordx4 v1, s[40:43], s0 offen offset:3072 lds
  v_cvt_pk_bf16_f32 v25, v10, v11
  s_waitcnt lgkmcnt(6)
  v_mfma_f32_32x32x16_bf16 v[240:255], a[28:31], v[20:23], v[240:255]
  ds_read_b64_tr_b16 a[24:25], v3 offset:17920
  ds_read_b64_tr_b16 a[26:27], v3 offset:22016
  v_fmac_f32 v6, v10, v10
  v_fmac_f32 v7, v11, v11
  v_lshlrev_b32 v12, 16, v26
  v_and_b32 v13, 0xffff0000, v26
  v_sub_f32 v12, v12, v5
  v_sub_f32 v13, v13, v5
  v_cvt_pk_bf16_f32 v26, v12, v13
  v_fmac_f32 v6, v12, v12
  v_fmac_f32 v7, v13, v13
  v_lshlrev_b32 v14, 16, v27
  v_and_b32 v15, 0xffff0000, v27
  v_sub_f32 v14, v14, v5
  v_sub_f32 v15, v15, v5
  v_cvt_pk_bf16_f32 v27, v14, v15
  v_fmac_f32 v6, v14, v14
  v_fmac_f32 v7, v15, v15
  v_mfma_f32_32x32x16_bf16 v[128:143], a[0:3], v[24:27], v[128:143]
  s_add_u32 m0, s31, 81920
  s_add_u32 s1, s8, 3072
  ds_read_b64_tr_b16 a[28:29], v3 offset:18176
  ds_read_b64_tr_b16 a[30:31], v3 offset:22272
  buffer_load_dwordx4 v2, s[44:47], s1 offen offset:0 lds
  v_mfma_f32_32x32x16_bf16 v[144:159], a[4:7], v[24:27], v[144:159]
  ds_read_b64_tr_b16 a[0:1], v3 offset:18432
  ds_read_b64_tr_b16 a[2:3], v3 offset:22528
  v_lshlrev_b32 v8, 16, v28
  v_and_b32 v9, 0xffff0000, v28
  v_sub_f32 v8, v8, v5
  v_sub_f32 v9, v9, v5
  v_mfma_f32_32x32x16_bf16 v[160:175], a[8:11], v[24:27], v[160:175]
  s_add_u32 s1, s8, 59392
  ds_read_b64_tr_b16 a[4:5], v3 offset:18688
  ds_read_b64_tr_b16 a[6:7], v3 offset:22784
  buffer_load_dwordx4 v2, s[44:47], s1 offen offset:1024 lds
  s_waitcnt lgkmcnt(6)
  v_mfma_f32_32x32x16_bf16 v[176:191], a[12:15], v[24:27], v[176:191]
  ds_read_b64_tr_b16 a[8:9], v3 offset:18944
  ds_read_b64_tr_b16 a[10:11], v3 offset:23040
  v_cvt_pk_bf16_f32 v28, v8, v9
  v_fmac_f32 v6, v8, v8
  v_fmac_f32 v7, v9, v9
  v_lshlrev_b32 v10, 16, v29
  v_mfma_f32_32x32x16_bf16 v[192:207], a[16:19], v[24:27], v[192:207]
  s_add_u32 s1, s8, 115712
  ds_read_b64_tr_b16 a[12:13], v3 offset:19200
  ds_read_b64_tr_b16 a[14:15], v3 offset:23296
  buffer_load_dwordx4 v2, s[44:47], s1 offen offset:2048 lds
  v_mfma_f32_32x32x16_bf16 v[208:223], a[20:23], v[24:27], v[208:223]
  ds_read_b64_tr_b16 a[16:17], v3 offset:19456
  ds_read_b64_tr_b16 a[18:19], v3 offset:23552
  v_and_b32 v11, 0xffff0000, v29
  v_sub_f32 v10, v10, v5
  v_sub_f32 v11, v11, v5
  v_cvt_pk_bf16_f32 v29, v10, v11
  v_mfma_f32_32x32x16_bf16 v[224:239], a[24:27], v[24:27], v[224:239]
  s_add_u32 s1, s8, 172032
  ds_read_b64_tr_b16 a[20:21], v3 offset:19712
  ds_read_b64_tr_b16 a[22:23], v3 offset:23808
  buffer_load_dwordx4 v2, s[44:47], s1 offen offset:3072 lds
  s_waitcnt lgkmcnt(6)
  v_mfma_f32_32x32x16_bf16 v[240:255], a[28:31], v[24:27], v[240:255]
  ds_read_b64_tr_b16 a[24:25], v3 offset:19968
  ds_read_b64_tr_b16 a[26:27], v3 offset:24064
  v_fmac_f32 v6, v10, v10
  v_fmac_f32 v7, v11, v11
  v_lshlrev_b32 v12, 16, v30
  v_and_b32 v13, 0xffff0000, v30
  v_sub_f32 v12, v12, v5
  v_sub_f32 v13, v13, v5
  v_cvt_pk_bf16_f32 v30, v12, v13
  v_fmac_f32 v6, v12, v12
  v_fmac_f32 v7, v13, v13
  v_lshlrev_b32 v14, 16, v31
  v_and_b32 v15, 0xffff0000, v31
  v_sub_f32 v14, v14, v5
  v_sub_f32 v15, v15, v5
  v_cvt_pk_bf16_f32 v31, v14, v15
  v_fmac_f32 v6, v14, v14
  v_fmac_f32 v7, v15, v15
  v_mfma_f32_32x32x16_bf16 v[128:143], a[0:3], v[28:31], v[128:143]
  s_add_u32 s26, s26, 1
  s_cmp_eq_u32 s26, 7
  s_cselect_b32 s26, 0, s26
  s_lshl_b32 s7, s26, 19
  s_mul_i32 s8, s26, 229376
  s_add_u32 m0, s31, 98304
  s_add_u32 s0, s7, 0
  ds_read_b64_tr_b16 a[28:29], v3 offset:20224
  ds_read_b64_tr_b16 a[30:31], v3 offset:24320
  buffer_load_dwordx4 v1, s[36:39], s0 offen offset:0 lds
  v_mfma_f32_32x32x16_bf16 v[144:159], a[4:7], v[28:31], v[144:159]
  s_waitcnt vmcnt(9)
  s_barrier
  ds_read_b64_tr_b16 a[0:1], v3 offset:32768
  ds_read_b64_tr_b16 a[2:3], v3 offset:36864
  v_lshlrev_b32 v8, 16, v32
  v_and_b32 v9, 0xffff0000, v32
  v_mfma_f32_32x32x16_bf16 v[160:175], a[8:11], v[28:31], v[160:175]
  ds_read_b64_tr_b16 a[4:5], v3 offset:33024
  ds_read_b64_tr_b16 a[6:7], v3 offset:37120
  buffer_load_dwordx4 v1, s[40:43], s0 offen offset:1024 lds
  v_sub_f32 v8, v8, v5
  s_waitcnt lgkmcnt(6)
  v_mfma_f32_32x32x16_bf16 v[176:191], a[12:15], v[28:31], v[176:191]
  ds_read_b64_tr_b16 a[8:9], v3 offset:33280
  ds_read_b64_tr_b16 a[10:11], v3 offset:37376
  v_sub_f32 v9, v9, v5
  v_cvt_pk_bf16_f32 v32, v8, v9
  v_fmac_f32 v6, v8, v8
  v_fmac_f32 v7, v9, v9
  v_mfma_f32_32x32x16_bf16 v[192:207], a[16:19], v[28:31], v[192:207]
  s_add_u32 s0, s7, 129024
  ds_read_b64_tr_b16 a[12:13], v3 offset:33536
  ds_read_b64_tr_b16 a[14:15], v3 offset:37632
  buffer_load_dwordx4 v1, s[36:39], s0 offen offset:2048 lds
  v_mfma_f32_32x32x16_bf16 v[208:223], a[20:23], v[28:31], v[208:223]
  ds_read_b64_tr_b16 a[16:17], v3 offset:33792
  ds_read_b64_tr_b16 a[18:19], v3 offset:37888
  v_lshlrev_b32 v10, 16, v33
  v_and_b32 v11, 0xffff0000, v33
  v_sub_f32 v10, v10, v5
  v_sub_f32 v11, v11, v5
  v_mfma_f32_32x32x16_bf16 v[224:239], a[24:27], v[28:31], v[224:239]
  ds_read_b64_tr_b16 a[20:21], v3 offset:34048
  ds_read_b64_tr_b16 a[22:23], v3 offset:38144
  buffer_load_dwordx4 v1, s[40:43], s0 offen offset:3072 lds
  v_cvt_pk_bf16_f32 v33, v10, v11
  s_waitcnt lgkmcnt(6)
  v_mfma_f32_32x32x16_bf16 v[240:255], a[28:31], v[28:31], v[240:255]
  ds_read_b64_tr_b16 a[24:25], v3 offset:34304
  ds_read_b64_tr_b16 a[26:27], v3 offset:38400
  v_fmac_f32 v6, v10, v10
  v_fmac_f32 v7, v11, v11
  v_lshlrev_b32 v12, 16, v34
  v_and_b32 v13, 0xffff0000, v34
  v_mfma_f32_32x32x16_bf16 a[32:47], a[0:3], v[16:19], 0
  s_add_u32 m0, s31, 114688
  s_add_u32 s0, s7, 262144
  ds_read_b64_tr_b16 a[28:29], v3 offset:34560
  ds_read_b64_tr_b16 a[30:31], v3 offset:38656
  buffer_load_dwordx4 v1, s[36:39], s0 offen offset:0 lds
  v_mfma_f32_32x32x16_bf16 a[48:63], a[4:7], v[16:19], 0
  ds_read_b64_tr_b16 a[0:1], v3 offset:34816
  ds_read_b64_tr_b16 a[2:3], v3 offset:38912
  v_sub_f32 v12, v12, v5
  v_sub_f32 v13, v13, v5
  v_cvt_pk_bf16_f32 v34, v12, v13
  v_fmac_f32 v6, v12, v12
  v_mfma_f32_32x32x16_bf16 a[64:79], a[8:11], v[16:19], 0
  ds_read_b64_tr_b16 a[4:5], v3 offset:35072
  ds_read_b64_tr_b16 a[6:7], v3 offset:39168
  buffer_load_dwordx4 v1, s[40:43], s0 offen offset:1024 lds
  v_fmac_f32 v7, v13, v13
  s_waitcnt lgkmcnt(6)
  v_mfma_f32_32x32x16_bf16 a[80:95], a[12:15], v[16:19], 0
  ds_read_b64_tr_b16 a[8:9], v3 offset:35328
  ds_read_b64_tr_b16 a[10:11], v3 offset:39424
  v_lshlrev_b32 v14, 16, v35
  v_and_b32 v15, 0xffff0000, v35
  v_sub_f32 v14, v14, v5
  v_sub_f32 v15, v15, v5
  v_mfma_f32_32x32x16_bf16 a[32:47], a[16:19], v[20:23], a[32:47]
  s_add_u32 s0, s7, 391168
  ds_read_b64_tr_b16 a[12:13], v3 offset:35584
  ds_read_b64_tr_b16 a[14:15], v3 offset:39680
  buffer_load_dwordx4 v1, s[36:39], s0 offen offset:2048 lds
  v_mfma_f32_32x32x16_bf16 a[48:63], a[20:23], v[20:23], a[48:63]
  ds_read_b64_tr_b16 a[16:17], v3 offset:35840
  ds_read_b64_tr_b16 a[18:19], v3 offset:39936
  v_cvt_pk_bf16_f32 v35, v14, v15
  v_fmac_f32 v6, v14, v14
  v_fmac_f32 v7, v15, v15
  v_lshlrev_b32 v8, 16, v36
  v_mfma_f32_32x32x16_bf16 a[64:79], a[24:27], v[20:23], a[64:79]
  ds_read_b64_tr_b16 a[20:21], v3 offset:36096
  ds_read_b64_tr_b16 a[22:23], v3 offset:40192
  buffer_load_dwordx4 v1, s[40:43], s0 offen offset:3072 lds
  v_and_b32 v9, 0xffff0000, v36
  s_waitcnt lgkmcnt(6)
  v_mfma_f32_32x32x16_bf16 a[80:95], a[28:31], v[20:23], a[80:95]
  ds_read_b64_tr_b16 a[24:25], v3 offset:36352
  ds_read_b64_tr_b16 a[26:27], v3 offset:40448
  v_sub_f32 v8, v8, v5
  v_sub_f32 v9, v9, v5
  v_cvt_pk_bf16_f32 v36, v8, v9
  v_fmac_f32 v6, v8, v8
  v_mfma_f32_32x32x16_bf16 a[32:47], a[0:3], v[24:27], a[32:47]
  s_add_u32 m0, s31, 131072
  s_add_u32 s1, s8, 3072
  ds_read_b64_tr_b16 a[28:29], v3 offset:36608
  ds_read_b64_tr_b16 a[30:31], v3 offset:40704
  buffer_load_dwordx4 v2, s[44:47], s1 offen offset:0 lds
  v_mfma_f32_32x32x16_bf16 a[48:63], a[4:7], v[24:27], a[48:63]
  ds_read_b64_tr_b16 a[0:1], v3 offset:49152
  ds_read_b64_tr_b16 a[2:3], v3 offset:53248
  v_fmac_f32 v7, v9, v9
  v_lshlrev_b32 v10, 16, v37
  v_and_b32 v11, 0xffff0000, v37
  v_sub_f32 v10, v10, v5
  v_mfma_f32_32x32x16_bf16 a[64:79], a[8:11], v[24:27], a[64:79]
  s_add_u32 s1, s8, 59392
  ds_read_b64_tr_b16 a[4:5], v3 offset:49408
  ds_read_b64_tr_b16 a[6:7], v3 offset:53504
  buffer_load_dwordx4 v2, s[44:47], s1 offen offset:1024 lds
  s_waitcnt lgkmcnt(6)
  v_mfma_f32_32x32x16_bf16 a[80:95], a[12:15], v[24:27], a[80:95]
  ds_read_b64_tr_b16 a[8:9], v3 offset:49664
  ds_read_b64_tr_b16 a[10:11], v3 offset:53760
  v_sub_f32 v11, v11, v5
  v_cvt_pk_bf16_f32 v37, v10, v11
  v_fmac_f32 v6, v10, v10
  v_fmac_f32 v7, v11, v11
  v_mfma_f32_32x32x16_bf16 a[32:47], a[16:19], v[28:31], a[32:47]
  s_add_u32 s1, s8, 115712
  ds_read_b64_tr_b16 a[12:13], v3 offset:49920
  ds_read_b64_tr_b16 a[14:15], v3 offset:54016
  buffer_load_dwordx4 v2, s[44:47], s1 offen offset:2048 lds
  v_mfma_f32_32x32x16_bf16 a[48:63], a[20:23], v[28:31], a[48:63]
  ds_read_b64_tr_b16 a[16:17], v3 offset:50176
  ds_read_b64_tr_b16 a[18:19], v3 offset:54272
  v_lshlrev_b32 v12, 16, v38
  v_and_b32 v13, 0xffff0000, v38
  v_sub_f32 v12, v12, v5
  v_sub_f32 v13, v13, v5
  v_mfma_f32_32x32x16_bf16 a[64:79], a[24:27], v[28:31], a[64:79]
  s_add_u32 s1, s8, 172032
  ds_read_b64_tr_b16 a[20:21], v3 offset:50432
  ds_read_b64_tr_b16 a[22:23], v3 offset:54528
  buffer_load_dwordx4 v2, s[44:47], s1 offen offset:3072 lds
  s_waitcnt lgkmcnt(6)
  v_mfma_f32_32x32x16_bf16 a[80:95], a[28:31], v[28:31], a[80:95]
  ds_read_b64_tr_b16 a[24:25], v3 offset:50688
  ds_read_b64_tr_b16 a[26:27], v3 offset:54784
  v_cvt_pk_bf16_f32 v38, v12, v13
  v_fmac_f32 v6, v12, v12
  v_fmac_f32 v7, v13, v13
  v_lshlrev_b32 v14, 16, v39
  v_mfma_f32_32x32x16_bf16 v[128:143], a[0:3], v[32:35], v[128:143]
  s_add_u32 s26, s26, 1
  s_cmp_eq_u32 s26, 7
  s_cselect_b32 s26, 0, s26
  s_lshl_b32 s7, s26, 19
  s_mul_i32 s8, s26, 229376
  s_add_u32 m0, s31, 147456
  s_add_u32 s0, s7, 0
  ds_read_b64_tr_b16 a[28:29], v3 offset:50944
  ds_read_b64_tr_b16 a[30:31], v3 offset:55040
  buffer_load_dwordx4 v1, s[36:39], s0 offen offset:0 lds
  v_mfma_f32_32x32x16_bf16 v[144:159], a[4:7], v[32:35], v[144:159]
  ds_read_b64_tr_b16 a[0:1], v3 offset:51200
  ds_read_b64_tr_b16 a[2:3], v3 offset:55296
  v_and_b32 v15, 0xffff0000, v39
  v_sub_f32 v14, v14, v5
  v_sub_f32 v15, v15, v5
  v_cvt_pk_bf16_f32 v39, v14, v15
  v_mfma_f32_32x32x16_bf16 v[160:175], a[8:11], v[32:35], v[160:175]
  ds_read_b64_tr_b16 a[4:5], v3 offset:51456
  ds_read_b64_tr_b16 a[6:7], v3 offset:55552
  buffer_load_dwordx4 v1, s[40:43], s0 offen offset:1024 lds
  v_fmac_f32 v6, v14, v14
  s_waitcnt lgkmcnt(6)
  v_mfma_f32_32x32x16_bf16 v[176:191], a[12:15], v[32:35], v[176:191]
  ds_read_b64_tr_b16 a[8:9], v3 offset:51712
  ds_read_b64_tr_b16 a[10:11], v3 offset:55808
  v_fmac_f32 v7, v15, v15
  v_lshlrev_b32 v8, 16, v40
  v_and_b32 v9, 0xffff0000, v40
  v_sub_f32 v8, v8, v5
  v_mfma_f32_32x32x16_bf16 v[192:207], a[16:19], v[32:35], v[192:207]
  s_add_u32 s0, s7, 129024
  ds_read_b64_tr_b16 a[12:13], v3 offset:51968
  ds_read_b64_tr_b16 a[14:15], v3 offset:56064
  buffer_load_dwordx4 v1, s[36:39], s0 offen offset:2048 lds
  v_mfma_f32_32x32x16_bf16 v[208:223], a[20:23], v[32:35], v[208:223]
  ds_read_b64_tr_b16 a[16:17], v3 offset:52224
  ds_read_b64_tr_b16 a[18:19], v3 offset:56320
  v_sub_f32 v9, v9, v5
  v_cvt_pk_bf16_f32 v40, v8, v9
  v_fmac_f32 v6, v8, v8
  v_fmac_f32 v7, v9, v9
  v_mfma_f32_32x32x16_bf16 v[224:239], a[24:27], v[32:35], v[224:239]
  ds_read_b64_tr_b16 a[20:21], v3 offset:52480
  ds_read_b64_tr_b16 a[22:23], v3 offset:56576
  buffer_load_dwordx4 v1, s[40:43], s0 offen offset:3072 lds
  v_lshlrev_b32 v10, 16, v41
  s_waitcnt lgkmcnt(6)
  v_mfma_f32_32x32x16_bf16 v[240:255], a[28:31], v[32:35], v[240:255]
  ds_read_b64_tr_b16 a[24:25], v3 offset:52736
  ds_read_b64_tr_b16 a[26:27], v3 offset:56832
  v_and_b32 v11, 0xffff0000, v41
  v_sub_f32 v10, v10, v5
  v_sub_f32 v11, v11, v5
  v_cvt_pk_bf16_f32 v41, v10, v11
  v_mfma_f32_32x32x16_bf16 v[128:143], a[0:3], v[36:39], v[128:143]
  s_add_u32 m0, s31, 0
  s_add_u32 s0, s7, 262144
  ds_read_b64_tr_b16 a[28:29], v3 offset:52992
  ds_read_b64_tr_b16 a[30:31], v3 offset:57088
  buffer_load_dwordx4 v1, s[36:39], s0 offen offset:0 lds
  v_add_u32 v3, 0x00010000, v3
  v_mfma_f32_32x32x16_bf16 v[144:159], a[4:7], v[36:39], v[144:159]
  s_waitcnt vmcnt(17)
  s_barrier
  ds_read_b64_tr_b16 a[0:1], v3 offset:0
  ds_read_b64_tr_b16 a[2:3], v3 offset:4096
  v_fmac_f32 v6, v10, v10
  v_fmac_f32 v7, v11, v11
  v_mfma_f32_32x32x16_bf16 v[160:175], a[8:11], v[36:39], v[160:175]
  ds_read_b64_tr_b16 a[4:5], v3 offset:256
  ds_read_b64_tr_b16 a[6:7], v3 offset:4352
  buffer_load_dwordx4 v1, s[40:43], s0 offen offset:1024 lds
  v_lshlrev_b32 v12, 16, v42
  s_waitcnt lgkmcnt(6)
  v_mfma_f32_32x32x16_bf16 v[176:191], a[12:15], v[36:39], v[176:191]
  ds_read_b64_tr_b16 a[8:9], v3 offset:512
  ds_read_b64_tr_b16 a[10:11], v3 offset:4608
  v_and_b32 v13, 0xffff0000, v42
  v_sub_f32 v12, v12, v5
  v_sub_f32 v13, v13, v5
  v_cvt_pk_bf16_f32 v42, v12, v13
  v_mfma_f32_32x32x16_bf16 v[192:207], a[16:19], v[36:39], v[192:207]
  s_add_u32 s0, s7, 391168
  ds_read_b64_tr_b16 a[12:13], v3 offset:768
  ds_read_b64_tr_b16 a[14:15], v3 offset:4864
  buffer_load_dwordx4 v1, s[36:39], s0 offen offset:2048 lds
  v_mfma_f32_32x32x16_bf16 v[208:223], a[20:23], v[36:39], v[208:223]
  ds_read_b64_tr_b16 a[16:17], v3 offset:1024
  ds_read_b64_tr_b16 a[18:19], v3 offset:5120
  v_fmac_f32 v6, v12, v12
  v_fmac_f32 v7, v13, v13
  v_lshlrev_b32 v14, 16, v43
  v_and_b32 v15, 0xffff0000, v43
  v_mfma_f32_32x32x16_bf16 v[224:239], a[24:27], v[36:39], v[224:239]
  ds_read_b64_tr_b16 a[20:21], v3 offset:1280
  ds_read_b64_tr_b16 a[22:23], v3 offset:5376
  buffer_load_dwordx4 v1, s[40:43], s0 offen offset:3072 lds
  v_sub_f32 v14, v14, v5
  s_waitcnt lgkmcnt(6)
  v_mfma_f32_32x32x16_bf16 v[240:255], a[28:31], v[36:39], v[240:255]
  ds_read_b64_tr_b16 a[24:25], v3 offset:1536
  ds_read_b64_tr_b16 a[26:27], v3 offset:5632
  v_sub_f32 v15, v15, v5
  v_cvt_pk_bf16_f32 v43, v14, v15
  v_fmac_f32 v6, v14, v14
  v_fmac_f32 v7, v15, v15
  v_mfma_f32_32x32x16_bf16 v[128:143], a[0:3], v[40:43], v[128:143]
  ds_read_b64_tr_b16 a[28:29], v3 offset:1792
  ds_read_b64_tr_b16 a[30:31], v3 offset:5888
  v_lshlrev_b32 v8, 16, v44
  v_and_b32 v9, 0xffff0000, v44
  v_sub_f32 v8, v8, v5
  v_sub_f32 v9, v9, v5
  v_mfma_f32_32x32x16_bf16 v[144:159], a[4:7], v[40:43], v[144:159]
  ds_read_b64_tr_b16 a[0:1], v3 offset:2048
  ds_read_b64_tr_b16 a[2:3], v3 offset:6144
  v_cvt_pk_bf16_f32 v44, v8, v9
  v_fmac_f32 v6, v8, v8
  v_fmac_f32 v7, v9, v9
  v_lshlrev_b32 v10, 16, v45
  v_mfma_f32_32x32x16_bf16 v[160:175], a[8:11], v[40:43], v[160:175]
  s_add_u32 m0, s31, 16384
  s_add_u32 s1, s8, 3072
  ds_read_b64_tr_b16 a[4:5], v3 offset:2304
  ds_read_b64_tr_b16 a[6:7], v3 offset:6400
  buffer_load_dwordx4 v2, s[44:47], s1 offen offset:0 lds
  s_waitcnt lgkmcnt(6)
  v_mfma_f32_32x32x16_bf16 v[176:191], a[12:15], v[40:43], v[176:191]
  ds_read_b64_tr_b16 a[8:9], v3 offset:2560
  ds_read_b64_tr_b16 a[10:11], v3 offset:6656
  v_and_b32 v11, 0xffff0000, v45
  v_sub_f32 v10, v10, v5
  v_sub_f32 v11, v11, v5
  v_cvt_pk_bf16_f32 v45, v10, v11
  v_mfma_f32_32x32x16_bf16 v[192:207], a[16:19], v[40:43], v[192:207]
  ds_read_b64_tr_b16 a[12:13], v3 offset:2816
  ds_read_b64_tr_b16 a[14:15], v3 offset:6912
  v_fmac_f32 v6, v10, v10
  v_fmac_f32 v7, v11, v11
  v_lshlrev_b32 v12, 16, v46
  v_and_b32 v13, 0xffff0000, v46
  v_mfma_f32_32x32x16_bf16 v[208:223], a[20:23], v[40:43], v[208:223]
  ds_read_b64_tr_b16 a[16:17], v3 offset:3072
  ds_read_b64_tr_b16 a[18:19], v3 offset:7168
  v_sub_f32 v12, v12, v5
  v_sub_f32 v13, v13, v5
  v_cvt_pk_bf16_f32 v46, v12, v13
  v_fmac_f32 v6, v12, v12
  v_mfma_f32_32x32x16_bf16 v[224:239], a[24:27], v[40:43], v[224:239]
  s_add_u32 s1, s8, 59392
  ds_read_b64_tr_b16 a[20:21], v3 offset:3328
  ds_read_b64_tr_b16 a[22:23], v3 offset:7424
  buffer_load_dwordx4 v2, s[44:47], s1 offen offset:1024 lds
  s_waitcnt lgkmcnt(6)
  v_mfma_f32_32x32x16_bf16 v[240:255], a[28:31], v[40:43], v[240:255]
  ds_read_b64_tr_b16 a[24:25], v3 offset:3584
  ds_read_b64_tr_b16 a[26:27], v3 offset:7680
  v_fmac_f32 v7, v13, v13
  v_lshlrev_b32 v14, 16, v47
  v_and_b32 v15, 0xffff0000, v47
  v_sub_f32 v14, v14, v5
  v_sub_f32 v15, v15, v5
  v_cvt_pk_bf16_f32 v47, v14, v15
  v_fmac_f32 v6, v14, v14
  v_fmac_f32 v7, v15, v15
  v_mfma_f32_32x32x16_bf16 v[128:143], a[0:3], v[44:47], v[128:143]
  ds_read_b64_tr_b16 a[28:29], v3 offset:3840
  ds_read_b64_tr_b16 a[30:31], v3 offset:7936
  v_lshlrev_b32 v8, 16, v48
  v_and_b32 v9, 0xffff0000, v48
  v_sub_f32 v8, v8, v5
  v_sub_f32 v9, v9, v5
  v_mfma_f32_32x32x16_bf16 v[144:159], a[4:7], v[44:47], v[144:159]
  ds_read_b64_tr_b16 a[0:1], v3 offset:16384
  ds_read_b64_tr_b16 a[2:3], v3 offset:20480
  v_cvt_pk_bf16_f32 v48, v8, v9
  v_fmac_f32 v6, v8, v8
  v_fmac_f32 v7, v9, v9
  v_lshlrev_b32 v10, 16, v49
  v_mfma_f32_32x32x16_bf16 v[160:175], a[8:11], v[44:47], v[160:175]
  s_add_u32 s1, s8, 115712
  ds_read_b64_tr_b16 a[4:5], v3 offset:16640
  ds_read_b64_tr_b16 a[6:7], v3 offset:20736
  buffer_load_dwordx4 v2, s[44:47], s1 offen offset:2048 lds
  s_waitcnt lgkmcnt(6)
  v_mfma_f32_32x32x16_bf16 v[176:191], a[12:15], v[44:47], v[176:191]
  ds_read_b64_tr_b16 a[8:9], v3 offset:16896
  ds_read_b64_tr_b16 a[10:11], v3 offset:20992
  v_and_b32 v11, 0xffff0000, v49
  v_sub_f32 v10, v10, v5
  v_sub_f32 v11, v11, v5
  v_cvt_pk_bf16_f32 v49, v10, v11
  v_mfma_f32_32x32x16_bf16 v[192:207], a[16:19], v[44:47], v[192:207]
  ds_read_b64_tr_b16 a[12:13], v3 offset:17152
  ds_read_b64_tr_b16 a[14:15], v3 offset:21248
  v_fmac_f32 v6, v10, v10
  v_fmac_f32 v7, v11, v11
  v_lshlrev_b32 v12, 16, v50
  v_and_b32 v13, 0xffff0000, v50
  v_mfma_f32_32x32x16_bf16 v[208:223], a[20:23], v[44:47], v[208:223]
  ds_read_b64_tr_b16 a[16:17], v3 offset:17408
  ds_read_b64_tr_b16 a[18:19], v3 offset:21504
  v_sub_f32 v12, v12, v5
  v_sub_f32 v13, v13, v5
  v_cvt_pk_bf16_f32 v50, v12, v13
  v_fmac_f32 v6, v12, v12
  v_mfma_f32_32x32x16_bf16 v[224:239], a[24:27], v[44:47], v[224:239]
  s_add_u32 s1, s8, 172032
  ds_read_b64_tr_b16 a[20:21], v3 offset:17664
  ds_read_b64_tr_b16 a[22:23], v3 offset:21760
  buffer_load_dwordx4 v2, s[44:47], s1 offen offset:3072 lds
  s_waitcnt lgkmcnt(6)
  v_mfma_f32_32x32x16_bf16 v[240:255], a[28:31], v[44:47], v[240:255]
  ds_read_b64_tr_b16 a[24:25], v3 offset:17920
  ds_read_b64_tr_b16 a[26:27], v3 offset:22016
  v_fmac_f32 v7, v13, v13
  v_lshlrev_b32 v14, 16, v51
  v_and_b32 v15, 0xffff0000, v51
  v_sub_f32 v14, v14, v5
  v_mfma_f32_32x32x16_bf16 a[32:47], a[0:3], v[32:35], a[32:47]
  ds_read_b64_tr_b16 a[28:29], v3 offset:18176
  ds_read_b64_tr_b16 a[30:31], v3 offset:22272
  v_sub_f32 v15, v15, v5
  v_cvt_pk_bf16_f32 v51, v14, v15
  v_fmac_f32 v6, v14, v14
  v_fmac_f32 v7, v15, v15
  v_mfma_f32_32x32x16_bf16 a[48:63], a[4:7], v[32:35], a[48:63]
  ds_read_b64_tr_b16 a[0:1], v3 offset:18432
  ds_read_b64_tr_b16 a[2:3], v3 offset:22528
  v_lshlrev_b32 v8, 16, v52
  v_and_b32 v9, 0xffff0000, v52
  v_sub_f32 v8, v8, v5
  v_sub_f32 v9, v9, v5
  v_mfma_f32_32x32x16_bf16 a[64:79], a[8:11], v[32:35], a[64:79]
  s_add_u32 s26, s26, 1
  s_cmp_eq_u32 s26, 7
  s_cselect_b32 s26, 0, s26
  s_lshl_b32 s7, s26, 19
  s_mul_i32 s8, s26, 229376
  s_add_u32 m0, s31, 32768
  s_add_u32 s0, s7, 0
  ds_read_b64_tr_b16 a[4:5], v3 offset:18688
  ds_read_b64_tr_b16 a[6:7], v3 offset:22784
  buffer_load_dwordx4 v1, s[36:39], s0 offen offset:0 lds
  s_waitcnt lgkmcnt(6)
  v_mfma_f32_32x32x16_bf16 a[80:95], a[12:15], v[32:35], a[80:95]
  ds_read_b64_tr_b16 a[8:9], v3 offset:18944
  ds_read_b64_tr_b16 a[10:11], v3 offset:23040
  v_cvt_pk_bf16_f32 v52, v8, v9
  v_fmac_f32 v6, v8, v8
  v_fmac_f32 v7, v9, v9
  v_lshlrev_b32 v10, 16, v53
  v_mfma_f32_32x32x16_bf16 a[32:47], a[16:19], v[36:39], a[32:47]
  ds_read_b64_tr_b16 a[12:13], v3 offset:19200
  ds_read_b64_tr_b16 a[14:15], v3 offset:23296
  v_and_b32 v11, 0xffff0000, v53
  v_sub_f32 v10, v10, v5
  v_sub_f32 v11, v11, v5
  v_cvt_pk_bf16_f32 v53, v10, v11
  v_mfma_f32_32x32x16_bf16 a[48:63], a[20:23], v[36:39], a[48:63]
  ds_read_b64_tr_b16 a[16:17], v3 offset:19456
  ds_read_b64_tr_b16 a[18:19], v3 offset:23552
  v_fmac_f32 v6, v10, v10
  v_fmac_f32 v7, v11, v11
  v_lshlrev_b32 v12, 16, v54
  v_and_b32 v13, 0xffff0000, v54
  v_mfma_f32_32x32x16_bf16 a[64:79], a[24:27], v[36:39], a[64:79]
  ds_read_b64_tr_b16 a[20:21], v3 offset:19712
L_padh1:
  s_cbranch_execz L_padh5
  ds_read_b64_tr_b16 a[22:23], v3 offset:23808
  buffer_load_dwordx4 v1, s[40:43], s0 offen offset:1024 lds
  v_sub_f32 v12, v12, v5
  s_waitcnt lgkmcnt(6)
  v_mfma_f32_32x32x16_bf16 a[80:95], a[28:31], v[36:39], a[80:95]
  ds_read_b64_tr_b16 a[24:25], v3 offset:19968
  ds_read_b64_tr_b16 a[26:27], v3 offset:24064
  v_sub_f32 v13, v13, v5
  v_cvt_pk_bf16_f32 v54, v12, v13
  v_fmac_f32 v6, v12, v12
  v_fmac_f32 v7, v13, v13
  v_mfma_f32_32x32x16_bf16 a[32:47], a[0:3], v[40:43], a[32:47]
  s_add_u32 s0, s7, 129024
  ds_read_b64_tr_b16 a[28:29], v3 offset:20224
  ds_read_b64_tr_b16 a[30:31], v3 offset:24320
  buffer_load_dwordx4 v1, s[36:39], s0 offen offset:2048 lds
  v_mfma_f32_32x32x16_bf16 a[48:63], a[4:7], v[40:43], a[48:63]
  s_waitcnt vmcnt(19)
  s_barrier
  ds_read_b64_tr_b16 a[0:1], v3 offset:32768
  ds_read_b64_tr_b16 a[2:3], v3 offset:36864
  v_lshlrev_b32 v14, 16, v55
  v_and_b32 v15, 0xffff0000, v55
  v_mfma_f32_32x32x16_bf16 a[64:79], a[8:11], v[40:43], a[64:79]
  ds_read_b64_tr_b16 a[4:5], v3 offset:33024
  ds_read_b64_tr_b16 a[6:7], v3 offset:37120
  buffer_load_dwordx4 v1, s[40:43], s0 offen offset:3072 lds
  v_sub_f32 v14, v14, v5
  s_waitcnt lgkmcnt(6)
  v_mfma_f32_32x32x16_bf16 a[80:95], a[12:15], v[40:43], a[80:95]
  ds_read_b64_tr_b16 a[8:9], v3 offset:33280
  ds_read_b64_tr_b16 a[10:11], v3 offset:37376
  v_sub_f32 v15, v15, v5
  v_cvt_pk_bf16_f32 v55, v14, v15
  v_fmac_f32 v6, v14, v14
  v_fmac_f32 v7, v15, v15
  v_mfma_f32_32x32x16_bf16 a[32:47], a[16:19], v[44:47], a[32:47]
  ds_read_b64_tr_b16 a[12:13], v3 offset:33536
  ds_read_b64_tr_b16 a[14:15], v3 offset:37632
  v_lshlrev_b32 v8, 16, v56
  v_and_b32 v9, 0xffff0000, v56
  v_sub_f32 v8, v8, v5
  v_sub_f32 v9, v9, v5
  v_mfma_f32_32x32x16_bf16 a[48:63], a[20:23], v[44:47], a[48:63]
  ds_read_b64_tr_b16 a[16:17], v3 offset:33792
  ds_read_b64_tr_b16 a[18:19], v3 offset:37888
  v_cvt_pk_bf16_f32 v56, v8, v9
  v_fmac_f32 v6, v8, v8
  v_fmac_f32 v7, v9, v9
  v_lshlrev_b32 v10, 16, v57
  v_mfma_f32_32x32x16_bf16 a[64:79], a[24:27], v[44:47], a[64:79]
  s_add_u32 m0, s31, 49152
  s_add_u32 s0, s7, 262144
  ds_read_b64_tr_b16 a[20:21], v3 offset:34048
  ds_read_b64_tr_b16 a[22:23], v3 offset:38144
  buffer_load_dwordx4 v1, s[36:39], s0 offen offset:0 lds
  s_waitcnt lgkmcnt(6)
  v_mfma_f32_32x32x16_bf16 a[80:95], a[28:31], v[44:47], a[80:95]
  ds_read_b64_tr_b16 a[24:25], v3 offset:34304
  ds_read_b64_tr_b16 a[26:27], v3 offset:38400
  v_and_b32 v11, 0xffff0000, v57
  v_sub_f32 v10, v10, v5
  v_sub_f32 v11, v11, v5
  v_cvt_pk_bf16_f32 v57, v10, v11
  v_mfma_f32_32x32x16_bf16 v[128:143], a[0:3], v[48:51], v[128:143]
  ds_read_b64_tr_b16 a[28:29], v3 offset:34560
  ds_read_b64_tr_b16 a[30:31], v3 offset:38656
  v_fmac_f32 v6, v10, v10
  v_fmac_f32 v7, v11, v11
  v_lshlrev_b32 v12, 16, v58
  v_and_b32 v13, 0xffff0000, v58
  v_mfma_f32_32x32x16_bf16 v[144:159], a[4:7], v[48:51], v[144:159]
  ds_read_b64_tr_b16 a[0:1], v3 offset:34816
  ds_read_b64_tr_b16 a[2:3], v3 offset:38912
  v_sub_f32 v12, v12, v5
  v_sub_f32 v13, v13, v5
  v_cvt_pk_bf16_f32 v58, v12, v13
  v_fmac_f32 v6, v12, v12
  v_mfma_f32_32x32x16_bf16 v[160:175], a[8:11], v[48:51], v[160:175]
  ds_read_b64_tr_b16 a[4:5], v3 offset:35072
  ds_read_b64_tr_b16 a[6:7], v3 offset:39168
  buffer_load_dwordx4 v1, s[40:43], s0 offen offset:1024 lds
  v_fmac_f32 v7, v13, v13
  s_waitcnt lgkmcnt(6)
  v_mfma_f32_32x32x16_bf16 v[176:191], a[12:15], v[48:51], v[176:191]
  ds_read_b64_tr_b16 a[8:9], v3 offset:35328
  ds_read_b64_tr_b16 a[10:11], v3 offset:39424
  v_lshlrev_b32 v14, 16, v59
  v_and_b32 v15, 0xffff0000, v59
  v_sub_f32 v14, v14, v5
  v_sub_f32 v15, v15, v5
  v_mfma_f32_32x32x16_bf16 v[192:207], a[16:19], v[48:51], v[192:207]
  ds_read_b64_tr_b16 a[12:13], v3 offset:35584
  ds_read_b64_tr_b16 a[14:15], v3 offset:39680
  v_cvt_pk_bf16_f32 v59, v14, v15
  v_fmac_f32 v6, v14, v14
  v_fmac_f32 v7, v15, v15
  v_lshlrev_b32 v8, 16, v60
  v_mfma_f32_32x32x16_bf16 v[208:223], a[20:23], v[48:51], v[208:223]
  ds_read_b64_tr_b16 a[16:17], v3 offset:35840
  ds_read_b64_tr_b16 a[18:19], v3 offset:39936
  v_and_b32 v9, 0xffff0000, v60
  v_sub_f32 v8, v8, v5
  v_sub_f32 v9, v9, v5
  v_cvt_pk_bf16_f32 v60, v8, v9
  v_mfma_f32_32x32x16_bf16 v[224:239], a[24:27], v[48:51], v[224:239]
  s_add_u32 s0, s7, 391168
  ds_read_b64_tr_b16 a[20:21], v3 offset:36096
  ds_read_b64_tr_b16 a[22:23], v3 offset:40192
  buffer_load_dwordx4 v1, s[36:39], s0 offen offset:2048 lds
  s_waitcnt lgkmcnt(6)
  v_mfma_f32_32x32x16_bf16 v[240:255], a[28:31], v[48:51], v[240:255]
  ds_read_b64_tr_b16 a[24:25], v3 offset:36352
  ds_read_b64_tr_b16 a[26:27], v3 offset:40448
  v_fmac_f32 v6, v8, v8
  v_fmac_f32 v7, v9, v9
  v_lshlrev_b32 v10, 16, v61
  v_and_b32 v11, 0xffff0000, v61
  v_mfma_f32_32x32x16_bf16 v[128:143], a[0:3], v[52:55], v[128:143]
  ds_read_b64_tr_b16 a[28:29], v3 offset:36608
  ds_read_b64_tr_b16 a[30:31], v3 offset:40704
  v_sub_f32 v10, v10, v5
  v_sub_f32 v11, v11, v5
  v_cvt_pk_bf16_f32 v61, v10, v11
  v_fmac_f32 v6, v10, v10
  v_mfma_f32_32x32x16_bf16 v[144:159], a[4:7], v[52:55], v[144:159]
  ds_read_b64_tr_b16 a[0:1], v3 offset:49152
  ds_read_b64_tr_b16 a[2:3], v3 offset:53248
  v_fmac_f32 v7, v11, v11
  v_lshlrev_b32 v12, 16, v62
  v_and_b32 v13, 0xffff0000, v62
  v_sub_f32 v12, v12, v5
  v_mfma_f32_32x32x16_bf16 v[160:175], a[8:11], v[52:55], v[160:175]
  ds_read_b64_tr_b16 a[4:5], v3 offset:49408
  ds_read_b64_tr_b16 a[6:7], v3 offset:53504
  buffer_load_dwordx4 v1, s[40:43], s0 offen offset:3072 lds
  v_sub_f32 v13, v13, v5
  s_waitcnt lgkmcnt(6)
  v_mfma_f32_32x32x16_bf16 v[176:191], a[12:15], v[52:55], v[176:191]
  ds_read_b64_tr_b16 a[8:9], v3 offset:49664
  ds_read_b64_tr_b16 a[10:11], v3 offset:53760
  v_cvt_pk_bf16_f32 v62, v12, v13
  v_fmac_f32 v6, v12, v12
  v_fmac_f32 v7, v13, v13
  v_lshlrev_b32 v14, 16, v63
  v_mfma_f32_32x32x16_bf16 v[192:207], a[16:19], v[52:55], v[192:207]
  ds_read_b64_tr_b16 a[12:13], v3 offset:49920
  ds_read_b64_tr_b16 a[14:15], v3 offset:54016
  v_and_b32 v15, 0xffff0000, v63
  v_sub_f32 v14, v14, v5
  v_sub_f32 v15, v15, v5
  v_cvt_pk_bf16_f32 v63, v14, v15
  v_mfma_f32_32x32x16_bf16 v[208:223], a[20:23], v[52:55], v[208:223]
  ds_read_b64_tr_b16 a[16:17], v3 offset:50176
  ds_read_b64_tr_b16 a[18:19], v3 offset:54272
  v_fmac_f32 v6, v14, v14
  v_fmac_f32 v7, v15, v15
  v_lshlrev_b32 v8, 16, v64
  v_and_b32 v9, 0xffff0000, v64
  v_mfma_f32_32x32x16_bf16 v[224:239], a[24:27], v[52:55], v[224:239]
  s_add_u32 m0, s31, 65536
  s_add_u32 s1, s8, 3072
  ds_read_b64_tr_b16 a[20:21], v3 offset:50432
  ds_read_b64_tr_b16 a[22:23], v3 offset:54528
  buffer_load_dwordx4 v2, s[44:47], s1 offen offset:0 lds
  s_waitcnt lgkmcnt(6)
  v_mfma_f32_32x32x16_bf16 v[240:255], a[28:31], v[52:55], v[240:255]
  ds_read_b64_tr_b16 a[24:25], v3 offset:50688
  ds_read_b64_tr_b16 a[26:27], v3 offset:54784
  v_sub_f32 v8, v8, v5
  v_sub_f32 v9, v9, v5
  v_cvt_pk_bf16_f32 v64, v8, v9
  v_fmac_f32 v6, v8, v8
  v_mfma_f32_32x32x16_bf16 v[128:143], a[0:3], v[56:59], v[128:143]
  ds_read_b64_tr_b16 a[28:29], v3 offset:50944
  ds_read_b64_tr_b16 a[30:31], v3 offset:55040
  v_fmac_f32 v7, v9, v9
  v_lshlrev_b32 v10, 16, v65
  v_and_b32 v11, 0xffff0000, v65
  v_sub_f32 v10, v10, v5
  v_mfma_f32_32x32x16_bf16 v[144:159], a[4:7], v[56:59], v[144:159]
  ds_read_b64_tr_b16 a[0:1], v3 offset:51200
  ds_read_b64_tr_b16 a[2:3], v3 offset:55296
  v_sub_f32 v11, v11, v5
  v_cvt_pk_bf16_f32 v65, v10, v11
  v_fmac_f32 v6, v10, v10
  v_fmac_f32 v7, v11, v11
  v_mfma_f32_32x32x16_bf16 v[160:175], a[8:11], v[56:59], v[160:175]
  s_add_u32 s1, s8, 59392
  ds_read_b64_tr_b16 a[4:5], v3 offset:51456
  ds_read_b64_tr_b16 a[6:7], v3 offset:55552
  buffer_load_dwordx4 v2, s[44:47], s1 offen offset:1024 lds
  s_waitcnt lgkmcnt(6)
  v_mfma_f32_32x32x16_bf16 v[176:191], a[12:15], v[56:59], v[176:191]
  ds_read_b64_tr_b16 a[8:9], v3 offset:51712
  ds_read_b64_tr_b16 a[10:11], v3 offset:55808
  v_lshlrev_b32 v12, 16, v66
  v_and_b32 v13, 0xffff0000, v66
  v_sub_f32 v12, v12, v5
  v_sub_f32 v13, v13, v5
  v_mfma_f32_32x32x16_bf16 v[192:207], a[16:19], v[56:59], v[192:207]
  ds_read_b64_tr_b16 a[12:13], v3 offset:51968
  ds_read_b64_tr_b16 a[14:15], v3 offset:56064
  v_cvt_pk_bf16_f32 v66, v12, v13
  v_fmac_f32 v6, v12, v12
  v_fmac_f32 v7, v13, v13
  v_lshlrev_b32 v14, 16, v67
  v_mfma_f32_32x32x16_bf16 v[208:223], a[20:23], v[56:59], v[208:223]
  ds_read_b64_tr_b16 a[16:17], v3 offset:52224
  ds_read_b64_tr_b16 a[18:19], v3 offset:56320
  v_and_b32 v15, 0xffff0000, v67
  v_sub_f32 v14, v14, v5
  v_sub_f32 v15, v15, v5
  v_cvt_pk_bf16_f32 v67, v14, v15
  v_mfma_f32_32x32x16_bf16 v[224:239], a[24:27], v[56:59], v[224:239]
  s_add_u32 s1, s8, 115712
  ds_read_b64_tr_b16 a[20:21], v3 offset:52480
  ds_read_b64_tr_b16 a[22:23], v3 offset:56576
  buffer_load_dwordx4 v2, s[44:47], s1 offen offset:2048 lds
  s_waitcnt lgkmcnt(6)
  v_mfma_f32_32x32x16_bf16 v[240:255], a[28:31], v[56:59], v[240:255]
  ds_read_b64_tr_b16 a[24:25], v3 offset:52736
  ds_read_b64_tr_b16 a[26:27], v3 offset:56832
  v_fmac_f32 v6, v14, v14
  v_fmac_f32 v7, v15, v15
  v_lshlrev_b32 v8, 16, v68
  v_and_b32 v9, 0xffff0000, v68
  v_mfma_f32_32x32x16_bf16 v[128:143], a[0:3], v[60:63], v[128:143]
  s_add_u32 s1, s8, 172032
  ds_read_b64_tr_b16 a[28:29], v3 offset:52992
  ds_read_b64_tr_b16 a[30:31], v3 offset:57088
  buffer_load_dwordx4 v2, s[44:47], s1 offen offset:3072 lds
  v_add_u32 v3, 0x00010000, v3
  v_mfma_f32_32x32x16_bf16 v[144:159], a[4:7], v[60:63], v[144:159]
  s_waitcnt vmcnt(20)
  s_barrier
  ds_read_b64_tr_b16 a[0:1], v3 offset:0
  ds_read_b64_tr_b16 a[2:3], v3 offset:4096
  v_accvgpr_read_b32 v0, a249
  v_sub_f32 v8, v8, v5
  v_mfma_f32_32x32x16_bf16 v[160:175], a[8:11], v[60:63], v[160:175]
  ds_read_b64_tr_b16 a[4:5], v3 offset:256
  ds_read_b64_tr_b16 a[6:7], v3 offset:4352
  buffer_load_dword a252, v0, s[72:75], 0 offen offset:0
  v_sub_f32 v9, v9, v5
  v_cvt_pk_bf16_f32 v68, v8, v9
  s_waitcnt lgkmcnt(6)
  v_mfma_f32_32x32x16_bf16 v[176:191], a[12:15], v[60:63], v[176:191]
  ds_read_b64_tr_b16 a[8:9], v3 offset:512
  ds_read_b64_tr_b16 a[10:11], v3 offset:4608
  v_fmac_f32 v6, v8, v8
  v_fmac_f32 v7, v9, v9
  v_lshlrev_b32 v10, 16, v69
  v_and_b32 v11, 0xffff0000, v69
  v_mfma_f32_32x32x16_bf16 v[192:207], a[16:19], v[60:63], v[192:207]
  s_add_u32 s26, s26, 1
  s_cmp_eq_u32 s26, 7
  s_cselect_b32 s26, 0, s26
  s_lshl_b32 s7, s26, 19
  s_mul_i32 s8, s26, 229376
  s_add_u32 m0, s31, 81920
  s_add_u32 s0, s7, 0
  ds_read_b64_tr_b16 a[12:13], v3 offset:768
  ds_read_b64_tr_b16 a[14:15], v3 offset:4864
  buffer_load_dwordx4 v1, s[36:39], s0 offen offset:0 lds
  v_mfma_f32_32x32x16_bf16 v[208:223], a[20:23], v[60:63], v[208:223]
  ds_read_b64_tr_b16 a[16:17], v3 offset:1024
  ds_read_b64_tr_b16 a[18:19], v3 offset:5120
  v_sub_f32 v10, v10, v5
  v_sub_f32 v11, v11, v5
  v_cvt_pk_bf16_f32 v69, v10, v11
  v_fmac_f32 v6, v10, v10
  v_mfma_f32_32x32x16_bf16 v[224:239], a[24:27], v[60:63], v[224:239]
  ds_read_b64_tr_b16 a[20:21], v3 offset:1280
  ds_read_b64_tr_b16 a[22:23], v3 offset:5376
  v_fmac_f32 v7, v11, v11
  v_lshlrev_b32 v12, 16, v70
  v_and_b32 v13, 0xffff0000, v70
  v_sub_f32 v12, v12, v5
  s_waitcnt lgkmcnt(6)
  v_mfma_f32_32x32x16_bf16 v[240:255], a[28:31], v[60:63], v[240:255]
  ds_read_b64_tr_b16 a[24:25], v3 offset:1536
  ds_read_b64_tr_b16 a[26:27], v3 offset:5632
  v_sub_f32 v13, v13, v5
  v_cvt_pk_bf16_f32 v70, v12, v13
  v_fmac_f32 v6, v12, v12
  v_fmac_f32 v7, v13, v13
  v_mfma_f32_32x32x16_bf16 a[32:47], a[0:3], v[48:51], a[32:47]
  ds_read_b64_tr_b16 a[28:29], v3 offset:1792
  ds_read_b64_tr_b16 a[30:31], v3 offset:5888
  buffer_load_dwordx4 v1, s[40:43], s0 offen offset:1024 lds
  v_lshlrev_b32 v14, 16, v71
  v_mfma_f32_32x32x16_bf16 a[48:63], a[4:7], v[48:51], a[48:63]
  ds_read_b64_tr_b16 a[0:1], v3 offset:2048
  ds_read_b64_tr_b16 a[2:3], v3 offset:6144
  v_and_b32 v15, 0xffff0000, v71
  v_sub_f32 v14, v14, v5
  v_sub_f32 v15, v15, v5
  v_cvt_pk_bf16_f32 v71, v14, v15
  v_mfma_f32_32x32x16_bf16 a[64:79], a[8:11], v[48:51], a[64:79]
  ds_read_b64_tr_b16 a[4:5], v3 offset:2304
  ds_read_b64_tr_b16 a[6:7], v3 offset:6400
  v_fmac_f32 v6, v14, v14
  v_fmac_f32 v7, v15, v15
  v_lshlrev_b32 v8, 16, v72
  v_and_b32 v9, 0xffff0000, v72
  s_waitcnt lgkmcnt(6)
  v_mfma_f32_32x32x16_bf16 a[80:95], a[12:15], v[48:51], a[80:95]
  ds_read_b64_tr_b16 a[8:9], v3 offset:2560
  ds_read_b64_tr_b16 a[10:11], v3 offset:6656
  v_sub_f32 v8, v8, v5
  v_sub_f32 v9, v9, v5
  v_cvt_pk_bf16_f32 v72, v8, v9
  v_fmac_f32 v6, v8, v8
  v_mfma_f32_32x32x16_bf16 a[32:47], a[16:19], v[52:55], a[32:47]
  s_add_u32 s0, s7, 129024
  ds_read_b64_tr_b16 a[12:13], v3 offset:2816
  ds_read_b64_tr_b16 a[14:15], v3 offset:6912
  buffer_load_dwordx4 v1, s[36:39], s0 offen offset:2048 lds
  v_mfma_f32_32x32x16_bf16 a[48:63], a[20:23], v[52:55], a[48:63]
  ds_read_b64_tr_b16 a[16:17], v3 offset:3072
  ds_read_b64_tr_b16 a[18:19], v3 offset:7168
  v_fmac_f32 v7, v9, v9
  v_lshlrev_b32 v10, 16, v73
  v_and_b32 v11, 0xffff0000, v73
  v_sub_f32 v10, v10, v5
  v_mfma_f32_32x32x16_bf16 a[64:79], a[24:27], v[52:55], a[64:79]
  ds_read_b64_tr_b16 a[20:21], v3 offset:3328
  ds_read_b64_tr_b16 a[22:23], v3 offset:7424
  v_sub_f32 v11, v11, v5
  v_cvt_pk_bf16_f32 v73, v10, v11
  v_fmac_f32 v6, v10, v10
  v_fmac_f32 v7, v11, v11
  s_waitcnt lgkmcnt(6)
  v_mfma_f32_32x32x16_bf16 a[80:95], a[28:31], v[52:55], a[80:95]
  ds_read_b64_tr_b16 a[24:25], v3 offset:3584
  ds_read_b64_tr_b16 a[26:27], v3 offset:7680
  v_lshlrev_b32 v12, 16, v74
  v_and_b32 v13, 0xffff0000, v74
  v_sub_f32 v12, v12, v5
  v_sub_f32 v13, v13, v5
  v_mfma_f32_32x32x16_bf16 a[32:47], a[0:3], v[56:59], a[32:47]
  ds_read_b64_tr_b16 a[28:29], v3 offset:3840
  ds_read_b64_tr_b16 a[30:31], v3 offset:7936
  buffer_load_dwordx4 v1, s[40:43], s0 offen offset:3072 lds
  v_cvt_pk_bf16_f32 v74, v12, v13
  v_mfma_f32_32x32x16_bf16 a[48:63], a[4:7], v[56:59], a[48:63]
  ds_read_b64_tr_b16 a[0:1], v3 offset:16384
  ds_read_b64_tr_b16 a[2:3], v3 offset:20480
  v_fmac_f32 v6, v12, v12
  v_fmac_f32 v7, v13, v13
  v_lshlrev_b32 v14, 16, v75
  v_and_b32 v15, 0xffff0000, v75
  v_mfma_f32_32x32x16_bf16 a[64:79], a[8:11], v[56:59], a[64:79]
  ds_read_b64_tr_b16 a[4:5], v3 offset:16640
  ds_read_b64_tr_b16 a[6:7], v3 offset:20736
  v_sub_f32 v14, v14, v5
  v_sub_f32 v15, v15, v5
  v_cvt_pk_bf16_f32 v75, v14, v15
  v_fmac_f32 v6, v14, v14
  s_waitcnt lgkmcnt(6)
  v_mfma_f32_32x32x16_bf16 a[80:95], a[12:15], v[56:59], a[80:95]
  ds_read_b64_tr_b16 a[8:9], v3 offset:16896
  ds_read_b64_tr_b16 a[10:11], v3 offset:20992
  v_fmac_f32 v7, v15, v15
  v_lshlrev_b32 v8, 16, v76
  v_and_b32 v9, 0xffff0000, v76
  v_sub_f32 v8, v8, v5
  v_mfma_f32_32x32x16_bf16 a[32:47], a[16:19], v[60:63], a[32:47]
  s_add_u32 m0, s31, 98304
  s_add_u32 s0, s7, 262144
  ds_read_b64_tr_b16 a[12:13], v3 offset:17152
  ds_read_b64_tr_b16 a[14:15], v3 offset:21248
  buffer_load_dwordx4 v1, s[36:39], s0 offen offset:0 lds
  v_mfma_f32_32x32x16_bf16 a[48:63], a[20:23], v[60:63], a[48:63]
  ds_read_b64_tr_b16 a[16:17], v3 offset:17408
  ds_read_b64_tr_b16 a[18:19], v3 offset:21504
  v_sub_f32 v9, v9, v5
  v_cvt_pk_bf16_f32 v76, v8, v9
  v_fmac_f32 v6, v8, v8
  v_fmac_f32 v7, v9, v9
  v_mfma_f32_32x32x16_bf16 a[64:79], a[24:27], v[60:63], a[64:79]
  ds_read_b64_tr_b16 a[20:21], v3 offset:17664
  ds_read_b64_tr_b16 a[22:23], v3 offset:21760
  v_lshlrev_b32 v10, 16, v77
  v_and_b32 v11, 0xffff0000, v77
  v_sub_f32 v10, v10, v5
  v_sub_f32 v11, v11, v5
  s_waitcnt lgkmcnt(6)
  v_mfma_f32_32x32x16_bf16 a[80:95], a[28:31], v[60:63], a[80:95]
  ds_read_b64_tr_b16 a[24:25], v3 offset:17920
  ds_read_b64_tr_b16 a[26:27], v3 offset:22016
  v_cvt_pk_bf16_f32 v77, v10, v11
  v_fmac_f32 v6, v10, v10
  v_fmac_f32 v7, v11, v11
  v_lshlrev_b32 v12, 16, v78
  v_mfma_f32_32x32x16_bf16 v[128:143], a[0:3], v[64:67], v[128:143]
  ds_read_b64_tr_b16 a[28:29], v3 offset:18176
  ds_read_b64_tr_b16 a[30:31], v3 offset:22272
  buffer_load_dwordx4 v1, s[40:43], s0 offen offset:1024 lds
  v_and_b32 v13, 0xffff0000, v78
  v_mfma_f32_32x32x16_bf16 v[144:159], a[4:7], v[64:67], v[144:159]
  ds_read_b64_tr_b16 a[0:1], v3 offset:18432
  ds_read_b64_tr_b16 a[2:3], v3 offset:22528
  v_sub_f32 v12, v12, v5
  v_sub_f32 v13, v13, v5
  v_cvt_pk_bf16_f32 v78, v12, v13
  v_fmac_f32 v6, v12, v12
  v_mfma_f32_32x32x16_bf16 v[160:175], a[8:11], v[64:67], v[160:175]
  ds_read_b64_tr_b16 a[4:5], v3 offset:18688
  ds_read_b64_tr_b16 a[6:7], v3 offset:22784
  v_fmac_f32 v7, v13, v13
  v_lshlrev_b32 v14, 16, v79
  v_and_b32 v15, 0xffff0000, v79
  v_sub_f32 v14, v14, v5
  s_waitcnt lgkmcnt(6)
  v_mfma_f32_32x32x16_bf16 v[176:191], a[12:15], v[64:67], v[176:191]
  ds_read_b64_tr_b16 a[8:9], v3 offset:18944
  ds_read_b64_tr_b16 a[10:11], v3 offset:23040
  v_sub_f32 v15, v15, v5
  v_cvt_pk_bf16_f32 v79, v14, v15
  v_fmac_f32 v6, v14, v14
  v_fmac_f32 v7, v15, v15
  v_mfma_f32_32x32x16_bf16 v[192:207], a[16:19], v[64:67], v[192:207]
  s_add_u32 s0, s7, 391168
  ds_read_b64_tr_b16 a[12:13], v3 offset:19200
  ds_read_b64_tr_b16 a[14:15], v3 offset:23296
  buffer_load_dwordx4 v1, s[36:39], s0 offen offset:2048 lds
  v_mfma_f32_32x32x16_bf16 v[208:223], a[20:23], v[64:67], v[208:223]
  ds_read_b64_tr_b16 a[16:17], v3 offset:19456
  ds_read_b64_tr_b16 a[18:19], v3 offset:23552
  v_lshlrev_b32 v8, 16, v80
  v_and_b32 v9, 0xffff0000, v80
  v_sub_f32 v8, v8, v5
  v_sub_f32 v9, v9, v5
  v_mfma_f32_32x32x16_bf16 v[224:239], a[24:27], v[64:67], v[224:239]
  ds_read_b64_tr_b16 a[20:21], v3 offset:19712
  ds_read_b64_tr_b16 a[22:23], v3 offset:23808
  v_cvt_pk_bf16_f32 v80, v8, v9
  v_fmac_f32 v6, v8, v8
  v_fmac_f32 v7, v9, v9
  v_lshlrev_b32 v10, 16, v81
  s_waitcnt lgkmcnt(6)
  v_mfma_f32_32x32x16_bf16 v[240:255], a[28:31], v[64:67], v[240:255]
  ds_read_b64_tr_b16 a[24:25], v3 offset:19968
  ds_read_b64_tr_b16 a[26:27], v3 offset:24064
  buffer_load_dwordx4 v1, s[40:43], s0 offen offset:3072 lds
  v_and_b32 v11, 0xffff0000, v81
  v_mfma_f32_32x32x16_bf16 v[128:143], a[0:3], v[68:71], v[128:143]
  ds_read_b64_tr_b16 a[28:29], v3 offset:20224
  ds_read_b64_tr_b16 a[30:31], v3 offset:24320
  v_sub_f32 v10, v10, v5
  v_sub_f32 v11, v11, v5
  v_cvt_pk_bf16_f32 v81, v10, v11
  v_add_u32 v3, 0xfffe0000, v3
  v_mfma_f32_32x32x16_bf16 v[144:159], a[4:7], v[68:71], v[144:159]
  s_waitcnt vmcnt(21)
  s_barrier
  ds_read_b64_tr_b16 a[0:1], v3 offset:0
  ds_read_b64_tr_b16 a[2:3], v3 offset:4096
  v_fmac_f32 v6, v10, v10
  v_fmac_f32 v7, v11, v11
  v_mfma_f32_32x32x16_bf16 v[160:175], a[8:11], v[68:71], v[160:175]
  ds_read_b64_tr_b16 a[4:5], v3 offset:256
  ds_read_b64_tr_b16 a[6:7], v3 offset:4352
  v_lshlrev_b32 v12, 16, v82
  v_and_b32 v13, 0xffff0000, v82
  v_sub_f32 v12, v12, v5
  v_sub_f32 v13, v13, v5
  s_waitcnt lgkmcnt(6)
  v_mfma_f32_32x32x16_bf16 v[176:191], a[12:15], v[68:71], v[176:191]
  s_add_u32 m0, s31, 114688
  s_add_u32 s1, s8, 3072
  ds_read_b64_tr_b16 a[8:9], v3 offset:512
  ds_read_b64_tr_b16 a[10:11], v3 offset:4608
  buffer_load_dwordx4 v2, s[44:47], s1 offen offset:0 lds
  v_mfma_f32_32x32x16_bf16 v[192:207], a[16:19], v[68:71], v[192:207]
  ds_read_b64_tr_b16 a[12:13], v3 offset:768
  ds_read_b64_tr_b16 a[14:15], v3 offset:4864
  v_cvt_pk_bf16_f32 v82, v12, v13
  v_fmac_f32 v6, v12, v12
  v_fmac_f32 v7, v13, v13
  v_lshlrev_b32 v14, 16, v83
  v_mfma_f32_32x32x16_bf16 v[208:223], a[20:23], v[68:71], v[208:223]
  ds_read_b64_tr_b16 a[16:17], v3 offset:1024
  ds_read_b64_tr_b16 a[18:19], v3 offset:5120
  v_and_b32 v15, 0xffff0000, v83
  v_sub_f32 v14, v14, v5
  v_sub_f32 v15, v15, v5
  v_cvt_pk_bf16_f32 v83, v14, v15
  v_mfma_f32_32x32x16_bf16 v[224:239], a[24:27], v[68:71], v[224:239]
  ds_read_b64_tr_b16 a[20:21], v3 offset:1280
  ds_read_b64_tr_b16 a[22:23], v3 offset:5376
  v_fmac_f32 v6, v14, v14
  v_fmac_f32 v7, v15, v15
  v_lshlrev_b32 v8, 16, v84
  v_and_b32 v9, 0xffff0000, v84
  s_waitcnt lgkmcnt(6)
  v_mfma_f32_32x32x16_bf16 v[240:255], a[28:31], v[68:71], v[240:255]
  s_add_u32 s1, s8, 59392
  ds_read_b64_tr_b16 a[24:25], v3 offset:1536
  ds_read_b64_tr_b16 a[26:27], v3 offset:5632
  buffer_load_dwordx4 v2, s[44:47], s1 offen offset:1024 lds
  v_mfma_f32_32x32x16_bf16 v[128:143], a[0:3], v[72:75], v[128:143]
  ds_read_b64_tr_b16 a[28:29], v3 offset:1792
  ds_read_b64_tr_b16 a[30:31], v3 offset:5888
  v_accvgpr_read_b32 v0, a249
  v_sub_f32 v8, v8, v5
  v_sub_f32 v9, v9, v5
  v_cvt_pk_bf16_f32 v84, v8, v9
  v_mfma_f32_32x32x16_bf16 v[144:159], a[4:7], v[72:75], v[144:159]
  ds_read_b64_tr_b16 a[0:1], v3 offset:2048
  ds_read_b64_tr_b16 a[2:3], v3 offset:6144
  buffer_load_dword a253, v0, s[72:75], 0 offen offset:3584
  v_fmac_f32 v6, v8, v8
  v_fmac_f32 v7, v9, v9
  v_mfma_f32_32x32x16_bf16 v[160:175], a[8:11], v[72:75], v[160:175]
  ds_read_b64_tr_b16 a[4:5], v3 offset:2304
  ds_read_b64_tr_b16 a[6:7], v3 offset:6400
  v_lshlrev_b32 v10, 16, v85
  v_and_b32 v11, 0xffff0000, v85
  v_sub_f32 v10, v10, v5
  v_sub_f32 v11, v11, v5
  s_waitcnt lgkmcnt(6)
  v_mfma_f32_32x32x16_bf16 v[176:191], a[12:15], v[72:75], v[176:191]
  s_add_u32 s1, s8, 115712
  ds_read_b64_tr_b16 a[8:9], v3 offset:2560
  ds_read_b64_tr_b16 a[10:11], v3 offset:6656
  buffer_load_dwordx4 v2, s[44:47], s1 offen offset:2048 lds
  v_mfma_f32_32x32x16_bf16 v[192:207], a[16:19], v[72:75], v[192:207]
  ds_read_b64_tr_b16 a[12:13], v3 offset:2816
  ds_read_b64_tr_b16 a[14:15], v3 offset:6912
  v_cvt_pk_bf16_f32 v85, v10, v11
  v_fmac_f32 v6, v10, v10
  v_fmac_f32 v7, v11, v11
  v_lshlrev_b32 v12, 16, v86
  v_mfma_f32_32x32x16_bf16 v[208:223], a[20:23], v[72:75], v[208:223]
  ds_read_b64_tr_b16 a[16:17], v3 offset:3072
  ds_read_b64_tr_b16 a[18:19], v3 offset:7168
  v_and_b32 v13, 0xffff0000, v86
  v_sub_f32 v12, v12, v5
  v_sub_f32 v13, v13, v5
  v_cvt_pk_bf16_f32 v86, v12, v13
  v_mfma_f32_32x32x16_bf16 v[224:239], a[24:27], v[72:75], v[224:239]
  ds_read_b64_tr_b16 a[20:21], v3 offset:3328
  ds_read_b64_tr_b16 a[22:23], v3 offset:7424
  v_fmac_f32 v6, v12, v12
  v_fmac_f32 v7, v13, v13
  v_lshlrev_b32 v14, 16, v87
  v_and_b32 v15, 0xffff0000, v87
  s_waitcnt lgkmcnt(6)
  v_mfma_f32_32x32x16_bf16 v[240:255], a[28:31], v[72:75], v[240:255]
  s_add_u32 s1, s8, 172032
  ds_read_b64_tr_b16 a[24:25], v3 offset:3584
  ds_read_b64_tr_b16 a[26:27], v3 offset:7680
  buffer_load_dwordx4 v2, s[44:47], s1 offen offset:3072 lds
  v_mfma_f32_32x32x16_bf16 v[128:143], a[0:3], v[76:79], v[128:143]
  ds_read_b64_tr_b16 a[28:29], v3 offset:3840
  ds_read_b64_tr_b16 a[30:31], v3 offset:7936
  v_sub_f32 v14, v14, v5
  v_sub_f32 v15, v15, v5
  v_cvt_pk_bf16_f32 v87, v14, v15
  v_fmac_f32 v6, v14, v14
  v_mfma_f32_32x32x16_bf16 v[144:159], a[4:7], v[76:79], v[144:159]
  ds_read_b64_tr_b16 a[0:1], v3 offset:16384
  ds_read_b64_tr_b16 a[2:3], v3 offset:20480
  v_fmac_f32 v7, v15, v15
  v_lshlrev_b32 v8, 16, v88
  v_and_b32 v9, 0xffff0000, v88
  v_sub_f32 v8, v8, v5
  v_mfma_f32_32x32x16_bf16 v[160:175], a[8:11], v[76:79], v[160:175]
  ds_read_b64_tr_b16 a[4:5], v3 offset:16640
  ds_read_b64_tr_b16 a[6:7], v3 offset:20736
  v_sub_f32 v9, v9, v5
  v_cvt_pk_bf16_f32 v88, v8, v9
  v_fmac_f32 v6, v8, v8
  v_fmac_f32 v7, v9, v9
  s_waitcnt lgkmcnt(6)
  v_mfma_f32_32x32x16_bf16 v[176:191], a[12:15], v[76:79], v[176:191]
  s_add_u32 s26, s26, 1
  s_cmp_eq_u32 s26, 7
  s_cselect_b32 s26, 0, s26
  s_lshl_b32 s7, s26, 19
  s_mul_i32 s8, s26, 229376
  s_add_u32 m0, s31, 131072
  s_add_u32 s0, s7, 0
  ds_read_b64_tr_b16 a[8:9], v3 offset:16896
  ds_read_b64_tr_b16 a[10:11], v3 offset:20992
  buffer_load_dwordx4 v1, s[36:39], s0 offen offset:0 lds
  v_mfma_f32_32x32x16_bf16 v[192:207], a[16:19], v[76:79], v[192:207]
  ds_read_b64_tr_b16 a[12:13], v3 offset:17152
  ds_read_b64_tr_b16 a[14:15], v3 offset:21248
  v_lshlrev_b32 v10, 16, v89
  v_and_b32 v11, 0xffff0000, v89
  v_sub_f32 v10, v10, v5
  v_sub_f32 v11, v11, v5
  v_mfma_f32_32x32x16_bf16 v[208:223], a[20:23], v[76:79], v[208:223]
  ds_read_b64_tr_b16 a[16:17], v3 offset:17408
  ds_read_b64_tr_b16 a[18:19], v3 offset:21504
  v_cvt_pk_bf16_f32 v89, v10, v11
  v_fmac_f32 v6, v10, v10
  v_fmac_f32 v7, v11, v11
  v_lshlrev_b32 v12, 16, v90
  v_mfma_f32_32x32x16_bf16 v[224:239], a[24:27], v[76:79], v[224:239]
  ds_read_b64_tr_b16 a[20:21], v3 offset:17664
  ds_read_b64_tr_b16 a[22:23], v3 offset:21760
  v_and_b32 v13, 0xffff0000, v90
  v_sub_f32 v12, v12, v5
  v_sub_f32 v13, v13, v5
  v_cvt_pk_bf16_f32 v90, v12, v13
  s_waitcnt lgkmcnt(6)
  v_mfma_f32_32x32x16_bf16 v[240:255], a[28:31], v[76:79], v[240:255]
  ds_read_b64_tr_b16 a[24:25], v3 offset:17920
  ds_read_b64_tr_b16 a[26:27], v3 offset:22016
  buffer_load_dwordx4 v1, s[40:43], s0 offen offset:1024 lds
  v_fmac_f32 v6, v12, v12
  v_mfma_f32_32x32x16_bf16 a[32:47], a[0:3], v[64:67], a[32:47]
  ds_read_b64_tr_b16 a[28:29], v3 offset:18176
  ds_read_b64_tr_b16 a[30:31], v3 offset:22272
  v_fmac_f32 v7, v13, v13
  v_lshlrev_b32 v14, 16, v91
  v_and_b32 v15, 0xffff0000, v91
  v_sub_f32 v14, v14, v5
  v_mfma_f32_32x32x16_bf16 a[48:63], a[4:7], v[64:67], a[48:63]
L_padh2:
  s_cbranch_execz L_padh6
  ds_read_b64_tr_b16 a[0:1], v3 offset:18432
  ds_read_b64_tr_b16 a[2:3], v3 offset:22528
  v_sub_f32 v15, v15, v5
  v_cvt_pk_bf16_f32 v91, v14, v15
  v_fmac_f32 v6, v14, v14
  v_fmac_f32 v7, v15, v15
  v_mfma_f32_32x32x16_bf16 a[64:79], a[8:11], v[64:67], a[64:79]
  ds_read_b64_tr_b16 a[4:5], v3 offset:18688
  ds_read_b64_tr_b16 a[6:7], v3 offset:22784
  v_lshlrev_b32 v8, 16, v92
  v_and_b32 v9, 0xffff0000, v92
  v_sub_f32 v8, v8, v5
  v_sub_f32 v9, v9, v5
  s_waitcnt lgkmcnt(6)
  v_mfma_f32_32x32x16_bf16 a[80:95], a[12:15], v[64:67], a[80:95]
  s_add_u32 s0, s7, 129024
  ds_read_b64_tr_b16 a[8:9], v3 offset:18944
  ds_read_b64_tr_b16 a[10:11], v3 offset:23040
  buffer_load_dwordx4 v1, s[36:39], s0 offen offset:2048 lds
  v_mfma_f32_32x32x16_bf16 a[32:47], a[16:19], v[68:71], a[32:47]
  ds_read_b64_tr_b16 a[12:13], v3 offset:19200
  ds_read_b64_tr_b16 a[14:15], v3 offset:23296
  v_cvt_pk_bf16_f32 v92, v8, v9
  v_fmac_f32 v6, v8, v8
  v_fmac_f32 v7, v9, v9
  v_lshlrev_b32 v10, 16, v93
  v_mfma_f32_32x32x16_bf16 a[48:63], a[20:23], v[68:71], a[48:63]
  ds_read_b64_tr_b16 a[16:17], v3 offset:19456
  ds_read_b64_tr_b16 a[18:19], v3 offset:23552
  v_and_b32 v11, 0xffff0000, v93
  v_sub_f32 v10, v10, v5
  v_sub_f32 v11, v11, v5
  v_cvt_pk_bf16_f32 v93, v10, v11
  v_mfma_f32_32x32x16_bf16 a[64:79], a[24:27], v[68:71], a[64:79]
  ds_read_b64_tr_b16 a[20:21], v3 offset:19712
  ds_read_b64_tr_b16 a[22:23], v3 offset:23808
  v_fmac_f32 v6, v10, v10
  v_fmac_f32 v7, v11, v11
  v_lshlrev_b32 v12, 16, v94
  v_and_b32 v13, 0xffff0000, v94
  s_waitcnt lgkmcnt(6)
  v_mfma_f32_32x32x16_bf16 a[80:95], a[28:31], v[68:71], a[80:95]
  ds_read_b64_tr_b16 a[24:25], v3 offset:19968
  ds_read_b64_tr_b16 a[26:27], v3 offset:24064
  buffer_load_dwordx4 v1, s[40:43], s0 offen offset:3072 lds
  v_sub_f32 v12, v12, v5
  v_mfma_f32_32x32x16_bf16 a[32:47], a[0:3], v[72:75], a[32:47]
  ds_read_b64_tr_b16 a[28:29], v3 offset:20224
  ds_read_b64_tr_b16 a[30:31], v3 offset:24320
  v_sub_f32 v13, v13, v5
  v_cvt_pk_bf16_f32 v94, v12, v13
  v_fmac_f32 v6, v12, v12
  v_fmac_f32 v7, v13, v13
  v_mfma_f32_32x32x16_bf16 a[48:63], a[4:7], v[72:75], a[48:63]
  s_waitcnt vmcnt(22)
  s_barrier
  ds_read_b64_tr_b16 a[0:1], v3 offset:32768
  ds_read_b64_tr_b16 a[2:3], v3 offset:36864
  v_lshlrev_b32 v14, 16, v95
  v_and_b32 v15, 0xffff0000, v95
  v_mfma_f32_32x32x16_bf16 a[64:79], a[8:11], v[72:75], a[64:79]
  ds_read_b64_tr_b16 a[4:5], v3 offset:33024
  ds_read_b64_tr_b16 a[6:7], v3 offset:37120
  v_sub_f32 v14, v14, v5
  v_sub_f32 v15, v15, v5
  v_cvt_pk_bf16_f32 v95, v14, v15
  v_fmac_f32 v6, v14, v14
  s_waitcnt lgkmcnt(6)
  v_mfma_f32_32x32x16_bf16 a[80:95], a[12:15], v[72:75], a[80:95]
  s_add_u32 m0, s31, 147456
  s_add_u32 s0, s7, 262144
  ds_read_b64_tr_b16 a[8:9], v3 offset:33280
  ds_read_b64_tr_b16 a[10:11], v3 offset:37376
  buffer_load_dwordx4 v1, s[36:39], s0 offen offset:0 lds
  v_mfma_f32_32x32x16_bf16 a[32:47], a[16:19], v[76:79], a[32:47]
  ds_read_b64_tr_b16 a[12:13], v3 offset:33536
  ds_read_b64_tr_b16 a[14:15], v3 offset:37632
  v_fmac_f32 v7, v15, v15
  v_lshlrev_b32 v8, 16, v96
  v_and_b32 v9, 0xffff0000, v96
  v_sub_f32 v8, v8, v5
  v_mfma_f32_32x32x16_bf16 a[48:63], a[20:23], v[76:79], a[48:63]
  ds_read_b64_tr_b16 a[16:17], v3 offset:33792
  ds_read_b64_tr_b16 a[18:19], v3 offset:37888
  v_sub_f32 v9, v9, v5
  v_cvt_pk_bf16_f32 v96, v8, v9
  v_fmac_f32 v6, v8, v8
  v_fmac_f32 v7, v9, v9
  v_mfma_f32_32x32x16_bf16 a[64:79], a[24:27], v[76:79], a[64:79]
  ds_read_b64_tr_b16 a[20:21], v3 offset:34048
  ds_read_b64_tr_b16 a[22:23], v3 offset:38144
  v_lshlrev_b32 v10, 16, v97
  v_and_b32 v11, 0xffff0000, v97
  v_sub_f32 v10, v10, v5
  v_sub_f32 v11, v11, v5
  s_waitcnt lgkmcnt(6)
  v_mfma_f32_32x32x16_bf16 a[80:95], a[28:31], v[76:79], a[80:95]
  ds_read_b64_tr_b16 a[24:25], v3 offset:34304
  ds_read_b64_tr_b16 a[26:27], v3 offset:38400
  buffer_load_dwordx4 v1, s[40:43], s0 offen offset:1024 lds
  v_cvt_pk_bf16_f32 v97, v10, v11
  v_mfma_f32_32x32x16_bf16 v[128:143], a[0:3], v[80:83], v[128:143]
  ds_read_b64_tr_b16 a[28:29], v3 offset:34560
  ds_read_b64_tr_b16 a[30:31], v3 offset:38656
  v_fmac_f32 v6, v10, v10
  v_fmac_f32 v7, v11, v11
  v_lshlrev_b32 v12, 16, v98
  v_and_b32 v13, 0xffff0000, v98
  v_mfma_f32_32x32x16_bf16 v[144:159], a[4:7], v[80:83], v[144:159]
  ds_read_b64_tr_b16 a[0:1], v3 offset:34816
  ds_read_b64_tr_b16 a[2:3], v3 offset:38912
  v_sub_f32 v12, v12, v5
  v_sub_f32 v13, v13, v5
  v_cvt_pk_bf16_f32 v98, v12, v13
  v_fmac_f32 v6, v12, v12
  v_mfma_f32_32x32x16_bf16 v[160:175], a[8:11], v[80:83], v[160:175]
  ds_read_b64_tr_b16 a[4:5], v3 offset:35072
  ds_read_b64_tr_b16 a[6:7], v3 offset:39168
  v_fmac_f32 v7, v13, v13
  v_lshlrev_b32 v14, 16, v99
  v_and_b32 v15, 0xffff0000, v99
  v_sub_f32 v14, v14, v5
  s_waitcnt lgkmcnt(6)
  v_mfma_f32_32x32x16_bf16 v[176:191], a[12:15], v[80:83], v[176:191]
  s_add_u32 s0, s7, 391168
  ds_read_b64_tr_b16 a[8:9], v3 offset:35328
  ds_read_b64_tr_b16 a[10:11], v3 offset:39424
  buffer_load_dwordx4 v1, s[36:39], s0 offen offset:2048 lds
  v_mfma_f32_32x32x16_bf16 v[192:207], a[16:19], v[80:83], v[192:207]
  ds_read_b64_tr_b16 a[12:13], v3 offset:35584
  ds_read_b64_tr_b16 a[14:15], v3 offset:39680
  v_sub_f32 v15, v15, v5
  v_cvt_pk_bf16_f32 v99, v14, v15
  v_fmac_f32 v6, v14, v14
  v_fmac_f32 v7, v15, v15
  v_mfma_f32_32x32x16_bf16 v[208:223], a[20:23], v[80:83], v[208:223]
  ds_read_b64_tr_b16 a[16:17], v3 offset:35840
  ds_read_b64_tr_b16 a[18:19], v3 offset:39936
  v_lshlrev_b32 v8, 16, v100
  v_and_b32 v9, 0xffff0000, v100
  v_sub_f32 v8, v8, v5
  v_sub_f32 v9, v9, v5
  v_mfma_f32_32x32x16_bf16 v[224:239], a[24:27], v[80:83], v[224:239]
  ds_read_b64_tr_b16 a[20:21], v3 offset:36096
  ds_read_b64_tr_b16 a[22:23], v3 offset:40192
  v_cvt_pk_bf16_f32 v100, v8, v9
  v_fmac_f32 v6, v8, v8
  v_fmac_f32 v7, v9, v9
  v_lshlrev_b32 v10, 16, v101
  s_waitcnt lgkmcnt(6)
  v_mfma_f32_32x32x16_bf16 v[240:255], a[28:31], v[80:83], v[240:255]
  ds_read_b64_tr_b16 a[24:25], v3 offset:36352
  ds_read_b64_tr_b16 a[26:27], v3 offset:40448
  buffer_load_dwordx4 v1, s[40:43], s0 offen offset:3072 lds
  v_and_b32 v11, 0xffff0000, v101
  v_mfma_f32_32x32x16_bf16 v[128:143], a[0:3], v[84:87], v[128:143]
  ds_read_b64_tr_b16 a[28:29], v3 offset:36608
  ds_read_b64_tr_b16 a[30:31], v3 offset:40704
  v_accvgpr_read_b32 v0, a249
  v_add_u32 v0, 7168, v0
  v_sub_f32 v10, v10, v5
  v_sub_f32 v11, v11, v5
  v_mfma_f32_32x32x16_bf16 v[144:159], a[4:7], v[84:87], v[144:159]
  ds_read_b64_tr_b16 a[0:1], v3 offset:49152
  ds_read_b64_tr_b16 a[2:3], v3 offset:53248
  buffer_load_dword a254, v0, s[72:75], 0 offen offset:0
  v_cvt_pk_bf16_f32 v101, v10, v11
  v_fmac_f32 v6, v10, v10
  v_mfma_f32_32x32x16_bf16 v[160:175], a[8:11], v[84:87], v[160:175]
  ds_read_b64_tr_b16 a[4:5], v3 offset:49408
  ds_read_b64_tr_b16 a[6:7], v3 offset:53504
  v_fmac_f32 v7, v11, v11
  v_lshlrev_b32 v12, 16, v102
  v_and_b32 v13, 0xffff0000, v102
  v_sub_f32 v12, v12, v5
  s_waitcnt lgkmcnt(6)
  v_mfma_f32_32x32x16_bf16 v[176:191], a[12:15], v[84:87], v[176:191]
  s_add_u32 m0, s31, 0
  s_add_u32 s1, s8, 3072
  ds_read_b64_tr_b16 a[8:9], v3 offset:49664
  ds_read_b64_tr_b16 a[10:11], v3 offset:53760
  buffer_load_dwordx4 v2, s[44:47], s1 offen offset:0 lds
  v_mfma_f32_32x32x16_bf16 v[192:207], a[16:19], v[84:87], v[192:207]
  ds_read_b64_tr_b16 a[12:13], v3 offset:49920
  ds_read_b64_tr_b16 a[14:15], v3 offset:54016
  v_sub_f32 v13, v13, v5
  v_cvt_pk_bf16_f32 v102, v12, v13
  v_fmac_f32 v6, v12, v12
  v_fmac_f32 v7, v13, v13
  v_mfma_f32_32x32x16_bf16 v[208:223], a[20:23], v[84:87], v[208:223]
  ds_read_b64_tr_b16 a[16:17], v3 offset:50176
  ds_read_b64_tr_b16 a[18:19], v3 offset:54272
  v_lshlrev_b32 v14, 16, v103
  v_and_b32 v15, 0xffff0000, v103
  v_sub_f32 v14, v14, v5
  v_sub_f32 v15, v15, v5
  v_mfma_f32_32x32x16_bf16 v[224:239], a[24:27], v[84:87], v[224:239]
  ds_read_b64_tr_b16 a[20:21], v3 offset:50432
  ds_read_b64_tr_b16 a[22:23], v3 offset:54528
  v_cvt_pk_bf16_f32 v103, v14, v15
  v_fmac_f32 v6, v14, v14
  v_fmac_f32 v7, v15, v15
  v_lshlrev_b32 v8, 16, v104
  s_waitcnt lgkmcnt(6)
  v_mfma_f32_32x32x16_bf16 v[240:255], a[28:31], v[84:87], v[240:255]
  s_add_u32 s1, s8, 59392
  ds_read_b64_tr_b16 a[24:25], v3 offset:50688
  ds_read_b64_tr_b16 a[26:27], v3 offset:54784
  buffer_load_dwordx4 v2, s[44:47], s1 offen offset:1024 lds
  v_mfma_f32_32x32x16_bf16 v[128:143], a[0:3], v[88:91], v[128:143]
  ds_read_b64_tr_b16 a[28:29], v3 offset:50944
  ds_read_b64_tr_b16 a[30:31], v3 offset:55040
  v_and_b32 v9, 0xffff0000, v104
  v_sub_f32 v8, v8, v5
  v_sub_f32 v9, v9, v5
  v_cvt_pk_bf16_f32 v104, v8, v9
  v_mfma_f32_32x32x16_bf16 v[144:159], a[4:7], v[88:91], v[144:159]
  ds_read_b64_tr_b16 a[0:1], v3 offset:51200
  ds_read_b64_tr_b16 a[2:3], v3 offset:55296
  v_fmac_f32 v6, v8, v8
  v_fmac_f32 v7, v9, v9
  v_lshlrev_b32 v10, 16, v105
  v_and_b32 v11, 0xffff0000, v105
  v_mfma_f32_32x32x16_bf16 v[160:175], a[8:11], v[88:91], v[160:175]
  ds_read_b64_tr_b16 a[4:5], v3 offset:51456
  ds_read_b64_tr_b16 a[6:7], v3 offset:55552
  v_sub_f32 v10, v10, v5
  v_sub_f32 v11, v11, v5
  v_cvt_pk_bf16_f32 v105, v10, v11
  v_fmac_f32 v6, v10, v10
  s_waitcnt lgkmcnt(6)
  v_mfma_f32_32x32x16_bf16 v[176:191], a[12:15], v[88:91], v[176:191]
  s_add_u32 s1, s8, 115712
  ds_read_b64_tr_b16 a[8:9], v3 offset:51712
  ds_read_b64_tr_b16 a[10:11], v3 offset:55808
  buffer_load_dwordx4 v2, s[44:47], s1 offen offset:2048 lds
  v_mfma_f32_32x32x16_bf16 v[192:207], a[16:19], v[88:91], v[192:207]
  ds_read_b64_tr_b16 a[12:13], v3 offset:51968
  ds_read_b64_tr_b16 a[14:15], v3 offset:56064
  v_fmac_f32 v7, v11, v11
  v_lshlrev_b32 v12, 16, v106
  v_and_b32 v13, 0xffff0000, v106
  v_sub_f32 v12, v12, v5
  v_mfma_f32_32x32x16_bf16 v[208:223], a[20:23], v[88:91], v[208:223]
  ds_read_b64_tr_b16 a[16:17], v3 offset:52224
  ds_read_b64_tr_b16 a[18:19], v3 offset:56320
  v_sub_f32 v13, v13, v5
  v_cvt_pk_bf16_f32 v106, v12, v13
  v_fmac_f32 v6, v12, v12
  v_fmac_f32 v7, v13, v13
  v_mfma_f32_32x32x16_bf16 v[224:239], a[24:27], v[88:91], v[224:239]
  ds_read_b64_tr_b16 a[20:21], v3 offset:52480
  ds_read_b64_tr_b16 a[22:23], v3 offset:56576
  v_lshlrev_b32 v14, 16, v107
  v_and_b32 v15, 0xffff0000, v107
  v_sub_f32 v14, v14, v5
  v_sub_f32 v15, v15, v5
  s_waitcnt lgkmcnt(6)
  v_mfma_f32_32x32x16_bf16 v[240:255], a[28:31], v[88:91], v[240:255]
  s_add_u32 s1, s8, 172032
  ds_read_b64_tr_b16 a[24:25], v3 offset:52736
  ds_read_b64_tr_b16 a[26:27], v3 offset:56832
  buffer_load_dwordx4 v2, s[44:47], s1 offen offset:3072 lds
  v_mfma_f32_32x32x16_bf16 v[128:143], a[0:3], v[92:95], v[128:143]
  ds_read_b64_tr_b16 a[28:29], v3 offset:52992
  ds_read_b64_tr_b16 a[30:31], v3 offset:57088
  v_cvt_pk_bf16_f32 v107, v14, v15
  v_fmac_f32 v6, v14, v14
  v_fmac_f32 v7, v15, v15
  v_add_u32 v3, 0x00010000, v3
  v_mfma_f32_32x32x16_bf16 v[144:159], a[4:7], v[92:95], v[144:159]
  s_waitcnt vmcnt(22)
  s_barrier
  ds_read_b64_tr_b16 a[0:1], v3 offset:0
  ds_read_b64_tr_b16 a[2:3], v3 offset:4096
  v_lshlrev_b32 v8, 16, v108
  v_and_b32 v9, 0xffff0000, v108
  v_mfma_f32_32x32x16_bf16 v[160:175], a[8:11], v[92:95], v[160:175]
  ds_read_b64_tr_b16 a[4:5], v3 offset:256
  ds_read_b64_tr_b16 a[6:7], v3 offset:4352
  v_sub_f32 v8, v8, v5
  v_sub_f32 v9, v9, v5
  v_cvt_pk_bf16_f32 v108, v8, v9
  v_fmac_f32 v6, v8, v8
  s_waitcnt lgkmcnt(6)
  v_mfma_f32_32x32x16_bf16 v[176:191], a[12:15], v[92:95], v[176:191]
  s_add_u32 m0, s31, 16384
  s_add_u32 s6, s2, 0
  s_and_b32 s6, s6, 0x3ffff
  ds_read_b64_tr_b16 a[8:9], v3 offset:512
  ds_read_b64_tr_b16 a[10:11], v3 offset:4608
  buffer_load_dwordx4 v4, s[48:51], s6 offen offset:0 lds
  v_mfma_f32_32x32x16_bf16 v[192:207], a[16:19], v[92:95], v[192:207]
  ds_read_b64_tr_b16 a[12:13], v3 offset:768
  ds_read_b64_tr_b16 a[14:15], v3 offset:4864
  v_fmac_f32 v7, v9, v9
  v_lshlrev_b32 v10, 16, v109
  v_and_b32 v11, 0xffff0000, v109
  v_sub_f32 v10, v10, v5
  v_mfma_f32_32x32x16_bf16 v[208:223], a[20:23], v[92:95], v[208:223]
  ds_read_b64_tr_b16 a[16:17], v3 offset:1024
  ds_read_b64_tr_b16 a[18:19], v3 offset:5120
  v_sub_f32 v11, v11, v5
  v_cvt_pk_bf16_f32 v109, v10, v11
  v_fmac_f32 v6, v10, v10
  v_fmac_f32 v7, v11, v11
  v_mfma_f32_32x32x16_bf16 v[224:239], a[24:27], v[92:95], v[224:239]
  ds_read_b64_tr_b16 a[20:21], v3 offset:1280
  ds_read_b64_tr_b16 a[22:23], v3 offset:5376
  v_lshlrev_b32 v12, 16, v110
  v_and_b32 v13, 0xffff0000, v110
  v_sub_f32 v12, v12, v5
  v_sub_f32 v13, v13, v5
  s_waitcnt lgkmcnt(6)
  v_mfma_f32_32x32x16_bf16 v[240:255], a[28:31], v[92:95], v[240:255]
  ds_read_b64_tr_b16 a[24:25], v3 offset:1536
  ds_read_b64_tr_b16 a[26:27], v3 offset:5632
  buffer_load_dwordx4 v4, s[52:55], s6 offen offset:1024 lds
  v_cvt_pk_bf16_f32 v110, v12, v13
  v_mfma_f32_32x32x16_bf16 a[32:47], a[0:3], v[80:83], a[32:47]
  ds_read_b64_tr_b16 a[28:29], v3 offset:1792
  ds_read_b64_tr_b16 a[30:31], v3 offset:5888
  v_fmac_f32 v6, v12, v12
  v_fmac_f32 v7, v13, v13
  v_lshlrev_b32 v14, 16, v111
  v_and_b32 v15, 0xffff0000, v111
  v_mfma_f32_32x32x16_bf16 a[48:63], a[4:7], v[80:83], a[48:63]
  ds_read_b64_tr_b16 a[0:1], v3 offset:2048
  ds_read_b64_tr_b16 a[2:3], v3 offset:6144
  v_sub_f32 v14, v14, v5
  v_sub_f32 v15, v15, v5
  v_cvt_pk_bf16_f32 v111, v14, v15
  v_fmac_f32 v6, v14, v14
  v_mfma_f32_32x32x16_bf16 a[64:79], a[8:11], v[80:83], a[64:79]
  ds_read_b64_tr_b16 a[4:5], v3 offset:2304
  ds_read_b64_tr_b16 a[6:7], v3 offset:6400
  v_fmac_f32 v7, v15, v15
  v_lshlrev_b32 v8, 16, v112
  v_and_b32 v9, 0xffff0000, v112
  v_sub_f32 v8, v8, v5
  s_waitcnt lgkmcnt(6)
  v_mfma_f32_32x32x16_bf16 a[80:95], a[12:15], v[80:83], a[80:95]
  ds_read_b64_tr_b16 a[8:9], v3 offset:2560
  ds_read_b64_tr_b16 a[10:11], v3 offset:6656
  buffer_load_dwordx4 v4, s[56:59], s6 offen offset:2048 lds
  v_sub_f32 v9, v9, v5
  v_mfma_f32_32x32x16_bf16 a[32:47], a[16:19], v[84:87], a[32:47]
  ds_read_b64_tr_b16 a[12:13], v3 offset:2816
  ds_read_b64_tr_b16 a[14:15], v3 offset:6912
  v_cvt_pk_bf16_f32 v112, v8, v9
  v_fmac_f32 v6, v8, v8
  v_fmac_f32 v7, v9, v9
  v_lshlrev_b32 v10, 16, v113
  v_mfma_f32_32x32x16_bf16 a[48:63], a[20:23], v[84:87], a[48:63]
  ds_read_b64_tr_b16 a[16:17], v3 offset:3072
  ds_read_b64_tr_b16 a[18:19], v3 offset:7168
  v_and_b32 v11, 0xffff0000, v113
  v_sub_f32 v10, v10, v5
  v_sub_f32 v11, v11, v5
  v_cvt_pk_bf16_f32 v113, v10, v11
  v_mfma_f32_32x32x16_bf16 a[64:79], a[24:27], v[84:87], a[64:79]
  ds_read_b64_tr_b16 a[20:21], v3 offset:3328
  ds_read_b64_tr_b16 a[22:23], v3 offset:7424
  v_fmac_f32 v6, v10, v10
  v_fmac_f32 v7, v11, v11
  v_lshlrev_b32 v12, 16, v114
  v_and_b32 v13, 0xffff0000, v114
  s_waitcnt lgkmcnt(6)
  v_mfma_f32_32x32x16_bf16 a[80:95], a[28:31], v[84:87], a[80:95]
  ds_read_b64_tr_b16 a[24:25], v3 offset:3584
  ds_read_b64_tr_b16 a[26:27], v3 offset:7680
  buffer_load_dwordx4 v4, s[60:63], s6 offen offset:3072 lds
  v_sub_f32 v12, v12, v5
  v_mfma_f32_32x32x16_bf16 a[32:47], a[0:3], v[88:91], a[32:47]
  ds_read_b64_tr_b16 a[28:29], v3 offset:3840
  ds_read_b64_tr_b16 a[30:31], v3 offset:7936
  v_sub_f32 v13, v13, v5
  v_cvt_pk_bf16_f32 v114, v12, v13
  v_fmac_f32 v6, v12, v12
  v_fmac_f32 v7, v13, v13
  v_mfma_f32_32x32x16_bf16 a[48:63], a[4:7], v[88:91], a[48:63]
  ds_read_b64_tr_b16 a[0:1], v3 offset:16384
  ds_read_b64_tr_b16 a[2:3], v3 offset:20480
  v_lshlrev_b32 v14, 16, v115
  v_and_b32 v15, 0xffff0000, v115
  v_sub_f32 v14, v14, v5
  v_sub_f32 v15, v15, v5
  v_mfma_f32_32x32x16_bf16 a[64:79], a[8:11], v[88:91], a[64:79]
  ds_read_b64_tr_b16 a[4:5], v3 offset:16640
  ds_read_b64_tr_b16 a[6:7], v3 offset:20736
  v_cvt_pk_bf16_f32 v115, v14, v15
  v_fmac_f32 v6, v14, v14
  v_fmac_f32 v7, v15, v15
  v_lshlrev_b32 v8, 16, v116
  s_waitcnt lgkmcnt(6)
  v_mfma_f32_32x32x16_bf16 a[80:95], a[12:15], v[88:91], a[80:95]
  s_add_u32 m0, s31, 32768
  s_add_u32 s6, s2, 16384
  s_and_b32 s6, s6, 0x3ffff
  ds_read_b64_tr_b16 a[8:9], v3 offset:16896
  ds_read_b64_tr_b16 a[10:11], v3 offset:20992
  buffer_load_dwordx4 v4, s[48:51], s6 offen offset:0 lds
  v_mfma_f32_32x32x16_bf16 a[32:47], a[16:19], v[92:95], a[32:47]
  ds_read_b64_tr_b16 a[12:13], v3 offset:17152
  ds_read_b64_tr_b16 a[14:15], v3 offset:21248
  v_and_b32 v9, 0xffff0000, v116
  v_sub_f32 v8, v8, v5
  v_sub_f32 v9, v9, v5
  v_cvt_pk_bf16_f32 v116, v8, v9
  v_mfma_f32_32x32x16_bf16 a[48:63], a[20:23], v[92:95], a[48:63]
  ds_read_b64_tr_b16 a[16:17], v3 offset:17408
  ds_read_b64_tr_b16 a[18:19], v3 offset:21504
  v_fmac_f32 v6, v8, v8
  v_fmac_f32 v7, v9, v9
  v_lshlrev_b32 v10, 16, v117
  v_and_b32 v11, 0xffff0000, v117
  v_mfma_f32_32x32x16_bf16 a[64:79], a[24:27], v[92:95], a[64:79]
  ds_read_b64_tr_b16 a[20:21], v3 offset:17664
  ds_read_b64_tr_b16 a[22:23], v3 offset:21760
  v_sub_f32 v10, v10, v5
  v_sub_f32 v11, v11, v5
  v_cvt_pk_bf16_f32 v117, v10, v11
  v_fmac_f32 v6, v10, v10
  s_waitcnt lgkmcnt(6)
  v_mfma_f32_32x32x16_bf16 a[80:95], a[28:31], v[92:95], a[80:95]
  ds_read_b64_tr_b16 a[24:25], v3 offset:17920
  ds_read_b64_tr_b16 a[26:27], v3 offset:22016
  buffer_load_dwordx4 v4, s[52:55], s6 offen offset:1024 lds
  v_fmac_f32 v7, v11, v11
  v_mfma_f32_32x32x16_bf16 v[128:143], a[0:3], v[96:99], v[128:143]
  ds_read_b64_tr_b16 a[28:29], v3 offset:18176
  ds_read_b64_tr_b16 a[30:31], v3 offset:22272
  v_accvgpr_read_b32 v0, a249
  v_add_u32 v0, 7168, v0
  v_lshlrev_b32 v12, 16, v118
  v_and_b32 v13, 0xffff0000, v118
  v_mfma_f32_32x32x16_bf16 v[144:159], a[4:7], v[96:99], v[144:159]
  ds_read_b64_tr_b16 a[0:1], v3 offset:18432
  ds_read_b64_tr_b16 a[2:3], v3 offset:22528
  buffer_load_dword a255, v0, s[72:75], 0 offen offset:3584
  v_sub_f32 v12, v12, v5
  v_sub_f32 v13, v13, v5
  v_mfma_f32_32x32x16_bf16 v[160:175], a[8:11], v[96:99], v[160:175]
  ds_read_b64_tr_b16 a[4:5], v3 offset:18688
  ds_read_b64_tr_b16 a[6:7], v3 offset:22784
  v_cvt_pk_bf16_f32 v118, v12, v13
  v_fmac_f32 v6, v12, v12
  v_fmac_f32 v7, v13, v13
  v_lshlrev_b32 v14, 16, v119
  s_waitcnt lgkmcnt(6)
  v_mfma_f32_32x32x16_bf16 v[176:191], a[12:15], v[96:99], v[176:191]
  ds_read_b64_tr_b16 a[8:9], v3 offset:18944
  ds_read_b64_tr_b16 a[10:11], v3 offset:23040
  buffer_load_dwordx4 v4, s[56:59], s6 offen offset:2048 lds
  v_and_b32 v15, 0xffff0000, v119
  v_mfma_f32_32x32x16_bf16 v[192:207], a[16:19], v[96:99], v[192:207]
  ds_read_b64_tr_b16 a[12:13], v3 offset:19200
  ds_read_b64_tr_b16 a[14:15], v3 offset:23296
  v_sub_f32 v14, v14, v5
  v_sub_f32 v15, v15, v5
  v_cvt_pk_bf16_f32 v119, v14, v15
  v_fmac_f32 v6, v14, v14
  v_mfma_f32_32x32x16_bf16 v[208:223], a[20:23], v[96:99], v[208:223]
  ds_read_b64_tr_b16 a[16:17], v3 offset:19456
  ds_read_b64_tr_b16 a[18:19], v3 offset:23552
  v_fmac_f32 v7, v15, v15
  v_lshlrev_b32 v8, 16, v120
  v_and_b32 v9, 0xffff0000, v120
  v_sub_f32 v8, v8, v5
  v_mfma_f32_32x32x16_bf16 v[224:239], a[24:27], v[96:99], v[224:239]
  ds_read_b64_tr_b16 a[20:21], v3 offset:19712
  ds_read_b64_tr_b16 a[22:23], v3 offset:23808
  v_sub_f32 v9, v9, v5
  v_cvt_pk_bf16_f32 v120, v8, v9
  v_fmac_f32 v6, v8, v8
  v_fmac_f32 v7, v9, v9
  s_waitcnt lgkmcnt(6)
  v_mfma_f32_32x32x16_bf16 v[240:255], a[28:31], v[96:99], v[240:255]
  ds_read_b64_tr_b16 a[24:25], v3 offset:19968
  ds_read_b64_tr_b16 a[26:27], v3 offset:24064
  buffer_load_dwordx4 v4, s[60:63], s6 offen offset:3072 lds
  v_lshlrev_b32 v10, 16, v121
  v_mfma_f32_32x32x16_bf16 v[128:143], a[0:3], v[100:103], v[128:143]
  ds_read_b64_tr_b16 a[28:29], v3 offset:20224
  ds_read_b64_tr_b16 a[30:31], v3 offset:24320
  v_and_b32 v11, 0xffff0000, v121
  v_sub_f32 v10, v10, v5
  v_sub_f32 v11, v11, v5
  v_cvt_pk_bf16_f32 v121, v10, v11
  v_mfma_f32_32x32x16_bf16 v[144:159], a[4:7], v[100:103], v[144:159]
  s_waitcnt vmcnt(22)
  s_barrier
  ds_read_b64_tr_b16 a[0:1], v3 offset:32768
  ds_read_b64_tr_b16 a[2:3], v3 offset:36864
  v_fmac_f32 v6, v10, v10
  v_fmac_f32 v7, v11, v11
  v_mfma_f32_32x32x16_bf16 v[160:175], a[8:11], v[100:103], v[160:175]
  ds_read_b64_tr_b16 a[4:5], v3 offset:33024
  ds_read_b64_tr_b16 a[6:7], v3 offset:37120
  v_lshlrev_b32 v12, 16, v122
  v_and_b32 v13, 0xffff0000, v122
  v_sub_f32 v12, v12, v5
  v_sub_f32 v13, v13, v5
  s_waitcnt lgkmcnt(6)
  v_mfma_f32_32x32x16_bf16 v[176:191], a[12:15], v[100:103], v[176:191]
  s_add_u32 m0, s31, 49152
  s_add_u32 s6, s2, 32768
  s_and_b32 s6, s6, 0x3ffff
  ds_read_b64_tr_b16 a[8:9], v3 offset:33280
  ds_read_b64_tr_b16 a[10:11], v3 offset:37376
  buffer_load_dwordx4 v4, s[48:51], s6 offen offset:0 lds
  v_mfma_f32_32x32x16_bf16 v[192:207], a[16:19], v[100:103], v[192:207]
  ds_read_b64_tr_b16 a[12:13], v3 offset:33536
  ds_read_b64_tr_b16 a[14:15], v3 offset:37632
  v_cvt_pk_bf16_f32 v122, v12, v13
  v_fmac_f32 v6, v12, v12
  v_fmac_f32 v7, v13, v13
  v_lshlrev_b32 v14, 16, v123
  v_mfma_f32_32x32x16_bf16 v[208:223], a[20:23], v[100:103], v[208:223]
  ds_read_b64_tr_b16 a[16:17], v3 offset:33792
  ds_read_b64_tr_b16 a[18:19], v3 offset:37888
  v_and_b32 v15, 0xffff0000, v123
  v_sub_f32 v14, v14, v5
  v_sub_f32 v15, v15, v5
  v_cvt_pk_bf16_f32 v123, v14, v15
  v_mfma_f32_32x32x16_bf16 v[224:239], a[24:27], v[100:103], v[224:239]
  ds_read_b64_tr_b16 a[20:21], v3 offset:34048
  ds_read_b64_tr_b16 a[22:23], v3 offset:38144
  v_fmac_f32 v6, v14, v14
  v_fmac_f32 v7, v15, v15
  v_lshlrev_b32 v8, 16, v124
  v_and_b32 v9, 0xffff0000, v124
  s_waitcnt lgkmcnt(6)
  v_mfma_f32_32x32x16_bf16 v[240:255], a[28:31], v[100:103], v[240:255]
  ds_read_b64_tr_b16 a[24:25], v3 offset:34304
  ds_read_b64_tr_b16 a[26:27], v3 offset:38400
  buffer_load_dwordx4 v4, s[52:55], s6 offen offset:1024 lds
  v_sub_f32 v8, v8, v5
  v_mfma_f32_32x32x16_bf16 v[128:143], a[0:3], v[104:107], v[128:143]
  ds_read_b64_tr_b16 a[28:29], v3 offset:34560
  ds_read_b64_tr_b16 a[30:31], v3 offset:38656
  v_sub_f32 v9, v9, v5
  v_cvt_pk_bf16_f32 v124, v8, v9
  v_fmac_f32 v6, v8, v8
  v_fmac_f32 v7, v9, v9
  v_mfma_f32_32x32x16_bf16 v[144:159], a[4:7], v[104:107], v[144:159]
  ds_read_b64_tr_b16 a[0:1], v3 offset:34816
  ds_read_b64_tr_b16 a[2:3], v3 offset:38912
  v_lshlrev_b32 v10, 16, v125
  v_and_b32 v11, 0xffff0000, v125
  v_sub_f32 v10, v10, v5
  v_sub_f32 v11, v11, v5
  v_mfma_f32_32x32x16_bf16 v[160:175], a[8:11], v[104:107], v[160:175]
  ds_read_b64_tr_b16 a[4:5], v3 offset:35072
  ds_read_b64_tr_b16 a[6:7], v3 offset:39168
  v_cvt_pk_bf16_f32 v125, v10, v11
  v_fmac_f32 v6, v10, v10
  v_fmac_f32 v7, v11, v11
  v_lshlrev_b32 v12, 16, v126
  s_waitcnt lgkmcnt(6)
  v_mfma_f32_32x32x16_bf16 v[176:191], a[12:15], v[104:107], v[176:191]
  ds_read_b64_tr_b16 a[8:9], v3 offset:35328
  ds_read_b64_tr_b16 a[10:11], v3 offset:39424
  buffer_load_dwordx4 v4, s[56:59], s6 offen offset:2048 lds
  v_and_b32 v13, 0xffff0000, v126
  v_mfma_f32_32x32x16_bf16 v[192:207], a[16:19], v[104:107], v[192:207]
  ds_read_b64_tr_b16 a[12:13], v3 offset:35584
  ds_read_b64_tr_b16 a[14:15], v3 offset:39680
  v_sub_f32 v12, v12, v5
  v_sub_f32 v13, v13, v5
  v_cvt_pk_bf16_f32 v126, v12, v13
  v_fmac_f32 v6, v12, v12
  v_mfma_f32_32x32x16_bf16 v[208:223], a[20:23], v[104:107], v[208:223]
  ds_read_b64_tr_b16 a[16:17], v3 offset:35840
  ds_read_b64_tr_b16 a[18:19], v3 offset:39936
  v_fmac_f32 v7, v13, v13
  v_lshlrev_b32 v14, 16, v127
  v_and_b32 v15, 0xffff0000, v127
  v_sub_f32 v14, v14, v5
  v_mfma_f32_32x32x16_bf16 v[224:239], a[24:27], v[104:107], v[224:239]
  ds_read_b64_tr_b16 a[20:21], v3 offset:36096
  ds_read_b64_tr_b16 a[22:23], v3 offset:40192
  v_sub_f32 v15, v15, v5
  v_cvt_pk_bf16_f32 v127, v14, v15
  v_fmac_f32 v6, v14, v14
  v_fmac_f32 v7, v15, v15
  s_waitcnt lgkmcnt(6)
  v_mfma_f32_32x32x16_bf16 v[240:255], a[28:31], v[104:107], v[240:255]
  ds_read_b64_tr_b16 a[24:25], v3 offset:36352
  ds_read_b64_tr_b16 a[26:27], v3 offset:40448
  buffer_load_dwordx4 v4, s[60:63], s6 offen offset:3072 lds
  v_accvgpr_read_b32 v2, a243
  v_mfma_f32_32x32x16_bf16 v[128:143], a[0:3], v[108:111], v[128:143]
  ds_read_b64_tr_b16 a[28:29], v3 offset:36608
  ds_read_b64_tr_b16 a[30:31], v3 offset:40704
  v_accvgpr_read_b32 v1, a242
  v_mfma_f32_32x32x16_bf16 v[144:159], a[4:7], v[108:111], v[144:159]
  ds_read_b64_tr_b16 a[0:1], v3 offset:49152
  ds_read_b64_tr_b16 a[2:3], v3 offset:53248
  v_mfma_f32_32x32x16_bf16 v[160:175], a[8:11], v[108:111], v[160:175]
  ds_read_b64_tr_b16 a[4:5], v3 offset:49408
  ds_read_b64_tr_b16 a[6:7], v3 offset:53504
  s_waitcnt lgkmcnt(6)
  v_mfma_f32_32x32x16_bf16 v[176:191], a[12:15], v[108:111], v[176:191]
  s_add_u32 m0, s31, 65536
  s_add_u32 s6, s2, 49152
  s_and_b32 s6, s6, 0x3ffff
  ds_read_b64_tr_b16 a[8:9], v3 offset:49664
  ds_read_b64_tr_b16 a[10:11], v3 offset:53760
  buffer_load_dwordx4 v4, s[48:51], s6 offen offset:0 lds
  v_mfma_f32_32x32x16_bf16 v[192:207], a[16:19], v[108:111], v[192:207]
  ds_read_b64_tr_b16 a[12:13], v3 offset:49920
  ds_read_b64_tr_b16 a[14:15], v3 offset:54016
  v_mfma_f32_32x32x16_bf16 v[208:223], a[20:23], v[108:111], v[208:223]
  ds_read_b64_tr_b16 a[16:17], v3 offset:50176
  ds_read_b64_tr_b16 a[18:19], v3 offset:54272
  v_mfma_f32_32x32x16_bf16 v[224:239], a[24:27], v[108:111], v[224:239]
  ds_read_b64_tr_b16 a[20:21], v3 offset:50432
L_padh3:
  s_cbranch_execz L_padh7
  ds_read_b64_tr_b16 a[22:23], v3 offset:54528
  s_waitcnt lgkmcnt(6)
  v_mfma_f32_32x32x16_bf16 v[240:255], a[28:31], v[108:111], v[240:255]
  ds_read_b64_tr_b16 a[24:25], v3 offset:50688
  ds_read_b64_tr_b16 a[26:27], v3 offset:54784
  buffer_load_dwordx4 v4, s[52:55], s6 offen offset:1024 lds
  v_mfma_f32_32x32x16_bf16 a[32:47], a[0:3], v[96:99], a[32:47]
  ds_read_b64_tr_b16 a[28:29], v3 offset:50944
  ds_read_b64_tr_b16 a[30:31], v3 offset:55040
  v_mfma_f32_32x32x16_bf16 a[48:63], a[4:7], v[96:99], a[48:63]
  ds_read_b64_tr_b16 a[0:1], v3 offset:51200
  ds_read_b64_tr_b16 a[2:3], v3 offset:55296
  v_mfma_f32_32x32x16_bf16 a[64:79], a[8:11], v[96:99], a[64:79]
  ds_read_b64_tr_b16 a[4:5], v3 offset:51456
  ds_read_b64_tr_b16 a[6:7], v3 offset:55552
  s_waitcnt lgkmcnt(6)
  v_mfma_f32_32x32x16_bf16 a[80:95], a[12:15], v[96:99], a[80:95]
  ds_read_b64_tr_b16 a[8:9], v3 offset:51712
  ds_read_b64_tr_b16 a[10:11], v3 offset:55808
  buffer_load_dwordx4 v4, s[56:59], s6 offen offset:2048 lds
  v_mfma_f32_32x32x16_bf16 a[32:47], a[16:19], v[100:103], a[32:47]
  ds_read_b64_tr_b16 a[12:13], v3 offset:51968
  ds_read_b64_tr_b16 a[14:15], v3 offset:56064
  v_mfma_f32_32x32x16_bf16 a[48:63], a[20:23], v[100:103], a[48:63]
  ds_read_b64_tr_b16 a[16:17], v3 offset:52224
  ds_read_b64_tr_b16 a[18:19], v3 offset:56320
  v_mfma_f32_32x32x16_bf16 a[64:79], a[24:27], v[100:103], a[64:79]
  ds_read_b64_tr_b16 a[20:21], v3 offset:52480
  ds_read_b64_tr_b16 a[22:23], v3 offset:56576
  s_waitcnt lgkmcnt(6)
  v_mfma_f32_32x32x16_bf16 a[80:95], a[28:31], v[100:103], a[80:95]
  ds_read_b64_tr_b16 a[24:25], v3 offset:52736
  ds_read_b64_tr_b16 a[26:27], v3 offset:56832
  buffer_load_dwordx4 v4, s[60:63], s6 offen offset:3072 lds
  v_mfma_f32_32x32x16_bf16 a[32:47], a[0:3], v[104:107], a[32:47]
  ds_read_b64_tr_b16 a[28:29], v3 offset:52992
  ds_read_b64_tr_b16 a[30:31], v3 offset:57088
  v_accvgpr_read_b32 v0, a250
  v_add_u32 v3, 0x00010000, v3
  v_mfma_f32_32x32x16_bf16 a[48:63], a[4:7], v[104:107], a[48:63]
  s_waitcnt vmcnt(22)
  s_barrier
  ds_read_b64_tr_b16 a[0:1], v3 offset:0
  ds_read_b64_tr_b16 a[2:3], v3 offset:4096
  buffer_load_dword a252, v0, s[32:35], 0 offen offset:0
  v_mfma_f32_32x32x16_bf16 a[64:79], a[8:11], v[104:107], a[64:79]
  ds_read_b64_tr_b16 a[4:5], v3 offset:256
  ds_read_b64_tr_b16 a[6:7], v3 offset:4352
  s_waitcnt lgkmcnt(6)
  v_mfma_f32_32x32x16_bf16 a[80:95], a[12:15], v[104:107], a[80:95]
  s_add_u32 m0, s31, 81920
  s_add_u32 s6, s2, 65536
  s_and_b32 s6, s6, 0x3ffff
  ds_read_b64_tr_b16 a[8:9], v3 offset:512
  ds_read_b64_tr_b16 a[10:11], v3 offset:4608
  buffer_load_dwordx4 v4, s[48:51], s6 offen offset:0 lds
  v_mfma_f32_32x32x16_bf16 a[32:47], a[16:19], v[108:111], a[32:47]
  ds_read_b64_tr_b16 a[12:13], v3 offset:768
  ds_read_b64_tr_b16 a[14:15], v3 offset:4864
  v_mfma_f32_32x32x16_bf16 a[48:63], a[20:23], v[108:111], a[48:63]
  ds_read_b64_tr_b16 a[16:17], v3 offset:1024
  ds_read_b64_tr_b16 a[18:19], v3 offset:5120
  v_mfma_f32_32x32x16_bf16 a[64:79], a[24:27], v[108:111], a[64:79]
  ds_read_b64_tr_b16 a[20:21], v3 offset:1280
  ds_read_b64_tr_b16 a[22:23], v3 offset:5376
  s_waitcnt lgkmcnt(6)
  v_mfma_f32_32x32x16_bf16 a[80:95], a[28:31], v[108:111], a[80:95]
  ds_read_b64_tr_b16 a[24:25], v3 offset:1536
  ds_read_b64_tr_b16 a[26:27], v3 offset:5632
  buffer_load_dwordx4 v4, s[52:55], s6 offen offset:1024 lds
  v_mfma_f32_32x32x16_bf16 v[128:143], a[0:3], v[112:115], v[128:143]
  ds_read_b64_tr_b16 a[28:29], v3 offset:1792
  ds_read_b64_tr_b16 a[30:31], v3 offset:5888
  v_mfma_f32_32x32x16_bf16 v[144:159], a[4:7], v[112:115], v[144:159]
  ds_read_b64_tr_b16 a[0:1], v3 offset:2048
  ds_read_b64_tr_b16 a[2:3], v3 offset:6144
  v_mfma_f32_32x32x16_bf16 v[160:175], a[8:11], v[112:115], v[160:175]
  ds_read_b64_tr_b16 a[4:5], v3 offset:2304
  ds_read_b64_tr_b16 a[6:7], v3 offset:6400
  s_waitcnt lgkmcnt(6)
  v_mfma_f32_32x32x16_bf16 v[176:191], a[12:15], v[112:115], v[176:191]
  ds_read_b64_tr_b16 a[8:9], v3 offset:2560
  ds_read_b64_tr_b16 a[10:11], v3 offset:6656
  buffer_load_dwordx4 v4, s[56:59], s6 offen offset:2048 lds
  v_mfma_f32_32x32x16_bf16 v[192:207], a[16:19], v[112:115], v[192:207]
  ds_read_b64_tr_b16 a[12:13], v3 offset:2816
  ds_read_b64_tr_b16 a[14:15], v3 offset:6912
  v_mfma_f32_32x32x16_bf16 v[208:223], a[20:23], v[112:115], v[208:223]
  ds_read_b64_tr_b16 a[16:17], v3 offset:3072
  ds_read_b64_tr_b16 a[18:19], v3 offset:7168
  v_mfma_f32_32x32x16_bf16 v[224:239], a[24:27], v[112:115], v[224:239]
  ds_read_b64_tr_b16 a[20:21], v3 offset:3328
  ds_read_b64_tr_b16 a[22:23], v3 offset:7424
  s_waitcnt lgkmcnt(6)
  v_mfma_f32_32x32x16_bf16 v[240:255], a[28:31], v[112:115], v[240:255]
  ds_read_b64_tr_b16 a[24:25], v3 offset:3584
  ds_read_b64_tr_b16 a[26:27], v3 offset:7680
  buffer_load_dwordx4 v4, s[60:63], s6 offen offset:3072 lds
  v_mfma_f32_32x32x16_bf16 v[128:143], a[0:3], v[116:119], v[128:143]
  ds_read_b64_tr_b16 a[28:29], v3 offset:3840
  ds_read_b64_tr_b16 a[30:31], v3 offset:7936
  v_mfma_f32_32x32x16_bf16 v[144:159], a[4:7], v[116:119], v[144:159]
  ds_read_b64_tr_b16 a[0:1], v3 offset:16384
  ds_read_b64_tr_b16 a[2:3], v3 offset:20480
  v_mfma_f32_32x32x16_bf16 v[160:175], a[8:11], v[116:119], v[160:175]
  ds_read_b64_tr_b16 a[4:5], v3 offset:16640
  ds_read_b64_tr_b16 a[6:7], v3 offset:20736
  s_waitcnt lgkmcnt(6)
  v_mfma_f32_32x32x16_bf16 v[176:191], a[12:15], v[116:119], v[176:191]
  s_add_u32 m0, s31, 98304
  s_add_u32 s6, s2, 81920
  s_and_b32 s6, s6, 0x3ffff
  ds_read_b64_tr_b16 a[8:9], v3 offset:16896
  ds_read_b64_tr_b16 a[10:11], v3 offset:20992
  buffer_load_dwordx4 v4, s[48:51], s6 offen offset:0 lds
  v_mfma_f32_32x32x16_bf16 v[192:207], a[16:19], v[116:119], v[192:207]
  ds_read_b64_tr_b16 a[12:13], v3 offset:17152
  ds_read_b64_tr_b16 a[14:15], v3 offset:21248
  v_mfma_f32_32x32x16_bf16 v[208:223], a[20:23], v[116:119], v[208:223]
  ds_read_b64_tr_b16 a[16:17], v3 offset:17408
  ds_read_b64_tr_b16 a[18:19], v3 offset:21504
  v_mfma_f32_32x32x16_bf16 v[224:239], a[24:27], v[116:119], v[224:239]
  ds_read_b64_tr_b16 a[20:21], v3 offset:17664
  ds_read_b64_tr_b16 a[22:23], v3 offset:21760
  s_waitcnt lgkmcnt(6)
  v_mfma_f32_32x32x16_bf16 v[240:255], a[28:31], v[116:119], v[240:255]
  ds_read_b64_tr_b16 a[24:25], v3 offset:17920
  ds_read_b64_tr_b16 a[26:27], v3 offset:22016
  buffer_load_dwordx4 v4, s[52:55], s6 offen offset:1024 lds
  v_mfma_f32_32x32x16_bf16 v[128:143], a[0:3], v[120:123], v[128:143]
  ds_read_b64_tr_b16 a[28:29], v3 offset:18176
  ds_read_b64_tr_b16 a[30:31], v3 offset:22272
  v_mfma_f32_32x32x16_bf16 v[144:159], a[4:7], v[120:123], v[144:159]
  ds_read_b64_tr_b16 a[0:1], v3 offset:18432
  ds_read_b64_tr_b16 a[2:3], v3 offset:22528
  v_mfma_f32_32x32x16_bf16 v[160:175], a[8:11], v[120:123], v[160:175]
  ds_read_b64_tr_b16 a[4:5], v3 offset:18688
  ds_read_b64_tr_b16 a[6:7], v3 offset:22784
  s_waitcnt lgkmcnt(6)
  v_mfma_f32_32x32x16_bf16 v[176:191], a[12:15], v[120:123], v[176:191]
  ds_read_b64_tr_b16 a[8:9], v3 offset:18944
  ds_read_b64_tr_b16 a[10:11], v3 offset:23040
  buffer_load_dwordx4 v4, s[56:59], s6 offen offset:2048 lds
  v_mfma_f32_32x32x16_bf16 v[192:207], a[16:19], v[120:123], v[192:207]
  ds_read_b64_tr_b16 a[12:13], v3 offset:19200
  ds_read_b64_tr_b16 a[14:15], v3 offset:23296
  v_mfma_f32_32x32x16_bf16 v[208:223], a[20:23], v[120:123], v[208:223]
  ds_read_b64_tr_b16 a[16:17], v3 offset:19456
  ds_read_b64_tr_b16 a[18:19], v3 offset:23552
  v_mfma_f32_32x32x16_bf16 v[224:239], a[24:27], v[120:123], v[224:239]
  ds_read_b64_tr_b16 a[20:21], v3 offset:19712
  ds_read_b64_tr_b16 a[22:23], v3 offset:23808
  s_waitcnt lgkmcnt(6)
  v_mfma_f32_32x32x16_bf16 v[240:255], a[28:31], v[120:123], v[240:255]
  ds_read_b64_tr_b16 a[24:25], v3 offset:19968
  ds_read_b64_tr_b16 a[26:27], v3 offset:24064
  buffer_load_dwordx4 v4, s[60:63], s6 offen offset:3072 lds
  v_mfma_f32_32x32x16_bf16 v[128:143], a[0:3], v[124:127], v[128:143]
  ds_read_b64_tr_b16 a[28:29], v3 offset:20224
  ds_read_b64_tr_b16 a[30:31], v3 offset:24320
  v_accvgpr_read_b32 v8, a244
  v_accvgpr_read_b32 v9, a245
  v_add_u32 v3, 0xfffe0000, v3
  v_mfma_f32_32x32x16_bf16 v[144:159], a[4:7], v[124:127], v[144:159]
  s_waitcnt vmcnt(22)
  s_barrier
  ds_read_b64_tr_b16 a[0:1], v3 offset:0
  ds_read_b64_tr_b16 a[2:3], v3 offset:4096
  v_mfma_f32_32x32x16_bf16 v[160:175], a[8:11], v[124:127], v[160:175]
  ds_read_b64_tr_b16 a[4:5], v3 offset:256
  ds_read_b64_tr_b16 a[6:7], v3 offset:4352
  s_waitcnt lgkmcnt(6)
  v_mfma_f32_32x32x16_bf16 v[176:191], a[12:15], v[124:127], v[176:191]
  s_add_u32 m0, s31, 114688
  s_add_u32 s6, s2, 98304
  s_and_b32 s6, s6, 0x3ffff
  ds_read_b64_tr_b16 a[8:9], v3 offset:512
  ds_read_b64_tr_b16 a[10:11], v3 offset:4608
  buffer_load_dwordx4 v4, s[48:51], s6 offen offset:0 lds
  v_mfma_f32_32x32x16_bf16 v[192:207], a[16:19], v[124:127], v[192:207]
  ds_read_b64_tr_b16 a[12:13], v3 offset:768
  ds_read_b64_tr_b16 a[14:15], v3 offset:4864
  v_add_f32 v10, v6, v7
  v_mov_b32 v11, v10
  s_nop 1
  v_permlane32_swap_b32 v10, v11
  v_add_f32 v10, v10, v11
  v_mfma_f32_32x32x16_bf16 v[208:223], a[20:23], v[124:127], v[208:223]
  ds_read_b64_tr_b16 a[16:17], v3 offset:1024
  ds_read_b64_tr_b16 a[18:19], v3 offset:5120
  v_mul_f32 v10, 0x3b124925, v10
  v_cvt_pk_bf16_f32 v10, v10, v10
  v_and_b32 v10, 0xffff0000, v10
  v_add_f32 v10, 0x3727c5ac, v10
  v_mfma_f32_32x32x16_bf16 v[224:239], a[24:27], v[124:127], v[224:239]
  ds_read_b64_tr_b16 a[20:21], v3 offset:1280
  ds_read_b64_tr_b16 a[22:23], v3 offset:5376
  v_cvt_pk_bf16_f32 v10, v10, v10
  v_and_b32 v10, 0xffff0000, v10
  v_sqrt_f32 v10, v10
  s_waitcnt lgkmcnt(6)
  v_mfma_f32_32x32x16_bf16 v[240:255], a[28:31], v[124:127], v[240:255]
  ds_read_b64_tr_b16 a[24:25], v3 offset:1536
  ds_read_b64_tr_b16 a[26:27], v3 offset:5632
  buffer_load_dwordx4 v4, s[52:55], s6 offen offset:1024 lds
  v_cvt_pk_bf16_f32 v12, v10, v10
  v_mfma_f32_32x32x16_bf16 a[32:47], a[0:3], v[112:115], a[32:47]
  ds_read_b64_tr_b16 a[28:29], v3 offset:1792
  ds_read_b64_tr_b16 a[30:31], v3 offset:5888
  v_accvgpr_read_b32 v0, a250
  v_and_b32 v10, 0xffff0000, v12
  v_rcp_f32 v10, v10
  v_mfma_f32_32x32x16_bf16 a[48:63], a[4:7], v[112:115], a[48:63]
  ds_read_b64_tr_b16 a[0:1], v3 offset:2048
  ds_read_b64_tr_b16 a[2:3], v3 offset:6144
  buffer_load_dword a253, v0, s[32:35], 0 offen offset:3584
  v_mov_b32 v13, v12
  v_mov_b32 v14, v12
  v_mfma_f32_32x32x16_bf16 a[64:79], a[8:11], v[112:115], a[64:79]
  ds_read_b64_tr_b16 a[4:5], v3 offset:2304
  ds_read_b64_tr_b16 a[6:7], v3 offset:6400
  v_mov_b32 v15, v12
  v_mul_f32 v5, 0x3db8aa3b, v10
  v_mul_f32 v6, 0xc0135761, v10
  v_mov_b32 v7, 0xff800000
  s_waitcnt lgkmcnt(6)
  v_mfma_f32_32x32x16_bf16 a[80:95], a[12:15], v[112:115], a[80:95]
  ds_read_b64_tr_b16 a[8:9], v3 offset:2560
  ds_read_b64_tr_b16 a[10:11], v3 offset:6656
  buffer_load_dwordx4 v4, s[56:59], s6 offen offset:2048 lds
  v_cvt_pk_bf16_f32 v128, v128, v129
  v_mfma_f32_32x32x16_bf16 a[32:47], a[16:19], v[116:119], a[32:47]
  ds_read_b64_tr_b16 a[12:13], v3 offset:2816
  ds_read_b64_tr_b16 a[14:15], v3 offset:6912
  v_cvt_pk_bf16_f32 v129, v130, v131
  v_cvt_pk_bf16_f32 v130, v132, v133
  v_cvt_pk_bf16_f32 v131, v134, v135
  v_cvt_pk_bf16_f32 v132, v136, v137
  v_mfma_f32_32x32x16_bf16 a[48:63], a[20:23], v[116:119], a[48:63]
  ds_read_b64_tr_b16 a[16:17], v3 offset:3072
  ds_read_b64_tr_b16 a[18:19], v3 offset:7168
  v_cvt_pk_bf16_f32 v133, v138, v139
  v_cvt_pk_bf16_f32 v134, v140, v141
  v_cvt_pk_bf16_f32 v135, v142, v143
  v_accvgpr_write_b32 a96, v128
  v_mfma_f32_32x32x16_bf16 a[64:79], a[24:27], v[116:119], a[64:79]
  ds_read_b64_tr_b16 a[20:21], v3 offset:3328
  ds_read_b64_tr_b16 a[22:23], v3 offset:7424
  v_accvgpr_write_b32 a97, v129
  v_accvgpr_write_b32 a98, v130
  v_accvgpr_write_b32 a99, v131
  v_accvgpr_write_b32 a100, v132
  s_waitcnt lgkmcnt(6)
  v_mfma_f32_32x32x16_bf16 a[80:95], a[28:31], v[116:119], a[80:95]
  ds_read_b64_tr_b16 a[24:25], v3 offset:3584
  ds_read_b64_tr_b16 a[26:27], v3 offset:7680
  buffer_load_dwordx4 v4, s[60:63], s6 offen offset:3072 lds
  v_accvgpr_write_b32 a101, v133
  v_mfma_f32_32x32x16_bf16 a[32:47], a[0:3], v[120:123], a[32:47]
  ds_read_b64_tr_b16 a[28:29], v3 offset:3840
  ds_read_b64_tr_b16 a[30:31], v3 offset:7936
  v_accvgpr_write_b32 a102, v134
  v_accvgpr_write_b32 a103, v135
  v_cvt_pk_bf16_f32 v144, v144, v145
  v_cvt_pk_bf16_f32 v145, v146, v147
  v_mfma_f32_32x32x16_bf16 a[48:63], a[4:7], v[120:123], a[48:63]
  v_cvt_pk_bf16_f32 v146, v148, v149
  v_cvt_pk_bf16_f32 v147, v150, v151
  v_cvt_pk_bf16_f32 v148, v152, v153
  v_cvt_pk_bf16_f32 v149, v154, v155
  v_cvt_pk_bf16_f32 v150, v156, v157
  v_cvt_pk_bf16_f32 v151, v158, v159
  v_mfma_f32_32x32x16_bf16 a[64:79], a[8:11], v[120:123], a[64:79]
  v_accvgpr_write_b32 a104, v144
  v_accvgpr_write_b32 a105, v145
  v_accvgpr_write_b32 a106, v146
  v_accvgpr_write_b32 a107, v147
  v_accvgpr_write_b32 a108, v148
  v_accvgpr_write_b32 a109, v149
  s_waitcnt lgkmcnt(2)
  v_mfma_f32_32x32x16_bf16 a[80:95], a[12:15], v[120:123], a[80:95]
  s_add_u32 m0, s31, 131072
  s_add_u32 s6, s2, 114688
  s_and_b32 s6, s6, 0x3ffff
  buffer_load_dwordx4 v4, s[48:51], s6 offen offset:0 lds
  v_mfma_f32_32x32x16_bf16 a[32:47], a[16:19], v[124:127], a[32:47]
  v_accvgpr_write_b32 a110, v150
  v_accvgpr_write_b32 a111, v151
  v_cvt_pk_bf16_f32 v160, v160, v161
  v_cvt_pk_bf16_f32 v161, v162, v163
  v_cvt_pk_bf16_f32 v162, v164, v165
  v_cvt_pk_bf16_f32 v163, v166, v167
  v_mfma_f32_32x32x16_bf16 a[48:63], a[20:23], v[124:127], a[48:63]
  ds_read_b128 a[0:3], v8 offset:16384
  v_cvt_pk_bf16_f32 v164, v168, v169
  v_cvt_pk_bf16_f32 v165, v170, v171
  v_cvt_pk_bf16_f32 v166, v172, v173
  v_cvt_pk_bf16_f32 v167, v174, v175
  v_accvgpr_write_b32 a112, v160
  v_mfma_f32_32x32x16_bf16 a[64:79], a[24:27], v[124:127], a[64:79]
  ds_read_b128 a[4:7], v9 offset:16384
  v_accvgpr_write_b32 a113, v161
  v_accvgpr_write_b32 a114, v162
  v_accvgpr_write_b32 a115, v163
  v_accvgpr_write_b32 a116, v164
  v_accvgpr_write_b32 a117, v165
  s_waitcnt lgkmcnt(2)
  v_mfma_f32_32x32x16_bf16 a[80:95], a[28:31], v[124:127], a[80:95]
  ds_read_b128 a[8:11], v8 offset:16640
  buffer_load_dwordx4 v4, s[52:55], s6 offen offset:1024 lds
  v_accvgpr_write_b32 a118, v166
  v_accvgpr_write_b32 a119, v167
  v_mfma_f32_32x32x16_bf16 a[32:47], a[224:227], v[12:15], a[32:47]
  ds_read_b128 a[12:15], v9 offset:16640
  v_cvt_pk_bf16_f32 v176, v176, v177
  v_cvt_pk_bf16_f32 v177, v178, v179
  v_cvt_pk_bf16_f32 v178, v180, v181
  v_cvt_pk_bf16_f32 v179, v182, v183
  v_cvt_pk_bf16_f32 v180, v184, v185
  v_mfma_f32_32x32x16_bf16 a[48:63], a[228:231], v[12:15], a[48:63]
  ds_read_b128 a[16:19], v8 offset:17408
  v_cvt_pk_bf16_f32 v181, v186, v187
  v_cvt_pk_bf16_f32 v182, v188, v189
  v_cvt_pk_bf16_f32 v183, v190, v191
  v_accvgpr_write_b32 a120, v176
  v_accvgpr_write_b32 a121, v177
  v_mfma_f32_32x32x16_bf16 a[64:79], a[232:235], v[12:15], a[64:79]
  ds_read_b128 a[20:23], v9 offset:17408
  v_accvgpr_write_b32 a122, v178
  v_accvgpr_write_b32 a123, v179
  v_accvgpr_write_b32 a124, v180
  v_accvgpr_write_b32 a125, v181
  v_accvgpr_write_b32 a126, v182
  v_mfma_f32_32x32x16_bf16 a[80:95], a[236:239], v[12:15], a[80:95]
  ds_read_b128 a[24:27], v8 offset:17664
  buffer_load_dwordx4 v4, s[56:59], s6 offen offset:2048 lds
  v_accvgpr_write_b32 a127, v183
  v_cvt_pk_bf16_f32 v192, v192, v193
  s_waitcnt lgkmcnt(3)
  v_mfma_f32_32x32x16_bf16 v[16:31], a[0:3], a[96:99], 0
  ds_read_b128 a[28:31], v9 offset:17664
  v_cvt_pk_bf16_f32 v193, v194, v195
  v_cvt_pk_bf16_f32 v194, v196, v197
  v_cvt_pk_bf16_f32 v195, v198, v199
  v_cvt_pk_bf16_f32 v196, v200, v201
  v_cvt_pk_bf16_f32 v197, v202, v203
  v_mfma_f32_32x32x16_bf16 v[16:31], a[4:7], a[100:103], v[16:31]
  ds_read_b128 a[0:3], v8 offset:18432
  v_cvt_pk_bf16_f32 v198, v204, v205
  v_cvt_pk_bf16_f32 v199, v206, v207
  v_accvgpr_write_b32 a128, v192
  v_accvgpr_write_b32 a129, v193
  v_accvgpr_write_b32 a130, v194
  v_mfma_f32_32x32x16_bf16 v[16:31], a[8:11], a[104:107], v[16:31]
  ds_read_b128 a[4:7], v9 offset:18432
  v_accvgpr_write_b32 a131, v195
  v_accvgpr_write_b32 a132, v196
  v_accvgpr_write_b32 a133, v197
  v_accvgpr_write_b32 a134, v198
  v_accvgpr_write_b32 a135, v199
  v_mfma_f32_32x32x16_bf16 v[16:31], a[12:15], a[108:111], v[16:31]
  ds_read_b128 a[8:11], v8 offset:18688
  buffer_load_dwordx4 v4, s[60:63], s6 offen offset:3072 lds
  v_cvt_pk_bf16_f32 v208, v208, v209
  v_cvt_pk_bf16_f32 v209, v210, v211
  s_waitcnt lgkmcnt(3)
  v_mfma_f32_32x32x16_bf16 v[16:31], a[16:19], a[112:115], v[16:31]
  ds_read_b128 a[12:15], v9 offset:18688
  v_cvt_pk_bf16_f32 v210, v212, v213
  v_cvt_pk_bf16_f32 v211, v214, v215
  v_cvt_pk_bf16_f32 v212, v216, v217
  v_cvt_pk_bf16_f32 v213, v218, v219
  v_cvt_pk_bf16_f32 v214, v220, v221
  v_mfma_f32_32x32x16_bf16 v[16:31], a[20:23], a[116:119], v[16:31]
  ds_read_b128 a[16:19], v8 offset:19456
  v_cvt_pk_bf16_f32 v215, v222, v223
  v_accvgpr_write_b32 a136, v208
  v_accvgpr_write_b32 a137, v209
  v_accvgpr_write_b32 a138, v210
  v_accvgpr_write_b32 a139, v211
  v_mfma_f32_32x32x16_bf16 v[16:31], a[24:27], a[120:123], v[16:31]
  ds_read_b128 a[20:23], v9 offset:19456
  v_accvgpr_write_b32 a140, v212
  v_accvgpr_write_b32 a141, v213
  v_accvgpr_write_b32 a142, v214
  v_accvgpr_write_b32 a143, v215
  v_cvt_pk_bf16_f32 v224, v224, v225
  v_mfma_f32_32x32x16_bf16 v[16:31], a[28:31], a[124:127], v[16:31]
  ds_read_b128 a[24:27], v8 offset:19712
  v_cvt_pk_bf16_f32 v225, v226, v227
  v_cvt_pk_bf16_f32 v226, v228, v229
  v_cvt_pk_bf16_f32 v227, v230, v231
  v_cvt_pk_bf16_f32 v228, v232, v233
  v_cvt_pk_bf16_f32 v229, v234, v235
  s_waitcnt lgkmcnt(3)
  v_mfma_f32_32x32x16_bf16 v[16:31], a[0:3], a[128:131], v[16:31]
  ds_read_b128 a[28:31], v9 offset:19712
  v_cvt_pk_bf16_f32 v230, v236, v237
  v_cvt_pk_bf16_f32 v231, v238, v239
  v_accvgpr_write_b32 a144, v224
  v_accvgpr_write_b32 a145, v225
  v_accvgpr_write_b32 a146, v226
  v_mfma_f32_32x32x16_bf16 v[16:31], a[4:7], a[132:135], v[16:31]
  s_add_u32 m0, s31, 147456
  s_add_u32 s6, s2, 131072
  s_and_b32 s6, s6, 0x3ffff
  s_waitcnt vmcnt(22)
  s_barrier
  ds_read_b128 a[0:3], v8 offset:32768
  buffer_load_dwordx4 v4, s[48:51], s6 offen offset:0 lds
  v_mfma_f32_32x32x16_bf16 v[16:31], a[8:11], a[136:139], v[16:31]
  ds_read_b128 a[4:7], v9 offset:32768
  v_accvgpr_write_b32 a147, v227
  v_accvgpr_write_b32 a148, v228
  v_accvgpr_write_b32 a149, v229
  v_accvgpr_write_b32 a150, v230
  v_accvgpr_write_b32 a151, v231
  v_mfma_f32_32x32x16_bf16 v[16:31], a[12:15], a[140:143], v[16:31]
  ds_read_b128 a[8:11], v8 offset:33024
  v_cvt_pk_bf16_f32 v240, v240, v241
  v_cvt_pk_bf16_f32 v241, v242, v243
  v_cvt_pk_bf16_f32 v242, v244, v245
  v_cvt_pk_bf16_f32 v243, v246, v247
  v_cvt_pk_bf16_f32 v244, v248, v249
  s_waitcnt lgkmcnt(3)
  v_mfma_f32_32x32x16_bf16 v[16:31], a[16:19], a[144:147], v[16:31]
  ds_read_b128 a[12:15], v9 offset:33024
  v_cvt_pk_bf16_f32 v245, v250, v251
  v_cvt_pk_bf16_f32 v246, v252, v253
  v_cvt_pk_bf16_f32 v247, v254, v255
  v_accvgpr_write_b32 a152, v240
  v_accvgpr_write_b32 a153, v241
  v_mfma_f32_32x32x16_bf16 v[16:31], a[20:23], a[148:151], v[16:31]
  ds_read_b128 a[16:19], v8 offset:33792
  buffer_load_dwordx4 v4, s[52:55], s6 offen offset:1024 lds
  v_accvgpr_write_b32 a154, v242
  v_accvgpr_write_b32 a155, v243
  v_accvgpr_write_b32 a156, v244
  v_accvgpr_write_b32 a157, v245
  v_accvgpr_write_b32 a158, v246
  v_accvgpr_write_b32 a159, v247
  v_mfma_f32_32x32x16_bf16 v[16:31], a[24:27], a[152:155], v[16:31]
  ds_read_b128 a[20:23], v9 offset:33792
  v_accvgpr_read_b32 v12, a246
  v_accvgpr_read_b32 v112, a32
  v_accvgpr_read_b32 v113, a33
  v_accvgpr_read_b32 v114, a34
  v_accvgpr_read_b32 v115, a35
  v_mfma_f32_32x32x16_bf16 v[16:31], a[28:31], a[156:159], v[16:31]
  ds_read_b128 a[24:27], v8 offset:34048
  v_mul_f32 v112, v6, v112
  v_mul_f32 v113, v6, v113
  v_mul_f32 v114, v6, v114
  v_mul_f32 v115, v6, v115
  v_mul_f32 v116, v112, v112
  s_waitcnt lgkmcnt(3)
  v_mfma_f32_32x32x16_bf16 v[32:47], a[0:3], a[96:99], 0
  ds_read_b128 a[28:31], v9 offset:34048
  v_mul_f32 v117, v113, v113
  v_mul_f32 v118, v114, v114
  v_mul_f32 v119, v115, v115
  v_fma_f32 v116, v116, s11, 1.0
  v_fma_f32 v117, v117, s11, 1.0
  v_mfma_f32_32x32x16_bf16 v[32:47], a[4:7], a[100:103], v[32:47]
  ds_read_b128 a[0:3], v8 offset:34816
  buffer_load_dwordx4 v4, s[56:59], s6 offen offset:2048 lds
  v_fma_f32 v118, v118, s11, 1.0
  v_fma_f32 v119, v119, s11, 1.0
  v_mfma_f32_32x32x16_bf16 v[32:47], a[8:11], a[104:107], v[32:47]
  ds_read_b128 a[4:7], v9 offset:34816
  v_mul_f32 v116, v112, v116
  v_mul_f32 v117, v113, v117
  v_mul_f32 v118, v114, v118
  v_mul_f32 v119, v115, v119
  v_accvgpr_read_b32 v3, a241
  v_mfma_f32_32x32x16_bf16 v[32:47], a[12:15], a[108:111], v[32:47]
  ds_read_b128 a[8:11], v8 offset:35072
  v_exp_f32 v116, v116
  v_exp_f32 v117, v117
  v_max3_f32 v7, v7, v16, v17
  s_waitcnt lgkmcnt(3)
  v_mfma_f32_32x32x16_bf16 v[32:47], a[16:19], a[112:115], v[32:47]
  ds_read_b128 a[12:15], v9 offset:35072
  v_exp_f32 v118, v118
  v_exp_f32 v119, v119
  v_add_f32 v116, 1.0, v116
  v_mfma_f32_32x32x16_bf16 v[32:47], a[20:23], a[116:119], v[32:47]
  ds_read_b128 a[16:19], v8 offset:35840
  buffer_load_dwordx4 v4, s[60:63], s6 offen offset:3072 lds
  v_add_f32 v117, 1.0, v117
  v_add_f32 v118, 1.0, v118
  v_mfma_f32_32x32x16_bf16 v[32:47], a[24:27], a[120:123], v[32:47]
  ds_read_b128 a[20:23], v9 offset:35840
  v_add_f32 v119, 1.0, v119
  v_rcp_f32 v116, v116
  v_rcp_f32 v117, v117
  v_mfma_f32_32x32x16_bf16 v[32:47], a[28:31], a[124:127], v[32:47]
  ds_read_b128 a[24:27], v8 offset:36096
  v_rcp_f32 v118, v118
  v_rcp_f32 v119, v119
  v_mul_f32 v112, v112, v116
  s_waitcnt lgkmcnt(3)
  v_mfma_f32_32x32x16_bf16 v[32:47], a[0:3], a[128:131], v[32:47]
  ds_read_b128 a[28:31], v9 offset:36096
  v_mul_f32 v113, v113, v117
  v_mul_f32 v114, v114, v118
  v_mul_f32 v115, v115, v119
  v_cvt_pk_bf16_f32 v112, v112, v113
  v_cvt_pk_bf16_f32 v113, v114, v115
  v_mfma_f32_32x32x16_bf16 v[32:47], a[4:7], a[132:135], v[32:47]
  s_add_u32 m0, s31, 0
  s_add_u32 s6, s2, 147456
  s_and_b32 s6, s6, 0x3ffff
  ds_read_b128 a[0:3], v8 offset:49152
  buffer_load_dwordx4 v4, s[48:51], s6 offen offset:0 lds
  v_mfma_f32_32x32x16_bf16 v[32:47], a[8:11], a[136:139], v[32:47]
  ds_read_b128 a[4:7], v9 offset:49152
  v_accvgpr_write_b32 a160, v112
  v_accvgpr_write_b32 a161, v113
  v_accvgpr_read_b32 v120, a36
  v_accvgpr_read_b32 v121, a37
  v_accvgpr_read_b32 v122, a38
  v_mfma_f32_32x32x16_bf16 v[32:47], a[12:15], a[140:143], v[32:47]
  ds_read_b128 a[8:11], v8 offset:49408
  v_accvgpr_read_b32 v123, a39
  v_mul_f32 v120, v6, v120
  v_mul_f32 v121, v6, v121
  v_mul_f32 v122, v6, v122
  v_mul_f32 v123, v6, v123
  s_waitcnt lgkmcnt(3)
  v_mfma_f32_32x32x16_bf16 v[32:47], a[16:19], a[144:147], v[32:47]
  ds_read_b128 a[12:15], v9 offset:49408
  v_mul_f32 v124, v120, v120
  v_mul_f32 v125, v121, v121
  v_mul_f32 v126, v122, v122
  v_mul_f32 v127, v123, v123
  v_fma_f32 v124, v124, s11, 1.0
  v_mfma_f32_32x32x16_bf16 v[32:47], a[20:23], a[148:151], v[32:47]
  ds_read_b128 a[16:19], v8 offset:50176
  buffer_load_dwordx4 v4, s[52:55], s6 offen offset:1024 lds
  v_fma_f32 v125, v125, s11, 1.0
  v_fma_f32 v126, v126, s11, 1.0
  v_mfma_f32_32x32x16_bf16 v[32:47], a[24:27], a[152:155], v[32:47]
  ds_read_b128 a[20:23], v9 offset:50176
  v_fma_f32 v127, v127, s11, 1.0
  v_mul_f32 v124, v120, v124
  v_mul_f32 v125, v121, v125
  v_mul_f32 v126, v122, v126
  v_mul_f32 v127, v123, v127
  v_mfma_f32_32x32x16_bf16 v[32:47], a[28:31], a[156:159], v[32:47]
  ds_read_b128 a[24:27], v8 offset:50432
  v_exp_f32 v124, v124
  v_exp_f32 v125, v125
  v_max3_f32 v7, v7, v18, v19
L_padh4:
  s_cbranch_execz L_padh8
  s_waitcnt lgkmcnt(3)
  v_mfma_f32_32x32x16_bf16 v[48:63], a[0:3], a[96:99], 0
  ds_read_b128 a[28:31], v9 offset:50432
  s_lshl_b32 s26, s97, 4
  v_exp_f32 v126, v126
  v_exp_f32 v127, v127
  v_mfma_f32_32x32x16_bf16 v[48:63], a[4:7], a[100:103], v[48:63]
  ds_read_b128 a[0:3], v8 offset:51200
  buffer_load_dwordx4 v4, s[56:59], s6 offen offset:2048 lds
  v_add_f32 v124, 1.0, v124
  v_add_f32 v125, 1.0, v125
  v_mfma_f32_32x32x16_bf16 v[48:63], a[8:11], a[104:107], v[48:63]
  ds_read_b128 a[4:7], v9 offset:51200
  buffer_load_dwordx2 v[14:15], off, s[92:95], s26 sc1
  v_add_f32 v126, 1.0, v126
  v_add_f32 v127, 1.0, v127
  v_max3_f32 v7, v7, v20, v21
  v_mfma_f32_32x32x16_bf16 v[48:63], a[12:15], a[108:111], v[48:63]
  ds_read_b128 a[8:11], v8 offset:51456
  v_rcp_f32 v124, v124
  v_rcp_f32 v125, v125
  v_max3_f32 v7, v7, v22, v23
  s_waitcnt lgkmcnt(3)
  v_mfma_f32_32x32x16_bf16 v[48:63], a[16:19], a[112:115], v[48:63]
  ds_read_b128 a[12:15], v9 offset:51456
  v_rcp_f32 v126, v126
  v_rcp_f32 v127, v127
  v_mul_f32 v120, v120, v124
  v_mfma_f32_32x32x16_bf16 v[48:63], a[20:23], a[116:119], v[48:63]
  ds_read_b128 a[16:19], v8 offset:52224
  buffer_load_dwordx4 v4, s[60:63], s6 offen offset:3072 lds
  v_mul_f32 v121, v121, v125
  v_mul_f32 v122, v122, v126
  v_mfma_f32_32x32x16_bf16 v[48:63], a[24:27], a[120:123], v[48:63]
  ds_read_b128 a[20:23], v9 offset:52224
  v_mul_f32 v123, v123, v127
  v_cvt_pk_bf16_f32 v120, v120, v121
  v_cvt_pk_bf16_f32 v121, v122, v123
  v_accvgpr_write_b32 a162, v120
  v_accvgpr_write_b32 a163, v121
  v_mfma_f32_32x32x16_bf16 v[48:63], a[28:31], a[124:127], v[48:63]
  ds_read_b128 a[24:27], v8 offset:52480
  v_accvgpr_read_b32 v112, a40
  v_accvgpr_read_b32 v113, a41
  v_accvgpr_read_b32 v114, a42
  v_accvgpr_read_b32 v115, a43
  v_mul_f32 v112, v6, v112
  s_waitcnt lgkmcnt(3)
  v_mfma_f32_32x32x16_bf16 v[48:63], a[0:3], a[128:131], v[48:63]
  ds_read_b128 a[28:31], v9 offset:52480
  v_mul_f32 v113, v6, v113
  v_mul_f32 v114, v6, v114
  v_mul_f32 v115, v6, v115
  v_mul_f32 v116, v112, v112
  v_add_u32 v8, 0x00010000, v8
  v_mfma_f32_32x32x16_bf16 v[48:63], a[4:7], a[132:135], v[48:63]
  s_add_u32 m0, s31, 16384
  s_add_u32 s6, s2, 163840
  s_and_b32 s6, s6, 0x3ffff
  s_waitcnt vmcnt(22)
  s_barrier
  ds_read_b128 a[0:3], v8 offset:0
  buffer_load_dwordx4 v4, s[48:51], s6 offen offset:0 lds
  v_add_u32 v9, 0x00010000, v9
  v_mfma_f32_32x32x16_bf16 v[48:63], a[8:11], a[136:139], v[48:63]
  ds_read_b128 a[4:7], v9 offset:0
  v_mul_f32 v117, v113, v113
  v_mul_f32 v118, v114, v114
  v_mul_f32 v119, v115, v115
  v_fma_f32 v116, v116, s11, 1.0
  v_fma_f32 v117, v117, s11, 1.0
  v_mfma_f32_32x32x16_bf16 v[48:63], a[12:15], a[140:143], v[48:63]
  ds_read_b128 a[8:11], v8 offset:256
  v_fma_f32 v118, v118, s11, 1.0
  v_fma_f32 v119, v119, s11, 1.0
  v_mul_f32 v116, v112, v116
  v_mul_f32 v117, v113, v117
  v_mul_f32 v118, v114, v118
  s_waitcnt lgkmcnt(3)
  v_mfma_f32_32x32x16_bf16 v[48:63], a[16:19], a[144:147], v[48:63]
  ds_read_b128 a[12:15], v9 offset:256
  v_mul_f32 v119, v115, v119
  v_exp_f32 v116, v116
  v_exp_f32 v117, v117
  v_mfma_f32_32x32x16_bf16 v[48:63], a[20:23], a[148:151], v[48:63]
  ds_read_b128 a[16:19], v8 offset:1024
  buffer_load_dwordx4 v4, s[52:55], s6 offen offset:1024 lds
  v_exp_f32 v118, v118
  v_mfma_f32_32x32x16_bf16 v[48:63], a[24:27], a[152:155], v[48:63]
  ds_read_b128 a[20:23], v9 offset:1024
  v_exp_f32 v119, v119
  v_add_f32 v116, 1.0, v116
  v_add_f32 v117, 1.0, v117
  v_add_f32 v118, 1.0, v118
  v_mfma_f32_32x32x16_bf16 v[48:63], a[28:31], a[156:159], v[48:63]
  ds_read_b128 a[24:27], v8 offset:1280
  v_add_f32 v119, 1.0, v119
  v_rcp_f32 v116, v116
  v_rcp_f32 v117, v117
  s_waitcnt lgkmcnt(3)
  v_mfma_f32_32x32x16_bf16 v[64:79], a[0:3], a[96:99], 0
  ds_read_b128 a[28:31], v9 offset:1280
  v_rcp_f32 v118, v118
  v_rcp_f32 v119, v119
  v_mul_f32 v112, v112, v116
  v_mfma_f32_32x32x16_bf16 v[64:79], a[4:7], a[100:103], v[64:79]
  ds_read_b128 a[0:3], v8 offset:2048
  buffer_load_dwordx4 v4, s[56:59], s6 offen offset:2048 lds
  v_mul_f32 v113, v113, v117
  v_mul_f32 v114, v114, v118
  v_mfma_f32_32x32x16_bf16 v[64:79], a[8:11], a[104:107], v[64:79]
  ds_read_b128 a[4:7], v9 offset:2048
  v_mul_f32 v115, v115, v119
  v_cvt_pk_bf16_f32 v112, v112, v113
  v_cvt_pk_bf16_f32 v113, v114, v115
  v_accvgpr_write_b32 a164, v112
  v_accvgpr_write_b32 a165, v113
  v_mfma_f32_32x32x16_bf16 v[64:79], a[12:15], a[108:111], v[64:79]
  ds_read_b128 a[8:11], v8 offset:2304
  v_accvgpr_read_b32 v120, a44
  v_accvgpr_read_b32 v121, a45
  v_accvgpr_read_b32 v122, a46
  v_accvgpr_read_b32 v123, a47
  v_mul_f32 v120, v6, v120
  s_waitcnt lgkmcnt(3)
  v_mfma_f32_32x32x16_bf16 v[64:79], a[16:19], a[112:115], v[64:79]
  ds_read_b128 a[12:15], v9 offset:2304
  v_mul_f32 v121, v6, v121
  v_mul_f32 v122, v6, v122
  v_mul_f32 v123, v6, v123
  v_mul_f32 v124, v120, v120
  v_mul_f32 v125, v121, v121
  v_mfma_f32_32x32x16_bf16 v[64:79], a[20:23], a[116:119], v[64:79]
  ds_read_b128 a[16:19], v8 offset:3072
  buffer_load_dwordx4 v4, s[60:63], s6 offen offset:3072 lds
  v_mul_f32 v126, v122, v122
  v_mul_f32 v127, v123, v123
  v_mfma_f32_32x32x16_bf16 v[64:79], a[24:27], a[120:123], v[64:79]
  ds_read_b128 a[20:23], v9 offset:3072
  v_fma_f32 v124, v124, s11, 1.0
  v_fma_f32 v125, v125, s11, 1.0
  v_fma_f32 v126, v126, s11, 1.0
  v_fma_f32 v127, v127, s11, 1.0
  v_mul_f32 v124, v120, v124
  v_mfma_f32_32x32x16_bf16 v[64:79], a[28:31], a[124:127], v[64:79]
  ds_read_b128 a[24:27], v8 offset:3328
  v_mul_f32 v125, v121, v125
  v_mul_f32 v126, v122, v126
  v_mul_f32 v127, v123, v127
  v_exp_f32 v124, v124
  s_waitcnt lgkmcnt(3)
  v_mfma_f32_32x32x16_bf16 v[64:79], a[0:3], a[128:131], v[64:79]
  ds_read_b128 a[28:31], v9 offset:3328
  v_exp_f32 v125, v125
  v_exp_f32 v126, v126
  v_max3_f32 v7, v7, v24, v25
  v_mfma_f32_32x32x16_bf16 v[64:79], a[4:7], a[132:135], v[64:79]
  s_add_u32 m0, s31, 32768
  s_add_u32 s6, s2, 180224
  s_and_b32 s6, s6, 0x3ffff
  ds_read_b128 a[0:3], v8 offset:16384
  buffer_load_dwordx4 v4, s[48:51], s6 offen offset:0 lds
  v_mfma_f32_32x32x16_bf16 v[64:79], a[8:11], a[136:139], v[64:79]
  ds_read_b128 a[4:7], v9 offset:16384
  v_exp_f32 v127, v127
  v_add_f32 v124, 1.0, v124
  v_add_f32 v125, 1.0, v125
  v_add_f32 v126, 1.0, v126
  v_mfma_f32_32x32x16_bf16 v[64:79], a[12:15], a[140:143], v[64:79]
  ds_read_b128 a[8:11], v8 offset:16640
  v_add_f32 v127, 1.0, v127
  v_rcp_f32 v124, v124
  v_rcp_f32 v125, v125
  s_waitcnt lgkmcnt(3)
  v_mfma_f32_32x32x16_bf16 v[64:79], a[16:19], a[144:147], v[64:79]
  ds_read_b128 a[12:15], v9 offset:16640
  v_rcp_f32 v126, v126
  v_rcp_f32 v127, v127
  v_mul_f32 v120, v120, v124
  v_mfma_f32_32x32x16_bf16 v[64:79], a[20:23], a[148:151], v[64:79]
  ds_read_b128 a[16:19], v8 offset:17408
  buffer_load_dwordx4 v4, s[52:55], s6 offen offset:1024 lds
  v_mul_f32 v121, v121, v125
  v_mul_f32 v122, v122, v126
  v_mfma_f32_32x32x16_bf16 v[64:79], a[24:27], a[152:155], v[64:79]
  ds_read_b128 a[20:23], v9 offset:17408
  v_mul_f32 v123, v123, v127
  v_cvt_pk_bf16_f32 v120, v120, v121
  v_cvt_pk_bf16_f32 v121, v122, v123
  v_accvgpr_write_b32 a166, v120
  v_accvgpr_write_b32 a167, v121
  v_mfma_f32_32x32x16_bf16 v[64:79], a[28:31], a[156:159], v[64:79]
  ds_read_b128 a[24:27], v8 offset:17664
  v_accvgpr_read_b32 v240, a48
  v_accvgpr_read_b32 v241, a49
  v_accvgpr_read_b32 v242, a50
  v_accvgpr_read_b32 v243, a51
  v_mul_f32 v240, v6, v240
  s_waitcnt lgkmcnt(3)
  v_mfma_f32_32x32x16_bf16 v[80:95], a[0:3], a[96:99], 0
  ds_read_b128 a[28:31], v9 offset:17664
  v_mul_f32 v241, v6, v241
  v_mul_f32 v242, v6, v242
  v_mul_f32 v243, v6, v243
  v_mul_f32 v244, v240, v240
  v_mul_f32 v245, v241, v241
  v_mfma_f32_32x32x16_bf16 v[80:95], a[4:7], a[100:103], v[80:95]
  ds_read_b128 a[0:3], v8 offset:18432
  buffer_load_dwordx4 v4, s[56:59], s6 offen offset:2048 lds
  v_mul_f32 v246, v242, v242
  v_mul_f32 v247, v243, v243
  v_mfma_f32_32x32x16_bf16 v[80:95], a[8:11], a[104:107], v[80:95]
  ds_read_b128 a[4:7], v9 offset:18432
  v_fma_f32 v244, v244, s11, 1.0
  v_fma_f32 v245, v245, s11, 1.0
  v_fma_f32 v246, v246, s11, 1.0
  v_fma_f32 v247, v247, s11, 1.0
  v_mul_f32 v244, v240, v244
  v_mfma_f32_32x32x16_bf16 v[80:95], a[12:15], a[108:111], v[80:95]
  ds_read_b128 a[8:11], v8 offset:18688
  v_mul_f32 v245, v241, v245
  v_mul_f32 v246, v242, v246
  v_mul_f32 v247, v243, v247
  v_exp_f32 v244, v244
  s_waitcnt lgkmcnt(3)
  v_mfma_f32_32x32x16_bf16 v[80:95], a[16:19], a[112:115], v[80:95]
  ds_read_b128 a[12:15], v9 offset:18688
  v_exp_f32 v245, v245
  v_exp_f32 v246, v246
  v_max3_f32 v7, v7, v26, v27
  v_mfma_f32_32x32x16_bf16 v[80:95], a[20:23], a[116:119], v[80:95]
  ds_read_b128 a[16:19], v8 offset:19456
  buffer_load_dwordx4 v4, s[60:63], s6 offen offset:3072 lds
  v_exp_f32 v247, v247
  v_mfma_f32_32x32x16_bf16 v[80:95], a[24:27], a[120:123], v[80:95]
  ds_read_b128 a[20:23], v9 offset:19456
  v_add_f32 v244, 1.0, v244
  v_add_f32 v245, 1.0, v245
  v_add_f32 v246, 1.0, v246
  v_add_f32 v247, 1.0, v247
  v_max3_f32 v7, v7, v28, v29
  v_mfma_f32_32x32x16_bf16 v[80:95], a[28:31], a[124:127], v[80:95]
  ds_read_b128 a[24:27], v8 offset:19712
  v_rcp_f32 v244, v244
  v_rcp_f32 v245, v245
  v_max3_f32 v7, v7, v30, v31
  s_waitcnt lgkmcnt(3)
  v_mfma_f32_32x32x16_bf16 v[80:95], a[0:3], a[128:131], v[80:95]
  ds_read_b128 a[28:31], v9 offset:19712
  v_rcp_f32 v246, v246
  v_rcp_f32 v247, v247
  v_mul_f32 v240, v240, v244
  v_mfma_f32_32x32x16_bf16 v[80:95], a[4:7], a[132:135], v[80:95]
  s_add_u32 m0, s31, 49152
  s_add_u32 s6, s2, 196608
  s_and_b32 s6, s6, 0x3ffff
  s_waitcnt vmcnt(21)
  s_barrier
  ds_read_b128 a[0:3], v8 offset:32768
  buffer_load_dwordx4 v4, s[48:51], s6 offen offset:0 lds
  v_mfma_f32_32x32x16_bf16 v[80:95], a[8:11], a[136:139], v[80:95]
  ds_read_b128 a[4:7], v9 offset:32768
  v_mul_f32 v241, v241, v245
  v_mul_f32 v242, v242, v246
  v_mul_f32 v243, v243, v247
  v_cvt_pk_bf16_f32 v240, v240, v241
  v_cvt_pk_bf16_f32 v241, v242, v243
  v_mfma_f32_32x32x16_bf16 v[80:95], a[12:15], a[140:143], v[80:95]
  ds_read_b128 a[8:11], v8 offset:33024
  v_accvgpr_write_b32 a168, v240
  v_accvgpr_write_b32 a169, v241
  v_accvgpr_read_b32 v248, a52
  v_accvgpr_read_b32 v249, a53
  v_accvgpr_read_b32 v250, a54
  s_waitcnt lgkmcnt(3)
  v_mfma_f32_32x32x16_bf16 v[80:95], a[16:19], a[144:147], v[80:95]
  ds_read_b128 a[12:15], v9 offset:33024
  v_accvgpr_read_b32 v251, a55
  v_mul_f32 v248, v6, v248
  v_mul_f32 v249, v6, v249
  v_mul_f32 v250, v6, v250
  v_mul_f32 v251, v6, v251
  v_mfma_f32_32x32x16_bf16 v[80:95], a[20:23], a[148:151], v[80:95]
  ds_read_b128 a[16:19], v8 offset:33792
  buffer_load_dwordx4 v4, s[52:55], s6 offen offset:1024 lds
  v_mul_f32 v252, v248, v248
  v_mul_f32 v253, v249, v249
  v_mfma_f32_32x32x16_bf16 v[80:95], a[24:27], a[152:155], v[80:95]
  ds_read_b128 a[20:23], v9 offset:33792
  v_mul_f32 v254, v250, v250
  v_mul_f32 v255, v251, v251
  v_fma_f32 v252, v252, s11, 1.0
  v_fma_f32 v253, v253, s11, 1.0
  v_fma_f32 v254, v254, s11, 1.0
  v_mfma_f32_32x32x16_bf16 v[80:95], a[28:31], a[156:159], v[80:95]
  ds_read_b128 a[24:27], v8 offset:34048
  v_fma_f32 v255, v255, s11, 1.0
  v_mul_f32 v252, v248, v252
  v_mul_f32 v253, v249, v253
  v_mul_f32 v254, v250, v254
  v_mul_f32 v255, v251, v255
  s_waitcnt lgkmcnt(3)
  v_mfma_f32_32x32x16_bf16 v[96:111], a[0:3], a[96:99], 0
  ds_read_b128 a[28:31], v9 offset:34048
  v_exp_f32 v252, v252
  v_exp_f32 v253, v253
  v_max3_f32 v7, v7, v32, v33
  v_mfma_f32_32x32x16_bf16 v[96:111], a[4:7], a[100:103], v[96:111]
  ds_read_b128 a[0:3], v8 offset:34816
  buffer_load_dwordx4 v4, s[56:59], s6 offen offset:2048 lds
  v_exp_f32 v254, v254
  v_mfma_f32_32x32x16_bf16 v[96:111], a[8:11], a[104:107], v[96:111]
  ds_read_b128 a[4:7], v9 offset:34816
  v_exp_f32 v255, v255
  v_add_f32 v252, 1.0, v252
  v_add_f32 v253, 1.0, v253
  v_add_f32 v254, 1.0, v254
  v_mfma_f32_32x32x16_bf16 v[96:111], a[12:15], a[108:111], v[96:111]
  ds_read_b128 a[8:11], v8 offset:35072
  v_add_f32 v255, 1.0, v255
  v_rcp_f32 v252, v252
  v_rcp_f32 v253, v253
  s_waitcnt lgkmcnt(3)
  v_mfma_f32_32x32x16_bf16 v[96:111], a[16:19], a[112:115], v[96:111]
  ds_read_b128 a[12:15], v9 offset:35072
  v_rcp_f32 v254, v254
  v_rcp_f32 v255, v255
  v_mul_f32 v248, v248, v252
  v_mfma_f32_32x32x16_bf16 v[96:111], a[20:23], a[116:119], v[96:111]
  ds_read_b128 a[16:19], v8 offset:35840
  buffer_load_dwordx4 v4, s[60:63], s6 offen offset:3072 lds
  v_mul_f32 v249, v249, v253
  v_mul_f32 v250, v250, v254
  v_mfma_f32_32x32x16_bf16 v[96:111], a[24:27], a[120:123], v[96:111]
  ds_read_b128 a[20:23], v9 offset:35840
  v_mul_f32 v251, v251, v255
  v_cvt_pk_bf16_f32 v248, v248, v249
  v_cvt_pk_bf16_f32 v249, v250, v251
  v_accvgpr_write_b32 a170, v248
  v_accvgpr_write_b32 a171, v249
  v_mfma_f32_32x32x16_bf16 v[96:111], a[28:31], a[124:127], v[96:111]
  ds_read_b128 a[24:27], v8 offset:36096
  v_accvgpr_read_b32 v240, a56
  v_accvgpr_read_b32 v241, a57
  v_accvgpr_read_b32 v242, a58
  v_accvgpr_read_b32 v243, a59
  v_mul_f32 v240, v6, v240
  s_waitcnt lgkmcnt(3)
  v_mfma_f32_32x32x16_bf16 v[96:111], a[0:3], a[128:131], v[96:111]
  ds_read_b128 a[28:31], v9 offset:36096
  v_mul_f32 v241, v6, v241
  v_mul_f32 v242, v6, v242
  v_mul_f32 v243, v6, v243
  v_mul_f32 v244, v240, v240
  v_mul_f32 v245, v241, v241
  v_mfma_f32_32x32x16_bf16 v[96:111], a[4:7], a[132:135], v[96:111]
  s_add_u32 m0, s31, 65536
  s_add_u32 s6, s2, 212992
  s_and_b32 s6, s6, 0x3ffff
  ds_read_b128 a[0:3], v8 offset:49152
  buffer_load_dwordx4 v4, s[48:51], s6 offen offset:0 lds
  v_mfma_f32_32x32x16_bf16 v[96:111], a[8:11], a[136:139], v[96:111]
  ds_read_b128 a[4:7], v9 offset:49152
  v_mul_f32 v246, v242, v242
  v_mul_f32 v247, v243, v243
  v_fma_f32 v244, v244, s11, 1.0
  v_fma_f32 v245, v245, s11, 1.0
  v_fma_f32 v246, v246, s11, 1.0
  v_mfma_f32_32x32x16_bf16 v[96:111], a[12:15], a[140:143], v[96:111]
  ds_read_b128 a[8:11], v8 offset:49408
  v_fma_f32 v247, v247, s11, 1.0
  v_mul_f32 v244, v240, v244
  v_mul_f32 v245, v241, v245
  v_mul_f32 v246, v242, v246
  v_mul_f32 v247, v243, v247
  s_waitcnt lgkmcnt(3)
  v_mfma_f32_32x32x16_bf16 v[96:111], a[16:19], a[144:147], v[96:111]
  ds_read_b128 a[12:15], v9 offset:49408
  v_exp_f32 v244, v244
  v_exp_f32 v245, v245
  v_max3_f32 v7, v7, v34, v35
  v_mfma_f32_32x32x16_bf16 v[96:111], a[20:23], a[148:151], v[96:111]
  ds_read_b128 a[16:19], v8 offset:50176
  buffer_load_dwordx4 v4, s[52:55], s6 offen offset:1024 lds
  v_exp_f32 v246, v246
  v_mfma_f32_32x32x16_bf16 v[96:111], a[24:27], a[152:155], v[96:111]
  ds_read_b128 a[20:23], v9 offset:50176
  v_exp_f32 v247, v247
  v_add_f32 v244, 1.0, v244
  v_add_f32 v245, 1.0, v245
  v_add_f32 v246, 1.0, v246
  v_mfma_f32_32x32x16_bf16 v[96:111], a[28:31], a[156:159], v[96:111]
  ds_read_b128 a[24:27], v8 offset:50432
  v_add_f32 v247, 1.0, v247
  v_rcp_f32 v244, v244
  v_rcp_f32 v245, v245
  s_waitcnt vmcnt(15)
  v_and_b32 v0, -7, v15
  v_cmp_ne_u32 vcc, v0, v14
  v_cmp_eq_u32 s[44:45], 0, v14
  s_nop 1
  s_or_b64 vcc, vcc, s[44:45]
  s_cbranch_vccnz L_spinNh
L_backNh:
  v_readfirstlane_b32 s26, v15
  v_mov_b32 v0, v15
  s_nop 0
  s_bfe_u32 s44, s26, 0x10001
  s_lshl_b32 s44, s44, 13
  s_add_u32 s9, s9, s44
  s_add_u32 s10, s10, s44
  s_add_u32 s29, s29, s44
  s_add_u32 s28, s28, s44
  s_bfe_u32 s44, s26, 0x10002
  s_lshl_b32 s44, s44, 13
  s_add_u32 s21, s21, s44
  s_add_u32 s27, s27, s44
  s_add_u32 s30, s30, s44
  s_waitcnt lgkmcnt(3)
  v_mfma_f32_32x32x16_bf16 v[112:127], a[0:3], a[96:99], 0
  ds_read_b128 a[28:31], v9 offset:50432
  v_rcp_f32 v246, v246
  v_rcp_f32 v247, v247
  v_mul_f32 v240, v240, v244
  v_mfma_f32_32x32x16_bf16 v[112:127], a[4:7], a[100:103], v[112:127]
  ds_read_b128 a[0:3], v8 offset:51200
  buffer_load_dwordx4 v4, s[56:59], s6 offen offset:2048 lds
  v_mul_f32 v241, v241, v245
  v_mul_f32 v242, v242, v246
  v_mfma_f32_32x32x16_bf16 v[112:127], a[8:11], a[104:107], v[112:127]
  ds_read_b128 a[4:7], v9 offset:51200
  v_mul_f32 v243, v243, v247
  v_cvt_pk_bf16_f32 v240, v240, v241
  v_cvt_pk_bf16_f32 v241, v242, v243
  v_accvgpr_write_b32 a172, v240
  v_accvgpr_write_b32 a173, v241
  v_mfma_f32_32x32x16_bf16 v[112:127], a[12:15], a[108:111], v[112:127]
  ds_read_b128 a[8:11], v8 offset:51456
  v_accvgpr_read_b32 v248, a60
  v_accvgpr_read_b32 v249, a61
  v_accvgpr_read_b32 v250, a62
  v_accvgpr_read_b32 v251, a63
  v_mul_f32 v248, v6, v248
  s_waitcnt lgkmcnt(3)
  v_mfma_f32_32x32x16_bf16 v[112:127], a[16:19], a[112:115], v[112:127]
  ds_read_b128 a[12:15], v9 offset:51456
  v_mul_f32 v249, v6, v249
  v_mul_f32 v250, v6, v250
  v_mul_f32 v251, v6, v251
  v_mul_f32 v252, v248, v248
  v_mul_f32 v253, v249, v249
  v_mfma_f32_32x32x16_bf16 v[112:127], a[20:23], a[116:119], v[112:127]
  ds_read_b128 a[16:19], v8 offset:52224
  buffer_load_dwordx4 v4, s[60:63], s6 offen offset:3072 lds
  v_mul_f32 v254, v250, v250
  v_mul_f32 v255, v251, v251
  v_mfma_f32_32x32x16_bf16 v[112:127], a[24:27], a[120:123], v[112:127]
  ds_read_b128 a[20:23], v9 offset:52224
  v_fma_f32 v252, v252, s11, 1.0
  v_fma_f32 v253, v253, s11, 1.0
  v_fma_f32 v254, v254, s11, 1.0
  v_fma_f32 v255, v255, s11, 1.0
  v_mul_f32 v252, v248, v252
  v_mfma_f32_32x32x16_bf16 v[112:127], a[28:31], a[124:127], v[112:127]
  ds_read_b128 a[24:27], v8 offset:52480
  v_mul_f32 v253, v249, v253
  v_mul_f32 v254, v250, v254
  v_mul_f32 v255, v251, v255
  v_exp_f32 v252, v252
  s_waitcnt lgkmcnt(3)
  v_mfma_f32_32x32x16_bf16 v[112:127], a[0:3], a[128:131], v[112:127]
  ds_read_b128 a[28:31], v9 offset:52480
  v_exp_f32 v253, v253
  v_exp_f32 v254, v254
  v_add_u32 v8, 0x00010000, v8
  v_mfma_f32_32x32x16_bf16 v[112:127], a[4:7], a[132:135], v[112:127]
  s_add_u32 m0, s31, 81920
  s_barrier
  ds_read_b128 a[0:3], v8 offset:0
  buffer_load_dwordx4 v2, s[72:75], s14 offen offset:0 lds
  v_add_u32 v9, 0x00010000, v9
  v_mfma_f32_32x32x16_bf16 v[112:127], a[8:11], a[136:139], v[112:127]
  ds_read_b128 a[4:7], v9 offset:0
  v_exp_f32 v255, v255
  v_add_f32 v252, 1.0, v252
  v_add_f32 v253, 1.0, v253
  v_add_f32 v254, 1.0, v254
  v_mfma_f32_32x32x16_bf16 v[112:127], a[12:15], a[140:143], v[112:127]
  ds_read_b128 a[8:11], v8 offset:256
  v_add_f32 v255, 1.0, v255
  v_rcp_f32 v252, v252
  v_rcp_f32 v253, v253
  s_waitcnt lgkmcnt(3)
  v_mfma_f32_32x32x16_bf16 v[112:127], a[16:19], a[144:147], v[112:127]
  ds_read_b128 a[12:15], v9 offset:256
  v_rcp_f32 v254, v254
  v_rcp_f32 v255, v255
  v_mul_f32 v248, v248, v252
  v_mfma_f32_32x32x16_bf16 v[112:127], a[20:23], a[148:151], v[112:127]
  ds_read_b128 a[16:19], v8 offset:1024
  buffer_load_dwordx4 v2, s[76:79], s14 offen offset:1024 lds
  v_mul_f32 v249, v249, v253
  v_mul_f32 v250, v250, v254
  v_mfma_f32_32x32x16_bf16 v[112:127], a[24:27], a[152:155], v[112:127]
  ds_read_b128 a[20:23], v9 offset:1024
  v_mul_f32 v251, v251, v255
  v_cvt_pk_bf16_f32 v248, v248, v249
  v_cvt_pk_bf16_f32 v249, v250, v251
  v_accvgpr_write_b32 a174, v248
  v_accvgpr_write_b32 a175, v249
  v_mfma_f32_32x32x16_bf16 v[112:127], a[28:31], a[156:159], v[112:127]
  ds_read_b128 a[24:27], v8 offset:1280
  v_accvgpr_read_b32 v240, a64
  v_accvgpr_read_b32 v241, a65
  v_accvgpr_read_b32 v242, a66
  v_accvgpr_read_b32 v243, a67
  v_mul_f32 v240, v6, v240
  s_waitcnt lgkmcnt(3)
  v_mfma_f32_32x32x16_bf16 a[192:207], a[0:3], a[96:99], 0
  ds_read_b128 a[28:31], v9 offset:1280
  v_mul_f32 v241, v6, v241
  v_mul_f32 v242, v6, v242
  v_mul_f32 v243, v6, v243
  v_mul_f32 v244, v240, v240
  v_mul_f32 v245, v241, v241
  v_mfma_f32_32x32x16_bf16 a[192:207], a[4:7], a[100:103], a[192:207]
  ds_read_b128 a[0:3], v8 offset:2048
  buffer_load_dwordx4 v2, s[80:83], s14 offen offset:2048 lds
  v_mul_f32 v246, v242, v242
  v_mul_f32 v247, v243, v243
  v_mfma_f32_32x32x16_bf16 a[192:207], a[8:11], a[104:107], a[192:207]
  ds_read_b128 a[4:7], v9 offset:2048
  v_fma_f32 v244, v244, s11, 1.0
  v_fma_f32 v245, v245, s11, 1.0
  v_fma_f32 v246, v246, s11, 1.0
  v_fma_f32 v247, v247, s11, 1.0
  v_mul_f32 v244, v240, v244
  v_mfma_f32_32x32x16_bf16 a[192:207], a[12:15], a[108:111], a[192:207]
  ds_read_b128 a[8:11], v8 offset:2304
  v_mul_f32 v245, v241, v245
  v_mul_f32 v246, v242, v246
  v_mul_f32 v247, v243, v247
  v_exp_f32 v244, v244
  s_waitcnt lgkmcnt(3)
  v_mfma_f32_32x32x16_bf16 a[192:207], a[16:19], a[112:115], a[192:207]
  ds_read_b128 a[12:15], v9 offset:2304
  v_exp_f32 v245, v245
  v_exp_f32 v246, v246
  v_max3_f32 v7, v7, v36, v37
  v_mfma_f32_32x32x16_bf16 a[192:207], a[20:23], a[116:119], a[192:207]
  ds_read_b128 a[16:19], v8 offset:3072
  buffer_load_dwordx4 v2, s[84:87], s14 offen offset:3072 lds
  v_exp_f32 v247, v247
  v_mfma_f32_32x32x16_bf16 a[192:207], a[24:27], a[120:123], a[192:207]
  ds_read_b128 a[20:23], v9 offset:3072
  v_add_f32 v244, 1.0, v244
  v_add_f32 v245, 1.0, v245
  v_add_f32 v246, 1.0, v246
  v_add_f32 v247, 1.0, v247
  v_max3_f32 v7, v7, v38, v39
  v_mfma_f32_32x32x16_bf16 a[192:207], a[28:31], a[124:127], a[192:207]
  ds_read_b128 a[24:27], v8 offset:3328
  v_rcp_f32 v244, v244
  v_rcp_f32 v245, v245
  v_max3_f32 v7, v7, v40, v41
  s_waitcnt lgkmcnt(3)
  v_mfma_f32_32x32x16_bf16 a[192:207], a[0:3], a[128:131], a[192:207]
  ds_read_b128 a[28:31], v9 offset:3328
  v_rcp_f32 v246, v246
  v_rcp_f32 v247, v247
  v_mul_f32 v240, v240, v244
  v_mfma_f32_32x32x16_bf16 a[192:207], a[4:7], a[132:135], a[192:207]
  s_add_u32 m0, s31, 98304
  s_add_u32 s6, s2, 229376
  s_and_b32 s6, s6, 0x3ffff
  ds_read_b128 a[0:3], v8 offset:16384
  buffer_load_dwordx4 v4, s[48:51], s6 offen offset:0 lds
  v_mfma_f32_32x32x16_bf16 a[192:207], a[8:11], a[136:139], a[192:207]
  ds_read_b128 a[4:7], v9 offset:16384
  v_mul_f32 v241, v241, v245
  v_mul_f32 v242, v242, v246
  v_mul_f32 v243, v243, v247
  v_cvt_pk_bf16_f32 v240, v240, v241
  v_cvt_pk_bf16_f32 v241, v242, v243
  v_mfma_f32_32x32x16_bf16 a[192:207], a[12:15], a[140:143], a[192:207]
  ds_read_b128 a[8:11], v8 offset:16640
  v_accvgpr_write_b32 a176, v240
  v_accvgpr_write_b32 a177, v241
  v_accvgpr_read_b32 v248, a68
  v_accvgpr_read_b32 v249, a69
  v_accvgpr_read_b32 v250, a70
  s_waitcnt lgkmcnt(3)
  v_mfma_f32_32x32x16_bf16 a[192:207], a[16:19], a[144:147], a[192:207]
  ds_read_b128 a[12:15], v9 offset:16640
  v_accvgpr_read_b32 v251, a71
  v_mul_f32 v248, v6, v248
  v_mul_f32 v249, v6, v249
  v_mul_f32 v250, v6, v250
  v_mul_f32 v251, v6, v251
  v_mfma_f32_32x32x16_bf16 a[192:207], a[20:23], a[148:151], a[192:207]
  ds_read_b128 a[16:19], v8 offset:17408
  buffer_load_dwordx4 v4, s[52:55], s6 offen offset:1024 lds
  v_mul_f32 v252, v248, v248
  v_mul_f32 v253, v249, v249
  v_mfma_f32_32x32x16_bf16 a[192:207], a[24:27], a[152:155], a[192:207]
  ds_read_b128 a[20:23], v9 offset:17408
  v_mul_f32 v254, v250, v250
  v_mul_f32 v255, v251, v251
  v_fma_f32 v252, v252, s11, 1.0
  v_fma_f32 v253, v253, s11, 1.0
  v_fma_f32 v254, v254, s11, 1.0
  v_mfma_f32_32x32x16_bf16 a[192:207], a[28:31], a[156:159], a[192:207]
  ds_read_b128 a[24:27], v8 offset:17664
  v_fma_f32 v255, v255, s11, 1.0
  v_mul_f32 v252, v248, v252
  v_mul_f32 v253, v249, v253
  v_mul_f32 v254, v250, v254
  v_mul_f32 v255, v251, v255
  s_waitcnt lgkmcnt(3)
  v_mfma_f32_32x32x16_bf16 a[208:223], a[0:3], a[96:99], 0
  ds_read_b128 a[28:31], v9 offset:17664
  v_exp_f32 v252, v252
  v_exp_f32 v253, v253
  v_max3_f32 v7, v7, v42, v43
  v_mfma_f32_32x32x16_bf16 a[208:223], a[4:7], a[100:103], a[208:223]
  ds_read_b128 a[0:3], v8 offset:18432
  buffer_load_dwordx4 v4, s[56:59], s6 offen offset:2048 lds
  v_exp_f32 v254, v254
  v_mfma_f32_32x32x16_bf16 a[208:223], a[8:11], a[104:107], a[208:223]
  ds_read_b128 a[4:7], v9 offset:18432
  v_exp_f32 v255, v255
  v_add_f32 v252, 1.0, v252
  v_add_f32 v253, 1.0, v253
  v_add_f32 v254, 1.0, v254
  v_mfma_f32_32x32x16_bf16 a[208:223], a[12:15], a[108:111], a[208:223]
  ds_read_b128 a[8:11], v8 offset:18688
  v_add_f32 v255, 1.0, v255
  v_rcp_f32 v252, v252
  v_rcp_f32 v253, v253
  s_waitcnt lgkmcnt(3)
  v_mfma_f32_32x32x16_bf16 a[208:223], a[16:19], a[112:115], a[208:223]
  ds_read_b128 a[12:15], v9 offset:18688
  v_rcp_f32 v254, v254
  v_rcp_f32 v255, v255
  v_mul_f32 v248, v248, v252
  v_mfma_f32_32x32x16_bf16 a[208:223], a[20:23], a[116:119], a[208:223]
  ds_read_b128 a[16:19], v8 offset:19456
  buffer_load_dwordx4 v4, s[60:63], s6 offen offset:3072 lds
  v_mul_f32 v249, v249, v253
  v_mul_f32 v250, v250, v254
  v_mfma_f32_32x32x16_bf16 a[208:223], a[24:27], a[120:123], a[208:223]
  ds_read_b128 a[20:23], v9 offset:19456
  v_mul_f32 v251, v251, v255
  v_cvt_pk_bf16_f32 v248, v248, v249
  v_cvt_pk_bf16_f32 v249, v250, v251
  v_accvgpr_write_b32 a178, v248
L_padh5:
  s_cbranch_execz L_padh9
  v_accvgpr_write_b32 a179, v249
  v_mfma_f32_32x32x16_bf16 a[208:223], a[28:31], a[124:127], a[208:223]
  ds_read_b128 a[24:27], v8 offset:19712
  v_accvgpr_read_b32 v240, a72
  v_accvgpr_read_b32 v241, a73
  v_accvgpr_read_b32 v242, a74
  v_accvgpr_read_b32 v243, a75
  v_mul_f32 v240, v6, v240
  s_waitcnt lgkmcnt(3)
  v_mfma_f32_32x32x16_bf16 a[208:223], a[0:3], a[128:131], a[208:223]
  ds_read_b128 a[28:31], v9 offset:19712
  v_mul_f32 v241, v6, v241
  v_mul_f32 v242, v6, v242
  v_mul_f32 v243, v6, v243
  v_mul_f32 v244, v240, v240
  v_add_u32 v8, 0xfffe0000, v8
  v_mfma_f32_32x32x16_bf16 a[208:223], a[4:7], a[132:135], a[208:223]
  s_add_u32 m0, s31, 114688
  s_add_u32 s6, s2, 245760
  s_and_b32 s6, s6, 0x3ffff
  s_waitcnt vmcnt(20)
  s_barrier
  ds_read_b128 a[0:3], v8 offset:0
  buffer_load_dwordx4 v4, s[48:51], s6 offen offset:0 lds
  v_add_u32 v9, 0xfffe0000, v9
  v_mfma_f32_32x32x16_bf16 a[208:223], a[8:11], a[136:139], a[208:223]
  ds_read_b128 a[4:7], v9 offset:0
  v_mul_f32 v245, v241, v241
  v_mul_f32 v246, v242, v242
  v_mul_f32 v247, v243, v243
  v_fma_f32 v244, v244, s11, 1.0
  v_fma_f32 v245, v245, s11, 1.0
  v_mfma_f32_32x32x16_bf16 a[208:223], a[12:15], a[140:143], a[208:223]
  ds_read_b128 a[8:11], v8 offset:256
  v_fma_f32 v246, v246, s11, 1.0
  v_fma_f32 v247, v247, s11, 1.0
  v_mul_f32 v244, v240, v244
  v_mul_f32 v245, v241, v245
  v_mul_f32 v246, v242, v246
  s_waitcnt lgkmcnt(3)
  v_mfma_f32_32x32x16_bf16 a[208:223], a[16:19], a[144:147], a[208:223]
  ds_read_b128 a[12:15], v9 offset:256
  v_mul_f32 v247, v243, v247
  v_exp_f32 v244, v244
  v_exp_f32 v245, v245
  v_mfma_f32_32x32x16_bf16 a[208:223], a[20:23], a[148:151], a[208:223]
  ds_read_b128 a[16:19], v8 offset:1024
  buffer_load_dwordx4 v4, s[52:55], s6 offen offset:1024 lds
  v_exp_f32 v246, v246
  v_mfma_f32_32x32x16_bf16 a[208:223], a[24:27], a[152:155], a[208:223]
  ds_read_b128 a[20:23], v9 offset:1024
  v_exp_f32 v247, v247
  v_add_f32 v244, 1.0, v244
  v_add_f32 v245, 1.0, v245
  v_add_f32 v246, 1.0, v246
  v_mfma_f32_32x32x16_bf16 a[208:223], a[28:31], a[156:159], a[208:223]
  ds_read_b128 a[24:27], v8 offset:1280
  v_add_f32 v247, 1.0, v247
  v_rcp_f32 v244, v244
  v_rcp_f32 v245, v245
  s_waitcnt lgkmcnt(3)
  v_mfma_f32_32x32x16_bf16 v[128:143], a[0:3], a[96:99], 0
  ds_read_b128 a[28:31], v9 offset:1280
  v_rcp_f32 v246, v246
  v_rcp_f32 v247, v247
  v_mul_f32 v240, v240, v244
  v_mfma_f32_32x32x16_bf16 v[128:143], a[4:7], a[100:103], v[128:143]
  ds_read_b128 a[0:3], v8 offset:2048
  buffer_load_dwordx4 v4, s[56:59], s6 offen offset:2048 lds
  v_mul_f32 v241, v241, v245
  v_mul_f32 v242, v242, v246
  v_mfma_f32_32x32x16_bf16 v[128:143], a[8:11], a[104:107], v[128:143]
  ds_read_b128 a[4:7], v9 offset:2048
  v_mul_f32 v243, v243, v247
  v_cvt_pk_bf16_f32 v240, v240, v241
  v_cvt_pk_bf16_f32 v241, v242, v243
  v_accvgpr_write_b32 a180, v240
  v_accvgpr_write_b32 a181, v241
  v_mfma_f32_32x32x16_bf16 v[128:143], a[12:15], a[108:111], v[128:143]
  ds_read_b128 a[8:11], v8 offset:2304
  v_accvgpr_read_b32 v248, a76
  v_accvgpr_read_b32 v249, a77
  v_accvgpr_read_b32 v250, a78
  v_accvgpr_read_b32 v251, a79
  v_mul_f32 v248, v6, v248
  s_waitcnt lgkmcnt(3)
  v_mfma_f32_32x32x16_bf16 v[128:143], a[16:19], a[112:115], v[128:143]
  ds_read_b128 a[12:15], v9 offset:2304
  v_mul_f32 v249, v6, v249
  v_mul_f32 v250, v6, v250
  v_mul_f32 v251, v6, v251
  v_mul_f32 v252, v248, v248
  v_mul_f32 v253, v249, v249
  v_mfma_f32_32x32x16_bf16 v[128:143], a[20:23], a[116:119], v[128:143]
  ds_read_b128 a[16:19], v8 offset:3072
  buffer_load_dwordx4 v4, s[60:63], s6 offen offset:3072 lds
  v_mul_f32 v254, v250, v250
  v_mul_f32 v255, v251, v251
  v_mfma_f32_32x32x16_bf16 v[128:143], a[24:27], a[120:123], v[128:143]
  ds_read_b128 a[20:23], v9 offset:3072
  v_fma_f32 v252, v252, s11, 1.0
  v_fma_f32 v253, v253, s11, 1.0
  v_fma_f32 v254, v254, s11, 1.0
  v_fma_f32 v255, v255, s11, 1.0
  v_mul_f32 v252, v248, v252
  v_mfma_f32_32x32x16_bf16 v[128:143], a[28:31], a[124:127], v[128:143]
  ds_read_b128 a[24:27], v8 offset:3328
  v_mul_f32 v253, v249, v253
  v_mul_f32 v254, v250, v254
  v_mul_f32 v255, v251, v255
  v_exp_f32 v252, v252
  s_waitcnt lgkmcnt(3)
  v_mfma_f32_32x32x16_bf16 v[128:143], a[0:3], a[128:131], v[128:143]
  ds_read_b128 a[28:31], v9 offset:3328
  v_exp_f32 v253, v253
  v_exp_f32 v254, v254
  v_max3_f32 v7, v7, v44, v45
  v_mfma_f32_32x32x16_bf16 v[128:143], a[4:7], a[132:135], v[128:143]
  s_add_u32 m0, s31, 131072
  ds_read_b128 a[0:3], v8 offset:16384
  buffer_load_dwordx4 v2, s[72:75], s15 offen offset:0 lds
  v_max3_f32 v7, v7, v46, v47
  v_mfma_f32_32x32x16_bf16 v[128:143], a[8:11], a[136:139], v[128:143]
  ds_read_b128 a[4:7], v9 offset:16384
  v_exp_f32 v255, v255
  v_add_f32 v252, 1.0, v252
  v_add_f32 v253, 1.0, v253
  v_add_f32 v254, 1.0, v254
  v_mfma_f32_32x32x16_bf16 v[128:143], a[12:15], a[140:143], v[128:143]
  ds_read_b128 a[8:11], v8 offset:16640
  v_add_f32 v255, 1.0, v255
  v_rcp_f32 v252, v252
  v_rcp_f32 v253, v253
  s_waitcnt lgkmcnt(3)
  v_mfma_f32_32x32x16_bf16 v[128:143], a[16:19], a[144:147], v[128:143]
  ds_read_b128 a[12:15], v9 offset:16640
  v_rcp_f32 v254, v254
  v_rcp_f32 v255, v255
  v_mul_f32 v248, v248, v252
  v_mfma_f32_32x32x16_bf16 v[128:143], a[20:23], a[148:151], v[128:143]
  ds_read_b128 a[16:19], v8 offset:17408
  buffer_load_dwordx4 v2, s[76:79], s15 offen offset:1024 lds
  v_mul_f32 v249, v249, v253
  v_mul_f32 v250, v250, v254
  v_mfma_f32_32x32x16_bf16 v[128:143], a[24:27], a[152:155], v[128:143]
  ds_read_b128 a[20:23], v9 offset:17408
  v_mul_f32 v251, v251, v255
  v_cvt_pk_bf16_f32 v248, v248, v249
  v_cvt_pk_bf16_f32 v249, v250, v251
  v_accvgpr_write_b32 a182, v248
  v_accvgpr_write_b32 a183, v249
  v_mfma_f32_32x32x16_bf16 v[128:143], a[28:31], a[156:159], v[128:143]
  ds_read_b128 a[24:27], v8 offset:17664
  v_accvgpr_read_b32 v240, a80
  v_accvgpr_read_b32 v241, a81
  v_accvgpr_read_b32 v242, a82
  v_accvgpr_read_b32 v243, a83
  v_mul_f32 v240, v6, v240
  s_waitcnt lgkmcnt(3)
  v_mfma_f32_32x32x16_bf16 v[144:159], a[0:3], a[96:99], 0
  ds_read_b128 a[28:31], v9 offset:17664
  v_mul_f32 v241, v6, v241
  v_mul_f32 v242, v6, v242
  v_mul_f32 v243, v6, v243
  v_mul_f32 v244, v240, v240
  v_mul_f32 v245, v241, v241
  v_mfma_f32_32x32x16_bf16 v[144:159], a[4:7], a[100:103], v[144:159]
  ds_read_b128 a[0:3], v8 offset:18432
  buffer_load_dwordx4 v2, s[80:83], s15 offen offset:2048 lds
  v_mul_f32 v246, v242, v242
  v_mul_f32 v247, v243, v243
  v_mfma_f32_32x32x16_bf16 v[144:159], a[8:11], a[104:107], v[144:159]
  ds_read_b128 a[4:7], v9 offset:18432
  v_fma_f32 v244, v244, s11, 1.0
  v_fma_f32 v245, v245, s11, 1.0
  v_fma_f32 v246, v246, s11, 1.0
  v_fma_f32 v247, v247, s11, 1.0
  v_mul_f32 v244, v240, v244
  v_mfma_f32_32x32x16_bf16 v[144:159], a[12:15], a[108:111], v[144:159]
  ds_read_b128 a[8:11], v8 offset:18688
  v_mul_f32 v245, v241, v245
  v_mul_f32 v246, v242, v246
  v_mul_f32 v247, v243, v247
  v_exp_f32 v244, v244
  s_waitcnt lgkmcnt(3)
  v_mfma_f32_32x32x16_bf16 v[144:159], a[16:19], a[112:115], v[144:159]
  ds_read_b128 a[12:15], v9 offset:18688
  v_exp_f32 v245, v245
  v_exp_f32 v246, v246
  v_max3_f32 v7, v7, v48, v49
  v_mfma_f32_32x32x16_bf16 v[144:159], a[20:23], a[116:119], v[144:159]
  ds_read_b128 a[16:19], v8 offset:19456
  buffer_load_dwordx4 v2, s[84:87], s15 offen offset:3072 lds
  v_exp_f32 v247, v247
  v_mfma_f32_32x32x16_bf16 v[144:159], a[24:27], a[120:123], v[144:159]
  ds_read_b128 a[20:23], v9 offset:19456
  v_add_f32 v244, 1.0, v244
  v_add_f32 v245, 1.0, v245
  v_add_f32 v246, 1.0, v246
  v_add_f32 v247, 1.0, v247
  v_max3_f32 v7, v7, v50, v51
  v_mfma_f32_32x32x16_bf16 v[144:159], a[28:31], a[124:127], v[144:159]
  ds_read_b128 a[24:27], v8 offset:19712
  v_rcp_f32 v244, v244
  v_rcp_f32 v245, v245
  v_max3_f32 v7, v7, v52, v53
  s_waitcnt lgkmcnt(3)
  v_mfma_f32_32x32x16_bf16 v[144:159], a[0:3], a[128:131], v[144:159]
  ds_read_b128 a[28:31], v9 offset:19712
  v_rcp_f32 v246, v246
  v_rcp_f32 v247, v247
  v_mul_f32 v240, v240, v244
  v_mfma_f32_32x32x16_bf16 v[144:159], a[4:7], a[132:135], v[144:159]
  s_add_u32 m0, s31, 147456
  s_add_u32 s6, s2, 0
  s_and_b32 s6, s6, 0x3ffff
  s_waitcnt vmcnt(20)
  s_barrier
  ds_read_b128 a[0:3], v8 offset:32768
  buffer_load_dwordx4 v1, s[64:67], s6 offen offset:0 lds
  v_mfma_f32_32x32x16_bf16 v[144:159], a[8:11], a[136:139], v[144:159]
  ds_read_b128 a[4:7], v9 offset:32768
  v_mul_f32 v241, v241, v245
  v_mul_f32 v242, v242, v246
  v_mul_f32 v243, v243, v247
  v_cvt_pk_bf16_f32 v240, v240, v241
  v_cvt_pk_bf16_f32 v241, v242, v243
  v_mfma_f32_32x32x16_bf16 v[144:159], a[12:15], a[140:143], v[144:159]
  ds_read_b128 a[8:11], v8 offset:33024
  s_mov_b32 s48, s12
  s_mov_b32 s49, s13
  s_mov_b32 s50, 0x00038000
  s_mov_b32 s51, 0x00020000
  v_accvgpr_write_b32 a184, v240
  s_waitcnt lgkmcnt(3)
  v_mfma_f32_32x32x16_bf16 v[144:159], a[16:19], a[144:147], v[144:159]
  ds_read_b128 a[12:15], v9 offset:33024
  s_add_u32 s52, s48, 0x00001800
  s_addc_u32 s53, s49, 0
  s_sub_u32 s54, s50, 0x00001800
  s_mov_b32 s55, 0x00020000
  v_accvgpr_write_b32 a185, v241
  v_mfma_f32_32x32x16_bf16 v[144:159], a[20:23], a[148:151], v[144:159]
  ds_read_b128 a[16:19], v8 offset:33792
  buffer_load_dwordx4 v1, s[68:71], s6 offen offset:1024 lds
  s_add_u32 s56, s48, 0x00003000
  s_addc_u32 s57, s49, 0
  v_mfma_f32_32x32x16_bf16 v[144:159], a[24:27], a[152:155], v[144:159]
  ds_read_b128 a[20:23], v9 offset:33792
  s_sub_u32 s58, s50, 0x00003000
  s_mov_b32 s59, 0x00020000
  s_add_u32 s60, s48, 0x00004800
  s_addc_u32 s61, s49, 0
  s_sub_u32 s62, s50, 0x00004800
  v_mfma_f32_32x32x16_bf16 v[144:159], a[28:31], a[156:159], v[144:159]
  ds_read_b128 a[24:27], v8 offset:34048
  s_mov_b32 s63, 0x00020000
  v_accvgpr_read_b32 v248, a84
  v_accvgpr_read_b32 v249, a85
  v_accvgpr_read_b32 v250, a86
  v_accvgpr_read_b32 v251, a87
  s_waitcnt lgkmcnt(3)
  v_mfma_f32_32x32x16_bf16 v[160:175], a[0:3], a[96:99], 0
  ds_read_b128 a[28:31], v9 offset:34048
  v_mul_f32 v248, v6, v248
  v_mul_f32 v249, v6, v249
  v_mul_f32 v250, v6, v250
  v_mul_f32 v251, v6, v251
  v_mul_f32 v252, v248, v248
  v_mfma_f32_32x32x16_bf16 v[160:175], a[4:7], a[100:103], v[160:175]
  ds_read_b128 a[0:3], v8 offset:34816
  buffer_load_dwordx4 v1, s[64:67], s6 offen offset:2048 lds
  v_mul_f32 v253, v249, v249
  v_mul_f32 v254, v250, v250
  v_mfma_f32_32x32x16_bf16 v[160:175], a[8:11], a[104:107], v[160:175]
  ds_read_b128 a[4:7], v9 offset:34816
  v_mul_f32 v255, v251, v251
  v_fma_f32 v252, v252, s11, 1.0
  v_fma_f32 v253, v253, s11, 1.0
  v_fma_f32 v254, v254, s11, 1.0
  v_fma_f32 v255, v255, s11, 1.0
  v_mfma_f32_32x32x16_bf16 v[160:175], a[12:15], a[108:111], v[160:175]
  ds_read_b128 a[8:11], v8 offset:35072
  v_mul_f32 v252, v248, v252
  v_mul_f32 v253, v249, v253
  v_mul_f32 v254, v250, v254
  v_mul_f32 v255, v251, v255
  v_max3_f32 v7, v7, v54, v55
  s_waitcnt lgkmcnt(3)
  v_mfma_f32_32x32x16_bf16 v[160:175], a[16:19], a[112:115], v[160:175]
  ds_read_b128 a[12:15], v9 offset:35072
  v_exp_f32 v252, v252
  v_exp_f32 v253, v253
  v_max3_f32 v7, v7, v56, v57
  v_mfma_f32_32x32x16_bf16 v[160:175], a[20:23], a[116:119], v[160:175]
  ds_read_b128 a[16:19], v8 offset:35840
  buffer_load_dwordx4 v1, s[68:71], s6 offen offset:3072 lds
  v_exp_f32 v254, v254
  v_mfma_f32_32x32x16_bf16 v[160:175], a[24:27], a[120:123], v[160:175]
  ds_read_b128 a[20:23], v9 offset:35840
  v_exp_f32 v255, v255
  v_add_f32 v252, 1.0, v252
  v_add_f32 v253, 1.0, v253
  v_add_f32 v254, 1.0, v254
  v_mfma_f32_32x32x16_bf16 v[160:175], a[28:31], a[124:127], v[160:175]
  ds_read_b128 a[24:27], v8 offset:36096
  v_add_f32 v255, 1.0, v255
  v_rcp_f32 v252, v252
  v_rcp_f32 v253, v253
  s_waitcnt lgkmcnt(3)
  v_mfma_f32_32x32x16_bf16 v[160:175], a[0:3], a[128:131], v[160:175]
  ds_read_b128 a[28:31], v9 offset:36096
  v_rcp_f32 v254, v254
  v_rcp_f32 v255, v255
  v_mul_f32 v248, v248, v252
  v_mfma_f32_32x32x16_bf16 v[160:175], a[4:7], a[132:135], v[160:175]
  s_add_u32 m0, s31, 0
  ds_read_b128 a[0:3], v8 offset:49152
  buffer_load_dwordx4 v2, s[72:75], s16 offen offset:0 lds
  v_mul_f32 v249, v249, v253
  v_mfma_f32_32x32x16_bf16 v[160:175], a[8:11], a[136:139], v[160:175]
  ds_read_b128 a[4:7], v9 offset:49152
  v_mul_f32 v250, v250, v254
  v_mul_f32 v251, v251, v255
  v_cvt_pk_bf16_f32 v248, v248, v249
  v_cvt_pk_bf16_f32 v249, v250, v251
  v_accvgpr_write_b32 a186, v248
  v_mfma_f32_32x32x16_bf16 v[160:175], a[12:15], a[140:143], v[160:175]
  ds_read_b128 a[8:11], v8 offset:49408
  v_accvgpr_write_b32 a187, v249
  v_accvgpr_read_b32 v240, a88
  v_accvgpr_read_b32 v241, a89
  v_accvgpr_read_b32 v242, a90
  v_accvgpr_read_b32 v243, a91
  s_waitcnt lgkmcnt(3)
  v_mfma_f32_32x32x16_bf16 v[160:175], a[16:19], a[144:147], v[160:175]
  ds_read_b128 a[12:15], v9 offset:49408
  v_mul_f32 v240, v6, v240
  v_mul_f32 v241, v6, v241
  v_mul_f32 v242, v6, v242
  v_mul_f32 v243, v6, v243
  v_mul_f32 v244, v240, v240
  v_mfma_f32_32x32x16_bf16 v[160:175], a[20:23], a[148:151], v[160:175]
  ds_read_b128 a[16:19], v8 offset:50176
  buffer_load_dwordx4 v2, s[76:79], s16 offen offset:1024 lds
  v_mul_f32 v245, v241, v241
  v_mul_f32 v246, v242, v242
  v_mfma_f32_32x32x16_bf16 v[160:175], a[24:27], a[152:155], v[160:175]
  ds_read_b128 a[20:23], v9 offset:50176
  v_mul_f32 v247, v243, v243
  v_fma_f32 v244, v244, s11, 1.0
  v_fma_f32 v245, v245, s11, 1.0
  v_fma_f32 v246, v246, s11, 1.0
  v_fma_f32 v247, v247, s11, 1.0
  v_mfma_f32_32x32x16_bf16 v[160:175], a[28:31], a[156:159], v[160:175]
  ds_read_b128 a[24:27], v8 offset:50432
  v_mul_f32 v244, v240, v244
  v_mul_f32 v245, v241, v245
  v_mul_f32 v246, v242, v246
  v_mul_f32 v247, v243, v247
  v_max3_f32 v7, v7, v58, v59
  s_waitcnt lgkmcnt(3)
  v_mfma_f32_32x32x16_bf16 v[176:191], a[0:3], a[96:99], 0
  ds_read_b128 a[28:31], v9 offset:50432
  v_exp_f32 v244, v244
  v_exp_f32 v245, v245
  v_max3_f32 v7, v7, v60, v61
  v_mfma_f32_32x32x16_bf16 v[176:191], a[4:7], a[100:103], v[176:191]
  ds_read_b128 a[0:3], v8 offset:51200
  buffer_load_dwordx4 v2, s[80:83], s16 offen offset:2048 lds
  v_exp_f32 v246, v246
  v_mfma_f32_32x32x16_bf16 v[176:191], a[8:11], a[104:107], v[176:191]
  ds_read_b128 a[4:7], v9 offset:51200
  v_exp_f32 v247, v247
  v_add_f32 v244, 1.0, v244
  v_add_f32 v245, 1.0, v245
  v_add_f32 v246, 1.0, v246
  v_mfma_f32_32x32x16_bf16 v[176:191], a[12:15], a[108:111], v[176:191]
  ds_read_b128 a[8:11], v8 offset:51456
  v_add_f32 v247, 1.0, v247
  v_rcp_f32 v244, v244
  v_rcp_f32 v245, v245
  s_waitcnt lgkmcnt(3)
  v_mfma_f32_32x32x16_bf16 v[176:191], a[16:19], a[112:115], v[176:191]
  ds_read_b128 a[12:15], v9 offset:51456
  v_rcp_f32 v246, v246
  v_rcp_f32 v247, v247
  v_mul_f32 v240, v240, v244
  v_mfma_f32_32x32x16_bf16 v[176:191], a[20:23], a[116:119], v[176:191]
  ds_read_b128 a[16:19], v8 offset:52224
  buffer_load_dwordx4 v2, s[84:87], s16 offen offset:3072 lds
  v_mul_f32 v241, v241, v245
  v_mul_f32 v242, v242, v246
  v_mfma_f32_32x32x16_bf16 v[176:191], a[24:27], a[120:123], v[176:191]
  ds_read_b128 a[20:23], v9 offset:52224
  v_mul_f32 v243, v243, v247
  v_cvt_pk_bf16_f32 v240, v240, v241
  v_cvt_pk_bf16_f32 v241, v242, v243
  v_accvgpr_write_b32 a188, v240
  v_accvgpr_write_b32 a189, v241
  v_mfma_f32_32x32x16_bf16 v[176:191], a[28:31], a[124:127], v[176:191]
  ds_read_b128 a[24:27], v8 offset:52480
  v_accvgpr_read_b32 v248, a92
  v_accvgpr_read_b32 v249, a93
  v_accvgpr_read_b32 v250, a94
  v_accvgpr_read_b32 v251, a95
  v_mul_f32 v248, v6, v248
  s_waitcnt lgkmcnt(3)
  v_mfma_f32_32x32x16_bf16 v[176:191], a[0:3], a[128:131], v[176:191]
  ds_read_b128 a[28:31], v9 offset:52480
  v_mul_f32 v249, v6, v249
  v_mul_f32 v250, v6, v250
  v_mul_f32 v251, v6, v251
  v_mul_f32 v252, v248, v248
  v_add_u32 v8, 0x00010000, v8
  v_mfma_f32_32x32x16_bf16 v[176:191], a[4:7], a[132:135], v[176:191]
  s_add_u32 m0, s31, 16384
  s_add_u32 s6, s2, 16384
  s_and_b32 s6, s6, 0x3ffff
  s_waitcnt vmcnt(20)
  s_barrier
  ds_read_b128 a[0:3], v8 offset:0
  buffer_load_dwordx4 v1, s[64:67], s6 offen offset:0 lds
  v_add_u32 v9, 0x00010000, v9
  v_mfma_f32_32x32x16_bf16 v[176:191], a[8:11], a[136:139], v[176:191]
  ds_read_b128 a[4:7], v9 offset:0
  v_mul_f32 v253, v249, v249
  v_mul_f32 v254, v250, v250
  v_mul_f32 v255, v251, v251
  v_fma_f32 v252, v252, s11, 1.0
  v_fma_f32 v253, v253, s11, 1.0
  v_mfma_f32_32x32x16_bf16 v[176:191], a[12:15], a[140:143], v[176:191]
  ds_read_b128 a[8:11], v8 offset:256
  v_fma_f32 v254, v254, s11, 1.0
  v_fma_f32 v255, v255, s11, 1.0
  v_mul_f32 v252, v248, v252
  v_mul_f32 v253, v249, v253
  v_mul_f32 v254, v250, v254
  s_waitcnt lgkmcnt(3)
  v_mfma_f32_32x32x16_bf16 v[176:191], a[16:19], a[144:147], v[176:191]
  ds_read_b128 a[12:15], v9 offset:256
  v_mul_f32 v255, v251, v255
  v_exp_f32 v252, v252
  v_exp_f32 v253, v253
  v_mfma_f32_32x32x16_bf16 v[176:191], a[20:23], a[148:151], v[176:191]
  ds_read_b128 a[16:19], v8 offset:1024
  buffer_load_dwordx4 v1, s[68:71], s6 offen offset:1024 lds
  v_exp_f32 v254, v254
  v_mfma_f32_32x32x16_bf16 v[176:191], a[24:27], a[152:155], v[176:191]
  ds_read_b128 a[20:23], v9 offset:1024
  v_exp_f32 v255, v255
  v_add_f32 v252, 1.0, v252
  v_add_f32 v253, 1.0, v253
  v_add_f32 v254, 1.0, v254
  v_mfma_f32_32x32x16_bf16 v[176:191], a[28:31], a[156:159], v[176:191]
  ds_read_b128 a[24:27], v8 offset:1280
  v_add_f32 v255, 1.0, v255
  v_rcp_f32 v252, v252
  v_rcp_f32 v253, v253
  s_waitcnt lgkmcnt(3)
  v_mfma_f32_32x32x16_bf16 v[192:207], a[0:3], a[96:99], 0
  ds_read_b128 a[28:31], v9 offset:1280
  v_rcp_f32 v254, v254
  v_rcp_f32 v255, v255
  v_mul_f32 v248, v248, v252
  v_mfma_f32_32x32x16_bf16 v[192:207], a[4:7], a[100:103], v[192:207]
  ds_read_b128 a[0:3], v8 offset:2048
  buffer_load_dwordx4 v1, s[64:67], s6 offen offset:2048 lds
  v_mul_f32 v249, v249, v253
  v_mul_f32 v250, v250, v254
  v_mfma_f32_32x32x16_bf16 v[192:207], a[8:11], a[104:107], v[192:207]
  ds_read_b128 a[4:7], v9 offset:2048
  v_mul_f32 v251, v251, v255
  v_cvt_pk_bf16_f32 v248, v248, v249
  v_cvt_pk_bf16_f32 v249, v250, v251
  v_accvgpr_write_b32 a190, v248
  v_accvgpr_write_b32 a191, v249
  v_mfma_f32_32x32x16_bf16 v[192:207], a[12:15], a[108:111], v[192:207]
  ds_read_b128 a[8:11], v8 offset:2304
  v_max3_f32 v7, v7, v62, v63
  v_max3_f32 v7, v7, v64, v65
  v_max3_f32 v7, v7, v66, v67
  v_max3_f32 v7, v7, v68, v69
  v_max3_f32 v7, v7, v70, v71
  s_waitcnt lgkmcnt(3)
  v_mfma_f32_32x32x16_bf16 v[192:207], a[16:19], a[112:115], v[192:207]
  ds_read_b128 a[12:15], v9 offset:2304
  v_max3_f32 v7, v7, v72, v73
  v_max3_f32 v7, v7, v74, v75
  v_max3_f32 v7, v7, v76, v77
  v_max3_f32 v7, v7, v78, v79
  v_max3_f32 v7, v7, v80, v81
  v_mfma_f32_32x32x16_bf16 v[192:207], a[20:23], a[116:119], v[192:207]
  ds_read_b128 a[16:19], v8 offset:3072
  buffer_load_dwordx4 v1, s[68:71], s6 offen offset:3072 lds
  v_max3_f32 v7, v7, v82, v83
  v_max3_f32 v7, v7, v84, v85
  v_mfma_f32_32x32x16_bf16 v[192:207], a[24:27], a[120:123], v[192:207]
  ds_read_b128 a[20:23], v9 offset:3072
  v_max3_f32 v7, v7, v86, v87
  v_max3_f32 v7, v7, v88, v89
  v_max3_f32 v7, v7, v90, v91
  v_max3_f32 v7, v7, v92, v93
  v_max3_f32 v7, v7, v94, v95
  v_mfma_f32_32x32x16_bf16 v[192:207], a[28:31], a[124:127], v[192:207]
  ds_read_b128 a[24:27], v8 offset:3328
  v_max3_f32 v7, v7, v96, v97
  v_max3_f32 v7, v7, v98, v99
  v_max3_f32 v7, v7, v100, v101
  v_max3_f32 v7, v7, v102, v103
  v_max3_f32 v7, v7, v104, v105
  s_waitcnt lgkmcnt(3)
  v_mfma_f32_32x32x16_bf16 v[192:207], a[0:3], a[128:131], v[192:207]
  ds_read_b128 a[28:31], v9 offset:3328
  v_max3_f32 v7, v7, v106, v107
  v_max3_f32 v7, v7, v108, v109
  v_max3_f32 v7, v7, v110, v111
  v_max3_f32 v7, v7, v112, v113
  v_add_u32 v3, 0x00010000, v3
  v_mfma_f32_32x32x16_bf16 v[192:207], a[4:7], a[132:135], v[192:207]
  s_add_u32 m0, s31, 32768
  ds_read_b64_tr_b16 a[0:1], v3 offset:16384
  ds_read_b64_tr_b16 a[2:3], v3 offset:16896
  buffer_load_dwordx4 v2, s[72:75], s17 offen offset:0 lds
  v_mfma_f32_32x32x16_bf16 v[192:207], a[8:11], a[136:139], v[192:207]
  ds_read_b64_tr_b16 a[4:5], v3 offset:18432
  ds_read_b64_tr_b16 a[6:7], v3 offset:18944
  v_max3_f32 v7, v7, v114, v115
  v_max3_f32 v7, v7, v116, v117
  v_max3_f32 v7, v7, v118, v119
  v_max3_f32 v7, v7, v120, v121
  v_mfma_f32_32x32x16_bf16 v[192:207], a[12:15], a[140:143], v[192:207]
  ds_read_b64_tr_b16 a[8:9], v3 offset:20480
  ds_read_b64_tr_b16 a[10:11], v3 offset:20992
  v_max3_f32 v7, v7, v122, v123
  v_max3_f32 v7, v7, v124, v125
  v_max3_f32 v7, v7, v126, v127
  v_accvgpr_read_b32 v13, a192
  s_waitcnt lgkmcnt(6)
  v_mfma_f32_32x32x16_bf16 v[192:207], a[16:19], a[144:147], v[192:207]
  ds_read_b64_tr_b16 a[12:13], v3 offset:22528
  ds_read_b64_tr_b16 a[14:15], v3 offset:23040
  v_accvgpr_read_b32 v14, a193
  v_accvgpr_read_b32 v15, a194
  v_accvgpr_read_b32 v11, a195
  v_max3_f32 v7, v7, v13, v14
  v_mfma_f32_32x32x16_bf16 v[192:207], a[20:23], a[148:151], v[192:207]
  ds_read_b64_tr_b16 a[16:17], v3 offset:24576
  ds_read_b64_tr_b16 a[18:19], v3 offset:25088
  buffer_load_dwordx4 v2, s[76:79], s17 offen offset:1024 lds
  v_max3_f32 v7, v7, v15, v11
  v_mfma_f32_32x32x16_bf16 v[192:207], a[24:27], a[152:155], v[192:207]
  ds_read_b64_tr_b16 a[20:21], v3 offset:26624
  ds_read_b64_tr_b16 a[22:23], v3 offset:27136
  v_accvgpr_read_b32 v13, a196
  v_accvgpr_read_b32 v14, a197
  v_accvgpr_read_b32 v15, a198
  v_accvgpr_read_b32 v11, a199
  v_mfma_f32_32x32x16_bf16 v[192:207], a[28:31], a[156:159], v[192:207]
  ds_read_b64_tr_b16 a[24:25], v3 offset:28672
  ds_read_b64_tr_b16 a[26:27], v3 offset:29184
  v_max3_f32 v7, v7, v13, v14
  v_max3_f32 v7, v7, v15, v11
  v_accvgpr_read_b32 v13, a200
  v_accvgpr_read_b32 v14, a201
  s_waitcnt lgkmcnt(6)
  v_mfma_f32_32x32x16_bf16 v[240:255], a[0:3], a[160:163], 0
  ds_read_b64_tr_b16 a[28:29], v3 offset:30720
  ds_read_b64_tr_b16 a[30:31], v3 offset:31232
  v_accvgpr_read_b32 v15, a202
  v_accvgpr_read_b32 v11, a203
  v_max3_f32 v7, v7, v13, v14
  v_max3_f32 v7, v7, v15, v11
  v_mfma_f32_32x32x16_bf16 v[240:255], a[4:7], a[164:167], v[240:255]
  s_waitcnt vmcnt(18)
  s_barrier
  ds_read_b128 a[0:3], v8 offset:32768
  buffer_load_dwordx4 v2, s[80:83], s17 offen offset:2048 lds
  v_mfma_f32_32x32x16_bf16 v[240:255], a[8:11], a[168:171], v[240:255]
  ds_read_b128 a[4:7], v9 offset:32768
  v_accvgpr_read_b32 v13, a204
  v_accvgpr_read_b32 v14, a205
  v_accvgpr_read_b32 v15, a206
  v_accvgpr_read_b32 v11, a207
  v_max3_f32 v7, v7, v13, v14
  v_mfma_f32_32x32x16_bf16 v[240:255], a[12:15], a[172:175], v[240:255]
  ds_read_b128 a[8:11], v8 offset:33024
  v_max3_f32 v7, v7, v15, v11
  v_accvgpr_read_b32 v13, a208
  v_accvgpr_read_b32 v14, a209
  v_accvgpr_read_b32 v15, a210
  v_accvgpr_read_b32 v11, a211
  s_waitcnt lgkmcnt(3)
  v_mfma_f32_32x32x16_bf16 v[240:255], a[16:19], a[176:179], v[240:255]
  ds_read_b128 a[12:15], v9 offset:33024
  v_max3_f32 v7, v7, v13, v14
  v_max3_f32 v7, v7, v15, v11
  v_accvgpr_read_b32 v13, a212
  v_accvgpr_read_b32 v14, a213
  v_accvgpr_read_b32 v15, a214
  v_mfma_f32_32x32x16_bf16 v[240:255], a[20:23], a[180:183], v[240:255]
  ds_read_b128 a[16:19], v8 offset:33792
  buffer_load_dwordx4 v2, s[84:87], s17 offen offset:3072 lds
  v_accvgpr_read_b32 v11, a215
  v_max3_f32 v7, v7, v13, v14
  v_mfma_f32_32x32x16_bf16 v[240:255], a[24:27], a[184:187], v[240:255]
  ds_read_b128 a[20:23], v9 offset:33792
  v_max3_f32 v7, v7, v15, v11
  v_accvgpr_read_b32 v13, a216
  v_accvgpr_read_b32 v14, a217
  v_accvgpr_read_b32 v15, a218
  v_accvgpr_read_b32 v11, a219
  v_mfma_f32_32x32x16_bf16 v[240:255], a[28:31], a[188:191], v[240:255]
  ds_read_b128 a[24:27], v8 offset:34048
  v_max3_f32 v7, v7, v13, v14
L_padh6:
  s_cbranch_execz L_padh10
  v_max3_f32 v7, v7, v15, v11
  v_accvgpr_read_b32 v13, a220
  v_accvgpr_read_b32 v14, a221
  v_accvgpr_read_b32 v15, a222
  s_waitcnt lgkmcnt(3)
  v_mfma_f32_32x32x16_bf16 v[208:223], a[0:3], a[96:99], 0
  ds_read_b128 a[28:31], v9 offset:34048
  v_accvgpr_read_b32 v11, a223
  v_max3_f32 v7, v7, v13, v14
  v_max3_f32 v7, v7, v15, v11
  v_max3_f32 v7, v7, v128, v129
  v_max3_f32 v7, v7, v130, v131
  v_mfma_f32_32x32x16_bf16 v[208:223], a[4:7], a[100:103], v[208:223]
  s_add_u32 m0, s31, 49152
  s_add_u32 s6, s2, 32768
  s_and_b32 s6, s6, 0x3ffff
  ds_read_b128 a[0:3], v8 offset:34816
  buffer_load_dwordx4 v1, s[64:67], s6 offen offset:0 lds
  v_mfma_f32_32x32x16_bf16 v[208:223], a[8:11], a[104:107], v[208:223]
  ds_read_b128 a[4:7], v9 offset:34816
  s_mul_i32 s7, s14, 65536
  s_add_u32 s7, s7, s21
  v_cvt_pk_bf16_f32 v240, v240, v241
  v_cvt_pk_bf16_f32 v241, v242, v243
  v_cvt_pk_bf16_f32 v242, v244, v245
  v_mfma_f32_32x32x16_bf16 v[208:223], a[12:15], a[108:111], v[208:223]
  ds_read_b128 a[8:11], v8 offset:35072
  v_cvt_pk_bf16_f32 v243, v246, v247
  v_cvt_pk_bf16_f32 v244, v248, v249
  v_cvt_pk_bf16_f32 v245, v250, v251
  v_cvt_pk_bf16_f32 v246, v252, v253
  v_cvt_pk_bf16_f32 v247, v254, v255
  s_waitcnt lgkmcnt(3)
  v_mfma_f32_32x32x16_bf16 v[208:223], a[16:19], a[112:115], v[208:223]
  ds_read_b128 a[12:15], v9 offset:35072
  buffer_store_dwordx4 v[240:243], v12, s[88:91], s7 offen offset:0 sc1
  v_max3_f32 v7, v7, v132, v133
  v_max3_f32 v7, v7, v134, v135
  v_max3_f32 v7, v7, v136, v137
  v_mfma_f32_32x32x16_bf16 v[208:223], a[20:23], a[116:119], v[208:223]
  ds_read_b128 a[16:19], v8 offset:35840
  buffer_load_dwordx4 v1, s[68:71], s6 offen offset:1024 lds
  v_max3_f32 v7, v7, v138, v139
  v_max3_f32 v7, v7, v140, v141
  v_mfma_f32_32x32x16_bf16 v[208:223], a[24:27], a[120:123], v[208:223]
  ds_read_b128 a[20:23], v9 offset:35840
  buffer_store_dwordx4 v[244:247], v12, s[88:91], s7 offen offset:1024 sc1
  v_max3_f32 v7, v7, v142, v143
  v_max3_f32 v7, v7, v144, v145
  v_max3_f32 v7, v7, v146, v147
  v_mfma_f32_32x32x16_bf16 v[208:223], a[28:31], a[124:127], v[208:223]
  ds_read_b128 a[24:27], v8 offset:36096
  v_max3_f32 v7, v7, v148, v149
  v_max3_f32 v7, v7, v150, v151
  v_max3_f32 v7, v7, v152, v153
  v_max3_f32 v7, v7, v154, v155
  v_max3_f32 v7, v7, v156, v157
  s_waitcnt lgkmcnt(3)
  v_mfma_f32_32x32x16_bf16 v[208:223], a[0:3], a[128:131], v[208:223]
  ds_read_b128 a[28:31], v9 offset:36096
  v_max3_f32 v7, v7, v158, v159
  v_max3_f32 v7, v7, v160, v161
  v_max3_f32 v7, v7, v162, v163
  v_max3_f32 v7, v7, v164, v165
  v_max3_f32 v7, v7, v166, v167
  v_mfma_f32_32x32x16_bf16 v[208:223], a[4:7], a[132:135], v[208:223]
  ds_read_b64_tr_b16 a[0:1], v3 offset:16640
  ds_read_b64_tr_b16 a[2:3], v3 offset:17152
  buffer_load_dwordx4 v1, s[64:67], s6 offen offset:2048 lds
  v_max3_f32 v7, v7, v168, v169
  v_mfma_f32_32x32x16_bf16 v[208:223], a[8:11], a[136:139], v[208:223]
  ds_read_b64_tr_b16 a[4:5], v3 offset:18688
  ds_read_b64_tr_b16 a[6:7], v3 offset:19200
  v_max3_f32 v7, v7, v170, v171
  v_max3_f32 v7, v7, v172, v173
  v_max3_f32 v7, v7, v174, v175
  v_max3_f32 v7, v7, v176, v177
  v_mfma_f32_32x32x16_bf16 v[208:223], a[12:15], a[140:143], v[208:223]
  ds_read_b64_tr_b16 a[8:9], v3 offset:20736
  ds_read_b64_tr_b16 a[10:11], v3 offset:21248
  v_max3_f32 v7, v7, v178, v179
  v_max3_f32 v7, v7, v180, v181
  v_max3_f32 v7, v7, v182, v183
  v_max3_f32 v7, v7, v184, v185
  s_waitcnt lgkmcnt(6)
  v_mfma_f32_32x32x16_bf16 v[208:223], a[16:19], a[144:147], v[208:223]
  ds_read_b64_tr_b16 a[12:13], v3 offset:22784
  ds_read_b64_tr_b16 a[14:15], v3 offset:23296
  v_max3_f32 v7, v7, v186, v187
  v_max3_f32 v7, v7, v188, v189
  v_max3_f32 v7, v7, v190, v191
  v_max3_f32 v7, v7, v192, v193
  v_mfma_f32_32x32x16_bf16 v[208:223], a[20:23], a[148:151], v[208:223]
  ds_read_b64_tr_b16 a[16:17], v3 offset:24832
  ds_read_b64_tr_b16 a[18:19], v3 offset:25344
  buffer_load_dwordx4 v1, s[68:71], s6 offen offset:3072 lds
  v_max3_f32 v7, v7, v194, v195
  v_mfma_f32_32x32x16_bf16 v[208:223], a[24:27], a[152:155], v[208:223]
  ds_read_b64_tr_b16 a[20:21], v3 offset:26880
  ds_read_b64_tr_b16 a[22:23], v3 offset:27392
  v_max3_f32 v7, v7, v196, v197
  v_max3_f32 v7, v7, v198, v199
  v_max3_f32 v7, v7, v200, v201
  v_max3_f32 v7, v7, v202, v203
  v_mfma_f32_32x32x16_bf16 v[208:223], a[28:31], a[156:159], v[208:223]
  ds_read_b64_tr_b16 a[24:25], v3 offset:28928
  ds_read_b64_tr_b16 a[26:27], v3 offset:29440
  v_max3_f32 v7, v7, v204, v205
  v_max3_f32 v7, v7, v206, v207
  v_accvgpr_read_b32 v4, a240
  s_waitcnt lgkmcnt(6)
  v_mfma_f32_32x32x16_bf16 v[240:255], a[0:3], a[160:163], 0
  ds_read_b64_tr_b16 a[28:29], v3 offset:30976
  ds_read_b64_tr_b16 a[30:31], v3 offset:31488
  v_mfma_f32_32x32x16_bf16 v[240:255], a[4:7], a[164:167], v[240:255]
  s_add_u32 m0, s31, 65536
  ds_read_b128 a[0:3], v8 offset:49152
  buffer_load_dwordx4 v2, s[72:75], s18 offen offset:0 lds
  v_mfma_f32_32x32x16_bf16 v[240:255], a[8:11], a[168:171], v[240:255]
  ds_read_b128 a[4:7], v9 offset:49152
  v_max3_f32 v7, v7, v208, v209
  v_max3_f32 v7, v7, v210, v211
  v_max3_f32 v7, v7, v212, v213
  v_max3_f32 v7, v7, v214, v215
  v_max3_f32 v7, v7, v216, v217
  v_mfma_f32_32x32x16_bf16 v[240:255], a[12:15], a[172:175], v[240:255]
  ds_read_b128 a[8:11], v8 offset:49408
  v_max3_f32 v7, v7, v218, v219
  v_max3_f32 v7, v7, v220, v221
  v_max3_f32 v7, v7, v222, v223
  s_waitcnt lgkmcnt(3)
  v_mfma_f32_32x32x16_bf16 v[240:255], a[16:19], a[176:179], v[240:255]
  ds_read_b128 a[12:15], v9 offset:49408
  v_mfma_f32_32x32x16_bf16 v[240:255], a[20:23], a[180:183], v[240:255]
  ds_read_b128 a[16:19], v8 offset:50176
  buffer_load_dwordx4 v2, s[76:79], s18 offen offset:1024 lds
  v_mfma_f32_32x32x16_bf16 v[240:255], a[24:27], a[184:187], v[240:255]
  ds_read_b128 a[20:23], v9 offset:50176
  v_mfma_f32_32x32x16_bf16 v[240:255], a[28:31], a[188:191], v[240:255]
  ds_read_b128 a[24:27], v8 offset:50432
  buffer_load_dwordx4 v2, s[80:83], s18 offen offset:2048 lds
  s_waitcnt lgkmcnt(3)
  v_mfma_f32_32x32x16_bf16 v[224:239], a[0:3], a[96:99], 0
  ds_read_b128 a[28:31], v9 offset:50432
  v_mfma_f32_32x32x16_bf16 v[224:239], a[4:7], a[100:103], v[224:239]
  ds_read_b128 a[0:3], v8 offset:51200
  buffer_load_dwordx4 v2, s[84:87], s18 offen offset:3072 lds
  v_mfma_f32_32x32x16_bf16 v[224:239], a[8:11], a[104:107], v[224:239]
  ds_read_b128 a[4:7], v9 offset:51200
  s_mul_i32 s8, s14, 65536
  s_add_u32 s8, s8, s27
  v_cvt_pk_bf16_f32 v240, v240, v241
  v_cvt_pk_bf16_f32 v241, v242, v243
  v_cvt_pk_bf16_f32 v242, v244, v245
  v_mfma_f32_32x32x16_bf16 v[224:239], a[12:15], a[108:111], v[224:239]
  ds_read_b128 a[8:11], v8 offset:51456
  v_cvt_pk_bf16_f32 v243, v246, v247
  v_cvt_pk_bf16_f32 v244, v248, v249
  v_cvt_pk_bf16_f32 v245, v250, v251
  v_cvt_pk_bf16_f32 v246, v252, v253
  v_cvt_pk_bf16_f32 v247, v254, v255
  s_waitcnt lgkmcnt(3)
  v_mfma_f32_32x32x16_bf16 v[224:239], a[16:19], a[112:115], v[224:239]
  ds_read_b128 a[12:15], v9 offset:51456
  buffer_store_dwordx4 v[240:243], v12, s[88:91], s8 offen offset:0 sc1
  v_mfma_f32_32x32x16_bf16 v[224:239], a[20:23], a[116:119], v[224:239]
  ds_read_b128 a[16:19], v8 offset:52224
  buffer_store_dwordx4 v[244:247], v12, s[88:91], s8 offen offset:1024 sc1
  v_mfma_f32_32x32x16_bf16 v[224:239], a[24:27], a[120:123], v[224:239]
  ds_read_b128 a[20:23], v9 offset:52224
  v_mfma_f32_32x32x16_bf16 v[224:239], a[28:31], a[124:127], v[224:239]
  ds_read_b128 a[24:27], v8 offset:52480
  s_waitcnt lgkmcnt(3)
  v_mfma_f32_32x32x16_bf16 v[224:239], a[0:3], a[128:131], v[224:239]
  ds_read_b128 a[28:31], v9 offset:52480
  v_add_u32 v3, 0x00010000, v3
  v_mfma_f32_32x32x16_bf16 v[224:239], a[4:7], a[132:135], v[224:239]
  s_add_u32 m0, s31, 81920
  s_add_u32 s6, s2, 49152
  s_and_b32 s6, s6, 0x3ffff
  s_waitcnt vmcnt(24)
  s_barrier
  ds_read_b64_tr_b16 a[0:1], v3 offset:0
  ds_read_b64_tr_b16 a[2:3], v3 offset:512
  buffer_load_dwordx4 v1, s[64:67], s6 offen offset:0 lds
  v_mfma_f32_32x32x16_bf16 v[224:239], a[8:11], a[136:139], v[224:239]
  ds_read_b64_tr_b16 a[4:5], v3 offset:2048
  ds_read_b64_tr_b16 a[6:7], v3 offset:2560
  v_mfma_f32_32x32x16_bf16 v[224:239], a[12:15], a[140:143], v[224:239]
  ds_read_b64_tr_b16 a[8:9], v3 offset:4096
  ds_read_b64_tr_b16 a[10:11], v3 offset:4608
  s_waitcnt lgkmcnt(6)
  v_mfma_f32_32x32x16_bf16 v[224:239], a[16:19], a[144:147], v[224:239]
  ds_read_b64_tr_b16 a[12:13], v3 offset:6144
  ds_read_b64_tr_b16 a[14:15], v3 offset:6656
  v_mfma_f32_32x32x16_bf16 v[224:239], a[20:23], a[148:151], v[224:239]
  ds_read_b64_tr_b16 a[16:17], v3 offset:8192
  ds_read_b64_tr_b16 a[18:19], v3 offset:8704
  buffer_load_dwordx4 v1, s[68:71], s6 offen offset:1024 lds
  v_mfma_f32_32x32x16_bf16 v[224:239], a[24:27], a[152:155], v[224:239]
  ds_read_b64_tr_b16 a[20:21], v3 offset:10240
  ds_read_b64_tr_b16 a[22:23], v3 offset:10752
  v_mfma_f32_32x32x16_bf16 v[224:239], a[28:31], a[156:159], v[224:239]
  ds_read_b64_tr_b16 a[24:25], v3 offset:12288
  ds_read_b64_tr_b16 a[26:27], v3 offset:12800
  s_waitcnt lgkmcnt(6)
  v_mfma_f32_32x32x16_bf16 v[240:255], a[0:3], a[160:163], 0
  ds_read_b64_tr_b16 a[28:29], v3 offset:14336
  ds_read_b64_tr_b16 a[30:31], v3 offset:14848
  v_add_u32 v4, 0x00020000, v4
  v_mfma_f32_32x32x16_bf16 v[240:255], a[4:7], a[164:167], v[240:255]
  ds_read_b64_tr_b16 a[0:1], v4 offset:16384
  ds_read_b64_tr_b16 a[2:3], v4 offset:20480
  buffer_load_dwordx4 v1, s[64:67], s6 offen offset:2048 lds
  s_mov_b32 s46, 0x3f803f80
  v_mfma_f32_32x32x16_bf16 v[240:255], a[8:11], a[168:171], v[240:255]
  ds_read_b64_tr_b16 a[4:5], v4 offset:16640
  ds_read_b64_tr_b16 a[6:7], v4 offset:20736
  v_max3_f32 v7, v7, v224, v225
  v_max3_f32 v7, v7, v226, v227
  v_max3_f32 v7, v7, v228, v229
  v_max3_f32 v7, v7, v230, v231
  v_mfma_f32_32x32x16_bf16 v[240:255], a[12:15], a[172:175], v[240:255]
  ds_read_b64_tr_b16 a[8:9], v4 offset:16896
  ds_read_b64_tr_b16 a[10:11], v4 offset:20992
  v_max3_f32 v7, v7, v232, v233
  v_max3_f32 v7, v7, v234, v235
  v_max3_f32 v7, v7, v236, v237
  v_max3_f32 v7, v7, v238, v239
  s_waitcnt lgkmcnt(6)
  v_mfma_f32_32x32x16_bf16 v[240:255], a[16:19], a[176:179], v[240:255]
  ds_read_b64_tr_b16 a[12:13], v4 offset:17152
  ds_read_b64_tr_b16 a[14:15], v4 offset:21248
  v_mov_b32 v13, v7
  s_nop 1
  v_permlane32_swap_b32 v13, v7
  v_max_f32 v7, v7, v13
  v_mul_f32 v7, v7, v5
  v_mfma_f32_32x32x16_bf16 v[240:255], a[20:23], a[180:183], v[240:255]
  ds_read_b64_tr_b16 a[16:17], v4 offset:17408
  ds_read_b64_tr_b16 a[18:19], v4 offset:21504
  buffer_load_dwordx4 v1, s[68:71], s6 offen offset:3072 lds
  v_sub_f32 v7, 0, v7
  v_mfma_f32_32x32x16_bf16 v[240:255], a[24:27], a[184:187], v[240:255]
  ds_read_b64_tr_b16 a[20:21], v4 offset:17664
  ds_read_b64_tr_b16 a[22:23], v4 offset:21760
  s_mov_b32 s45, 0x33803380
  v_accvgpr_write_b32 a232, s46
  v_accvgpr_write_b32 a233, s46
  v_fma_f32 v16, v16, v5, v7
  v_mfma_f32_32x32x16_bf16 v[240:255], a[28:31], a[188:191], v[240:255]
  ds_read_b64_tr_b16 a[24:25], v4 offset:17920
  ds_read_b64_tr_b16 a[26:27], v4 offset:22016
  v_fma_f32 v17, v17, v5, v7
  v_fma_f32 v18, v18, v5, v7
  v_fma_f32 v19, v19, v5, v7
  v_fma_f32 v20, v20, v5, v7
  v_fma_f32 v21, v21, v5, v7
  v_fma_f32 v22, v22, v5, v7
  v_fma_f32 v23, v23, v5, v7
  v_exp_f32 v16, v16
  v_exp_f32 v17, v17
  v_exp_f32 v18, v18
  v_exp_f32 v19, v19
  v_exp_f32 v20, v20
  v_exp_f32 v21, v21
  v_exp_f32 v22, v22
  v_exp_f32 v23, v23
  v_cvt_pk_bf16_f32 v16, v16, v17
  v_cvt_pk_bf16_f32 v17, v18, v19
  v_cvt_pk_bf16_f32 v18, v20, v21
  v_cvt_pk_bf16_f32 v19, v22, v23
  v_pk_max_u16 v16, v16, s45
  v_pk_max_u16 v17, v17, s45
  v_pk_max_u16 v18, v18, s45
  v_pk_max_u16 v19, v19, s45
  v_mfma_f32_4x4x4_16b_bf16 a[224:227], a[232:233], v[16:17], 0
  s_nop 0
  v_mfma_f32_4x4x4_16b_bf16 a[228:231], a[232:233], v[18:19], 0
  s_waitcnt lgkmcnt(6)
  v_mfma_f32_32x32x16_bf16 a[32:47], a[0:3], v[16:19], 0
  ds_read_b64_tr_b16 a[28:29], v4 offset:18176
  ds_read_b64_tr_b16 a[30:31], v4 offset:22272
  v_fma_f32 v24, v24, v5, v7
  v_fma_f32 v25, v25, v5, v7
  v_fma_f32 v26, v26, v5, v7
  v_fma_f32 v27, v27, v5, v7
  v_mfma_f32_32x32x16_bf16 a[48:63], a[4:7], v[16:19], 0
  s_add_u32 m0, s31, 98304
  ds_read_b64_tr_b16 a[0:1], v3 offset:256
  ds_read_b64_tr_b16 a[2:3], v3 offset:768
  buffer_load_dwordx4 v2, s[72:75], s19 offen offset:0 lds
  v_mfma_f32_32x32x16_bf16 a[64:79], a[8:11], v[16:19], 0
  ds_read_b64_tr_b16 a[4:5], v3 offset:2304
  ds_read_b64_tr_b16 a[6:7], v3 offset:2816
  s_mul_i32 s7, s15, 65536
  s_add_u32 s7, s7, s21
  v_cvt_pk_bf16_f32 v240, v240, v241
  v_cvt_pk_bf16_f32 v241, v242, v243
  v_mfma_f32_32x32x16_bf16 a[80:95], a[12:15], v[16:19], 0
  ds_read_b64_tr_b16 a[8:9], v3 offset:4352
  ds_read_b64_tr_b16 a[10:11], v3 offset:4864
  v_cvt_pk_bf16_f32 v242, v244, v245
  v_cvt_pk_bf16_f32 v243, v246, v247
  v_cvt_pk_bf16_f32 v244, v248, v249
  v_cvt_pk_bf16_f32 v245, v250, v251
  s_waitcnt lgkmcnt(6)
  v_mfma_f32_32x32x16_bf16 a[96:111], a[16:19], v[16:19], 0
  ds_read_b64_tr_b16 a[12:13], v3 offset:6400
  ds_read_b64_tr_b16 a[14:15], v3 offset:6912
  v_cvt_pk_bf16_f32 v246, v252, v253
  v_cvt_pk_bf16_f32 v247, v254, v255
  v_fma_f32 v28, v28, v5, v7
  v_fma_f32 v29, v29, v5, v7
  v_mfma_f32_32x32x16_bf16 a[112:127], a[20:23], v[16:19], 0
  ds_read_b64_tr_b16 a[16:17], v3 offset:8448
  ds_read_b64_tr_b16 a[18:19], v3 offset:8960
  buffer_load_dwordx4 v2, s[76:79], s19 offen offset:1024 lds
  v_fma_f32 v30, v30, v5, v7
  v_mfma_f32_32x32x16_bf16 a[128:143], a[24:27], v[16:19], 0
  ds_read_b64_tr_b16 a[20:21], v3 offset:10496
  ds_read_b64_tr_b16 a[22:23], v3 offset:11008
  buffer_store_dwordx4 v[240:243], v12, s[88:91], s7 offen offset:0 sc1
  v_fma_f32 v31, v31, v5, v7
  v_mfma_f32_32x32x16_bf16 a[144:159], a[28:31], v[16:19], 0
  ds_read_b64_tr_b16 a[24:25], v3 offset:12544
  ds_read_b64_tr_b16 a[26:27], v3 offset:13056
  buffer_store_dwordx4 v[244:247], v12, s[88:91], s7 offen offset:1024 sc1
  v_exp_f32 v24, v24
  s_waitcnt lgkmcnt(6)
  v_mfma_f32_32x32x16_bf16 v[240:255], a[0:3], a[160:163], 0
  ds_read_b64_tr_b16 a[28:29], v3 offset:14592
  ds_read_b64_tr_b16 a[30:31], v3 offset:15104
  v_exp_f32 v25, v25
  v_exp_f32 v26, v26
  v_mfma_f32_32x32x16_bf16 v[240:255], a[4:7], a[164:167], v[240:255]
  ds_read_b64_tr_b16 a[0:1], v4 offset:24576
  ds_read_b64_tr_b16 a[2:3], v4 offset:28672
  buffer_load_dwordx4 v2, s[80:83], s19 offen offset:2048 lds
  v_mfma_f32_32x32x16_bf16 v[240:255], a[8:11], a[168:171], v[240:255]
  ds_read_b64_tr_b16 a[4:5], v4 offset:24832
  ds_read_b64_tr_b16 a[6:7], v4 offset:28928
  v_exp_f32 v27, v27
  v_exp_f32 v28, v28
  v_mfma_f32_32x32x16_bf16 v[240:255], a[12:15], a[172:175], v[240:255]
  ds_read_b64_tr_b16 a[8:9], v4 offset:25088
  ds_read_b64_tr_b16 a[10:11], v4 offset:29184
  v_exp_f32 v29, v29
  v_exp_f32 v30, v30
  s_waitcnt lgkmcnt(6)
  v_mfma_f32_32x32x16_bf16 v[240:255], a[16:19], a[176:179], v[240:255]
  ds_read_b64_tr_b16 a[12:13], v4 offset:25344
  ds_read_b64_tr_b16 a[14:15], v4 offset:29440
  v_exp_f32 v31, v31
  v_cvt_pk_bf16_f32 v20, v24, v25
  v_cvt_pk_bf16_f32 v21, v26, v27
  v_mfma_f32_32x32x16_bf16 v[240:255], a[20:23], a[180:183], v[240:255]
  ds_read_b64_tr_b16 a[16:17], v4 offset:25600
  ds_read_b64_tr_b16 a[18:19], v4 offset:29696
  buffer_load_dwordx4 v2, s[84:87], s19 offen offset:3072 lds
  v_cvt_pk_bf16_f32 v22, v28, v29
  v_mfma_f32_32x32x16_bf16 v[240:255], a[24:27], a[184:187], v[240:255]
  ds_read_b64_tr_b16 a[20:21], v4 offset:25856
  ds_read_b64_tr_b16 a[22:23], v4 offset:29952
  v_cvt_pk_bf16_f32 v23, v30, v31
  v_pk_max_u16 v20, v20, s45
  v_pk_max_u16 v21, v21, s45
  v_pk_max_u16 v22, v22, s45
  v_mfma_f32_32x32x16_bf16 v[240:255], a[28:31], a[188:191], v[240:255]
  ds_read_b64_tr_b16 a[24:25], v4 offset:26112
  ds_read_b64_tr_b16 a[26:27], v4 offset:30208
  v_pk_max_u16 v23, v23, s45
  v_mfma_f32_4x4x4_16b_bf16 a[224:227], a[232:233], v[20:21], a[224:227]
  s_nop 0
  v_mfma_f32_4x4x4_16b_bf16 a[228:231], a[232:233], v[22:23], a[228:231]
  s_waitcnt lgkmcnt(6)
  v_mfma_f32_32x32x16_bf16 a[32:47], a[0:3], v[20:23], a[32:47]
  ds_read_b64_tr_b16 a[28:29], v4 offset:26368
  ds_read_b64_tr_b16 a[30:31], v4 offset:30464
  v_fma_f32 v32, v32, v5, v7
  v_fma_f32 v33, v33, v5, v7
  v_fma_f32 v34, v34, v5, v7
  v_add_u32 v3, 0xfffe0000, v3
  v_mfma_f32_32x32x16_bf16 a[48:63], a[4:7], v[20:23], a[48:63]
  s_add_u32 m0, s31, 114688
  s_add_u32 s6, s2, 65536
  s_and_b32 s6, s6, 0x3ffff
  s_waitcnt vmcnt(26)
  s_barrier
  ds_read_b64_tr_b16 a[0:1], v3 offset:0
  ds_read_b64_tr_b16 a[2:3], v3 offset:512
  buffer_load_dwordx4 v1, s[64:67], s6 offen offset:0 lds
  v_mfma_f32_32x32x16_bf16 a[64:79], a[8:11], v[20:23], a[64:79]
  ds_read_b64_tr_b16 a[4:5], v3 offset:2048
  ds_read_b64_tr_b16 a[6:7], v3 offset:2560
  s_mul_i32 s8, s15, 65536
  s_add_u32 s8, s8, s27
  v_cvt_pk_bf16_f32 v240, v240, v241
  v_cvt_pk_bf16_f32 v241, v242, v243
  v_mfma_f32_32x32x16_bf16 a[80:95], a[12:15], v[20:23], a[80:95]
  ds_read_b64_tr_b16 a[8:9], v3 offset:4096
  ds_read_b64_tr_b16 a[10:11], v3 offset:4608
  v_cvt_pk_bf16_f32 v242, v244, v245
  v_cvt_pk_bf16_f32 v243, v246, v247
  v_cvt_pk_bf16_f32 v244, v248, v249
  v_cvt_pk_bf16_f32 v245, v250, v251
  s_waitcnt lgkmcnt(6)
  v_mfma_f32_32x32x16_bf16 a[96:111], a[16:19], v[20:23], a[96:111]
  ds_read_b64_tr_b16 a[12:13], v3 offset:6144
  ds_read_b64_tr_b16 a[14:15], v3 offset:6656
  v_cvt_pk_bf16_f32 v246, v252, v253
  v_cvt_pk_bf16_f32 v247, v254, v255
  v_fma_f32 v35, v35, v5, v7
  v_fma_f32 v36, v36, v5, v7
  v_mfma_f32_32x32x16_bf16 a[112:127], a[20:23], v[20:23], a[112:127]
  ds_read_b64_tr_b16 a[16:17], v3 offset:8192
  ds_read_b64_tr_b16 a[18:19], v3 offset:8704
  buffer_load_dwordx4 v1, s[68:71], s6 offen offset:1024 lds
  v_fma_f32 v37, v37, v5, v7
  v_mfma_f32_32x32x16_bf16 a[128:143], a[24:27], v[20:23], a[128:143]
  ds_read_b64_tr_b16 a[20:21], v3 offset:10240
  ds_read_b64_tr_b16 a[22:23], v3 offset:10752
  buffer_store_dwordx4 v[240:243], v12, s[88:91], s8 offen offset:0 sc1
  v_fma_f32 v38, v38, v5, v7
  v_fma_f32 v39, v39, v5, v7
  v_mfma_f32_32x32x16_bf16 a[144:159], a[28:31], v[20:23], a[144:159]
  ds_read_b64_tr_b16 a[24:25], v3 offset:12288
  ds_read_b64_tr_b16 a[26:27], v3 offset:12800
  buffer_store_dwordx4 v[244:247], v12, s[88:91], s8 offen offset:1024 sc1
  v_exp_f32 v32, v32
  s_waitcnt lgkmcnt(6)
  v_mfma_f32_32x32x16_bf16 v[240:255], a[0:3], a[160:163], 0
  ds_read_b64_tr_b16 a[28:29], v3 offset:14336
  ds_read_b64_tr_b16 a[30:31], v3 offset:14848
  v_exp_f32 v33, v33
  v_add_u32 v4, 0xfffe0000, v4
  v_mfma_f32_32x32x16_bf16 v[240:255], a[4:7], a[164:167], v[240:255]
  ds_read_b64_tr_b16 a[0:1], v4 offset:16384
  ds_read_b64_tr_b16 a[2:3], v4 offset:20480
  buffer_load_dwordx4 v1, s[64:67], s6 offen offset:2048 lds
  v_mfma_f32_32x32x16_bf16 v[240:255], a[8:11], a[168:171], v[240:255]
  ds_read_b64_tr_b16 a[4:5], v4 offset:16640
  ds_read_b64_tr_b16 a[6:7], v4 offset:20736
  v_exp_f32 v34, v34
  v_exp_f32 v35, v35
  v_mfma_f32_32x32x16_bf16 v[240:255], a[12:15], a[172:175], v[240:255]
  ds_read_b64_tr_b16 a[8:9], v4 offset:16896
  ds_read_b64_tr_b16 a[10:11], v4 offset:20992
  v_exp_f32 v36, v36
  v_exp_f32 v37, v37
  s_waitcnt lgkmcnt(6)
  v_mfma_f32_32x32x16_bf16 v[240:255], a[16:19], a[176:179], v[240:255]
  ds_read_b64_tr_b16 a[12:13], v4 offset:17152
  ds_read_b64_tr_b16 a[14:15], v4 offset:21248
  v_exp_f32 v38, v38
  v_exp_f32 v39, v39
  v_mfma_f32_32x32x16_bf16 v[240:255], a[20:23], a[180:183], v[240:255]
  ds_read_b64_tr_b16 a[16:17], v4 offset:17408
  ds_read_b64_tr_b16 a[18:19], v4 offset:21504
  buffer_load_dwordx4 v1, s[68:71], s6 offen offset:3072 lds
  v_cvt_pk_bf16_f32 v32, v32, v33
  v_mfma_f32_32x32x16_bf16 v[240:255], a[24:27], a[184:187], v[240:255]
  ds_read_b64_tr_b16 a[20:21], v4 offset:17664
  ds_read_b64_tr_b16 a[22:23], v4 offset:21760
  v_cvt_pk_bf16_f32 v33, v34, v35
  v_cvt_pk_bf16_f32 v34, v36, v37
  v_cvt_pk_bf16_f32 v35, v38, v39
  v_pk_max_u16 v32, v32, s45
  v_mfma_f32_32x32x16_bf16 v[240:255], a[28:31], a[188:191], v[240:255]
  ds_read_b64_tr_b16 a[24:25], v4 offset:17920
  ds_read_b64_tr_b16 a[26:27], v4 offset:22016
  v_pk_max_u16 v33, v33, s45
  v_pk_max_u16 v34, v34, s45
  v_pk_max_u16 v35, v35, s45
  v_mfma_f32_4x4x4_16b_bf16 a[224:227], a[232:233], v[32:33], a[224:227]
  s_nop 0
  v_mfma_f32_4x4x4_16b_bf16 a[228:231], a[232:233], v[34:35], a[228:231]
  s_waitcnt lgkmcnt(6)
  v_mfma_f32_32x32x16_bf16 a[32:47], a[0:3], v[32:35], a[32:47]
  ds_read_b64_tr_b16 a[28:29], v4 offset:18176
  ds_read_b64_tr_b16 a[30:31], v4 offset:22272
  v_fma_f32 v40, v40, v5, v7
  v_fma_f32 v41, v41, v5, v7
  v_fma_f32 v42, v42, v5, v7
  v_fma_f32 v43, v43, v5, v7
  v_mfma_f32_32x32x16_bf16 a[48:63], a[4:7], v[32:35], a[48:63]
  s_add_u32 m0, s31, 131072
  ds_read_b64_tr_b16 a[0:1], v3 offset:256
  ds_read_b64_tr_b16 a[2:3], v3 offset:768
  buffer_load_dwordx4 v2, s[72:75], s20 offen offset:0 lds
  v_mfma_f32_32x32x16_bf16 a[64:79], a[8:11], v[32:35], a[64:79]
  ds_read_b64_tr_b16 a[4:5], v3 offset:2304
  ds_read_b64_tr_b16 a[6:7], v3 offset:2816
  s_mul_i32 s7, s16, 65536
  s_add_u32 s7, s7, s21
  v_cvt_pk_bf16_f32 v240, v240, v241
  v_cvt_pk_bf16_f32 v241, v242, v243
  v_mfma_f32_32x32x16_bf16 a[80:95], a[12:15], v[32:35], a[80:95]
  ds_read_b64_tr_b16 a[8:9], v3 offset:4352
  ds_read_b64_tr_b16 a[10:11], v3 offset:4864
  v_cvt_pk_bf16_f32 v242, v244, v245
  v_cvt_pk_bf16_f32 v243, v246, v247
  v_cvt_pk_bf16_f32 v244, v248, v249
  v_cvt_pk_bf16_f32 v245, v250, v251
  s_waitcnt lgkmcnt(6)
  v_mfma_f32_32x32x16_bf16 a[96:111], a[16:19], v[32:35], a[96:111]
  ds_read_b64_tr_b16 a[12:13], v3 offset:6400
  ds_read_b64_tr_b16 a[14:15], v3 offset:6912
  v_cvt_pk_bf16_f32 v246, v252, v253
  v_cvt_pk_bf16_f32 v247, v254, v255
  v_fma_f32 v44, v44, v5, v7
  v_fma_f32 v45, v45, v5, v7
  v_mfma_f32_32x32x16_bf16 a[112:127], a[20:23], v[32:35], a[112:127]
  ds_read_b64_tr_b16 a[16:17], v3 offset:8448
  ds_read_b64_tr_b16 a[18:19], v3 offset:8960
  buffer_load_dwordx4 v2, s[76:79], s20 offen offset:1024 lds
  v_fma_f32 v46, v46, v5, v7
  v_mfma_f32_32x32x16_bf16 a[128:143], a[24:27], v[32:35], a[128:143]
  ds_read_b64_tr_b16 a[20:21], v3 offset:10496
  ds_read_b64_tr_b16 a[22:23], v3 offset:11008
  buffer_store_dwordx4 v[240:243], v12, s[88:91], s7 offen offset:0 sc1
  v_fma_f32 v47, v47, v5, v7
  v_mfma_f32_32x32x16_bf16 a[144:159], a[28:31], v[32:35], a[144:159]
  ds_read_b64_tr_b16 a[24:25], v3 offset:12544
  ds_read_b64_tr_b16 a[26:27], v3 offset:13056
  buffer_store_dwordx4 v[244:247], v12, s[88:91], s7 offen offset:1024 sc1
  v_exp_f32 v40, v40
  s_waitcnt lgkmcnt(6)
  v_mfma_f32_32x32x16_bf16 v[240:255], a[0:3], a[160:163], 0
  ds_read_b64_tr_b16 a[28:29], v3 offset:14592
  ds_read_b64_tr_b16 a[30:31], v3 offset:15104
  v_exp_f32 v41, v41
  v_exp_f32 v42, v42
  v_mfma_f32_32x32x16_bf16 v[240:255], a[4:7], a[164:167], v[240:255]
  ds_read_b64_tr_b16 a[0:1], v4 offset:24576
  ds_read_b64_tr_b16 a[2:3], v4 offset:28672
  buffer_load_dwordx4 v2, s[80:83], s20 offen offset:2048 lds
  v_mfma_f32_32x32x16_bf16 v[240:255], a[8:11], a[168:171], v[240:255]
  ds_read_b64_tr_b16 a[4:5], v4 offset:24832
  ds_read_b64_tr_b16 a[6:7], v4 offset:28928
  v_exp_f32 v43, v43
  v_exp_f32 v44, v44
  v_mfma_f32_32x32x16_bf16 v[240:255], a[12:15], a[172:175], v[240:255]
  ds_read_b64_tr_b16 a[8:9], v4 offset:25088
  ds_read_b64_tr_b16 a[10:11], v4 offset:29184
  v_exp_f32 v45, v45
  v_exp_f32 v46, v46
  s_waitcnt lgkmcnt(6)
L_padh7:
  s_cbranch_execz L_padh11
  v_mfma_f32_32x32x16_bf16 v[240:255], a[16:19], a[176:179], v[240:255]
  ds_read_b64_tr_b16 a[12:13], v4 offset:25344
  ds_read_b64_tr_b16 a[14:15], v4 offset:29440
  v_exp_f32 v47, v47
  v_cvt_pk_bf16_f32 v36, v40, v41
  v_cvt_pk_bf16_f32 v37, v42, v43
  v_mfma_f32_32x32x16_bf16 v[240:255], a[20:23], a[180:183], v[240:255]
  ds_read_b64_tr_b16 a[16:17], v4 offset:25600
  ds_read_b64_tr_b16 a[18:19], v4 offset:29696
  buffer_load_dwordx4 v2, s[84:87], s20 offen offset:3072 lds
  v_cvt_pk_bf16_f32 v38, v44, v45
  v_mfma_f32_32x32x16_bf16 v[240:255], a[24:27], a[184:187], v[240:255]
  ds_read_b64_tr_b16 a[20:21], v4 offset:25856
  ds_read_b64_tr_b16 a[22:23], v4 offset:29952
  v_cvt_pk_bf16_f32 v39, v46, v47
  v_pk_max_u16 v36, v36, s45
  v_pk_max_u16 v37, v37, s45
  v_pk_max_u16 v38, v38, s45
  v_mfma_f32_32x32x16_bf16 v[240:255], a[28:31], a[188:191], v[240:255]
  ds_read_b64_tr_b16 a[24:25], v4 offset:26112
  ds_read_b64_tr_b16 a[26:27], v4 offset:30208
  v_pk_max_u16 v39, v39, s45
  v_mfma_f32_4x4x4_16b_bf16 a[224:227], a[232:233], v[36:37], a[224:227]
  s_nop 0
  v_mfma_f32_4x4x4_16b_bf16 a[228:231], a[232:233], v[38:39], a[228:231]
  s_waitcnt lgkmcnt(6)
  v_mfma_f32_32x32x16_bf16 a[32:47], a[0:3], v[36:39], a[32:47]
  ds_read_b64_tr_b16 a[28:29], v4 offset:26368
  ds_read_b64_tr_b16 a[30:31], v4 offset:30464
  v_fma_f32 v48, v48, v5, v7
  v_fma_f32 v49, v49, v5, v7
  v_fma_f32 v50, v50, v5, v7
  v_fma_f32 v51, v51, v5, v7
  v_mfma_f32_32x32x16_bf16 a[48:63], a[4:7], v[36:39], a[48:63]
  s_add_u32 m0, s31, 147456
  s_add_u32 s6, s2, 81920
  s_and_b32 s6, s6, 0x3ffff
  s_waitcnt vmcnt(28)
  s_barrier
  ds_read_b64_tr_b16 a[0:1], v3 offset:32768
  ds_read_b64_tr_b16 a[2:3], v3 offset:33280
  buffer_load_dwordx4 v1, s[64:67], s6 offen offset:0 lds
  v_mfma_f32_32x32x16_bf16 a[64:79], a[8:11], v[36:39], a[64:79]
  ds_read_b64_tr_b16 a[4:5], v3 offset:34816
  ds_read_b64_tr_b16 a[6:7], v3 offset:35328
  s_mul_i32 s8, s16, 65536
  s_add_u32 s8, s8, s27
  v_cvt_pk_bf16_f32 v240, v240, v241
  v_cvt_pk_bf16_f32 v241, v242, v243
  v_mfma_f32_32x32x16_bf16 a[80:95], a[12:15], v[36:39], a[80:95]
  ds_read_b64_tr_b16 a[8:9], v3 offset:36864
  ds_read_b64_tr_b16 a[10:11], v3 offset:37376
  v_cvt_pk_bf16_f32 v242, v244, v245
  v_cvt_pk_bf16_f32 v243, v246, v247
  v_cvt_pk_bf16_f32 v244, v248, v249
  v_cvt_pk_bf16_f32 v245, v250, v251
  s_waitcnt lgkmcnt(6)
  v_mfma_f32_32x32x16_bf16 a[96:111], a[16:19], v[36:39], a[96:111]
  ds_read_b64_tr_b16 a[12:13], v3 offset:38912
  ds_read_b64_tr_b16 a[14:15], v3 offset:39424
  v_cvt_pk_bf16_f32 v246, v252, v253
  v_cvt_pk_bf16_f32 v247, v254, v255
  v_fma_f32 v52, v52, v5, v7
  v_fma_f32 v53, v53, v5, v7
  v_mfma_f32_32x32x16_bf16 a[112:127], a[20:23], v[36:39], a[112:127]
  ds_read_b64_tr_b16 a[16:17], v3 offset:40960
  ds_read_b64_tr_b16 a[18:19], v3 offset:41472
  buffer_load_dwordx4 v1, s[68:71], s6 offen offset:1024 lds
  v_fma_f32 v54, v54, v5, v7
  v_mfma_f32_32x32x16_bf16 a[128:143], a[24:27], v[36:39], a[128:143]
  ds_read_b64_tr_b16 a[20:21], v3 offset:43008
  ds_read_b64_tr_b16 a[22:23], v3 offset:43520
  buffer_store_dwordx4 v[240:243], v12, s[88:91], s8 offen offset:0 sc1
  v_fma_f32 v55, v55, v5, v7
  v_mfma_f32_32x32x16_bf16 a[144:159], a[28:31], v[36:39], a[144:159]
  ds_read_b64_tr_b16 a[24:25], v3 offset:45056
  ds_read_b64_tr_b16 a[26:27], v3 offset:45568
  buffer_store_dwordx4 v[244:247], v12, s[88:91], s8 offen offset:1024 sc1
  v_exp_f32 v48, v48
  s_waitcnt lgkmcnt(6)
  v_mfma_f32_32x32x16_bf16 v[240:255], a[0:3], a[160:163], 0
  ds_read_b64_tr_b16 a[28:29], v3 offset:47104
  ds_read_b64_tr_b16 a[30:31], v3 offset:47616
  v_exp_f32 v49, v49
  v_exp_f32 v50, v50
  v_mfma_f32_32x32x16_bf16 v[240:255], a[4:7], a[164:167], v[240:255]
  ds_read_b64_tr_b16 a[0:1], v4 offset:49152
  ds_read_b64_tr_b16 a[2:3], v4 offset:53248
  buffer_load_dwordx4 v1, s[64:67], s6 offen offset:2048 lds
  v_mfma_f32_32x32x16_bf16 v[240:255], a[8:11], a[168:171], v[240:255]
  ds_read_b64_tr_b16 a[4:5], v4 offset:49408
  ds_read_b64_tr_b16 a[6:7], v4 offset:53504
  v_exp_f32 v51, v51
  v_exp_f32 v52, v52
  v_mfma_f32_32x32x16_bf16 v[240:255], a[12:15], a[172:175], v[240:255]
  ds_read_b64_tr_b16 a[8:9], v4 offset:49664
  ds_read_b64_tr_b16 a[10:11], v4 offset:53760
  v_exp_f32 v53, v53
  v_exp_f32 v54, v54
  s_waitcnt lgkmcnt(6)
  v_mfma_f32_32x32x16_bf16 v[240:255], a[16:19], a[176:179], v[240:255]
  ds_read_b64_tr_b16 a[12:13], v4 offset:49920
  ds_read_b64_tr_b16 a[14:15], v4 offset:54016
  v_exp_f32 v55, v55
  v_cvt_pk_bf16_f32 v48, v48, v49
  v_cvt_pk_bf16_f32 v49, v50, v51
  v_mfma_f32_32x32x16_bf16 v[240:255], a[20:23], a[180:183], v[240:255]
  ds_read_b64_tr_b16 a[16:17], v4 offset:50176
  ds_read_b64_tr_b16 a[18:19], v4 offset:54272
  buffer_load_dwordx4 v1, s[68:71], s6 offen offset:3072 lds
  v_cvt_pk_bf16_f32 v50, v52, v53
  v_mfma_f32_32x32x16_bf16 v[240:255], a[24:27], a[184:187], v[240:255]
  ds_read_b64_tr_b16 a[20:21], v4 offset:50432
  ds_read_b64_tr_b16 a[22:23], v4 offset:54528
  v_cvt_pk_bf16_f32 v51, v54, v55
  v_pk_max_u16 v48, v48, s45
  v_pk_max_u16 v49, v49, s45
  v_pk_max_u16 v50, v50, s45
  v_mfma_f32_32x32x16_bf16 v[240:255], a[28:31], a[188:191], v[240:255]
  ds_read_b64_tr_b16 a[24:25], v4 offset:50688
  ds_read_b64_tr_b16 a[26:27], v4 offset:54784
  v_pk_max_u16 v51, v51, s45
  v_mfma_f32_4x4x4_16b_bf16 a[224:227], a[232:233], v[48:49], a[224:227]
  s_nop 0
  v_mfma_f32_4x4x4_16b_bf16 a[228:231], a[232:233], v[50:51], a[228:231]
  s_waitcnt lgkmcnt(6)
  v_mfma_f32_32x32x16_bf16 a[32:47], a[0:3], v[48:51], a[32:47]
  ds_read_b64_tr_b16 a[28:29], v4 offset:50944
  ds_read_b64_tr_b16 a[30:31], v4 offset:55040
  v_fma_f32 v56, v56, v5, v7
  v_fma_f32 v57, v57, v5, v7
  v_fma_f32 v58, v58, v5, v7
  v_fma_f32 v59, v59, v5, v7
  v_mfma_f32_32x32x16_bf16 a[48:63], a[4:7], v[48:51], a[48:63]
  s_add_u32 m0, s31, 0
  s_add_u32 s6, s2, 98304
  s_and_b32 s6, s6, 0x3ffff
  ds_read_b64_tr_b16 a[0:1], v3 offset:33024
  ds_read_b64_tr_b16 a[2:3], v3 offset:33536
  buffer_load_dwordx4 v1, s[64:67], s6 offen offset:0 lds
  v_mfma_f32_32x32x16_bf16 a[64:79], a[8:11], v[48:51], a[64:79]
  ds_read_b64_tr_b16 a[4:5], v3 offset:35072
  ds_read_b64_tr_b16 a[6:7], v3 offset:35584
  s_mul_i32 s7, s17, 65536
  s_add_u32 s7, s7, s21
  v_cvt_pk_bf16_f32 v240, v240, v241
  v_cvt_pk_bf16_f32 v241, v242, v243
  v_mfma_f32_32x32x16_bf16 a[80:95], a[12:15], v[48:51], a[80:95]
  ds_read_b64_tr_b16 a[8:9], v3 offset:37120
  ds_read_b64_tr_b16 a[10:11], v3 offset:37632
  v_cvt_pk_bf16_f32 v242, v244, v245
  v_cvt_pk_bf16_f32 v243, v246, v247
  v_cvt_pk_bf16_f32 v244, v248, v249
  v_cvt_pk_bf16_f32 v245, v250, v251
  s_waitcnt lgkmcnt(6)
  v_mfma_f32_32x32x16_bf16 a[96:111], a[16:19], v[48:51], a[96:111]
  ds_read_b64_tr_b16 a[12:13], v3 offset:39168
  ds_read_b64_tr_b16 a[14:15], v3 offset:39680
  v_cvt_pk_bf16_f32 v246, v252, v253
  v_cvt_pk_bf16_f32 v247, v254, v255
  v_fma_f32 v60, v60, v5, v7
  v_fma_f32 v61, v61, v5, v7
  v_mfma_f32_32x32x16_bf16 a[112:127], a[20:23], v[48:51], a[112:127]
  ds_read_b64_tr_b16 a[16:17], v3 offset:41216
  ds_read_b64_tr_b16 a[18:19], v3 offset:41728
  buffer_load_dwordx4 v1, s[68:71], s6 offen offset:1024 lds
  v_fma_f32 v62, v62, v5, v7
  v_mfma_f32_32x32x16_bf16 a[128:143], a[24:27], v[48:51], a[128:143]
  ds_read_b64_tr_b16 a[20:21], v3 offset:43264
  ds_read_b64_tr_b16 a[22:23], v3 offset:43776
  buffer_store_dwordx4 v[240:243], v12, s[88:91], s7 offen offset:0 sc1
  v_fma_f32 v63, v63, v5, v7
  v_mfma_f32_32x32x16_bf16 a[144:159], a[28:31], v[48:51], a[144:159]
  ds_read_b64_tr_b16 a[24:25], v3 offset:45312
  ds_read_b64_tr_b16 a[26:27], v3 offset:45824
  buffer_store_dwordx4 v[244:247], v12, s[88:91], s7 offen offset:1024 sc1
  v_exp_f32 v56, v56
  s_waitcnt lgkmcnt(6)
  v_mfma_f32_32x32x16_bf16 v[240:255], a[0:3], a[160:163], 0
  ds_read_b64_tr_b16 a[28:29], v3 offset:47360
  ds_read_b64_tr_b16 a[30:31], v3 offset:47872
  v_exp_f32 v57, v57
  v_exp_f32 v58, v58
  v_mfma_f32_32x32x16_bf16 v[240:255], a[4:7], a[164:167], v[240:255]
  ds_read_b64_tr_b16 a[0:1], v4 offset:57344
  ds_read_b64_tr_b16 a[2:3], v4 offset:61440
  buffer_load_dwordx4 v1, s[64:67], s6 offen offset:2048 lds
  v_mfma_f32_32x32x16_bf16 v[240:255], a[8:11], a[168:171], v[240:255]
  ds_read_b64_tr_b16 a[4:5], v4 offset:57600
  ds_read_b64_tr_b16 a[6:7], v4 offset:61696
  v_exp_f32 v59, v59
  v_exp_f32 v60, v60
  v_mfma_f32_32x32x16_bf16 v[240:255], a[12:15], a[172:175], v[240:255]
  ds_read_b64_tr_b16 a[8:9], v4 offset:57856
  ds_read_b64_tr_b16 a[10:11], v4 offset:61952
  v_exp_f32 v61, v61
  v_exp_f32 v62, v62
  s_waitcnt lgkmcnt(6)
  v_mfma_f32_32x32x16_bf16 v[240:255], a[16:19], a[176:179], v[240:255]
  ds_read_b64_tr_b16 a[12:13], v4 offset:58112
  ds_read_b64_tr_b16 a[14:15], v4 offset:62208
  v_exp_f32 v63, v63
  v_cvt_pk_bf16_f32 v52, v56, v57
  v_cvt_pk_bf16_f32 v53, v58, v59
  v_mfma_f32_32x32x16_bf16 v[240:255], a[20:23], a[180:183], v[240:255]
  ds_read_b64_tr_b16 a[16:17], v4 offset:58368
  ds_read_b64_tr_b16 a[18:19], v4 offset:62464
  buffer_load_dwordx4 v1, s[68:71], s6 offen offset:3072 lds
  v_cvt_pk_bf16_f32 v54, v60, v61
  v_mfma_f32_32x32x16_bf16 v[240:255], a[24:27], a[184:187], v[240:255]
  ds_read_b64_tr_b16 a[20:21], v4 offset:58624
  ds_read_b64_tr_b16 a[22:23], v4 offset:62720
  v_cvt_pk_bf16_f32 v55, v62, v63
  v_pk_max_u16 v52, v52, s45
  v_pk_max_u16 v53, v53, s45
  v_pk_max_u16 v54, v54, s45
  v_mfma_f32_32x32x16_bf16 v[240:255], a[28:31], a[188:191], v[240:255]
  ds_read_b64_tr_b16 a[24:25], v4 offset:58880
  ds_read_b64_tr_b16 a[26:27], v4 offset:62976
  v_pk_max_u16 v55, v55, s45
  v_mfma_f32_4x4x4_16b_bf16 a[224:227], a[232:233], v[52:53], a[224:227]
  s_nop 0
  v_mfma_f32_4x4x4_16b_bf16 a[228:231], a[232:233], v[54:55], a[228:231]
  s_waitcnt lgkmcnt(6)
  v_mfma_f32_32x32x16_bf16 a[32:47], a[0:3], v[52:55], a[32:47]
  ds_read_b64_tr_b16 a[28:29], v4 offset:59136
  ds_read_b64_tr_b16 a[30:31], v4 offset:63232
  v_fma_f32 v64, v64, v5, v7
  v_fma_f32 v65, v65, v5, v7
  v_fma_f32 v66, v66, v5, v7
  v_add_u32 v3, 0x00010000, v3
  v_mfma_f32_32x32x16_bf16 a[48:63], a[4:7], v[52:55], a[48:63]
  s_add_u32 m0, s31, 16384
  s_add_u32 s6, s2, 114688
  s_and_b32 s6, s6, 0x3ffff
  s_waitcnt vmcnt(30)
  s_barrier
  ds_read_b64_tr_b16 a[0:1], v3 offset:0
  ds_read_b64_tr_b16 a[2:3], v3 offset:512
  buffer_load_dwordx4 v1, s[64:67], s6 offen offset:0 lds
  v_mfma_f32_32x32x16_bf16 a[64:79], a[8:11], v[52:55], a[64:79]
  ds_read_b64_tr_b16 a[4:5], v3 offset:2048
  ds_read_b64_tr_b16 a[6:7], v3 offset:2560
  s_mul_i32 s8, s17, 65536
  s_add_u32 s8, s8, s27
  v_cvt_pk_bf16_f32 v240, v240, v241
  v_cvt_pk_bf16_f32 v241, v242, v243
  v_mfma_f32_32x32x16_bf16 a[80:95], a[12:15], v[52:55], a[80:95]
  ds_read_b64_tr_b16 a[8:9], v3 offset:4096
  ds_read_b64_tr_b16 a[10:11], v3 offset:4608
  v_cvt_pk_bf16_f32 v242, v244, v245
  v_cvt_pk_bf16_f32 v243, v246, v247
  v_cvt_pk_bf16_f32 v244, v248, v249
  v_cvt_pk_bf16_f32 v245, v250, v251
  s_waitcnt lgkmcnt(6)
  v_mfma_f32_32x32x16_bf16 a[96:111], a[16:19], v[52:55], a[96:111]
  ds_read_b64_tr_b16 a[12:13], v3 offset:6144
  ds_read_b64_tr_b16 a[14:15], v3 offset:6656
  v_cvt_pk_bf16_f32 v246, v252, v253
  v_cvt_pk_bf16_f32 v247, v254, v255
  v_fma_f32 v67, v67, v5, v7
  v_fma_f32 v68, v68, v5, v7
  v_mfma_f32_32x32x16_bf16 a[112:127], a[20:23], v[52:55], a[112:127]
  ds_read_b64_tr_b16 a[16:17], v3 offset:8192
  ds_read_b64_tr_b16 a[18:19], v3 offset:8704
  buffer_load_dwordx4 v1, s[68:71], s6 offen offset:1024 lds
  v_fma_f32 v69, v69, v5, v7
  v_mfma_f32_32x32x16_bf16 a[128:143], a[24:27], v[52:55], a[128:143]
  ds_read_b64_tr_b16 a[20:21], v3 offset:10240
  ds_read_b64_tr_b16 a[22:23], v3 offset:10752
  buffer_store_dwordx4 v[240:243], v12, s[88:91], s8 offen offset:0 sc1
  v_fma_f32 v70, v70, v5, v7
  v_fma_f32 v71, v71, v5, v7
  v_mfma_f32_32x32x16_bf16 a[144:159], a[28:31], v[52:55], a[144:159]
  ds_read_b64_tr_b16 a[24:25], v3 offset:12288
  ds_read_b64_tr_b16 a[26:27], v3 offset:12800
  buffer_store_dwordx4 v[244:247], v12, s[88:91], s8 offen offset:1024 sc1
  v_exp_f32 v64, v64
  s_waitcnt lgkmcnt(6)
  v_mfma_f32_32x32x16_bf16 v[240:255], a[0:3], a[160:163], 0
  ds_read_b64_tr_b16 a[28:29], v3 offset:14336
  ds_read_b64_tr_b16 a[30:31], v3 offset:14848
  v_exp_f32 v65, v65
  v_add_u32 v4, 0x00010000, v4
  v_mfma_f32_32x32x16_bf16 v[240:255], a[4:7], a[164:167], v[240:255]
  ds_read_b64_tr_b16 a[0:1], v4 offset:16384
  ds_read_b64_tr_b16 a[2:3], v4 offset:20480
  buffer_load_dwordx4 v1, s[64:67], s6 offen offset:2048 lds
  v_mfma_f32_32x32x16_bf16 v[240:255], a[8:11], a[168:171], v[240:255]
  ds_read_b64_tr_b16 a[4:5], v4 offset:16640
  ds_read_b64_tr_b16 a[6:7], v4 offset:20736
  v_exp_f32 v66, v66
  v_exp_f32 v67, v67
  v_mfma_f32_32x32x16_bf16 v[240:255], a[12:15], a[172:175], v[240:255]
  ds_read_b64_tr_b16 a[8:9], v4 offset:16896
  ds_read_b64_tr_b16 a[10:11], v4 offset:20992
  v_exp_f32 v68, v68
  v_exp_f32 v69, v69
  s_waitcnt lgkmcnt(6)
  v_mfma_f32_32x32x16_bf16 v[240:255], a[16:19], a[176:179], v[240:255]
  ds_read_b64_tr_b16 a[12:13], v4 offset:17152
  ds_read_b64_tr_b16 a[14:15], v4 offset:21248
  v_exp_f32 v70, v70
  v_exp_f32 v71, v71
  v_mfma_f32_32x32x16_bf16 v[240:255], a[20:23], a[180:183], v[240:255]
  ds_read_b64_tr_b16 a[16:17], v4 offset:17408
  ds_read_b64_tr_b16 a[18:19], v4 offset:21504
  buffer_load_dwordx4 v1, s[68:71], s6 offen offset:3072 lds
  v_cvt_pk_bf16_f32 v64, v64, v65
  v_mfma_f32_32x32x16_bf16 v[240:255], a[24:27], a[184:187], v[240:255]
  ds_read_b64_tr_b16 a[20:21], v4 offset:17664
  ds_read_b64_tr_b16 a[22:23], v4 offset:21760
  v_cvt_pk_bf16_f32 v65, v66, v67
  v_cvt_pk_bf16_f32 v66, v68, v69
  v_cvt_pk_bf16_f32 v67, v70, v71
  v_pk_max_u16 v64, v64, s45
  v_mfma_f32_32x32x16_bf16 v[240:255], a[28:31], a[188:191], v[240:255]
  ds_read_b64_tr_b16 a[24:25], v4 offset:17920
  ds_read_b64_tr_b16 a[26:27], v4 offset:22016
  v_pk_max_u16 v65, v65, s45
  v_pk_max_u16 v66, v66, s45
  v_pk_max_u16 v67, v67, s45
  v_mfma_f32_4x4x4_16b_bf16 a[224:227], a[232:233], v[64:65], a[224:227]
  s_nop 0
  v_mfma_f32_4x4x4_16b_bf16 a[228:231], a[232:233], v[66:67], a[228:231]
  s_waitcnt lgkmcnt(6)
  v_mfma_f32_32x32x16_bf16 a[32:47], a[0:3], v[64:67], a[32:47]
  ds_read_b64_tr_b16 a[28:29], v4 offset:18176
  ds_read_b64_tr_b16 a[30:31], v4 offset:22272
  v_fma_f32 v72, v72, v5, v7
  v_fma_f32 v73, v73, v5, v7
  v_fma_f32 v74, v74, v5, v7
  v_fma_f32 v75, v75, v5, v7
  v_mfma_f32_32x32x16_bf16 a[48:63], a[4:7], v[64:67], a[48:63]
  s_add_u32 m0, s31, 32768
  s_add_u32 s6, s2, 131072
  s_and_b32 s6, s6, 0x3ffff
  ds_read_b64_tr_b16 a[0:1], v3 offset:256
  ds_read_b64_tr_b16 a[2:3], v3 offset:768
  buffer_load_dwordx4 v1, s[64:67], s6 offen offset:0 lds
  v_mfma_f32_32x32x16_bf16 a[64:79], a[8:11], v[64:67], a[64:79]
  ds_read_b64_tr_b16 a[4:5], v3 offset:2304
  ds_read_b64_tr_b16 a[6:7], v3 offset:2816
  s_mul_i32 s7, s18, 65536
  s_add_u32 s7, s7, s21
  v_cvt_pk_bf16_f32 v240, v240, v241
  v_cvt_pk_bf16_f32 v241, v242, v243
  v_mfma_f32_32x32x16_bf16 a[80:95], a[12:15], v[64:67], a[80:95]
  ds_read_b64_tr_b16 a[8:9], v3 offset:4352
  ds_read_b64_tr_b16 a[10:11], v3 offset:4864
  v_cvt_pk_bf16_f32 v242, v244, v245
  v_cvt_pk_bf16_f32 v243, v246, v247
  v_cvt_pk_bf16_f32 v244, v248, v249
  v_cvt_pk_bf16_f32 v245, v250, v251
  s_waitcnt lgkmcnt(6)
  v_mfma_f32_32x32x16_bf16 a[96:111], a[16:19], v[64:67], a[96:111]
  ds_read_b64_tr_b16 a[12:13], v3 offset:6400
  ds_read_b64_tr_b16 a[14:15], v3 offset:6912
  v_cvt_pk_bf16_f32 v246, v252, v253
  v_cvt_pk_bf16_f32 v247, v254, v255
  v_fma_f32 v76, v76, v5, v7
  v_fma_f32 v77, v77, v5, v7
  v_mfma_f32_32x32x16_bf16 a[112:127], a[20:23], v[64:67], a[112:127]
  ds_read_b64_tr_b16 a[16:17], v3 offset:8448
  ds_read_b64_tr_b16 a[18:19], v3 offset:8960
  buffer_load_dwordx4 v1, s[68:71], s6 offen offset:1024 lds
  v_fma_f32 v78, v78, v5, v7
  v_mfma_f32_32x32x16_bf16 a[128:143], a[24:27], v[64:67], a[128:143]
  ds_read_b64_tr_b16 a[20:21], v3 offset:10496
  ds_read_b64_tr_b16 a[22:23], v3 offset:11008
  buffer_store_dwordx4 v[240:243], v12, s[88:91], s7 offen offset:0 sc1
  v_fma_f32 v79, v79, v5, v7
  v_mfma_f32_32x32x16_bf16 a[144:159], a[28:31], v[64:67], a[144:159]
  ds_read_b64_tr_b16 a[24:25], v3 offset:12544
  ds_read_b64_tr_b16 a[26:27], v3 offset:13056
  buffer_store_dwordx4 v[244:247], v12, s[88:91], s7 offen offset:1024 sc1
  v_exp_f32 v72, v72
  s_waitcnt lgkmcnt(6)
  v_mfma_f32_32x32x16_bf16 v[240:255], a[0:3], a[160:163], 0
  ds_read_b64_tr_b16 a[28:29], v3 offset:14592
  ds_read_b64_tr_b16 a[30:31], v3 offset:15104
  v_exp_f32 v73, v73
  v_exp_f32 v74, v74
  v_mfma_f32_32x32x16_bf16 v[240:255], a[4:7], a[164:167], v[240:255]
  ds_read_b64_tr_b16 a[0:1], v4 offset:24576
  ds_read_b64_tr_b16 a[2:3], v4 offset:28672
  buffer_load_dwordx4 v1, s[64:67], s6 offen offset:2048 lds
  v_mfma_f32_32x32x16_bf16 v[240:255], a[8:11], a[168:171], v[240:255]
  ds_read_b64_tr_b16 a[4:5], v4 offset:24832
  ds_read_b64_tr_b16 a[6:7], v4 offset:28928
  v_exp_f32 v75, v75
  v_exp_f32 v76, v76
  v_mfma_f32_32x32x16_bf16 v[240:255], a[12:15], a[172:175], v[240:255]
  ds_read_b64_tr_b16 a[8:9], v4 offset:25088
  ds_read_b64_tr_b16 a[10:11], v4 offset:29184
  v_exp_f32 v77, v77
  v_exp_f32 v78, v78
  s_waitcnt lgkmcnt(6)
  v_mfma_f32_32x32x16_bf16 v[240:255], a[16:19], a[176:179], v[240:255]
  ds_read_b64_tr_b16 a[12:13], v4 offset:25344
  ds_read_b64_tr_b16 a[14:15], v4 offset:29440
  v_exp_f32 v79, v79
  v_cvt_pk_bf16_f32 v68, v72, v73
  v_cvt_pk_bf16_f32 v69, v74, v75
  v_mfma_f32_32x32x16_bf16 v[240:255], a[20:23], a[180:183], v[240:255]
  ds_read_b64_tr_b16 a[16:17], v4 offset:25600
  ds_read_b64_tr_b16 a[18:19], v4 offset:29696
  buffer_load_dwordx4 v1, s[68:71], s6 offen offset:3072 lds
  v_cvt_pk_bf16_f32 v70, v76, v77
  v_mfma_f32_32x32x16_bf16 v[240:255], a[24:27], a[184:187], v[240:255]
  ds_read_b64_tr_b16 a[20:21], v4 offset:25856
  ds_read_b64_tr_b16 a[22:23], v4 offset:29952
  v_cvt_pk_bf16_f32 v71, v78, v79
  v_pk_max_u16 v68, v68, s45
  v_pk_max_u16 v69, v69, s45
  v_pk_max_u16 v70, v70, s45
  v_mfma_f32_32x32x16_bf16 v[240:255], a[28:31], a[188:191], v[240:255]
  ds_read_b64_tr_b16 a[24:25], v4 offset:26112
  ds_read_b64_tr_b16 a[26:27], v4 offset:30208
  v_pk_max_u16 v71, v71, s45
  v_mfma_f32_4x4x4_16b_bf16 a[224:227], a[232:233], v[68:69], a[224:227]
  s_nop 0
  v_mfma_f32_4x4x4_16b_bf16 a[228:231], a[232:233], v[70:71], a[228:231]
  s_waitcnt lgkmcnt(6)
  v_mfma_f32_32x32x16_bf16 a[32:47], a[0:3], v[68:71], a[32:47]
  ds_read_b64_tr_b16 a[28:29], v4 offset:26368
  ds_read_b64_tr_b16 a[30:31], v4 offset:30464
  v_fma_f32 v80, v80, v5, v7
  v_fma_f32 v81, v81, v5, v7
  v_fma_f32 v82, v82, v5, v7
  v_fma_f32 v83, v83, v5, v7
  v_mfma_f32_32x32x16_bf16 a[48:63], a[4:7], v[68:71], a[48:63]
  s_add_u32 m0, s31, 49152
  s_add_u32 s6, s2, 147456
  s_and_b32 s6, s6, 0x3ffff
  s_waitcnt vmcnt(30)
  s_barrier
  ds_read_b64_tr_b16 a[0:1], v3 offset:32768
  ds_read_b64_tr_b16 a[2:3], v3 offset:33280
  buffer_load_dwordx4 v1, s[64:67], s6 offen offset:0 lds
  v_mfma_f32_32x32x16_bf16 a[64:79], a[8:11], v[68:71], a[64:79]
  ds_read_b64_tr_b16 a[4:5], v3 offset:34816
  ds_read_b64_tr_b16 a[6:7], v3 offset:35328
  s_mul_i32 s8, s18, 65536
  s_add_u32 s8, s8, s27
  v_cvt_pk_bf16_f32 v240, v240, v241
  v_cvt_pk_bf16_f32 v241, v242, v243
  v_mfma_f32_32x32x16_bf16 a[80:95], a[12:15], v[68:71], a[80:95]
  ds_read_b64_tr_b16 a[8:9], v3 offset:36864
  ds_read_b64_tr_b16 a[10:11], v3 offset:37376
  v_cvt_pk_bf16_f32 v242, v244, v245
  v_cvt_pk_bf16_f32 v243, v246, v247
  v_cvt_pk_bf16_f32 v244, v248, v249
  v_cvt_pk_bf16_f32 v245, v250, v251
  s_waitcnt lgkmcnt(6)
  v_mfma_f32_32x32x16_bf16 a[96:111], a[16:19], v[68:71], a[96:111]
  ds_read_b64_tr_b16 a[12:13], v3 offset:38912
  ds_read_b64_tr_b16 a[14:15], v3 offset:39424
  v_cvt_pk_bf16_f32 v246, v252, v253
  v_cvt_pk_bf16_f32 v247, v254, v255
  v_fma_f32 v84, v84, v5, v7
  v_fma_f32 v85, v85, v5, v7
  v_mfma_f32_32x32x16_bf16 a[112:127], a[20:23], v[68:71], a[112:127]
  ds_read_b64_tr_b16 a[16:17], v3 offset:40960
  ds_read_b64_tr_b16 a[18:19], v3 offset:41472
  buffer_load_dwordx4 v1, s[68:71], s6 offen offset:1024 lds
  v_fma_f32 v86, v86, v5, v7
  v_mfma_f32_32x32x16_bf16 a[128:143], a[24:27], v[68:71], a[128:143]
  ds_read_b64_tr_b16 a[20:21], v3 offset:43008
  ds_read_b64_tr_b16 a[22:23], v3 offset:43520
  buffer_store_dwordx4 v[240:243], v12, s[88:91], s8 offen offset:0 sc1
  v_fma_f32 v87, v87, v5, v7
  v_mfma_f32_32x32x16_bf16 a[144:159], a[28:31], v[68:71], a[144:159]
  ds_read_b64_tr_b16 a[24:25], v3 offset:45056
  ds_read_b64_tr_b16 a[26:27], v3 offset:45568
  buffer_store_dwordx4 v[244:247], v12, s[88:91], s8 offen offset:1024 sc1
  v_exp_f32 v80, v80
  s_waitcnt lgkmcnt(6)
  v_mfma_f32_32x32x16_bf16 v[240:255], a[0:3], a[160:163], 0
  ds_read_b64_tr_b16 a[28:29], v3 offset:47104
  ds_read_b64_tr_b16 a[30:31], v3 offset:47616
  v_exp_f32 v81, v81
  v_exp_f32 v82, v82
  v_mfma_f32_32x32x16_bf16 v[240:255], a[4:7], a[164:167], v[240:255]
  ds_read_b64_tr_b16 a[0:1], v4 offset:49152
  ds_read_b64_tr_b16 a[2:3], v4 offset:53248
  buffer_load_dwordx4 v1, s[64:67], s6 offen offset:2048 lds
  v_mfma_f32_32x32x16_bf16 v[240:255], a[8:11], a[168:171], v[240:255]
  ds_read_b64_tr_b16 a[4:5], v4 offset:49408
  ds_read_b64_tr_b16 a[6:7], v4 offset:53504
  v_exp_f32 v83, v83
  v_exp_f32 v84, v84
  v_mfma_f32_32x32x16_bf16 v[240:255], a[12:15], a[172:175], v[240:255]
  ds_read_b64_tr_b16 a[8:9], v4 offset:49664
  ds_read_b64_tr_b16 a[10:11], v4 offset:53760
  v_exp_f32 v85, v85
  v_exp_f32 v86, v86
  s_waitcnt lgkmcnt(6)
  v_mfma_f32_32x32x16_bf16 v[240:255], a[16:19], a[176:179], v[240:255]
  ds_read_b64_tr_b16 a[12:13], v4 offset:49920
  ds_read_b64_tr_b16 a[14:15], v4 offset:54016
  v_exp_f32 v87, v87
  v_cvt_pk_bf16_f32 v80, v80, v81
  v_cvt_pk_bf16_f32 v81, v82, v83
  v_mfma_f32_32x32x16_bf16 v[240:255], a[20:23], a[180:183], v[240:255]
  ds_read_b64_tr_b16 a[16:17], v4 offset:50176
  ds_read_b64_tr_b16 a[18:19], v4 offset:54272
  buffer_load_dwordx4 v1, s[68:71], s6 offen offset:3072 lds
  v_cvt_pk_bf16_f32 v82, v84, v85
  v_mfma_f32_32x32x16_bf16 v[240:255], a[24:27], a[184:187], v[240:255]
  ds_read_b64_tr_b16 a[20:21], v4 offset:50432
  ds_read_b64_tr_b16 a[22:23], v4 offset:54528
  v_cvt_pk_bf16_f32 v83, v86, v87
  v_pk_max_u16 v80, v80, s45
  v_pk_max_u16 v81, v81, s45
  v_pk_max_u16 v82, v82, s45
  v_mfma_f32_32x32x16_bf16 v[240:255], a[28:31], a[188:191], v[240:255]
  ds_read_b64_tr_b16 a[24:25], v4 offset:50688
  ds_read_b64_tr_b16 a[26:27], v4 offset:54784
  v_pk_max_u16 v83, v83, s45
  v_mfma_f32_4x4x4_16b_bf16 a[224:227], a[232:233], v[80:81], a[224:227]
  s_nop 0
  v_mfma_f32_4x4x4_16b_bf16 a[228:231], a[232:233], v[82:83], a[228:231]
  s_waitcnt lgkmcnt(6)
  v_mfma_f32_32x32x16_bf16 a[32:47], a[0:3], v[80:83], a[32:47]
  ds_read_b64_tr_b16 a[28:29], v4 offset:50944
  ds_read_b64_tr_b16 a[30:31], v4 offset:55040
  v_fma_f32 v88, v88, v5, v7
  v_fma_f32 v89, v89, v5, v7
  v_fma_f32 v90, v90, v5, v7
  v_fma_f32 v91, v91, v5, v7
  v_mfma_f32_32x32x16_bf16 a[48:63], a[4:7], v[80:83], a[48:63]
  s_add_u32 m0, s31, 65536
  s_add_u32 s6, s2, 163840
  s_and_b32 s6, s6, 0x3ffff
  ds_read_b64_tr_b16 a[0:1], v3 offset:33024
  ds_read_b64_tr_b16 a[2:3], v3 offset:33536
  buffer_load_dwordx4 v1, s[64:67], s6 offen offset:0 lds
  v_mfma_f32_32x32x16_bf16 a[64:79], a[8:11], v[80:83], a[64:79]
  ds_read_b64_tr_b16 a[4:5], v3 offset:35072
  ds_read_b64_tr_b16 a[6:7], v3 offset:35584
  s_mul_i32 s7, s19, 65536
  s_add_u32 s7, s7, s21
  v_cvt_pk_bf16_f32 v240, v240, v241
  v_cvt_pk_bf16_f32 v241, v242, v243
  v_mfma_f32_32x32x16_bf16 a[80:95], a[12:15], v[80:83], a[80:95]
  ds_read_b64_tr_b16 a[8:9], v3 offset:37120
  ds_read_b64_tr_b16 a[10:11], v3 offset:37632
  v_cvt_pk_bf16_f32 v242, v244, v245
  v_cvt_pk_bf16_f32 v243, v246, v247
  v_cvt_pk_bf16_f32 v244, v248, v249
  v_cvt_pk_bf16_f32 v245, v250, v251
L_padh8:
  s_cbranch_execz L_padh12
  s_waitcnt lgkmcnt(6)
  v_mfma_f32_32x32x16_bf16 a[96:111], a[16:19], v[80:83], a[96:111]
  ds_read_b64_tr_b16 a[12:13], v3 offset:39168
  ds_read_b64_tr_b16 a[14:15], v3 offset:39680
  v_cvt_pk_bf16_f32 v246, v252, v253
  v_cvt_pk_bf16_f32 v247, v254, v255
  v_fma_f32 v92, v92, v5, v7
  v_fma_f32 v93, v93, v5, v7
  v_mfma_f32_32x32x16_bf16 a[112:127], a[20:23], v[80:83], a[112:127]
  ds_read_b64_tr_b16 a[16:17], v3 offset:41216
  ds_read_b64_tr_b16 a[18:19], v3 offset:41728
  buffer_load_dwordx4 v1, s[68:71], s6 offen offset:1024 lds
  v_fma_f32 v94, v94, v5, v7
  v_mfma_f32_32x32x16_bf16 a[128:143], a[24:27], v[80:83], a[128:143]
  ds_read_b64_tr_b16 a[20:21], v3 offset:43264
  ds_read_b64_tr_b16 a[22:23], v3 offset:43776
  buffer_store_dwordx4 v[240:243], v12, s[88:91], s7 offen offset:0 sc1
  v_fma_f32 v95, v95, v5, v7
  v_mfma_f32_32x32x16_bf16 a[144:159], a[28:31], v[80:83], a[144:159]
  ds_read_b64_tr_b16 a[24:25], v3 offset:45312
  ds_read_b64_tr_b16 a[26:27], v3 offset:45824
  buffer_store_dwordx4 v[244:247], v12, s[88:91], s7 offen offset:1024 sc1
  v_exp_f32 v88, v88
  s_waitcnt lgkmcnt(6)
  v_mfma_f32_32x32x16_bf16 v[240:255], a[0:3], a[160:163], 0
  ds_read_b64_tr_b16 a[28:29], v3 offset:47360
  ds_read_b64_tr_b16 a[30:31], v3 offset:47872
  v_exp_f32 v89, v89
  v_exp_f32 v90, v90
  v_mfma_f32_32x32x16_bf16 v[240:255], a[4:7], a[164:167], v[240:255]
  ds_read_b64_tr_b16 a[0:1], v4 offset:57344
  ds_read_b64_tr_b16 a[2:3], v4 offset:61440
  buffer_load_dwordx4 v1, s[64:67], s6 offen offset:2048 lds
  v_mfma_f32_32x32x16_bf16 v[240:255], a[8:11], a[168:171], v[240:255]
  ds_read_b64_tr_b16 a[4:5], v4 offset:57600
  ds_read_b64_tr_b16 a[6:7], v4 offset:61696
  v_exp_f32 v91, v91
  v_exp_f32 v92, v92
  v_mfma_f32_32x32x16_bf16 v[240:255], a[12:15], a[172:175], v[240:255]
  ds_read_b64_tr_b16 a[8:9], v4 offset:57856
  ds_read_b64_tr_b16 a[10:11], v4 offset:61952
  v_exp_f32 v93, v93
  v_exp_f32 v94, v94
  s_waitcnt lgkmcnt(6)
  v_mfma_f32_32x32x16_bf16 v[240:255], a[16:19], a[176:179], v[240:255]
  ds_read_b64_tr_b16 a[12:13], v4 offset:58112
  ds_read_b64_tr_b16 a[14:15], v4 offset:62208
  v_exp_f32 v95, v95
  v_cvt_pk_bf16_f32 v84, v88, v89
  v_cvt_pk_bf16_f32 v85, v90, v91
  v_mfma_f32_32x32x16_bf16 v[240:255], a[20:23], a[180:183], v[240:255]
  ds_read_b64_tr_b16 a[16:17], v4 offset:58368
  ds_read_b64_tr_b16 a[18:19], v4 offset:62464
  buffer_load_dwordx4 v1, s[68:71], s6 offen offset:3072 lds
  v_cvt_pk_bf16_f32 v86, v92, v93
  v_mfma_f32_32x32x16_bf16 v[240:255], a[24:27], a[184:187], v[240:255]
  ds_read_b64_tr_b16 a[20:21], v4 offset:58624
  ds_read_b64_tr_b16 a[22:23], v4 offset:62720
  v_cvt_pk_bf16_f32 v87, v94, v95
  v_pk_max_u16 v84, v84, s45
  v_pk_max_u16 v85, v85, s45
  v_pk_max_u16 v86, v86, s45
  v_mfma_f32_32x32x16_bf16 v[240:255], a[28:31], a[188:191], v[240:255]
  ds_read_b64_tr_b16 a[24:25], v4 offset:58880
  ds_read_b64_tr_b16 a[26:27], v4 offset:62976
  v_pk_max_u16 v87, v87, s45
  v_mfma_f32_4x4x4_16b_bf16 a[224:227], a[232:233], v[84:85], a[224:227]
  s_nop 0
  v_mfma_f32_4x4x4_16b_bf16 a[228:231], a[232:233], v[86:87], a[228:231]
  s_waitcnt lgkmcnt(6)
  v_mfma_f32_32x32x16_bf16 a[32:47], a[0:3], v[84:87], a[32:47]
  ds_read_b64_tr_b16 a[28:29], v4 offset:59136
  ds_read_b64_tr_b16 a[30:31], v4 offset:63232
  v_fma_f32 v96, v96, v5, v7
  v_fma_f32 v97, v97, v5, v7
  v_fma_f32 v98, v98, v5, v7
  v_add_u32 v3, 0x00010000, v3
  v_mfma_f32_32x32x16_bf16 a[48:63], a[4:7], v[84:87], a[48:63]
  s_add_u32 m0, s31, 81920
  s_add_u32 s6, s2, 180224
  s_and_b32 s6, s6, 0x3ffff
  s_waitcnt vmcnt(30)
  s_barrier
  ds_read_b64_tr_b16 a[0:1], v3 offset:0
  ds_read_b64_tr_b16 a[2:3], v3 offset:512
  buffer_load_dwordx4 v1, s[64:67], s6 offen offset:0 lds
  v_mfma_f32_32x32x16_bf16 a[64:79], a[8:11], v[84:87], a[64:79]
  ds_read_b64_tr_b16 a[4:5], v3 offset:2048
  ds_read_b64_tr_b16 a[6:7], v3 offset:2560
  s_mul_i32 s8, s19, 65536
  s_add_u32 s8, s8, s27
  v_cvt_pk_bf16_f32 v240, v240, v241
  v_cvt_pk_bf16_f32 v241, v242, v243
  v_mfma_f32_32x32x16_bf16 a[80:95], a[12:15], v[84:87], a[80:95]
  ds_read_b64_tr_b16 a[8:9], v3 offset:4096
  ds_read_b64_tr_b16 a[10:11], v3 offset:4608
  v_cvt_pk_bf16_f32 v242, v244, v245
  v_cvt_pk_bf16_f32 v243, v246, v247
  v_cvt_pk_bf16_f32 v244, v248, v249
  v_cvt_pk_bf16_f32 v245, v250, v251
  s_waitcnt lgkmcnt(6)
  v_mfma_f32_32x32x16_bf16 a[96:111], a[16:19], v[84:87], a[96:111]
  ds_read_b64_tr_b16 a[12:13], v3 offset:6144
  ds_read_b64_tr_b16 a[14:15], v3 offset:6656
  v_cvt_pk_bf16_f32 v246, v252, v253
  v_cvt_pk_bf16_f32 v247, v254, v255
  v_fma_f32 v99, v99, v5, v7
  v_fma_f32 v100, v100, v5, v7
  v_mfma_f32_32x32x16_bf16 a[112:127], a[20:23], v[84:87], a[112:127]
  ds_read_b64_tr_b16 a[16:17], v3 offset:8192
  ds_read_b64_tr_b16 a[18:19], v3 offset:8704
  buffer_load_dwordx4 v1, s[68:71], s6 offen offset:1024 lds
  v_fma_f32 v101, v101, v5, v7
  v_mfma_f32_32x32x16_bf16 a[128:143], a[24:27], v[84:87], a[128:143]
  ds_read_b64_tr_b16 a[20:21], v3 offset:10240
  ds_read_b64_tr_b16 a[22:23], v3 offset:10752
  buffer_store_dwordx4 v[240:243], v12, s[88:91], s8 offen offset:0 sc1
  v_fma_f32 v102, v102, v5, v7
  v_fma_f32 v103, v103, v5, v7
  v_mfma_f32_32x32x16_bf16 a[144:159], a[28:31], v[84:87], a[144:159]
  ds_read_b64_tr_b16 a[24:25], v3 offset:12288
  ds_read_b64_tr_b16 a[26:27], v3 offset:12800
  buffer_store_dwordx4 v[244:247], v12, s[88:91], s8 offen offset:1024 sc1
  v_exp_f32 v96, v96
  s_waitcnt lgkmcnt(6)
  v_mfma_f32_32x32x16_bf16 v[240:255], a[0:3], a[160:163], 0
  ds_read_b64_tr_b16 a[28:29], v3 offset:14336
  ds_read_b64_tr_b16 a[30:31], v3 offset:14848
  v_exp_f32 v97, v97
  v_add_u32 v4, 0x00010000, v4
  v_mfma_f32_32x32x16_bf16 v[240:255], a[4:7], a[164:167], v[240:255]
  ds_read_b64_tr_b16 a[0:1], v4 offset:16384
  ds_read_b64_tr_b16 a[2:3], v4 offset:20480
  buffer_load_dwordx4 v1, s[64:67], s6 offen offset:2048 lds
  v_mfma_f32_32x32x16_bf16 v[240:255], a[8:11], a[168:171], v[240:255]
  ds_read_b64_tr_b16 a[4:5], v4 offset:16640
  ds_read_b64_tr_b16 a[6:7], v4 offset:20736
  v_exp_f32 v98, v98
  v_exp_f32 v99, v99
  v_mfma_f32_32x32x16_bf16 v[240:255], a[12:15], a[172:175], v[240:255]
  ds_read_b64_tr_b16 a[8:9], v4 offset:16896
  ds_read_b64_tr_b16 a[10:11], v4 offset:20992
  v_exp_f32 v100, v100
  v_exp_f32 v101, v101
  s_waitcnt lgkmcnt(6)
  v_mfma_f32_32x32x16_bf16 v[240:255], a[16:19], a[176:179], v[240:255]
  ds_read_b64_tr_b16 a[12:13], v4 offset:17152
  ds_read_b64_tr_b16 a[14:15], v4 offset:21248
  v_exp_f32 v102, v102
  v_exp_f32 v103, v103
  v_mfma_f32_32x32x16_bf16 v[240:255], a[20:23], a[180:183], v[240:255]
  ds_read_b64_tr_b16 a[16:17], v4 offset:17408
  ds_read_b64_tr_b16 a[18:19], v4 offset:21504
  buffer_load_dwordx4 v1, s[68:71], s6 offen offset:3072 lds
  v_cvt_pk_bf16_f32 v96, v96, v97
  v_mfma_f32_32x32x16_bf16 v[240:255], a[24:27], a[184:187], v[240:255]
  ds_read_b64_tr_b16 a[20:21], v4 offset:17664
  ds_read_b64_tr_b16 a[22:23], v4 offset:21760
  v_cvt_pk_bf16_f32 v97, v98, v99
  v_cvt_pk_bf16_f32 v98, v100, v101
  v_cvt_pk_bf16_f32 v99, v102, v103
  v_pk_max_u16 v96, v96, s45
  v_mfma_f32_32x32x16_bf16 v[240:255], a[28:31], a[188:191], v[240:255]
  ds_read_b64_tr_b16 a[24:25], v4 offset:17920
  ds_read_b64_tr_b16 a[26:27], v4 offset:22016
  v_pk_max_u16 v97, v97, s45
  v_pk_max_u16 v98, v98, s45
  v_pk_max_u16 v99, v99, s45
  v_mfma_f32_4x4x4_16b_bf16 a[224:227], a[232:233], v[96:97], a[224:227]
  s_nop 0
  v_mfma_f32_4x4x4_16b_bf16 a[228:231], a[232:233], v[98:99], a[228:231]
  s_waitcnt lgkmcnt(6)
  v_mfma_f32_32x32x16_bf16 a[32:47], a[0:3], v[96:99], a[32:47]
  ds_read_b64_tr_b16 a[28:29], v4 offset:18176
  ds_read_b64_tr_b16 a[30:31], v4 offset:22272
  v_fma_f32 v104, v104, v5, v7
  v_fma_f32 v105, v105, v5, v7
  v_fma_f32 v106, v106, v5, v7
  v_fma_f32 v107, v107, v5, v7
  v_mfma_f32_32x32x16_bf16 a[48:63], a[4:7], v[96:99], a[48:63]
  s_add_u32 m0, s31, 98304
  s_add_u32 s6, s2, 196608
  s_and_b32 s6, s6, 0x3ffff
  ds_read_b64_tr_b16 a[0:1], v3 offset:256
  ds_read_b64_tr_b16 a[2:3], v3 offset:768
  buffer_load_dwordx4 v1, s[64:67], s6 offen offset:0 lds
  v_mfma_f32_32x32x16_bf16 a[64:79], a[8:11], v[96:99], a[64:79]
  ds_read_b64_tr_b16 a[4:5], v3 offset:2304
  ds_read_b64_tr_b16 a[6:7], v3 offset:2816
  s_mul_i32 s7, s20, 65536
  s_add_u32 s7, s7, s21
  v_cvt_pk_bf16_f32 v240, v240, v241
  v_cvt_pk_bf16_f32 v241, v242, v243
  v_mfma_f32_32x32x16_bf16 a[80:95], a[12:15], v[96:99], a[80:95]
  ds_read_b64_tr_b16 a[8:9], v3 offset:4352
  ds_read_b64_tr_b16 a[10:11], v3 offset:4864
  v_cvt_pk_bf16_f32 v242, v244, v245
  v_cvt_pk_bf16_f32 v243, v246, v247
  v_cvt_pk_bf16_f32 v244, v248, v249
  v_cvt_pk_bf16_f32 v245, v250, v251
  s_waitcnt lgkmcnt(6)
  v_mfma_f32_32x32x16_bf16 a[96:111], a[16:19], v[96:99], a[96:111]
  ds_read_b64_tr_b16 a[12:13], v3 offset:6400
  ds_read_b64_tr_b16 a[14:15], v3 offset:6912
  v_cvt_pk_bf16_f32 v246, v252, v253
  v_cvt_pk_bf16_f32 v247, v254, v255
  v_fma_f32 v108, v108, v5, v7
  v_fma_f32 v109, v109, v5, v7
  v_mfma_f32_32x32x16_bf16 a[112:127], a[20:23], v[96:99], a[112:127]
  ds_read_b64_tr_b16 a[16:17], v3 offset:8448
  ds_read_b64_tr_b16 a[18:19], v3 offset:8960
  buffer_load_dwordx4 v1, s[68:71], s6 offen offset:1024 lds
  v_fma_f32 v110, v110, v5, v7
  v_mfma_f32_32x32x16_bf16 a[128:143], a[24:27], v[96:99], a[128:143]
  ds_read_b64_tr_b16 a[20:21], v3 offset:10496
  ds_read_b64_tr_b16 a[22:23], v3 offset:11008
  buffer_store_dwordx4 v[240:243], v12, s[88:91], s7 offen offset:0 sc1
  v_fma_f32 v111, v111, v5, v7
  v_mfma_f32_32x32x16_bf16 a[144:159], a[28:31], v[96:99], a[144:159]
  ds_read_b64_tr_b16 a[24:25], v3 offset:12544
  ds_read_b64_tr_b16 a[26:27], v3 offset:13056
  buffer_store_dwordx4 v[244:247], v12, s[88:91], s7 offen offset:1024 sc1
  v_exp_f32 v104, v104
  s_waitcnt lgkmcnt(6)
  v_mfma_f32_32x32x16_bf16 v[240:255], a[0:3], a[160:163], 0
  ds_read_b64_tr_b16 a[28:29], v3 offset:14592
  ds_read_b64_tr_b16 a[30:31], v3 offset:15104
  v_exp_f32 v105, v105
  v_exp_f32 v106, v106
  v_mfma_f32_32x32x16_bf16 v[240:255], a[4:7], a[164:167], v[240:255]
  ds_read_b64_tr_b16 a[0:1], v4 offset:24576
  ds_read_b64_tr_b16 a[2:3], v4 offset:28672
  buffer_load_dwordx4 v1, s[64:67], s6 offen offset:2048 lds
  v_mfma_f32_32x32x16_bf16 v[240:255], a[8:11], a[168:171], v[240:255]
  ds_read_b64_tr_b16 a[4:5], v4 offset:24832
  ds_read_b64_tr_b16 a[6:7], v4 offset:28928
  v_exp_f32 v107, v107
  v_exp_f32 v108, v108
  v_mfma_f32_32x32x16_bf16 v[240:255], a[12:15], a[172:175], v[240:255]
  ds_read_b64_tr_b16 a[8:9], v4 offset:25088
  ds_read_b64_tr_b16 a[10:11], v4 offset:29184
  v_exp_f32 v109, v109
  v_exp_f32 v110, v110
  s_waitcnt lgkmcnt(6)
  v_mfma_f32_32x32x16_bf16 v[240:255], a[16:19], a[176:179], v[240:255]
  ds_read_b64_tr_b16 a[12:13], v4 offset:25344
  ds_read_b64_tr_b16 a[14:15], v4 offset:29440
  v_exp_f32 v111, v111
  v_cvt_pk_bf16_f32 v100, v104, v105
  v_cvt_pk_bf16_f32 v101, v106, v107
  v_mfma_f32_32x32x16_bf16 v[240:255], a[20:23], a[180:183], v[240:255]
  ds_read_b64_tr_b16 a[16:17], v4 offset:25600
  ds_read_b64_tr_b16 a[18:19], v4 offset:29696
  buffer_load_dwordx4 v1, s[68:71], s6 offen offset:3072 lds
  v_cvt_pk_bf16_f32 v102, v108, v109
  v_mfma_f32_32x32x16_bf16 v[240:255], a[24:27], a[184:187], v[240:255]
  ds_read_b64_tr_b16 a[20:21], v4 offset:25856
  ds_read_b64_tr_b16 a[22:23], v4 offset:29952
  v_cvt_pk_bf16_f32 v103, v110, v111
  v_pk_max_u16 v100, v100, s45
  v_pk_max_u16 v101, v101, s45
  v_pk_max_u16 v102, v102, s45
  v_mfma_f32_32x32x16_bf16 v[240:255], a[28:31], a[188:191], v[240:255]
  ds_read_b64_tr_b16 a[24:25], v4 offset:26112
  ds_read_b64_tr_b16 a[26:27], v4 offset:30208
  v_pk_max_u16 v103, v103, s45
  v_mfma_f32_4x4x4_16b_bf16 a[224:227], a[232:233], v[100:101], a[224:227]
  s_nop 0
  v_mfma_f32_4x4x4_16b_bf16 a[228:231], a[232:233], v[102:103], a[228:231]
  s_waitcnt lgkmcnt(6)
  v_mfma_f32_32x32x16_bf16 a[32:47], a[0:3], v[100:103], a[32:47]
  ds_read_b64_tr_b16 a[28:29], v4 offset:26368
  ds_read_b64_tr_b16 a[30:31], v4 offset:30464
  v_fma_f32 v112, v112, v5, v7
  v_fma_f32 v113, v113, v5, v7
  v_fma_f32 v114, v114, v5, v7
  v_add_u32 v4, 0xfffe0000, v4
  v_mfma_f32_32x32x16_bf16 a[48:63], a[4:7], v[100:103], a[48:63]
  s_add_u32 m0, s31, 114688
  s_add_u32 s6, s2, 212992
  s_and_b32 s6, s6, 0x3ffff
  s_waitcnt vmcnt(30)
  s_barrier
  ds_read_b64_tr_b16 a[0:1], v4 offset:0
  ds_read_b64_tr_b16 a[2:3], v4 offset:4096
  buffer_load_dwordx4 v1, s[64:67], s6 offen offset:0 lds
  v_mfma_f32_32x32x16_bf16 a[64:79], a[8:11], v[100:103], a[64:79]
  ds_read_b64_tr_b16 a[4:5], v4 offset:256
  ds_read_b64_tr_b16 a[6:7], v4 offset:4352
  v_fma_f32 v115, v115, v5, v7
  v_fma_f32 v116, v116, v5, v7
  v_fma_f32 v117, v117, v5, v7
  v_fma_f32 v118, v118, v5, v7
  v_mfma_f32_32x32x16_bf16 a[80:95], a[12:15], v[100:103], a[80:95]
  ds_read_b64_tr_b16 a[8:9], v4 offset:512
  ds_read_b64_tr_b16 a[10:11], v4 offset:4608
  v_fma_f32 v119, v119, v5, v7
  v_exp_f32 v112, v112
  s_mul_i32 s8, s20, 65536
  s_waitcnt lgkmcnt(6)
  v_mfma_f32_32x32x16_bf16 a[96:111], a[16:19], v[100:103], a[96:111]
  ds_read_b64_tr_b16 a[12:13], v4 offset:768
  ds_read_b64_tr_b16 a[14:15], v4 offset:4864
  v_exp_f32 v113, v113
  v_exp_f32 v114, v114
  v_mfma_f32_32x32x16_bf16 a[112:127], a[20:23], v[100:103], a[112:127]
  ds_read_b64_tr_b16 a[16:17], v4 offset:1024
  ds_read_b64_tr_b16 a[18:19], v4 offset:5120
  buffer_load_dwordx4 v1, s[68:71], s6 offen offset:1024 lds
  s_add_u32 s8, s8, s27
  v_mfma_f32_32x32x16_bf16 a[128:143], a[24:27], v[100:103], a[128:143]
  ds_read_b64_tr_b16 a[20:21], v4 offset:1280
  ds_read_b64_tr_b16 a[22:23], v4 offset:5376
  v_exp_f32 v115, v115
  v_exp_f32 v116, v116
  v_mfma_f32_32x32x16_bf16 a[144:159], a[28:31], v[100:103], a[144:159]
  ds_read_b64_tr_b16 a[24:25], v4 offset:1536
  ds_read_b64_tr_b16 a[26:27], v4 offset:5632
  v_exp_f32 v117, v117
  v_exp_f32 v118, v118
  v_exp_f32 v119, v119
  v_cvt_pk_bf16_f32 v112, v112, v113
  v_cvt_pk_bf16_f32 v113, v114, v115
  v_cvt_pk_bf16_f32 v114, v116, v117
  v_cvt_pk_bf16_f32 v115, v118, v119
  v_pk_max_u16 v112, v112, s45
  v_pk_max_u16 v113, v113, s45
  v_pk_max_u16 v114, v114, s45
  v_pk_max_u16 v115, v115, s45
  v_mfma_f32_4x4x4_16b_bf16 a[224:227], a[232:233], v[112:113], a[224:227]
  s_nop 0
  v_mfma_f32_4x4x4_16b_bf16 a[228:231], a[232:233], v[114:115], a[228:231]
  s_waitcnt lgkmcnt(6)
  v_mfma_f32_32x32x16_bf16 a[32:47], a[0:3], v[112:115], a[32:47]
  ds_read_b64_tr_b16 a[28:29], v4 offset:1792
  ds_read_b64_tr_b16 a[30:31], v4 offset:5888
  v_cvt_pk_bf16_f32 v240, v240, v241
  v_cvt_pk_bf16_f32 v241, v242, v243
  v_cvt_pk_bf16_f32 v242, v244, v245
  v_cvt_pk_bf16_f32 v243, v246, v247
  v_cvt_pk_bf16_f32 v244, v248, v249
  v_cvt_pk_bf16_f32 v245, v250, v251
  v_cvt_pk_bf16_f32 v246, v252, v253
  v_cvt_pk_bf16_f32 v247, v254, v255
  buffer_store_dwordx4 v[240:243], v12, s[88:91], s8 offen offset:0 sc1
  buffer_store_dwordx4 v[244:247], v12, s[88:91], s8 offen offset:1024 sc1
  v_mfma_f32_32x32x16_bf16 a[48:63], a[4:7], v[112:115], a[48:63]
  ds_read_b64_tr_b16 a[0:1], v4 offset:8192
  ds_read_b64_tr_b16 a[2:3], v4 offset:12288
  buffer_load_dwordx4 v1, s[64:67], s6 offen offset:2048 lds
  v_fma_f32 v120, v120, v5, v7
  v_mfma_f32_32x32x16_bf16 a[64:79], a[8:11], v[112:115], a[64:79]
  ds_read_b64_tr_b16 a[4:5], v4 offset:8448
  ds_read_b64_tr_b16 a[6:7], v4 offset:12544
  v_fma_f32 v121, v121, v5, v7
  v_fma_f32 v122, v122, v5, v7
  v_fma_f32 v123, v123, v5, v7
  v_fma_f32 v124, v124, v5, v7
  v_mfma_f32_32x32x16_bf16 a[80:95], a[12:15], v[112:115], a[80:95]
  ds_read_b64_tr_b16 a[8:9], v4 offset:8704
  ds_read_b64_tr_b16 a[10:11], v4 offset:12800
  v_fma_f32 v125, v125, v5, v7
  v_fma_f32 v126, v126, v5, v7
  v_fma_f32 v127, v127, v5, v7
  s_waitcnt lgkmcnt(6)
  v_mfma_f32_32x32x16_bf16 a[96:111], a[16:19], v[112:115], a[96:111]
  ds_read_b64_tr_b16 a[12:13], v4 offset:8960
  ds_read_b64_tr_b16 a[14:15], v4 offset:13056
  v_exp_f32 v120, v120
  v_exp_f32 v121, v121
  v_mfma_f32_32x32x16_bf16 a[112:127], a[20:23], v[112:115], a[112:127]
  ds_read_b64_tr_b16 a[16:17], v4 offset:9216
  ds_read_b64_tr_b16 a[18:19], v4 offset:13312
  buffer_load_dwordx4 v1, s[68:71], s6 offen offset:3072 lds
  v_mfma_f32_32x32x16_bf16 a[128:143], a[24:27], v[112:115], a[128:143]
  ds_read_b64_tr_b16 a[20:21], v4 offset:9472
  ds_read_b64_tr_b16 a[22:23], v4 offset:13568
  v_exp_f32 v122, v122
  v_exp_f32 v123, v123
  v_mfma_f32_32x32x16_bf16 a[144:159], a[28:31], v[112:115], a[144:159]
  ds_read_b64_tr_b16 a[24:25], v4 offset:9728
  ds_read_b64_tr_b16 a[26:27], v4 offset:13824
  v_exp_f32 v124, v124
  v_exp_f32 v125, v125
  v_exp_f32 v126, v126
  v_exp_f32 v127, v127
  v_cvt_pk_bf16_f32 v116, v120, v121
  v_cvt_pk_bf16_f32 v117, v122, v123
  v_cvt_pk_bf16_f32 v118, v124, v125
  v_cvt_pk_bf16_f32 v119, v126, v127
  v_pk_max_u16 v116, v116, s45
  v_pk_max_u16 v117, v117, s45
  v_pk_max_u16 v118, v118, s45
  v_pk_max_u16 v119, v119, s45
  v_mfma_f32_4x4x4_16b_bf16 a[224:227], a[232:233], v[116:117], a[224:227]
  s_nop 0
  v_mfma_f32_4x4x4_16b_bf16 a[228:231], a[232:233], v[118:119], a[228:231]
  s_waitcnt lgkmcnt(6)
  v_mfma_f32_32x32x16_bf16 a[32:47], a[0:3], v[116:119], a[32:47]
  ds_read_b64_tr_b16 a[28:29], v4 offset:9984
  ds_read_b64_tr_b16 a[30:31], v4 offset:14080
  v_accvgpr_read_b32 v48, a192
  v_accvgpr_read_b32 v49, a193
  v_accvgpr_read_b32 v50, a194
  v_accvgpr_read_b32 v51, a195
  v_mfma_f32_32x32x16_bf16 a[48:63], a[4:7], v[116:119], a[48:63]
  s_add_u32 m0, s31, 131072
  s_add_u32 s6, s2, 229376
  s_and_b32 s6, s6, 0x3ffff
  ds_read_b64_tr_b16 a[0:1], v4 offset:16384
  ds_read_b64_tr_b16 a[2:3], v4 offset:20480
  buffer_load_dwordx4 v1, s[64:67], s6 offen offset:0 lds
  v_mfma_f32_32x32x16_bf16 a[64:79], a[8:11], v[116:119], a[64:79]
  ds_read_b64_tr_b16 a[4:5], v4 offset:16640
  ds_read_b64_tr_b16 a[6:7], v4 offset:20736
  v_accvgpr_read_b32 v52, a196
  v_accvgpr_read_b32 v53, a197
  v_accvgpr_read_b32 v54, a198
  v_accvgpr_read_b32 v55, a199
  v_mfma_f32_32x32x16_bf16 a[80:95], a[12:15], v[116:119], a[80:95]
  ds_read_b64_tr_b16 a[8:9], v4 offset:16896
  ds_read_b64_tr_b16 a[10:11], v4 offset:20992
  v_fma_f32 v48, v48, v5, v7
  v_fma_f32 v49, v49, v5, v7
  v_fma_f32 v50, v50, v5, v7
  v_fma_f32 v51, v51, v5, v7
  s_waitcnt lgkmcnt(6)
  v_mfma_f32_32x32x16_bf16 a[96:111], a[16:19], v[116:119], a[96:111]
  ds_read_b64_tr_b16 a[12:13], v4 offset:17152
  ds_read_b64_tr_b16 a[14:15], v4 offset:21248
  v_fma_f32 v52, v52, v5, v7
  v_fma_f32 v53, v53, v5, v7
  v_fma_f32 v54, v54, v5, v7
  v_fma_f32 v55, v55, v5, v7
  v_mfma_f32_32x32x16_bf16 a[112:127], a[20:23], v[116:119], a[112:127]
  ds_read_b64_tr_b16 a[16:17], v4 offset:17408
  ds_read_b64_tr_b16 a[18:19], v4 offset:21504
  buffer_load_dwordx4 v1, s[68:71], s6 offen offset:1024 lds
  v_mfma_f32_32x32x16_bf16 a[128:143], a[24:27], v[116:119], a[128:143]
  ds_read_b64_tr_b16 a[20:21], v4 offset:17664
  ds_read_b64_tr_b16 a[22:23], v4 offset:21760
  v_exp_f32 v48, v48
  v_exp_f32 v49, v49
  v_mfma_f32_32x32x16_bf16 a[144:159], a[28:31], v[116:119], a[144:159]
  ds_read_b64_tr_b16 a[24:25], v4 offset:17920
  ds_read_b64_tr_b16 a[26:27], v4 offset:22016
  v_exp_f32 v50, v50
  v_exp_f32 v51, v51
  v_exp_f32 v52, v52
  v_exp_f32 v53, v53
  v_exp_f32 v54, v54
  v_exp_f32 v55, v55
  v_cvt_pk_bf16_f32 v48, v48, v49
  v_cvt_pk_bf16_f32 v49, v50, v51
  v_cvt_pk_bf16_f32 v50, v52, v53
  v_cvt_pk_bf16_f32 v51, v54, v55
  v_pk_max_u16 v48, v48, s45
  v_pk_max_u16 v49, v49, s45
  v_pk_max_u16 v50, v50, s45
  v_pk_max_u16 v51, v51, s45
  v_mfma_f32_4x4x4_16b_bf16 a[224:227], a[232:233], v[48:49], a[224:227]
  s_nop 0
  v_mfma_f32_4x4x4_16b_bf16 a[228:231], a[232:233], v[50:51], a[228:231]
  s_waitcnt lgkmcnt(6)
  v_mfma_f32_32x32x16_bf16 a[32:47], a[0:3], v[48:51], a[32:47]
  ds_read_b64_tr_b16 a[28:29], v4 offset:18176
  ds_read_b64_tr_b16 a[30:31], v4 offset:22272
  v_accvgpr_read_b32 v56, a200
  v_accvgpr_read_b32 v57, a201
  v_accvgpr_read_b32 v58, a202
  v_accvgpr_read_b32 v59, a203
  v_mfma_f32_32x32x16_bf16 a[48:63], a[4:7], v[48:51], a[48:63]
  ds_read_b64_tr_b16 a[0:1], v4 offset:24576
  ds_read_b64_tr_b16 a[2:3], v4 offset:28672
  buffer_load_dwordx4 v1, s[64:67], s6 offen offset:2048 lds
  v_accvgpr_read_b32 v60, a204
  v_mfma_f32_32x32x16_bf16 a[64:79], a[8:11], v[48:51], a[64:79]
  ds_read_b64_tr_b16 a[4:5], v4 offset:24832
  ds_read_b64_tr_b16 a[6:7], v4 offset:28928
  v_accvgpr_read_b32 v61, a205
  v_accvgpr_read_b32 v62, a206
  v_accvgpr_read_b32 v63, a207
  v_fma_f32 v56, v56, v5, v7
  v_mfma_f32_32x32x16_bf16 a[80:95], a[12:15], v[48:51], a[80:95]
  ds_read_b64_tr_b16 a[8:9], v4 offset:25088
  ds_read_b64_tr_b16 a[10:11], v4 offset:29184
  v_fma_f32 v57, v57, v5, v7
  v_fma_f32 v58, v58, v5, v7
  v_fma_f32 v59, v59, v5, v7
  v_fma_f32 v60, v60, v5, v7
  s_waitcnt lgkmcnt(6)
  v_mfma_f32_32x32x16_bf16 a[96:111], a[16:19], v[48:51], a[96:111]
  ds_read_b64_tr_b16 a[12:13], v4 offset:25344
  ds_read_b64_tr_b16 a[14:15], v4 offset:29440
  v_fma_f32 v61, v61, v5, v7
  v_fma_f32 v62, v62, v5, v7
  v_fma_f32 v63, v63, v5, v7
  s_lshl_b32 s99, s96, 2
  v_mfma_f32_32x32x16_bf16 a[112:127], a[20:23], v[48:51], a[112:127]
  ds_read_b64_tr_b16 a[16:17], v4 offset:25600
  ds_read_b64_tr_b16 a[18:19], v4 offset:29696
  buffer_load_dwordx4 v1, s[68:71], s6 offen offset:3072 lds
  s_add_u32 s99, s99, s28
  v_mfma_f32_32x32x16_bf16 a[128:143], a[24:27], v[48:51], a[128:143]
  ds_read_b64_tr_b16 a[20:21], v4 offset:25856
  ds_read_b64_tr_b16 a[22:23], v4 offset:29952
  v_exp_f32 v56, v56
  v_exp_f32 v57, v57
  v_mfma_f32_32x32x16_bf16 a[144:159], a[28:31], v[48:51], a[144:159]
  ds_read_b64_tr_b16 a[24:25], v4 offset:26112
  ds_read_b64_tr_b16 a[26:27], v4 offset:30208
  v_exp_f32 v58, v58
  v_exp_f32 v59, v59
  v_exp_f32 v60, v60
  v_exp_f32 v61, v61
  v_exp_f32 v62, v62
  v_exp_f32 v63, v63
  v_cvt_pk_bf16_f32 v52, v56, v57
  v_cvt_pk_bf16_f32 v53, v58, v59
  v_cvt_pk_bf16_f32 v54, v60, v61
  v_cvt_pk_bf16_f32 v55, v62, v63
  v_pk_max_u16 v52, v52, s45
  v_pk_max_u16 v53, v53, s45
  v_pk_max_u16 v54, v54, s45
  v_pk_max_u16 v55, v55, s45
  v_mfma_f32_4x4x4_16b_bf16 a[224:227], a[232:233], v[52:53], a[224:227]
  s_nop 0
  v_mfma_f32_4x4x4_16b_bf16 a[228:231], a[232:233], v[54:55], a[228:231]
  s_add_u32 s99, s99, 7168
  s_waitcnt vmcnt(6)
  buffer_store_dword v0, off, s[88:91], s99 sc1
  s_waitcnt lgkmcnt(6)
  v_mfma_f32_32x32x16_bf16 a[32:47], a[0:3], v[52:55], a[32:47]
  ds_read_b64_tr_b16 a[28:29], v4 offset:26368
  ds_read_b64_tr_b16 a[30:31], v4 offset:30464
  v_accvgpr_read_b32 v64, a208
  v_accvgpr_read_b32 v65, a209
  v_accvgpr_read_b32 v66, a210
  v_accvgpr_read_b32 v67, a211
  v_mfma_f32_32x32x16_bf16 a[48:63], a[4:7], v[52:55], a[48:63]
  s_add_u32 m0, s31, 147456
  s_add_u32 s6, s2, 245760
  s_and_b32 s6, s6, 0x3ffff
  s_barrier
  ds_read_b64_tr_b16 a[0:1], v4 offset:32768
  ds_read_b64_tr_b16 a[2:3], v4 offset:36864
  buffer_load_dwordx4 v1, s[64:67], s6 offen offset:0 lds
  v_mfma_f32_32x32x16_bf16 a[64:79], a[8:11], v[52:55], a[64:79]
  ds_read_b64_tr_b16 a[4:5], v4 offset:33024
  ds_read_b64_tr_b16 a[6:7], v4 offset:37120
  v_accvgpr_read_b32 v68, a212
  v_accvgpr_read_b32 v69, a213
  v_accvgpr_read_b32 v70, a214
  v_accvgpr_read_b32 v71, a215
  v_mfma_f32_32x32x16_bf16 a[80:95], a[12:15], v[52:55], a[80:95]
  ds_read_b64_tr_b16 a[8:9], v4 offset:33280
  ds_read_b64_tr_b16 a[10:11], v4 offset:37376
  v_fma_f32 v64, v64, v5, v7
  v_fma_f32 v65, v65, v5, v7
L_padh9:
  s_cbranch_execz L_padh13
  v_fma_f32 v66, v66, v5, v7
  v_fma_f32 v67, v67, v5, v7
  s_waitcnt lgkmcnt(6)
  v_mfma_f32_32x32x16_bf16 a[96:111], a[16:19], v[52:55], a[96:111]
  ds_read_b64_tr_b16 a[12:13], v4 offset:33536
  ds_read_b64_tr_b16 a[14:15], v4 offset:37632
  v_fma_f32 v68, v68, v5, v7
  v_fma_f32 v69, v69, v5, v7
  v_fma_f32 v70, v70, v5, v7
  v_fma_f32 v71, v71, v5, v7
  v_mfma_f32_32x32x16_bf16 a[112:127], a[20:23], v[52:55], a[112:127]
  ds_read_b64_tr_b16 a[16:17], v4 offset:33792
  ds_read_b64_tr_b16 a[18:19], v4 offset:37888
  buffer_load_dwordx4 v1, s[68:71], s6 offen offset:1024 lds
  v_accvgpr_read_b32 v104, a247
  v_mfma_f32_32x32x16_bf16 a[128:143], a[24:27], v[52:55], a[128:143]
  ds_read_b64_tr_b16 a[20:21], v4 offset:34048
  ds_read_b64_tr_b16 a[22:23], v4 offset:38144
  v_exp_f32 v64, v64
  v_exp_f32 v65, v65
  v_mfma_f32_32x32x16_bf16 a[144:159], a[28:31], v[52:55], a[144:159]
  ds_read_b64_tr_b16 a[24:25], v4 offset:34304
  ds_read_b64_tr_b16 a[26:27], v4 offset:38400
  v_exp_f32 v66, v66
  v_exp_f32 v67, v67
  v_exp_f32 v68, v68
  v_exp_f32 v69, v69
  v_exp_f32 v70, v70
  v_exp_f32 v71, v71
  v_cvt_pk_bf16_f32 v64, v64, v65
  v_cvt_pk_bf16_f32 v65, v66, v67
  v_cvt_pk_bf16_f32 v66, v68, v69
  v_cvt_pk_bf16_f32 v67, v70, v71
  v_pk_max_u16 v64, v64, s45
  v_pk_max_u16 v65, v65, s45
  v_pk_max_u16 v66, v66, s45
  v_pk_max_u16 v67, v67, s45
  v_mfma_f32_4x4x4_16b_bf16 a[224:227], a[232:233], v[64:65], a[224:227]
  s_nop 0
  v_mfma_f32_4x4x4_16b_bf16 a[228:231], a[232:233], v[66:67], a[228:231]
  s_waitcnt lgkmcnt(6)
  v_mfma_f32_32x32x16_bf16 a[32:47], a[0:3], v[64:67], a[32:47]
  ds_read_b64_tr_b16 a[28:29], v4 offset:34560
  ds_read_b64_tr_b16 a[30:31], v4 offset:38656
  v_accvgpr_read_b32 v72, a216
  v_accvgpr_read_b32 v73, a217
  v_accvgpr_read_b32 v74, a218
  v_accvgpr_read_b32 v75, a219
  v_mfma_f32_32x32x16_bf16 a[48:63], a[4:7], v[64:67], a[48:63]
  ds_read_b64_tr_b16 a[0:1], v4 offset:40960
  ds_read_b64_tr_b16 a[2:3], v4 offset:45056
  buffer_load_dwordx4 v1, s[64:67], s6 offen offset:2048 lds
  v_accvgpr_read_b32 v76, a220
  v_mfma_f32_32x32x16_bf16 a[64:79], a[8:11], v[64:67], a[64:79]
  ds_read_b64_tr_b16 a[4:5], v4 offset:41216
  ds_read_b64_tr_b16 a[6:7], v4 offset:45312
  v_accvgpr_read_b32 v77, a221
  v_accvgpr_read_b32 v78, a222
  v_accvgpr_read_b32 v79, a223
  v_fma_f32 v72, v72, v5, v7
  v_mfma_f32_32x32x16_bf16 a[80:95], a[12:15], v[64:67], a[80:95]
  ds_read_b64_tr_b16 a[8:9], v4 offset:41472
  ds_read_b64_tr_b16 a[10:11], v4 offset:45568
  v_fma_f32 v73, v73, v5, v7
  v_fma_f32 v74, v74, v5, v7
  v_fma_f32 v75, v75, v5, v7
  v_fma_f32 v76, v76, v5, v7
  s_waitcnt lgkmcnt(6)
  v_mfma_f32_32x32x16_bf16 a[96:111], a[16:19], v[64:67], a[96:111]
  ds_read_b64_tr_b16 a[12:13], v4 offset:41728
  ds_read_b64_tr_b16 a[14:15], v4 offset:45824
  v_fma_f32 v77, v77, v5, v7
  v_fma_f32 v78, v78, v5, v7
  v_fma_f32 v79, v79, v5, v7
  v_lshrrev_b32 v105, 9, v12
  v_mfma_f32_32x32x16_bf16 a[112:127], a[20:23], v[64:67], a[112:127]
  ds_read_b64_tr_b16 a[16:17], v4 offset:41984
  ds_read_b64_tr_b16 a[18:19], v4 offset:46080
  buffer_load_dwordx4 v1, s[68:71], s6 offen offset:3072 lds
  v_lshrrev_b32 v106, 3, v104
  v_mfma_f32_32x32x16_bf16 a[128:143], a[24:27], v[64:67], a[128:143]
  ds_read_b64_tr_b16 a[20:21], v4 offset:42240
  ds_read_b64_tr_b16 a[22:23], v4 offset:46336
  v_exp_f32 v72, v72
  v_exp_f32 v73, v73
  v_mfma_f32_32x32x16_bf16 a[144:159], a[28:31], v[64:67], a[144:159]
  ds_read_b64_tr_b16 a[24:25], v4 offset:42496
  ds_read_b64_tr_b16 a[26:27], v4 offset:46592
  v_exp_f32 v74, v74
  v_exp_f32 v75, v75
  v_exp_f32 v76, v76
  v_exp_f32 v77, v77
  v_exp_f32 v78, v78
  v_exp_f32 v79, v79
  v_cvt_pk_bf16_f32 v68, v72, v73
  v_cvt_pk_bf16_f32 v69, v74, v75
  v_cvt_pk_bf16_f32 v70, v76, v77
  v_cvt_pk_bf16_f32 v71, v78, v79
  v_pk_max_u16 v68, v68, s45
  v_pk_max_u16 v69, v69, s45
  v_pk_max_u16 v70, v70, s45
  v_pk_max_u16 v71, v71, s45
  v_mfma_f32_4x4x4_16b_bf16 a[224:227], a[232:233], v[68:69], a[224:227]
  s_nop 0
  v_mfma_f32_4x4x4_16b_bf16 a[228:231], a[232:233], v[70:71], a[228:231]
  s_waitcnt lgkmcnt(6)
  v_mfma_f32_32x32x16_bf16 a[32:47], a[0:3], v[68:71], a[32:47]
  ds_read_b64_tr_b16 a[28:29], v4 offset:42752
  ds_read_b64_tr_b16 a[30:31], v4 offset:46848
  v_fma_f32 v128, v128, v5, v7
  v_fma_f32 v129, v129, v5, v7
  v_fma_f32 v130, v130, v5, v7
  v_fma_f32 v131, v131, v5, v7
  v_mfma_f32_32x32x16_bf16 a[48:63], a[4:7], v[68:71], a[48:63]
  s_add_u32 m0, s31, 0
  ds_read_b64_tr_b16 a[0:1], v4 offset:49152
  ds_read_b64_tr_b16 a[2:3], v4 offset:53248
  buffer_load_dwordx4 v2, s[48:51], s14 offen offset:0 lds
  v_mfma_f32_32x32x16_bf16 a[64:79], a[8:11], v[68:71], a[64:79]
  ds_read_b64_tr_b16 a[4:5], v4 offset:49408
  ds_read_b64_tr_b16 a[6:7], v4 offset:53504
  v_fma_f32 v132, v132, v5, v7
  v_fma_f32 v133, v133, v5, v7
  v_fma_f32 v134, v134, v5, v7
  v_fma_f32 v135, v135, v5, v7
  v_mfma_f32_32x32x16_bf16 a[80:95], a[12:15], v[68:71], a[80:95]
  ds_read_b64_tr_b16 a[8:9], v4 offset:49664
  ds_read_b64_tr_b16 a[10:11], v4 offset:53760
  v_exp_f32 v128, v128
  v_exp_f32 v129, v129
  s_waitcnt lgkmcnt(6)
  v_mfma_f32_32x32x16_bf16 a[96:111], a[16:19], v[68:71], a[96:111]
  ds_read_b64_tr_b16 a[12:13], v4 offset:49920
  ds_read_b64_tr_b16 a[14:15], v4 offset:54016
  v_exp_f32 v130, v130
  v_exp_f32 v131, v131
  v_mfma_f32_32x32x16_bf16 a[112:127], a[20:23], v[68:71], a[112:127]
  ds_read_b64_tr_b16 a[16:17], v4 offset:50176
  ds_read_b64_tr_b16 a[18:19], v4 offset:54272
  buffer_load_dwordx4 v2, s[52:55], s14 offen offset:1024 lds
  v_sub_u32 v106, v106, v105
  v_mfma_f32_32x32x16_bf16 a[128:143], a[24:27], v[68:71], a[128:143]
  ds_read_b64_tr_b16 a[20:21], v4 offset:50432
  ds_read_b64_tr_b16 a[22:23], v4 offset:54528
  v_exp_f32 v132, v132
  v_exp_f32 v133, v133
  v_mfma_f32_32x32x16_bf16 a[144:159], a[28:31], v[68:71], a[144:159]
  ds_read_b64_tr_b16 a[24:25], v4 offset:50688
  ds_read_b64_tr_b16 a[26:27], v4 offset:54784
  v_exp_f32 v134, v134
  v_exp_f32 v135, v135
  v_cvt_pk_bf16_f32 v128, v128, v129
  v_cvt_pk_bf16_f32 v129, v130, v131
  v_cvt_pk_bf16_f32 v130, v132, v133
  v_cvt_pk_bf16_f32 v131, v134, v135
  v_pk_max_u16 v128, v128, s45
  v_pk_max_u16 v129, v129, s45
  v_pk_max_u16 v130, v130, s45
  v_pk_max_u16 v131, v131, s45
  v_mfma_f32_4x4x4_16b_bf16 a[224:227], a[232:233], v[128:129], a[224:227]
  s_nop 0
  v_mfma_f32_4x4x4_16b_bf16 a[228:231], a[232:233], v[130:131], a[228:231]
  s_waitcnt lgkmcnt(6)
  v_mfma_f32_32x32x16_bf16 a[32:47], a[0:3], v[128:131], a[32:47]
  ds_read_b64_tr_b16 a[28:29], v4 offset:50944
  ds_read_b64_tr_b16 a[30:31], v4 offset:55040
  v_fma_f32 v136, v136, v5, v7
  v_fma_f32 v137, v137, v5, v7
  v_fma_f32 v138, v138, v5, v7
  v_fma_f32 v139, v139, v5, v7
  v_mfma_f32_32x32x16_bf16 a[48:63], a[4:7], v[128:131], a[48:63]
  ds_read_b64_tr_b16 a[0:1], v4 offset:57344
  ds_read_b64_tr_b16 a[2:3], v4 offset:61440
  buffer_load_dwordx4 v2, s[56:59], s14 offen offset:2048 lds
  v_fma_f32 v140, v140, v5, v7
  v_mfma_f32_32x32x16_bf16 a[64:79], a[8:11], v[128:131], a[64:79]
  ds_read_b64_tr_b16 a[4:5], v4 offset:57600
  ds_read_b64_tr_b16 a[6:7], v4 offset:61696
  v_fma_f32 v141, v141, v5, v7
  v_fma_f32 v142, v142, v5, v7
  v_fma_f32 v143, v143, v5, v7
  v_and_b32 v107, 1, v104
  v_mfma_f32_32x32x16_bf16 a[80:95], a[12:15], v[128:131], a[80:95]
  ds_read_b64_tr_b16 a[8:9], v4 offset:57856
  ds_read_b64_tr_b16 a[10:11], v4 offset:61952
  v_exp_f32 v136, v136
  v_exp_f32 v137, v137
  s_waitcnt lgkmcnt(6)
  v_mfma_f32_32x32x16_bf16 a[96:111], a[16:19], v[128:131], a[96:111]
  ds_read_b64_tr_b16 a[12:13], v4 offset:58112
  ds_read_b64_tr_b16 a[14:15], v4 offset:62208
  v_exp_f32 v138, v138
  v_exp_f32 v139, v139
  v_mfma_f32_32x32x16_bf16 a[112:127], a[20:23], v[128:131], a[112:127]
  ds_read_b64_tr_b16 a[16:17], v4 offset:58368
  ds_read_b64_tr_b16 a[18:19], v4 offset:62464
  buffer_load_dwordx4 v2, s[60:63], s14 offen offset:3072 lds
  v_lshlrev_b32 v107, 4, v107
  v_mfma_f32_32x32x16_bf16 a[128:143], a[24:27], v[128:131], a[128:143]
  ds_read_b64_tr_b16 a[20:21], v4 offset:58624
  ds_read_b64_tr_b16 a[22:23], v4 offset:62720
  v_exp_f32 v140, v140
  v_exp_f32 v141, v141
  v_mfma_f32_32x32x16_bf16 a[144:159], a[28:31], v[128:131], a[144:159]
  ds_read_b64_tr_b16 a[24:25], v4 offset:58880
  ds_read_b64_tr_b16 a[26:27], v4 offset:62976
  v_exp_f32 v142, v142
  v_exp_f32 v143, v143
  v_cvt_pk_bf16_f32 v132, v136, v137
  v_cvt_pk_bf16_f32 v133, v138, v139
  v_cvt_pk_bf16_f32 v134, v140, v141
  v_cvt_pk_bf16_f32 v135, v142, v143
  v_pk_max_u16 v132, v132, s45
  v_pk_max_u16 v133, v133, s45
  v_pk_max_u16 v134, v134, s45
  v_pk_max_u16 v135, v135, s45
  v_mfma_f32_4x4x4_16b_bf16 a[224:227], a[232:233], v[132:133], a[224:227]
  s_nop 0
  v_mfma_f32_4x4x4_16b_bf16 a[228:231], a[232:233], v[134:135], a[228:231]
  s_waitcnt lgkmcnt(6)
  v_mfma_f32_32x32x16_bf16 a[32:47], a[0:3], v[132:135], a[32:47]
  ds_read_b64_tr_b16 a[28:29], v4 offset:59136
  ds_read_b64_tr_b16 a[30:31], v4 offset:63232
  v_fma_f32 v144, v144, v5, v7
  v_fma_f32 v145, v145, v5, v7
  v_fma_f32 v146, v146, v5, v7
  v_add_u32 v4, 0x00010000, v4
  v_mfma_f32_32x32x16_bf16 a[48:63], a[4:7], v[132:135], a[48:63]
  s_add_u32 m0, s31, 16384
  s_barrier
  ds_read_b64_tr_b16 a[0:1], v4 offset:0
  ds_read_b64_tr_b16 a[2:3], v4 offset:4096
  buffer_load_dwordx4 v2, s[48:51], s15 offen offset:0 lds
  v_mfma_f32_32x32x16_bf16 a[64:79], a[8:11], v[132:135], a[64:79]
  ds_read_b64_tr_b16 a[4:5], v4 offset:256
  ds_read_b64_tr_b16 a[6:7], v4 offset:4352
  v_fma_f32 v147, v147, v5, v7
  v_fma_f32 v148, v148, v5, v7
  v_fma_f32 v149, v149, v5, v7
  v_fma_f32 v150, v150, v5, v7
  v_mfma_f32_32x32x16_bf16 a[80:95], a[12:15], v[132:135], a[80:95]
  ds_read_b64_tr_b16 a[8:9], v4 offset:512
  ds_read_b64_tr_b16 a[10:11], v4 offset:4608
  v_fma_f32 v151, v151, v5, v7
  v_exp_f32 v144, v144
  v_mov_b32 v108, 0x3f80
  s_waitcnt lgkmcnt(6)
  v_mfma_f32_32x32x16_bf16 a[96:111], a[16:19], v[132:135], a[96:111]
  ds_read_b64_tr_b16 a[12:13], v4 offset:768
  ds_read_b64_tr_b16 a[14:15], v4 offset:4864
  v_exp_f32 v145, v145
  v_exp_f32 v146, v146
  v_mfma_f32_32x32x16_bf16 a[112:127], a[20:23], v[132:135], a[112:127]
  ds_read_b64_tr_b16 a[16:17], v4 offset:1024
  ds_read_b64_tr_b16 a[18:19], v4 offset:5120
  buffer_load_dwordx4 v2, s[52:55], s15 offen offset:1024 lds
  v_lshlrev_b32 v107, v107, v108
  v_mfma_f32_32x32x16_bf16 a[128:143], a[24:27], v[132:135], a[128:143]
  ds_read_b64_tr_b16 a[20:21], v4 offset:1280
  ds_read_b64_tr_b16 a[22:23], v4 offset:5376
  v_exp_f32 v147, v147
  v_exp_f32 v148, v148
  v_mfma_f32_32x32x16_bf16 a[144:159], a[28:31], v[132:135], a[144:159]
  ds_read_b64_tr_b16 a[24:25], v4 offset:1536
  ds_read_b64_tr_b16 a[26:27], v4 offset:5632
  v_exp_f32 v149, v149
  v_exp_f32 v150, v150
  v_exp_f32 v151, v151
  v_cvt_pk_bf16_f32 v144, v144, v145
  v_cvt_pk_bf16_f32 v145, v146, v147
  v_cvt_pk_bf16_f32 v146, v148, v149
  v_cvt_pk_bf16_f32 v147, v150, v151
  v_pk_max_u16 v144, v144, s45
  v_pk_max_u16 v145, v145, s45
  v_pk_max_u16 v146, v146, s45
  v_pk_max_u16 v147, v147, s45
  v_mfma_f32_4x4x4_16b_bf16 a[224:227], a[232:233], v[144:145], a[224:227]
  s_nop 0
  v_mfma_f32_4x4x4_16b_bf16 a[228:231], a[232:233], v[146:147], a[228:231]
  s_waitcnt lgkmcnt(6)
  v_mfma_f32_32x32x16_bf16 a[32:47], a[0:3], v[144:147], a[32:47]
  ds_read_b64_tr_b16 a[28:29], v4 offset:1792
  ds_read_b64_tr_b16 a[30:31], v4 offset:5888
  v_lshrrev_b32 v13, 2, v12
  v_min_u32 v13, 52, v13
  s_add_u32 s1, s28, 7168
  v_fma_f32 v152, v152, v5, v7
  v_mfma_f32_32x32x16_bf16 a[48:63], a[4:7], v[144:147], a[48:63]
  ds_read_b64_tr_b16 a[0:1], v4 offset:8192
  ds_read_b64_tr_b16 a[2:3], v4 offset:12288
  buffer_load_dwordx4 v2, s[56:59], s15 offen offset:2048 lds
  v_fma_f32 v153, v153, v5, v7
  v_mfma_f32_32x32x16_bf16 a[64:79], a[8:11], v[144:147], a[64:79]
  ds_read_b64_tr_b16 a[4:5], v4 offset:8448
  ds_read_b64_tr_b16 a[6:7], v4 offset:12544
  buffer_load_dword v14, v13, s[88:91], s1 offen offset:0 sc1
  v_fma_f32 v154, v154, v5, v7
  v_fma_f32 v155, v155, v5, v7
  v_mfma_f32_32x32x16_bf16 a[80:95], a[12:15], v[144:147], a[80:95]
  ds_read_b64_tr_b16 a[8:9], v4 offset:8704
  ds_read_b64_tr_b16 a[10:11], v4 offset:12800
  v_fma_f32 v156, v156, v5, v7
  v_fma_f32 v157, v157, v5, v7
  v_fma_f32 v158, v158, v5, v7
  v_fma_f32 v159, v159, v5, v7
  s_waitcnt lgkmcnt(6)
  v_mfma_f32_32x32x16_bf16 a[96:111], a[16:19], v[144:147], a[96:111]
  ds_read_b64_tr_b16 a[12:13], v4 offset:8960
  ds_read_b64_tr_b16 a[14:15], v4 offset:13056
  v_exp_f32 v152, v152
  v_exp_f32 v153, v153
  v_mfma_f32_32x32x16_bf16 a[112:127], a[20:23], v[144:147], a[112:127]
  ds_read_b64_tr_b16 a[16:17], v4 offset:9216
  ds_read_b64_tr_b16 a[18:19], v4 offset:13312
  buffer_load_dwordx4 v2, s[60:63], s15 offen offset:3072 lds
  v_bfe_u32 v108, v104, 1, 2
  v_mfma_f32_32x32x16_bf16 a[128:143], a[24:27], v[144:147], a[128:143]
  ds_read_b64_tr_b16 a[20:21], v4 offset:9472
  ds_read_b64_tr_b16 a[22:23], v4 offset:13568
  v_exp_f32 v154, v154
  v_exp_f32 v155, v155
  v_mfma_f32_32x32x16_bf16 a[144:159], a[28:31], v[144:147], a[144:159]
  ds_read_b64_tr_b16 a[24:25], v4 offset:9728
  ds_read_b64_tr_b16 a[26:27], v4 offset:13824
  v_exp_f32 v156, v156
  v_exp_f32 v157, v157
  v_exp_f32 v158, v158
  v_exp_f32 v159, v159
  v_cvt_pk_bf16_f32 v148, v152, v153
  v_cvt_pk_bf16_f32 v149, v154, v155
  v_cvt_pk_bf16_f32 v150, v156, v157
  v_cvt_pk_bf16_f32 v151, v158, v159
  v_pk_max_u16 v148, v148, s45
  v_pk_max_u16 v149, v149, s45
  v_pk_max_u16 v150, v150, s45
  v_pk_max_u16 v151, v151, s45
  v_mfma_f32_4x4x4_16b_bf16 a[224:227], a[232:233], v[148:149], a[224:227]
  s_nop 0
  v_mfma_f32_4x4x4_16b_bf16 a[228:231], a[232:233], v[150:151], a[228:231]
  s_waitcnt lgkmcnt(6)
  v_mfma_f32_32x32x16_bf16 a[32:47], a[0:3], v[148:151], a[32:47]
  ds_read_b64_tr_b16 a[28:29], v4 offset:9984
  ds_read_b64_tr_b16 a[30:31], v4 offset:14080
  v_fma_f32 v160, v160, v5, v7
  v_fma_f32 v161, v161, v5, v7
  v_fma_f32 v162, v162, v5, v7
  v_fma_f32 v163, v163, v5, v7
  v_mfma_f32_32x32x16_bf16 a[48:63], a[4:7], v[148:151], a[48:63]
  s_add_u32 m0, s31, 32768
  s_add_u32 s6, s14, 114688
  ds_read_b64_tr_b16 a[0:1], v4 offset:16384
  ds_read_b64_tr_b16 a[2:3], v4 offset:20480
  buffer_load_dwordx4 v2, s[48:51], s6 offen offset:0 lds
  v_mfma_f32_32x32x16_bf16 a[64:79], a[8:11], v[148:151], a[64:79]
  ds_read_b64_tr_b16 a[4:5], v4 offset:16640
  ds_read_b64_tr_b16 a[6:7], v4 offset:20736
  v_fma_f32 v164, v164, v5, v7
  v_fma_f32 v165, v165, v5, v7
  v_fma_f32 v166, v166, v5, v7
  v_fma_f32 v167, v167, v5, v7
  v_mfma_f32_32x32x16_bf16 a[80:95], a[12:15], v[148:151], a[80:95]
  ds_read_b64_tr_b16 a[8:9], v4 offset:16896
  ds_read_b64_tr_b16 a[10:11], v4 offset:20992
  v_exp_f32 v160, v160
  v_exp_f32 v161, v161
  s_waitcnt lgkmcnt(6)
  v_mfma_f32_32x32x16_bf16 a[96:111], a[16:19], v[148:151], a[96:111]
  ds_read_b64_tr_b16 a[12:13], v4 offset:17152
  ds_read_b64_tr_b16 a[14:15], v4 offset:21248
  v_exp_f32 v162, v162
  v_exp_f32 v163, v163
  v_mfma_f32_32x32x16_bf16 a[112:127], a[20:23], v[148:151], a[112:127]
  ds_read_b64_tr_b16 a[16:17], v4 offset:17408
  ds_read_b64_tr_b16 a[18:19], v4 offset:21504
  buffer_load_dwordx4 v2, s[52:55], s6 offen offset:1024 lds
  v_lshl_add_u32 v108, v106, 1, v108
  v_mfma_f32_32x32x16_bf16 a[128:143], a[24:27], v[148:151], a[128:143]
  ds_read_b64_tr_b16 a[20:21], v4 offset:17664
  ds_read_b64_tr_b16 a[22:23], v4 offset:21760
  v_exp_f32 v164, v164
  v_exp_f32 v165, v165
  v_mfma_f32_32x32x16_bf16 a[144:159], a[28:31], v[148:151], a[144:159]
  ds_read_b64_tr_b16 a[24:25], v4 offset:17920
  ds_read_b64_tr_b16 a[26:27], v4 offset:22016
  v_exp_f32 v166, v166
  v_exp_f32 v167, v167
  v_cvt_pk_bf16_f32 v160, v160, v161
  v_cvt_pk_bf16_f32 v161, v162, v163
  v_cvt_pk_bf16_f32 v162, v164, v165
  v_cvt_pk_bf16_f32 v163, v166, v167
  v_pk_max_u16 v160, v160, s45
  v_pk_max_u16 v161, v161, s45
  v_pk_max_u16 v162, v162, s45
  v_pk_max_u16 v163, v163, s45
  v_mfma_f32_4x4x4_16b_bf16 a[224:227], a[232:233], v[160:161], a[224:227]
  s_nop 0
  v_mfma_f32_4x4x4_16b_bf16 a[228:231], a[232:233], v[162:163], a[228:231]
  s_waitcnt lgkmcnt(6)
  v_mfma_f32_32x32x16_bf16 a[32:47], a[0:3], v[160:163], a[32:47]
  ds_read_b64_tr_b16 a[28:29], v4 offset:18176
  ds_read_b64_tr_b16 a[30:31], v4 offset:22272
  v_fma_f32 v168, v168, v5, v7
  v_fma_f32 v169, v169, v5, v7
  v_fma_f32 v170, v170, v5, v7
  v_fma_f32 v171, v171, v5, v7
  v_mfma_f32_32x32x16_bf16 a[48:63], a[4:7], v[160:163], a[48:63]
  ds_read_b64_tr_b16 a[0:1], v4 offset:24576
  ds_read_b64_tr_b16 a[2:3], v4 offset:28672
  buffer_load_dwordx4 v2, s[56:59], s6 offen offset:2048 lds
  v_fma_f32 v172, v172, v5, v7
  v_mfma_f32_32x32x16_bf16 a[64:79], a[8:11], v[160:163], a[64:79]
  ds_read_b64_tr_b16 a[4:5], v4 offset:24832
  ds_read_b64_tr_b16 a[6:7], v4 offset:28928
  v_fma_f32 v173, v173, v5, v7
  v_fma_f32 v174, v174, v5, v7
  v_fma_f32 v175, v175, v5, v7
  v_and_b32 v109, 1, v106
  v_mfma_f32_32x32x16_bf16 a[80:95], a[12:15], v[160:163], a[80:95]
  ds_read_b64_tr_b16 a[8:9], v4 offset:25088
  ds_read_b64_tr_b16 a[10:11], v4 offset:29184
  v_exp_f32 v168, v168
  v_exp_f32 v169, v169
  s_waitcnt lgkmcnt(6)
  v_mfma_f32_32x32x16_bf16 a[96:111], a[16:19], v[160:163], a[96:111]
  ds_read_b64_tr_b16 a[12:13], v4 offset:25344
  ds_read_b64_tr_b16 a[14:15], v4 offset:29440
  v_exp_f32 v170, v170
  v_exp_f32 v171, v171
  v_mfma_f32_32x32x16_bf16 a[112:127], a[20:23], v[160:163], a[112:127]
  ds_read_b64_tr_b16 a[16:17], v4 offset:25600
  ds_read_b64_tr_b16 a[18:19], v4 offset:29696
  buffer_load_dwordx4 v2, s[60:63], s6 offen offset:3072 lds
  v_lshl_add_u32 v108, v109, 5, v108
  v_mfma_f32_32x32x16_bf16 a[128:143], a[24:27], v[160:163], a[128:143]
  ds_read_b64_tr_b16 a[20:21], v4 offset:25856
  ds_read_b64_tr_b16 a[22:23], v4 offset:29952
  v_exp_f32 v172, v172
  v_exp_f32 v173, v173
  v_mfma_f32_32x32x16_bf16 a[144:159], a[28:31], v[160:163], a[144:159]
  ds_read_b64_tr_b16 a[24:25], v4 offset:26112
  ds_read_b64_tr_b16 a[26:27], v4 offset:30208
  v_exp_f32 v174, v174
  v_exp_f32 v175, v175
  v_cvt_pk_bf16_f32 v164, v168, v169
  v_cvt_pk_bf16_f32 v165, v170, v171
  v_cvt_pk_bf16_f32 v166, v172, v173
  v_cvt_pk_bf16_f32 v167, v174, v175
  v_pk_max_u16 v164, v164, s45
  v_pk_max_u16 v165, v165, s45
  v_pk_max_u16 v166, v166, s45
  v_pk_max_u16 v167, v167, s45
  v_mfma_f32_4x4x4_16b_bf16 a[224:227], a[232:233], v[164:165], a[224:227]
  s_nop 0
  v_mfma_f32_4x4x4_16b_bf16 a[228:231], a[232:233], v[166:167], a[228:231]
  s_waitcnt lgkmcnt(6)
  v_mfma_f32_32x32x16_bf16 a[32:47], a[0:3], v[164:167], a[32:47]
  ds_read_b64_tr_b16 a[28:29], v4 offset:26368
  ds_read_b64_tr_b16 a[30:31], v4 offset:30464
  s_waitcnt vmcnt(5)
  v_cmp_ne_u32 vcc, s26, v14
  s_cbranch_vccnz L_spin0
L_back0:
  v_fma_f32 v176, v176, v5, v7
  v_fma_f32 v177, v177, v5, v7
  v_mfma_f32_32x32x16_bf16 a[48:63], a[4:7], v[164:167], a[48:63]
  s_add_u32 m0, s31, 49152
  s_add_u32 s6, s15, 114688
  s_barrier
  ds_read_b64_tr_b16 a[0:1], v4 offset:32768
  ds_read_b64_tr_b16 a[2:3], v4 offset:36864
  buffer_load_dwordx4 v2, s[48:51], s6 offen offset:0 lds
  v_mfma_f32_32x32x16_bf16 a[64:79], a[8:11], v[164:167], a[64:79]
  ds_read_b64_tr_b16 a[4:5], v4 offset:33024
  ds_read_b64_tr_b16 a[6:7], v4 offset:37120
  buffer_load_dwordx4 a[160:163], v12, s[88:91], s30 offen offset:0 sc1
  v_fma_f32 v178, v178, v5, v7
  v_fma_f32 v179, v179, v5, v7
  v_mfma_f32_32x32x16_bf16 a[80:95], a[12:15], v[164:167], a[80:95]
  ds_read_b64_tr_b16 a[8:9], v4 offset:33280
  ds_read_b64_tr_b16 a[10:11], v4 offset:37376
  v_fma_f32 v180, v180, v5, v7
  v_fma_f32 v181, v181, v5, v7
  v_fma_f32 v182, v182, v5, v7
  v_fma_f32 v183, v183, v5, v7
  s_waitcnt lgkmcnt(6)
  v_mfma_f32_32x32x16_bf16 a[96:111], a[16:19], v[164:167], a[96:111]
  ds_read_b64_tr_b16 a[12:13], v4 offset:33536
  ds_read_b64_tr_b16 a[14:15], v4 offset:37632
  v_exp_f32 v176, v176
  v_exp_f32 v177, v177
  v_mfma_f32_32x32x16_bf16 a[112:127], a[20:23], v[164:167], a[112:127]
  ds_read_b64_tr_b16 a[16:17], v4 offset:33792
  ds_read_b64_tr_b16 a[18:19], v4 offset:37888
  buffer_load_dwordx4 v2, s[52:55], s6 offen offset:1024 lds
  v_mfma_f32_32x32x16_bf16 a[128:143], a[24:27], v[164:167], a[128:143]
  ds_read_b64_tr_b16 a[20:21], v4 offset:34048
  ds_read_b64_tr_b16 a[22:23], v4 offset:38144
  v_exp_f32 v178, v178
  v_exp_f32 v179, v179
  v_mfma_f32_32x32x16_bf16 a[144:159], a[28:31], v[164:167], a[144:159]
  ds_read_b64_tr_b16 a[24:25], v4 offset:34304
  ds_read_b64_tr_b16 a[26:27], v4 offset:38400
  buffer_load_dwordx4 a[164:167], v12, s[88:91], s30 offen offset:1024 sc1
  v_exp_f32 v180, v180
  v_exp_f32 v181, v181
  v_exp_f32 v182, v182
  v_exp_f32 v183, v183
  v_cvt_pk_bf16_f32 v176, v176, v177
  v_cvt_pk_bf16_f32 v177, v178, v179
  v_cvt_pk_bf16_f32 v178, v180, v181
  v_cvt_pk_bf16_f32 v179, v182, v183
  v_pk_max_u16 v176, v176, s45
  v_pk_max_u16 v177, v177, s45
  v_pk_max_u16 v178, v178, s45
  v_pk_max_u16 v179, v179, s45
  v_mfma_f32_4x4x4_16b_bf16 a[224:227], a[232:233], v[176:177], a[224:227]
  s_nop 0
  v_mfma_f32_4x4x4_16b_bf16 a[228:231], a[232:233], v[178:179], a[228:231]
  s_waitcnt lgkmcnt(6)
  v_mfma_f32_32x32x16_bf16 a[32:47], a[0:3], v[176:179], a[32:47]
  ds_read_b64_tr_b16 a[28:29], v4 offset:34560
  ds_read_b64_tr_b16 a[30:31], v4 offset:38656
  v_fma_f32 v184, v184, v5, v7
  v_fma_f32 v185, v185, v5, v7
  v_fma_f32 v186, v186, v5, v7
  v_fma_f32 v187, v187, v5, v7
  v_mfma_f32_32x32x16_bf16 a[48:63], a[4:7], v[176:179], a[48:63]
  ds_read_b64_tr_b16 a[0:1], v4 offset:40960
  ds_read_b64_tr_b16 a[2:3], v4 offset:45056
  buffer_load_dwordx4 v2, s[56:59], s6 offen offset:2048 lds
  v_fma_f32 v188, v188, v5, v7
  v_mfma_f32_32x32x16_bf16 a[64:79], a[8:11], v[176:179], a[64:79]
  ds_read_b64_tr_b16 a[4:5], v4 offset:41216
  ds_read_b64_tr_b16 a[6:7], v4 offset:45312
  v_fma_f32 v189, v189, v5, v7
  v_fma_f32 v190, v190, v5, v7
  v_fma_f32 v191, v191, v5, v7
  v_mfma_f32_32x32x16_bf16 a[80:95], a[12:15], v[176:179], a[80:95]
  ds_read_b64_tr_b16 a[8:9], v4 offset:41472
  ds_read_b64_tr_b16 a[10:11], v4 offset:45568
  v_exp_f32 v184, v184
  v_exp_f32 v185, v185
  s_waitcnt lgkmcnt(6)
  v_mfma_f32_32x32x16_bf16 a[96:111], a[16:19], v[176:179], a[96:111]
  ds_read_b64_tr_b16 a[12:13], v4 offset:41728
  ds_read_b64_tr_b16 a[14:15], v4 offset:45824
  s_add_u32 s30, s30, 16384
  v_exp_f32 v186, v186
  v_mfma_f32_32x32x16_bf16 a[112:127], a[20:23], v[176:179], a[112:127]
  ds_read_b64_tr_b16 a[16:17], v4 offset:41984
  ds_read_b64_tr_b16 a[18:19], v4 offset:46080
  buffer_load_dwordx4 v2, s[60:63], s6 offen offset:3072 lds
  v_mfma_f32_32x32x16_bf16 a[128:143], a[24:27], v[176:179], a[128:143]
  ds_read_b64_tr_b16 a[20:21], v4 offset:42240
  ds_read_b64_tr_b16 a[22:23], v4 offset:46336
  buffer_load_dwordx4 a[168:171], v12, s[88:91], s30 offen offset:0 sc1
  v_exp_f32 v187, v187
  v_mfma_f32_32x32x16_bf16 a[144:159], a[28:31], v[176:179], a[144:159]
  ds_read_b64_tr_b16 a[24:25], v4 offset:42496
  ds_read_b64_tr_b16 a[26:27], v4 offset:46592
  v_exp_f32 v188, v188
  v_exp_f32 v189, v189
  v_exp_f32 v190, v190
  v_exp_f32 v191, v191
  v_cvt_pk_bf16_f32 v180, v184, v185
  v_cvt_pk_bf16_f32 v181, v186, v187
  v_cvt_pk_bf16_f32 v182, v188, v189
  v_cvt_pk_bf16_f32 v183, v190, v191
  v_pk_max_u16 v180, v180, s45
  v_pk_max_u16 v181, v181, s45
  v_pk_max_u16 v182, v182, s45
  v_pk_max_u16 v183, v183, s45
  v_mfma_f32_4x4x4_16b_bf16 a[224:227], a[232:233], v[180:181], a[224:227]
  s_nop 0
L_padh10:
  s_cbranch_execz L_walk_done
  v_mfma_f32_4x4x4_16b_bf16 a[228:231], a[232:233], v[182:183], a[228:231]
  s_waitcnt lgkmcnt(6)
  v_mfma_f32_32x32x16_bf16 a[32:47], a[0:3], v[180:183], a[32:47]
  ds_read_b64_tr_b16 a[28:29], v4 offset:42752
  ds_read_b64_tr_b16 a[30:31], v4 offset:46848
  v_fma_f32 v192, v192, v5, v7
  v_fma_f32 v193, v193, v5, v7
  v_fma_f32 v194, v194, v5, v7
  v_fma_f32 v195, v195, v5, v7
  v_mfma_f32_32x32x16_bf16 a[48:63], a[4:7], v[180:183], a[48:63]
  s_add_u32 m0, s31, 65536
  ds_read_b64_tr_b16 a[0:1], v4 offset:49152
  ds_read_b64_tr_b16 a[2:3], v4 offset:53248
  buffer_load_dwordx4 v2, s[48:51], s16 offen offset:0 lds
  v_mfma_f32_32x32x16_bf16 a[64:79], a[8:11], v[180:183], a[64:79]
  ds_read_b64_tr_b16 a[4:5], v4 offset:49408
  ds_read_b64_tr_b16 a[6:7], v4 offset:53504
  buffer_load_dwordx4 a[172:175], v12, s[88:91], s30 offen offset:1024 sc1
  v_fma_f32 v196, v196, v5, v7
  v_fma_f32 v197, v197, v5, v7
  v_mfma_f32_32x32x16_bf16 a[80:95], a[12:15], v[180:183], a[80:95]
  ds_read_b64_tr_b16 a[8:9], v4 offset:49664
  ds_read_b64_tr_b16 a[10:11], v4 offset:53760
  v_fma_f32 v198, v198, v5, v7
  v_fma_f32 v199, v199, v5, v7
  v_exp_f32 v192, v192
  s_waitcnt lgkmcnt(6)
  v_mfma_f32_32x32x16_bf16 a[96:111], a[16:19], v[180:183], a[96:111]
  ds_read_b64_tr_b16 a[12:13], v4 offset:49920
  ds_read_b64_tr_b16 a[14:15], v4 offset:54016
  v_exp_f32 v193, v193
  v_exp_f32 v194, v194
  v_mfma_f32_32x32x16_bf16 a[112:127], a[20:23], v[180:183], a[112:127]
  ds_read_b64_tr_b16 a[16:17], v4 offset:50176
  ds_read_b64_tr_b16 a[18:19], v4 offset:54272
  buffer_load_dwordx4 v2, s[52:55], s16 offen offset:1024 lds
  v_mfma_f32_32x32x16_bf16 a[128:143], a[24:27], v[180:183], a[128:143]
  ds_read_b64_tr_b16 a[20:21], v4 offset:50432
  ds_read_b64_tr_b16 a[22:23], v4 offset:54528
  v_exp_f32 v195, v195
  v_exp_f32 v196, v196
  v_mfma_f32_32x32x16_bf16 a[144:159], a[28:31], v[180:183], a[144:159]
  ds_read_b64_tr_b16 a[24:25], v4 offset:50688
  ds_read_b64_tr_b16 a[26:27], v4 offset:54784
  v_exp_f32 v197, v197
  v_exp_f32 v198, v198
  v_exp_f32 v199, v199
  v_cvt_pk_bf16_f32 v192, v192, v193
  v_cvt_pk_bf16_f32 v193, v194, v195
  v_cvt_pk_bf16_f32 v194, v196, v197
  v_cvt_pk_bf16_f32 v195, v198, v199
  v_pk_max_u16 v192, v192, s45
  v_pk_max_u16 v193, v193, s45
  v_pk_max_u16 v194, v194, s45
  v_pk_max_u16 v195, v195, s45
  v_mfma_f32_4x4x4_16b_bf16 a[224:227], a[232:233], v[192:193], a[224:227]
  s_nop 0
  v_mfma_f32_4x4x4_16b_bf16 a[228:231], a[232:233], v[194:195], a[228:231]
  s_waitcnt lgkmcnt(6)
  v_mfma_f32_32x32x16_bf16 a[32:47], a[0:3], v[192:195], a[32:47]
  ds_read_b64_tr_b16 a[28:29], v4 offset:50944
  ds_read_b64_tr_b16 a[30:31], v4 offset:55040
  s_add_u32 s30, s30, 16384
  v_fma_f32 v200, v200, v5, v7
  v_fma_f32 v201, v201, v5, v7
  v_fma_f32 v202, v202, v5, v7
  buffer_load_dwordx4 a[176:179], v12, s[88:91], s30 offen offset:0 sc1
  v_mfma_f32_32x32x16_bf16 a[48:63], a[4:7], v[192:195], a[48:63]
  ds_read_b64_tr_b16 a[0:1], v4 offset:57344
  ds_read_b64_tr_b16 a[2:3], v4 offset:61440
  buffer_load_dwordx4 v2, s[56:59], s16 offen offset:2048 lds
  v_fma_f32 v203, v203, v5, v7
  v_mfma_f32_32x32x16_bf16 a[64:79], a[8:11], v[192:195], a[64:79]
  ds_read_b64_tr_b16 a[4:5], v4 offset:57600
  ds_read_b64_tr_b16 a[6:7], v4 offset:61696
  v_fma_f32 v204, v204, v5, v7
  v_fma_f32 v205, v205, v5, v7
  v_fma_f32 v206, v206, v5, v7
  v_fma_f32 v207, v207, v5, v7
  v_mfma_f32_32x32x16_bf16 a[80:95], a[12:15], v[192:195], a[80:95]
  ds_read_b64_tr_b16 a[8:9], v4 offset:57856
  ds_read_b64_tr_b16 a[10:11], v4 offset:61952
  buffer_load_dwordx4 a[180:183], v12, s[88:91], s30 offen offset:1024 sc1
  v_exp_f32 v200, v200
  s_waitcnt lgkmcnt(6)
  v_mfma_f32_32x32x16_bf16 a[96:111], a[16:19], v[192:195], a[96:111]
  ds_read_b64_tr_b16 a[12:13], v4 offset:58112
  ds_read_b64_tr_b16 a[14:15], v4 offset:62208
  v_exp_f32 v201, v201
  v_exp_f32 v202, v202
  v_mfma_f32_32x32x16_bf16 a[112:127], a[20:23], v[192:195], a[112:127]
  ds_read_b64_tr_b16 a[16:17], v4 offset:58368
  ds_read_b64_tr_b16 a[18:19], v4 offset:62464
  buffer_load_dwordx4 v2, s[60:63], s16 offen offset:3072 lds
  v_mfma_f32_32x32x16_bf16 a[128:143], a[24:27], v[192:195], a[128:143]
  ds_read_b64_tr_b16 a[20:21], v4 offset:58624
  ds_read_b64_tr_b16 a[22:23], v4 offset:62720
  v_exp_f32 v203, v203
  v_exp_f32 v204, v204
  v_mfma_f32_32x32x16_bf16 a[144:159], a[28:31], v[192:195], a[144:159]
  ds_read_b64_tr_b16 a[24:25], v4 offset:58880
  ds_read_b64_tr_b16 a[26:27], v4 offset:62976
  v_exp_f32 v205, v205
  v_exp_f32 v206, v206
  v_exp_f32 v207, v207
  v_cvt_pk_bf16_f32 v196, v200, v201
  v_cvt_pk_bf16_f32 v197, v202, v203
  v_cvt_pk_bf16_f32 v198, v204, v205
  v_cvt_pk_bf16_f32 v199, v206, v207
  v_pk_max_u16 v196, v196, s45
  v_pk_max_u16 v197, v197, s45
  v_pk_max_u16 v198, v198, s45
  v_pk_max_u16 v199, v199, s45
  v_mfma_f32_4x4x4_16b_bf16 a[224:227], a[232:233], v[196:197], a[224:227]
  s_nop 0
  v_mfma_f32_4x4x4_16b_bf16 a[228:231], a[232:233], v[198:199], a[228:231]
  s_waitcnt lgkmcnt(6)
  v_mfma_f32_32x32x16_bf16 a[32:47], a[0:3], v[196:199], a[32:47]
  ds_read_b64_tr_b16 a[28:29], v4 offset:59136
  ds_read_b64_tr_b16 a[30:31], v4 offset:63232
  s_add_u32 s30, s30, 16384
  v_fma_f32 v208, v208, v5, v7
  v_fma_f32 v209, v209, v5, v7
  v_add_u32 v4, 0x00010000, v4
  v_mfma_f32_32x32x16_bf16 a[48:63], a[4:7], v[196:199], a[48:63]
  s_add_u32 m0, s31, 81920
  s_add_u32 s6, s16, 114688
  s_barrier
  ds_read_b64_tr_b16 a[0:1], v4 offset:0
  ds_read_b64_tr_b16 a[2:3], v4 offset:4096
  buffer_load_dwordx4 v2, s[48:51], s6 offen offset:0 lds
  v_mfma_f32_32x32x16_bf16 a[64:79], a[8:11], v[196:199], a[64:79]
  ds_read_b64_tr_b16 a[4:5], v4 offset:256
  ds_read_b64_tr_b16 a[6:7], v4 offset:4352
  buffer_load_dwordx4 a[184:187], v12, s[88:91], s30 offen offset:0 sc1
  v_fma_f32 v210, v210, v5, v7
  v_fma_f32 v211, v211, v5, v7
  v_mfma_f32_32x32x16_bf16 a[80:95], a[12:15], v[196:199], a[80:95]
  ds_read_b64_tr_b16 a[8:9], v4 offset:512
  ds_read_b64_tr_b16 a[10:11], v4 offset:4608
  v_fma_f32 v212, v212, v5, v7
  v_fma_f32 v213, v213, v5, v7
  v_fma_f32 v214, v214, v5, v7
  v_fma_f32 v215, v215, v5, v7
  s_waitcnt lgkmcnt(6)
  v_mfma_f32_32x32x16_bf16 a[96:111], a[16:19], v[196:199], a[96:111]
  ds_read_b64_tr_b16 a[12:13], v4 offset:768
  ds_read_b64_tr_b16 a[14:15], v4 offset:4864
  v_exp_f32 v208, v208
  v_exp_f32 v209, v209
  v_mfma_f32_32x32x16_bf16 a[112:127], a[20:23], v[196:199], a[112:127]
  ds_read_b64_tr_b16 a[16:17], v4 offset:1024
  ds_read_b64_tr_b16 a[18:19], v4 offset:5120
  buffer_load_dwordx4 v2, s[52:55], s6 offen offset:1024 lds
  v_mfma_f32_32x32x16_bf16 a[128:143], a[24:27], v[196:199], a[128:143]
  ds_read_b64_tr_b16 a[20:21], v4 offset:1280
  ds_read_b64_tr_b16 a[22:23], v4 offset:5376
  buffer_load_dwordx4 a[188:191], v12, s[88:91], s30 offen offset:1024 sc1
  v_exp_f32 v210, v210
  v_mfma_f32_32x32x16_bf16 a[144:159], a[28:31], v[196:199], a[144:159]
  ds_read_b64_tr_b16 a[24:25], v4 offset:1536
  ds_read_b64_tr_b16 a[26:27], v4 offset:5632
  v_exp_f32 v211, v211
  v_exp_f32 v212, v212
  v_exp_f32 v213, v213
  v_exp_f32 v214, v214
  v_exp_f32 v215, v215
  v_cvt_pk_bf16_f32 v208, v208, v209
  v_cvt_pk_bf16_f32 v209, v210, v211
  v_cvt_pk_bf16_f32 v210, v212, v213
  v_cvt_pk_bf16_f32 v211, v214, v215
  v_pk_max_u16 v208, v208, s45
  v_pk_max_u16 v209, v209, s45
  v_pk_max_u16 v210, v210, s45
  v_pk_max_u16 v211, v211, s45
  v_mfma_f32_4x4x4_16b_bf16 a[224:227], a[232:233], v[208:209], a[224:227]
  s_nop 0
  v_mfma_f32_4x4x4_16b_bf16 a[228:231], a[232:233], v[210:211], a[228:231]
  s_waitcnt lgkmcnt(6)
  v_mfma_f32_32x32x16_bf16 a[32:47], a[0:3], v[208:211], a[32:47]
  ds_read_b64_tr_b16 a[28:29], v4 offset:1792
  ds_read_b64_tr_b16 a[30:31], v4 offset:5888
  v_fma_f32 v216, v216, v5, v7
  v_fma_f32 v217, v217, v5, v7
  v_fma_f32 v218, v218, v5, v7
  v_fma_f32 v219, v219, v5, v7
  v_mfma_f32_32x32x16_bf16 a[48:63], a[4:7], v[208:211], a[48:63]
  ds_read_b64_tr_b16 a[0:1], v4 offset:8192
  ds_read_b64_tr_b16 a[2:3], v4 offset:12288
  buffer_load_dwordx4 v2, s[56:59], s6 offen offset:2048 lds
  v_fma_f32 v220, v220, v5, v7
  v_mfma_f32_32x32x16_bf16 a[64:79], a[8:11], v[208:211], a[64:79]
  ds_read_b64_tr_b16 a[4:5], v4 offset:8448
  ds_read_b64_tr_b16 a[6:7], v4 offset:12544
  s_add_u32 s30, s30, 16384
  v_fma_f32 v221, v221, v5, v7
  v_fma_f32 v222, v222, v5, v7
  v_fma_f32 v223, v223, v5, v7
  v_mfma_f32_32x32x16_bf16 a[80:95], a[12:15], v[208:211], a[80:95]
  ds_read_b64_tr_b16 a[8:9], v4 offset:8704
  ds_read_b64_tr_b16 a[10:11], v4 offset:12800
  buffer_load_dwordx4 a[192:195], v12, s[88:91], s30 offen offset:0 sc1
  v_exp_f32 v216, v216
  s_waitcnt lgkmcnt(6)
  v_mfma_f32_32x32x16_bf16 a[96:111], a[16:19], v[208:211], a[96:111]
  ds_read_b64_tr_b16 a[12:13], v4 offset:8960
  ds_read_b64_tr_b16 a[14:15], v4 offset:13056
  v_exp_f32 v217, v217
  v_exp_f32 v218, v218
  v_mfma_f32_32x32x16_bf16 a[112:127], a[20:23], v[208:211], a[112:127]
  ds_read_b64_tr_b16 a[16:17], v4 offset:9216
  ds_read_b64_tr_b16 a[18:19], v4 offset:13312
  buffer_load_dwordx4 v2, s[60:63], s6 offen offset:3072 lds
  v_mfma_f32_32x32x16_bf16 a[128:143], a[24:27], v[208:211], a[128:143]
  ds_read_b64_tr_b16 a[20:21], v4 offset:9472
  ds_read_b64_tr_b16 a[22:23], v4 offset:13568
  v_exp_f32 v219, v219
  v_exp_f32 v220, v220
  v_mfma_f32_32x32x16_bf16 a[144:159], a[28:31], v[208:211], a[144:159]
  ds_read_b64_tr_b16 a[24:25], v4 offset:9728
  ds_read_b64_tr_b16 a[26:27], v4 offset:13824
  buffer_load_dwordx4 a[196:199], v12, s[88:91], s30 offen offset:1024 sc1
  v_exp_f32 v221, v221
  v_exp_f32 v222, v222
  v_exp_f32 v223, v223
  v_cvt_pk_bf16_f32 v212, v216, v217
  v_cvt_pk_bf16_f32 v213, v218, v219
  v_cvt_pk_bf16_f32 v214, v220, v221
  v_cvt_pk_bf16_f32 v215, v222, v223
  v_pk_max_u16 v212, v212, s45
  v_pk_max_u16 v213, v213, s45
  v_pk_max_u16 v214, v214, s45
  v_pk_max_u16 v215, v215, s45
  v_mfma_f32_4x4x4_16b_bf16 a[224:227], a[232:233], v[212:213], a[224:227]
  s_nop 0
  v_mfma_f32_4x4x4_16b_bf16 a[228:231], a[232:233], v[214:215], a[228:231]
  s_waitcnt lgkmcnt(6)
  v_mfma_f32_32x32x16_bf16 a[32:47], a[0:3], v[212:215], a[32:47]
  ds_read_b64_tr_b16 a[28:29], v4 offset:9984
  ds_read_b64_tr_b16 a[30:31], v4 offset:14080
  v_fma_f32 v224, v224, v5, v7
  v_fma_f32 v225, v225, v5, v7
  v_fma_f32 v226, v226, v5, v7
  v_fma_f32 v227, v227, v5, v7
  v_mfma_f32_32x32x16_bf16 a[48:63], a[4:7], v[212:215], a[48:63]
  s_add_u32 m0, s31, 98304
  ds_read_b64_tr_b16 a[0:1], v4 offset:16384
  ds_read_b64_tr_b16 a[2:3], v4 offset:20480
  buffer_load_dwordx4 v2, s[48:51], s17 offen offset:0 lds
  v_mfma_f32_32x32x16_bf16 a[64:79], a[8:11], v[212:215], a[64:79]
  ds_read_b64_tr_b16 a[4:5], v4 offset:16640
  ds_read_b64_tr_b16 a[6:7], v4 offset:20736
  v_fma_f32 v228, v228, v5, v7
  v_fma_f32 v229, v229, v5, v7
  v_fma_f32 v230, v230, v5, v7
  v_fma_f32 v231, v231, v5, v7
  v_mfma_f32_32x32x16_bf16 a[80:95], a[12:15], v[212:215], a[80:95]
  ds_read_b64_tr_b16 a[8:9], v4 offset:16896
  ds_read_b64_tr_b16 a[10:11], v4 offset:20992
  v_exp_f32 v224, v224
  v_exp_f32 v225, v225
  s_waitcnt lgkmcnt(6)
  v_mfma_f32_32x32x16_bf16 a[96:111], a[16:19], v[212:215], a[96:111]
  ds_read_b64_tr_b16 a[12:13], v4 offset:17152
  ds_read_b64_tr_b16 a[14:15], v4 offset:21248
  s_add_u32 s30, s30, 16384
  v_exp_f32 v226, v226
  v_mfma_f32_32x32x16_bf16 a[112:127], a[20:23], v[212:215], a[112:127]
  ds_read_b64_tr_b16 a[16:17], v4 offset:17408
  ds_read_b64_tr_b16 a[18:19], v4 offset:21504
  buffer_load_dwordx4 v2, s[52:55], s17 offen offset:1024 lds
  v_mfma_f32_32x32x16_bf16 a[128:143], a[24:27], v[212:215], a[128:143]
  ds_read_b64_tr_b16 a[20:21], v4 offset:17664
  ds_read_b64_tr_b16 a[22:23], v4 offset:21760
  buffer_load_dwordx4 a[200:203], v12, s[88:91], s30 offen offset:0 sc1
  v_exp_f32 v227, v227
  v_mfma_f32_32x32x16_bf16 a[144:159], a[28:31], v[212:215], a[144:159]
  ds_read_b64_tr_b16 a[24:25], v4 offset:17920
  ds_read_b64_tr_b16 a[26:27], v4 offset:22016
  v_exp_f32 v228, v228
  v_exp_f32 v229, v229
  v_exp_f32 v230, v230
  v_exp_f32 v231, v231
  v_cvt_pk_bf16_f32 v224, v224, v225
  v_cvt_pk_bf16_f32 v225, v226, v227
  v_cvt_pk_bf16_f32 v226, v228, v229
  v_cvt_pk_bf16_f32 v227, v230, v231
  v_pk_max_u16 v224, v224, s45
  v_pk_max_u16 v225, v225, s45
  v_pk_max_u16 v226, v226, s45
  v_pk_max_u16 v227, v227, s45
  v_mfma_f32_4x4x4_16b_bf16 a[224:227], a[232:233], v[224:225], a[224:227]
  s_nop 0
  v_mfma_f32_4x4x4_16b_bf16 a[228:231], a[232:233], v[226:227], a[228:231]
  s_waitcnt lgkmcnt(6)
  v_mfma_f32_32x32x16_bf16 a[32:47], a[0:3], v[224:227], a[32:47]
  ds_read_b64_tr_b16 a[28:29], v4 offset:18176
  ds_read_b64_tr_b16 a[30:31], v4 offset:22272
  v_fma_f32 v232, v232, v5, v7
  v_fma_f32 v233, v233, v5, v7
  v_fma_f32 v234, v234, v5, v7
  v_fma_f32 v235, v235, v5, v7
  v_mfma_f32_32x32x16_bf16 a[48:63], a[4:7], v[224:227], a[48:63]
  ds_read_b64_tr_b16 a[0:1], v4 offset:24576
  ds_read_b64_tr_b16 a[2:3], v4 offset:28672
  buffer_load_dwordx4 v2, s[56:59], s17 offen offset:2048 lds
  v_fma_f32 v236, v236, v5, v7
  v_mfma_f32_32x32x16_bf16 a[64:79], a[8:11], v[224:227], a[64:79]
  ds_read_b64_tr_b16 a[4:5], v4 offset:24832
  ds_read_b64_tr_b16 a[6:7], v4 offset:28928
  buffer_load_dwordx4 a[204:207], v12, s[88:91], s30 offen offset:1024 sc1
  v_fma_f32 v237, v237, v5, v7
  v_fma_f32 v238, v238, v5, v7
  v_mfma_f32_32x32x16_bf16 a[80:95], a[12:15], v[224:227], a[80:95]
  ds_read_b64_tr_b16 a[8:9], v4 offset:25088
  ds_read_b64_tr_b16 a[10:11], v4 offset:29184
  v_fma_f32 v239, v239, v5, v7
  v_exp_f32 v232, v232
  s_waitcnt lgkmcnt(6)
  v_mfma_f32_32x32x16_bf16 a[96:111], a[16:19], v[224:227], a[96:111]
  ds_read_b64_tr_b16 a[12:13], v4 offset:25344
  ds_read_b64_tr_b16 a[14:15], v4 offset:29440
  v_exp_f32 v233, v233
  v_exp_f32 v234, v234
  v_mfma_f32_32x32x16_bf16 a[112:127], a[20:23], v[224:227], a[112:127]
  ds_read_b64_tr_b16 a[16:17], v4 offset:25600
  ds_read_b64_tr_b16 a[18:19], v4 offset:29696
  buffer_load_dwordx4 v2, s[60:63], s17 offen offset:3072 lds
  v_mfma_f32_32x32x16_bf16 a[128:143], a[24:27], v[224:227], a[128:143]
  ds_read_b64_tr_b16 a[20:21], v4 offset:25856
  ds_read_b64_tr_b16 a[22:23], v4 offset:29952
  v_exp_f32 v235, v235
  v_exp_f32 v236, v236
  v_mfma_f32_32x32x16_bf16 a[144:159], a[28:31], v[224:227], a[144:159]
  ds_read_b64_tr_b16 a[24:25], v4 offset:26112
  ds_read_b64_tr_b16 a[26:27], v4 offset:30208
  v_exp_f32 v237, v237
  v_exp_f32 v238, v238
  v_exp_f32 v239, v239
  v_cvt_pk_bf16_f32 v228, v232, v233
  v_cvt_pk_bf16_f32 v229, v234, v235
  v_cvt_pk_bf16_f32 v230, v236, v237
  v_cvt_pk_bf16_f32 v231, v238, v239
  v_pk_max_u16 v228, v228, s45
  v_pk_max_u16 v229, v229, s45
  v_pk_max_u16 v230, v230, s45
  v_pk_max_u16 v231, v231, s45
  v_mfma_f32_4x4x4_16b_bf16 a[224:227], a[232:233], v[228:229], a[224:227]
  s_nop 0
  v_mfma_f32_4x4x4_16b_bf16 a[228:231], a[232:233], v[230:231], a[228:231]
  s_waitcnt lgkmcnt(6)
  v_mfma_f32_32x32x16_bf16 a[32:47], a[0:3], v[228:231], a[32:47]
  ds_read_b64_tr_b16 a[28:29], v4 offset:26368
  ds_read_b64_tr_b16 a[30:31], v4 offset:30464
  s_add_u32 s30, s30, 16384
  v_accvgpr_read_b32 v10, a224
  v_accvgpr_read_b32 v11, a228
  v_add_u32 v3, 0xfffe0000, v3
  buffer_load_dwordx4 a[208:211], v12, s[88:91], s30 offen offset:0 sc1
  v_mfma_f32_32x32x16_bf16 a[48:63], a[4:7], v[228:231], a[48:63]
  s_add_u32 m0, s31, 114688
  s_add_u32 s6, s17, 114688
  s_waitcnt vmcnt(33)
  s_barrier
  ds_read_b64_tr_b16 a[0:1], v3 offset:0
  ds_read_b64_tr_b16 a[2:3], v3 offset:512
  buffer_load_dwordx4 v2, s[48:51], s6 offen offset:0 lds
  v_mfma_f32_32x32x16_bf16 a[64:79], a[8:11], v[228:231], a[64:79]
  ds_read_b64_tr_b16 a[4:5], v3 offset:256
  ds_read_b64_tr_b16 a[6:7], v3 offset:768
  v_add_f32 v10, v10, v11
  v_mov_b32 v11, v10
  s_nop 1
  v_permlane32_swap_b32 v10, v11
  v_add_f32 v10, v10, v11
  v_rcp_f32 v10, v10
  v_mfma_f32_32x32x16_bf16 a[80:95], a[12:15], v[228:231], a[80:95]
  ds_read_b64_tr_b16 a[8:9], v3 offset:16384
  ds_read_b64_tr_b16 a[10:11], v3 offset:16896
  buffer_load_dwordx4 a[212:215], v12, s[88:91], s30 offen offset:1024 sc1
  s_waitcnt lgkmcnt(6)
  v_mfma_f32_32x32x16_bf16 a[96:111], a[16:19], v[228:231], a[96:111]
  ds_read_b64_tr_b16 a[12:13], v3 offset:16640
  ds_read_b64_tr_b16 a[14:15], v3 offset:17152
  v_cmp_eq_u32 vcc, 0, v108
  s_nop 1
  v_cndmask_b32 v96, 0, v107, vcc
  v_mfma_f32_32x32x16_bf16 a[112:127], a[20:23], v[228:231], a[112:127]
  ds_read_b64_tr_b16 a[16:17], v3 offset:2048
  ds_read_b64_tr_b16 a[18:19], v3 offset:2560
  buffer_load_dwordx4 v2, s[52:55], s6 offen offset:1024 lds
  v_accvgpr_read_b32 v80, a32
  v_cmp_eq_u32 vcc, 1, v108
  s_nop 1
  v_cndmask_b32 v97, 0, v107, vcc
  s_nop 1
  v_cmp_eq_u32 vcc, 2, v108
  s_nop 1
  v_cndmask_b32 v98, 0, v107, vcc
  s_nop 1
  v_cmp_eq_u32 vcc, 3, v108
  s_nop 1
  v_cndmask_b32 v99, 0, v107, vcc
  s_nop 1
  v_cmp_eq_u32 vcc, 4, v108
  s_nop 1
  v_cndmask_b32 v100, 0, v107, vcc
  s_nop 1
  v_cmp_eq_u32 vcc, 5, v108
  s_nop 1
  v_cndmask_b32 v101, 0, v107, vcc
  s_nop 1
  v_cmp_eq_u32 vcc, 6, v108
  s_nop 1
  v_cndmask_b32 v102, 0, v107, vcc
  s_nop 1
  v_cmp_eq_u32 vcc, 7, v108
  s_nop 1
  v_cndmask_b32 v103, 0, v107, vcc
  v_mfma_f32_32x32x16_bf16 a[128:143], a[24:27], v[228:231], a[128:143]
  ds_read_b64_tr_b16 a[20:21], v3 offset:2304
  ds_read_b64_tr_b16 a[22:23], v3 offset:2816
  v_accvgpr_read_b32 v81, a33
  v_accvgpr_read_b32 v82, a34
  v_accvgpr_read_b32 v83, a35
  v_accvgpr_read_b32 v84, a36
  v_mfma_f32_32x32x16_bf16 a[144:159], a[28:31], v[228:231], a[144:159]
  ds_read_b64_tr_b16 a[24:25], v3 offset:18432
  ds_read_b64_tr_b16 a[26:27], v3 offset:18944
  v_accvgpr_read_b32 v85, a37
  v_accvgpr_read_b32 v86, a38
  v_accvgpr_read_b32 v87, a39
  v_mul_f32 v80, v10, v80
  v_mul_f32 v81, v10, v81
  v_mul_f32 v82, v10, v82
  v_mul_f32 v83, v10, v83
  v_mul_f32 v84, v10, v84
  v_mul_f32 v85, v10, v85
  v_mul_f32 v86, v10, v86
  v_mul_f32 v87, v10, v87
  v_cvt_pk_bf16_f32 v128, v80, v81
  v_cvt_pk_bf16_f32 v129, v82, v83
  v_cvt_pk_bf16_f32 v130, v84, v85
  v_cvt_pk_bf16_f32 v131, v86, v87
  v_accvgpr_read_b32 v88, a40
  v_accvgpr_read_b32 v89, a41
  v_accvgpr_read_b32 v90, a42
  v_accvgpr_read_b32 v91, a43
  v_accvgpr_read_b32 v92, a44
  v_accvgpr_read_b32 v93, a45
  v_accvgpr_read_b32 v94, a46
  v_accvgpr_read_b32 v95, a47
  v_mul_f32 v88, v10, v88
  v_mul_f32 v89, v10, v89
  v_mul_f32 v90, v10, v90
  v_mul_f32 v91, v10, v91
  v_mul_f32 v92, v10, v92
  v_mul_f32 v93, v10, v93
  v_mul_f32 v94, v10, v94
  v_mul_f32 v95, v10, v95
  v_cvt_pk_bf16_f32 v132, v88, v89
  v_cvt_pk_bf16_f32 v133, v90, v91
  v_cvt_pk_bf16_f32 v134, v92, v93
  v_cvt_pk_bf16_f32 v135, v94, v95
  s_waitcnt lgkmcnt(6)
  v_mfma_f32_32x32x16_bf16 v[16:31], a[0:3], v[128:131], 0
  ds_read_b64_tr_b16 a[28:29], v3 offset:18688
  ds_read_b64_tr_b16 a[30:31], v3 offset:19200
  buffer_load_dwordx4 v2, s[56:59], s6 offen offset:2048 lds
  s_add_u32 s30, s30, 16384
  v_mfma_f32_32x32x16_bf16 v[32:47], a[4:7], v[128:131], 0
  ds_read_b64_tr_b16 a[0:1], v3 offset:4096
  ds_read_b64_tr_b16 a[2:3], v3 offset:4608
  buffer_load_dwordx4 a[216:219], v12, s[88:91], s30 offen offset:0 sc1
  v_accvgpr_read_b32 v80, a48
  v_accvgpr_read_b32 v81, a49
  v_mfma_f32_32x32x16_bf16 v[48:63], a[8:11], v[128:131], 0
  ds_read_b64_tr_b16 a[4:5], v3 offset:4352
  ds_read_b64_tr_b16 a[6:7], v3 offset:4864
  buffer_load_dwordx4 v2, s[60:63], s6 offen offset:3072 lds
  v_accvgpr_read_b32 v82, a50
  v_mfma_f32_32x32x16_bf16 v[64:79], a[12:15], v[128:131], 0
  ds_read_b64_tr_b16 a[8:9], v3 offset:20480
  ds_read_b64_tr_b16 a[10:11], v3 offset:20992
  v_accvgpr_read_b32 v83, a51
  v_accvgpr_read_b32 v84, a52
  v_accvgpr_read_b32 v85, a53
  v_accvgpr_read_b32 v86, a54
  s_waitcnt lgkmcnt(6)
  v_mfma_f32_32x32x16_bf16 v[16:31], a[16:19], v[132:135], v[16:31]
  s_add_u32 m0, s31, 131072
  ds_read_b64_tr_b16 a[12:13], v3 offset:20736
  ds_read_b64_tr_b16 a[14:15], v3 offset:21248
  buffer_load_dwordx4 v2, s[48:51], s18 offen offset:0 lds
  v_mfma_f32_32x32x16_bf16 v[32:47], a[20:23], v[132:135], v[32:47]
  ds_read_b64_tr_b16 a[16:17], v3 offset:6144
  ds_read_b64_tr_b16 a[18:19], v3 offset:6656
  buffer_load_dwordx4 a[220:223], v12, s[88:91], s30 offen offset:1024 sc1
  v_accvgpr_read_b32 v87, a55
  v_mul_f32 v80, v10, v80
  v_mfma_f32_32x32x16_bf16 v[48:63], a[24:27], v[132:135], v[48:63]
  ds_read_b64_tr_b16 a[20:21], v3 offset:6400
  ds_read_b64_tr_b16 a[22:23], v3 offset:6912
  buffer_load_dwordx4 v2, s[52:55], s18 offen offset:1024 lds
  v_mul_f32 v81, v10, v81
  v_mfma_f32_32x32x16_bf16 v[64:79], a[28:31], v[132:135], v[64:79]
  ds_read_b64_tr_b16 a[24:25], v3 offset:22528
  ds_read_b64_tr_b16 a[26:27], v3 offset:23040
  v_mul_f32 v82, v10, v82
  v_mul_f32 v83, v10, v83
  v_mul_f32 v84, v10, v84
  v_mul_f32 v85, v10, v85
  v_mul_f32 v86, v10, v86
  v_mul_f32 v87, v10, v87
  v_cvt_pk_bf16_f32 v136, v80, v81
  v_cvt_pk_bf16_f32 v137, v82, v83
  v_cvt_pk_bf16_f32 v138, v84, v85
  v_cvt_pk_bf16_f32 v139, v86, v87
  v_accvgpr_read_b32 v88, a56
  v_accvgpr_read_b32 v89, a57
  v_accvgpr_read_b32 v90, a58
  v_accvgpr_read_b32 v91, a59
  v_accvgpr_read_b32 v92, a60
  v_accvgpr_read_b32 v93, a61
  v_accvgpr_read_b32 v94, a62
  v_accvgpr_read_b32 v95, a63
  v_mul_f32 v88, v10, v88
  v_mul_f32 v89, v10, v89
  v_mul_f32 v90, v10, v90
  v_mul_f32 v91, v10, v91
  v_mul_f32 v92, v10, v92
  v_mul_f32 v93, v10, v93
  v_mul_f32 v94, v10, v94
  v_mul_f32 v95, v10, v95
  v_cvt_pk_bf16_f32 v140, v88, v89
  v_cvt_pk_bf16_f32 v141, v90, v91
  v_cvt_pk_bf16_f32 v142, v92, v93
  v_cvt_pk_bf16_f32 v143, v94, v95
  s_waitcnt lgkmcnt(6)
  v_mfma_f32_32x32x16_bf16 v[16:31], a[0:3], v[136:139], v[16:31]
  ds_read_b64_tr_b16 a[28:29], v3 offset:22784
  ds_read_b64_tr_b16 a[30:31], v3 offset:23296
  buffer_load_dwordx4 v2, s[56:59], s18 offen offset:2048 lds
  v_accvgpr_read_b32 v80, a64
  v_mfma_f32_32x32x16_bf16 v[32:47], a[4:7], v[136:139], v[32:47]
  ds_read_b64_tr_b16 a[0:1], v3 offset:8192
  ds_read_b64_tr_b16 a[2:3], v3 offset:8704
  v_accvgpr_read_b32 v81, a65
  v_accvgpr_read_b32 v82, a66
  v_accvgpr_read_b32 v83, a67
  v_accvgpr_read_b32 v84, a68
  v_mfma_f32_32x32x16_bf16 v[48:63], a[8:11], v[136:139], v[48:63]
  ds_read_b64_tr_b16 a[4:5], v3 offset:8448
  ds_read_b64_tr_b16 a[6:7], v3 offset:8960
  buffer_load_dwordx4 v2, s[60:63], s18 offen offset:3072 lds
  s_add_u32 s30, s30, 16384
  v_mfma_f32_32x32x16_bf16 v[64:79], a[12:15], v[136:139], v[64:79]
  ds_read_b64_tr_b16 a[8:9], v3 offset:24576
  ds_read_b64_tr_b16 a[10:11], v3 offset:25088
  buffer_load_dwordx4 v[240:243], v12, s[88:91], s30 offen offset:0 sc1
  v_accvgpr_read_b32 v85, a69
  v_accvgpr_read_b32 v86, a70
  s_waitcnt lgkmcnt(6)
  v_mfma_f32_32x32x16_bf16 v[16:31], a[16:19], v[140:143], v[16:31]
  ds_read_b64_tr_b16 a[12:13], v3 offset:24832
  ds_read_b64_tr_b16 a[14:15], v3 offset:25344
  v_accvgpr_read_b32 v87, a71
  v_mul_f32 v80, v10, v80
  v_mul_f32 v81, v10, v81
  v_mul_f32 v82, v10, v82
  v_mfma_f32_32x32x16_bf16 v[32:47], a[20:23], v[140:143], v[32:47]
  ds_read_b64_tr_b16 a[16:17], v3 offset:10240
  ds_read_b64_tr_b16 a[18:19], v3 offset:10752
  v_mul_f32 v83, v10, v83
  v_mul_f32 v84, v10, v84
  v_mul_f32 v85, v10, v85
  v_mul_f32 v86, v10, v86
  v_mfma_f32_32x32x16_bf16 v[48:63], a[24:27], v[140:143], v[48:63]
  ds_read_b64_tr_b16 a[20:21], v3 offset:10496
  ds_read_b64_tr_b16 a[22:23], v3 offset:11008
  v_mul_f32 v87, v10, v87
  v_cvt_pk_bf16_f32 v144, v80, v81
  v_cvt_pk_bf16_f32 v145, v82, v83
  v_cvt_pk_bf16_f32 v146, v84, v85
  v_mfma_f32_32x32x16_bf16 v[64:79], a[28:31], v[140:143], v[64:79]
  ds_read_b64_tr_b16 a[24:25], v3 offset:26624
  ds_read_b64_tr_b16 a[26:27], v3 offset:27136
L_padh11:
  s_cbranch_execz L_walk_done
  buffer_load_dwordx4 v[244:247], v12, s[88:91], s30 offen offset:1024 sc1
  v_cvt_pk_bf16_f32 v147, v86, v87
  v_accvgpr_read_b32 v88, a72
  v_accvgpr_read_b32 v89, a73
  v_accvgpr_read_b32 v90, a74
  v_accvgpr_read_b32 v91, a75
  v_accvgpr_read_b32 v92, a76
  v_accvgpr_read_b32 v93, a77
  v_accvgpr_read_b32 v94, a78
  v_accvgpr_read_b32 v95, a79
  v_mul_f32 v88, v10, v88
  v_mul_f32 v89, v10, v89
  v_mul_f32 v90, v10, v90
  v_mul_f32 v91, v10, v91
  v_mul_f32 v92, v10, v92
  v_mul_f32 v93, v10, v93
  v_mul_f32 v94, v10, v94
  v_mul_f32 v95, v10, v95
  v_cvt_pk_bf16_f32 v148, v88, v89
  v_cvt_pk_bf16_f32 v149, v90, v91
  v_cvt_pk_bf16_f32 v150, v92, v93
  v_cvt_pk_bf16_f32 v151, v94, v95
  s_waitcnt lgkmcnt(6)
  v_mfma_f32_32x32x16_bf16 v[16:31], a[0:3], v[144:147], v[16:31]
  ds_read_b64_tr_b16 a[28:29], v3 offset:26880
  ds_read_b64_tr_b16 a[30:31], v3 offset:27392
  v_accvgpr_read_b32 v80, a80
  v_accvgpr_read_b32 v81, a81
  v_accvgpr_read_b32 v82, a82
  v_accvgpr_read_b32 v83, a83
  v_mfma_f32_32x32x16_bf16 v[32:47], a[4:7], v[144:147], v[32:47]
  ds_read_b64_tr_b16 a[0:1], v3 offset:12288
  ds_read_b64_tr_b16 a[2:3], v3 offset:12800
  v_accvgpr_read_b32 v84, a84
  v_accvgpr_read_b32 v85, a85
  v_accvgpr_read_b32 v86, a86
  v_accvgpr_read_b32 v87, a87
  v_mfma_f32_32x32x16_bf16 v[48:63], a[8:11], v[144:147], v[48:63]
  ds_read_b64_tr_b16 a[4:5], v3 offset:12544
  ds_read_b64_tr_b16 a[6:7], v3 offset:13056
  v_mul_f32 v80, v10, v80
  v_mul_f32 v81, v10, v81
  v_mul_f32 v82, v10, v82
  v_mul_f32 v83, v10, v83
  v_mfma_f32_32x32x16_bf16 v[64:79], a[12:15], v[144:147], v[64:79]
  ds_read_b64_tr_b16 a[8:9], v3 offset:28672
  ds_read_b64_tr_b16 a[10:11], v3 offset:29184
  v_mul_f32 v84, v10, v84
  v_mul_f32 v85, v10, v85
  v_mul_f32 v86, v10, v86
  v_mul_f32 v87, v10, v87
  s_waitcnt lgkmcnt(6)
  v_mfma_f32_32x32x16_bf16 v[16:31], a[16:19], v[148:151], v[16:31]
  ds_read_b64_tr_b16 a[12:13], v3 offset:28928
  ds_read_b64_tr_b16 a[14:15], v3 offset:29440
  s_add_u32 s30, s30, 16384
  v_cvt_pk_bf16_f32 v152, v80, v81
  v_cvt_pk_bf16_f32 v153, v82, v83
  v_cvt_pk_bf16_f32 v154, v84, v85
  v_mfma_f32_32x32x16_bf16 v[32:47], a[20:23], v[148:151], v[32:47]
  ds_read_b64_tr_b16 a[16:17], v3 offset:14336
  ds_read_b64_tr_b16 a[18:19], v3 offset:14848
  buffer_load_dwordx4 v[248:251], v12, s[88:91], s30 offen offset:0 sc1
  v_cvt_pk_bf16_f32 v155, v86, v87
  v_accvgpr_read_b32 v88, a88
  v_mfma_f32_32x32x16_bf16 v[48:63], a[24:27], v[148:151], v[48:63]
  ds_read_b64_tr_b16 a[20:21], v3 offset:14592
  ds_read_b64_tr_b16 a[22:23], v3 offset:15104
  v_accvgpr_read_b32 v89, a89
  v_accvgpr_read_b32 v90, a90
  v_accvgpr_read_b32 v91, a91
  v_accvgpr_read_b32 v92, a92
  v_mfma_f32_32x32x16_bf16 v[64:79], a[28:31], v[148:151], v[64:79]
  ds_read_b64_tr_b16 a[24:25], v3 offset:30720
  ds_read_b64_tr_b16 a[26:27], v3 offset:31232
  v_accvgpr_read_b32 v93, a93
  v_accvgpr_read_b32 v94, a94
  v_accvgpr_read_b32 v95, a95
  v_mul_f32 v88, v10, v88
  v_mul_f32 v89, v10, v89
  v_mul_f32 v90, v10, v90
  v_mul_f32 v91, v10, v91
  v_mul_f32 v92, v10, v92
  v_mul_f32 v93, v10, v93
  v_mul_f32 v94, v10, v94
  v_mul_f32 v95, v10, v95
  v_cvt_pk_bf16_f32 v156, v88, v89
  v_cvt_pk_bf16_f32 v157, v90, v91
  v_cvt_pk_bf16_f32 v158, v92, v93
  v_cvt_pk_bf16_f32 v159, v94, v95
  s_waitcnt lgkmcnt(6)
  v_mfma_f32_32x32x16_bf16 v[16:31], a[0:3], v[152:155], v[16:31]
  ds_read_b64_tr_b16 a[28:29], v3 offset:30976
  ds_read_b64_tr_b16 a[30:31], v3 offset:31488
  s_mov_b32 s64, s4
  s_mov_b32 s65, s5
  s_mov_b32 s66, 0x001c0000
  s_mov_b32 s67, 0x00020000
  v_mfma_f32_32x32x16_bf16 v[32:47], a[4:7], v[152:155], v[32:47]
  s_add_u32 m0, s31, 147456
  s_add_u32 s6, s18, 114688
  s_waitcnt vmcnt(37)
  s_barrier
  ds_read_b64_tr_b16 a[0:1], v3 offset:32768
  ds_read_b64_tr_b16 a[2:3], v3 offset:33280
  buffer_load_dwordx4 v2, s[48:51], s6 offen offset:0 lds
  v_mfma_f32_32x32x16_bf16 v[48:63], a[8:11], v[152:155], v[48:63]
  ds_read_b64_tr_b16 a[4:5], v3 offset:33024
  ds_read_b64_tr_b16 a[6:7], v3 offset:33536
  buffer_load_dwordx4 v[252:255], v12, s[88:91], s30 offen offset:1024 sc1
  s_mov_b32 s68, s24
  s_mov_b32 s69, s25
  v_mfma_f32_32x32x16_bf16 v[64:79], a[12:15], v[152:155], v[64:79]
  ds_read_b64_tr_b16 a[8:9], v3 offset:49152
  ds_read_b64_tr_b16 a[10:11], v3 offset:49664
  buffer_load_dwordx4 v2, s[52:55], s6 offen offset:1024 lds
  s_mov_b32 s70, 0x001c0000
  s_waitcnt lgkmcnt(6)
  v_mfma_f32_32x32x16_bf16 v[16:31], a[16:19], v[156:159], v[16:31]
  ds_read_b64_tr_b16 a[12:13], v3 offset:49408
  ds_read_b64_tr_b16 a[14:15], v3 offset:49920
  s_mov_b32 s71, 0x00020000
  s_mov_b32 s72, s22
  s_mov_b32 s73, s23
  s_mov_b32 s74, 0x00000380
  v_mfma_f32_32x32x16_bf16 v[32:47], a[20:23], v[156:159], v[32:47]
  ds_read_b64_tr_b16 a[16:17], v3 offset:34816
  ds_read_b64_tr_b16 a[18:19], v3 offset:35328
  buffer_load_dwordx4 v2, s[56:59], s6 offen offset:2048 lds
  s_mov_b32 s75, 0x00020000
  v_lshrrev_b32 v105, 9, v12
  v_lshlrev_b32 v105, 4, v105
  s_min_u32 s101, s96, 13
  s_lshl_b32 s101, s101, 6
  v_add_u32 v105, s101, v105
  v_bfe_u32 v104, v12, 4, 5
  s_lshl_b32 s101, s97, 7
  v_add_u32 v104, s101, v104
  s_lshl_b32 s101, s3, 5
  v_add_u32 v104, s101, v104
  v_mul_u32_u24 v104, 896, v104
  v_add_u32 v104, v104, v105
  buffer_load_dwordx4 v[192:195], v104, s[64:67], 0 offen offset:0
  buffer_load_dwordx4 v[196:199], v104, s[64:67], 0 offen offset:32
  buffer_load_dwordx4 v[200:203], v105, s[72:75], 0 offen offset:0
  buffer_load_dwordx4 v[204:207], v105, s[72:75], 0 offen offset:32
  v_mfma_f32_32x32x16_bf16 v[48:63], a[24:27], v[156:159], v[48:63]
  ds_read_b64_tr_b16 a[20:21], v3 offset:35072
  ds_read_b64_tr_b16 a[22:23], v3 offset:35584
  v_accvgpr_read_b32 v80, a96
  v_accvgpr_read_b32 v81, a97
  v_accvgpr_read_b32 v82, a98
  v_accvgpr_read_b32 v83, a99
  v_mfma_f32_32x32x16_bf16 v[64:79], a[28:31], v[156:159], v[64:79]
  ds_read_b64_tr_b16 a[24:25], v3 offset:51200
  ds_read_b64_tr_b16 a[26:27], v3 offset:51712
  buffer_load_dwordx4 v2, s[60:63], s6 offen offset:3072 lds
  v_accvgpr_read_b32 v84, a100
  v_accvgpr_read_b32 v85, a101
  v_accvgpr_read_b32 v86, a102
  v_accvgpr_read_b32 v87, a103
  v_mul_f32 v80, v10, v80
  v_mul_f32 v81, v10, v81
  v_mul_f32 v82, v10, v82
  v_mul_f32 v83, v10, v83
  v_mul_f32 v84, v10, v84
  v_mul_f32 v85, v10, v85
  v_mul_f32 v86, v10, v86
  v_mul_f32 v87, v10, v87
  v_cvt_pk_bf16_f32 v160, v80, v81
  v_cvt_pk_bf16_f32 v161, v82, v83
  v_cvt_pk_bf16_f32 v162, v84, v85
  v_cvt_pk_bf16_f32 v163, v86, v87
  v_accvgpr_read_b32 v88, a104
  v_accvgpr_read_b32 v89, a105
  v_accvgpr_read_b32 v90, a106
  v_accvgpr_read_b32 v91, a107
  v_accvgpr_read_b32 v92, a108
  v_accvgpr_read_b32 v93, a109
  v_accvgpr_read_b32 v94, a110
  v_accvgpr_read_b32 v95, a111
  v_mul_f32 v88, v10, v88
  v_mul_f32 v89, v10, v89
  v_mul_f32 v90, v10, v90
  v_mul_f32 v91, v10, v91
  v_mul_f32 v92, v10, v92
  v_mul_f32 v93, v10, v93
  v_mul_f32 v94, v10, v94
  v_mul_f32 v95, v10, v95
  v_cvt_pk_bf16_f32 v164, v88, v89
  v_cvt_pk_bf16_f32 v165, v90, v91
  v_cvt_pk_bf16_f32 v166, v92, v93
  v_cvt_pk_bf16_f32 v167, v94, v95
  s_waitcnt lgkmcnt(6)
  v_mfma_f32_32x32x16_bf16 v[16:31], a[0:3], v[160:163], v[16:31]
  ds_read_b64_tr_b16 a[28:29], v3 offset:51456
  ds_read_b64_tr_b16 a[30:31], v3 offset:51968
  s_add_u32 s30, s30, 16384
  v_accvgpr_read_b32 v80, a112
  v_accvgpr_read_b32 v81, a113
  v_accvgpr_read_b32 v82, a114
  buffer_load_dwordx4 v[208:211], v12, s[88:91], s30 offen offset:0 sc1
  v_mfma_f32_32x32x16_bf16 v[32:47], a[4:7], v[160:163], v[32:47]
  ds_read_b64_tr_b16 a[0:1], v3 offset:36864
  ds_read_b64_tr_b16 a[2:3], v3 offset:37376
  v_accvgpr_read_b32 v83, a115
  v_accvgpr_read_b32 v84, a116
  v_accvgpr_read_b32 v85, a117
  v_accvgpr_read_b32 v86, a118
  v_mfma_f32_32x32x16_bf16 v[48:63], a[8:11], v[160:163], v[48:63]
  ds_read_b64_tr_b16 a[4:5], v3 offset:37120
  ds_read_b64_tr_b16 a[6:7], v3 offset:37632
  v_accvgpr_read_b32 v87, a119
  v_mul_f32 v80, v10, v80
  v_mul_f32 v81, v10, v81
  v_mul_f32 v82, v10, v82
  v_mfma_f32_32x32x16_bf16 v[64:79], a[12:15], v[160:163], v[64:79]
  ds_read_b64_tr_b16 a[8:9], v3 offset:53248
  ds_read_b64_tr_b16 a[10:11], v3 offset:53760
  buffer_load_dwordx4 v[212:215], v12, s[88:91], s30 offen offset:1024 sc1
  v_mul_f32 v83, v10, v83
  v_mul_f32 v84, v10, v84
  s_waitcnt lgkmcnt(6)
  v_mfma_f32_32x32x16_bf16 v[16:31], a[16:19], v[164:167], v[16:31]
  ds_read_b64_tr_b16 a[12:13], v3 offset:53504
  ds_read_b64_tr_b16 a[14:15], v3 offset:54016
  v_mul_f32 v85, v10, v85
  v_mul_f32 v86, v10, v86
  v_mul_f32 v87, v10, v87
  v_cvt_pk_bf16_f32 v168, v80, v81
  v_mfma_f32_32x32x16_bf16 v[32:47], a[20:23], v[164:167], v[32:47]
  ds_read_b64_tr_b16 a[16:17], v3 offset:38912
  ds_read_b64_tr_b16 a[18:19], v3 offset:39424
  v_cvt_pk_bf16_f32 v169, v82, v83
  v_cvt_pk_bf16_f32 v170, v84, v85
  v_cvt_pk_bf16_f32 v171, v86, v87
  v_accvgpr_read_b32 v88, a120
  v_mfma_f32_32x32x16_bf16 v[48:63], a[24:27], v[164:167], v[48:63]
  ds_read_b64_tr_b16 a[20:21], v3 offset:39168
  ds_read_b64_tr_b16 a[22:23], v3 offset:39680
  v_accvgpr_read_b32 v89, a121
  v_accvgpr_read_b32 v90, a122
  v_accvgpr_read_b32 v91, a123
  v_accvgpr_read_b32 v92, a124
  v_mfma_f32_32x32x16_bf16 v[64:79], a[28:31], v[164:167], v[64:79]
  ds_read_b64_tr_b16 a[24:25], v3 offset:55296
  ds_read_b64_tr_b16 a[26:27], v3 offset:55808
  v_accvgpr_read_b32 v93, a125
  v_accvgpr_read_b32 v94, a126
  v_accvgpr_read_b32 v95, a127
  v_mul_f32 v88, v10, v88
  v_mul_f32 v89, v10, v89
  v_mul_f32 v90, v10, v90
  v_mul_f32 v91, v10, v91
  v_mul_f32 v92, v10, v92
  v_mul_f32 v93, v10, v93
  v_mul_f32 v94, v10, v94
  v_mul_f32 v95, v10, v95
  v_cvt_pk_bf16_f32 v172, v88, v89
  v_cvt_pk_bf16_f32 v173, v90, v91
  v_cvt_pk_bf16_f32 v174, v92, v93
  v_cvt_pk_bf16_f32 v175, v94, v95
  s_waitcnt lgkmcnt(6)
  v_mfma_f32_32x32x16_bf16 v[16:31], a[0:3], v[168:171], v[16:31]
  ds_read_b64_tr_b16 a[28:29], v3 offset:55552
  ds_read_b64_tr_b16 a[30:31], v3 offset:56064
  s_add_u32 s30, s30, 16384
  v_accvgpr_read_b32 v80, a128
  v_accvgpr_read_b32 v81, a129
  v_accvgpr_read_b32 v82, a130
  v_mfma_f32_32x32x16_bf16 v[32:47], a[4:7], v[168:171], v[32:47]
  ds_read_b64_tr_b16 a[0:1], v3 offset:40960
  ds_read_b64_tr_b16 a[2:3], v3 offset:41472
  buffer_load_dwordx4 v[216:219], v12, s[88:91], s30 offen offset:0 sc1
  v_accvgpr_read_b32 v83, a131
  v_accvgpr_read_b32 v84, a132
  v_mfma_f32_32x32x16_bf16 v[48:63], a[8:11], v[168:171], v[48:63]
  ds_read_b64_tr_b16 a[4:5], v3 offset:41216
  ds_read_b64_tr_b16 a[6:7], v3 offset:41728
  v_accvgpr_read_b32 v85, a133
  v_accvgpr_read_b32 v86, a134
  v_accvgpr_read_b32 v87, a135
  v_mul_f32 v80, v10, v80
  v_mfma_f32_32x32x16_bf16 v[64:79], a[12:15], v[168:171], v[64:79]
  ds_read_b64_tr_b16 a[8:9], v3 offset:57344
  ds_read_b64_tr_b16 a[10:11], v3 offset:57856
  v_mul_f32 v81, v10, v81
  v_mul_f32 v82, v10, v82
  v_mul_f32 v83, v10, v83
  v_mul_f32 v84, v10, v84
  s_waitcnt lgkmcnt(6)
  v_mfma_f32_32x32x16_bf16 v[16:31], a[16:19], v[172:175], v[16:31]
  ds_read_b64_tr_b16 a[12:13], v3 offset:57600
  ds_read_b64_tr_b16 a[14:15], v3 offset:58112
  v_mul_f32 v85, v10, v85
  v_mul_f32 v86, v10, v86
  v_mul_f32 v87, v10, v87
  v_cvt_pk_bf16_f32 v176, v80, v81
  v_mfma_f32_32x32x16_bf16 v[32:47], a[20:23], v[172:175], v[32:47]
  ds_read_b64_tr_b16 a[16:17], v3 offset:43008
  ds_read_b64_tr_b16 a[18:19], v3 offset:43520
  buffer_load_dwordx4 v[220:223], v12, s[88:91], s30 offen offset:1024 sc1
  v_cvt_pk_bf16_f32 v177, v82, v83
  v_cvt_pk_bf16_f32 v178, v84, v85
  v_mfma_f32_32x32x16_bf16 v[48:63], a[24:27], v[172:175], v[48:63]
  ds_read_b64_tr_b16 a[20:21], v3 offset:43264
  ds_read_b64_tr_b16 a[22:23], v3 offset:43776
  v_cvt_pk_bf16_f32 v179, v86, v87
  v_accvgpr_read_b32 v88, a136
  v_accvgpr_read_b32 v89, a137
  v_accvgpr_read_b32 v90, a138
  v_mfma_f32_32x32x16_bf16 v[64:79], a[28:31], v[172:175], v[64:79]
  ds_read_b64_tr_b16 a[24:25], v3 offset:59392
  ds_read_b64_tr_b16 a[26:27], v3 offset:59904
  v_accvgpr_read_b32 v91, a139
  v_accvgpr_read_b32 v92, a140
  v_accvgpr_read_b32 v93, a141
  v_accvgpr_read_b32 v94, a142
  v_accvgpr_read_b32 v95, a143
  v_mul_f32 v88, v10, v88
  v_mul_f32 v89, v10, v89
  v_mul_f32 v90, v10, v90
  v_mul_f32 v91, v10, v91
  v_mul_f32 v92, v10, v92
  v_mul_f32 v93, v10, v93
  v_mul_f32 v94, v10, v94
  v_mul_f32 v95, v10, v95
  v_cvt_pk_bf16_f32 v180, v88, v89
  v_cvt_pk_bf16_f32 v181, v90, v91
  v_cvt_pk_bf16_f32 v182, v92, v93
  v_cvt_pk_bf16_f32 v183, v94, v95
  s_waitcnt lgkmcnt(6)
  v_mfma_f32_32x32x16_bf16 v[16:31], a[0:3], v[176:179], v[16:31]
  ds_read_b64_tr_b16 a[28:29], v3 offset:59648
  ds_read_b64_tr_b16 a[30:31], v3 offset:60160
  v_accvgpr_read_b32 v80, a144
  v_accvgpr_read_b32 v81, a145
  v_accvgpr_read_b32 v82, a146
  v_accvgpr_read_b32 v83, a147
  v_mfma_f32_32x32x16_bf16 v[32:47], a[4:7], v[176:179], v[32:47]
  ds_read_b64_tr_b16 a[0:1], v3 offset:45056
  ds_read_b64_tr_b16 a[2:3], v3 offset:45568
  v_accvgpr_read_b32 v84, a148
  v_accvgpr_read_b32 v85, a149
  v_accvgpr_read_b32 v86, a150
  v_accvgpr_read_b32 v87, a151
  v_mfma_f32_32x32x16_bf16 v[48:63], a[8:11], v[176:179], v[48:63]
  ds_read_b64_tr_b16 a[4:5], v3 offset:45312
  ds_read_b64_tr_b16 a[6:7], v3 offset:45824
  s_add_u32 s30, s30, 16384
  v_mul_f32 v80, v10, v80
  v_mul_f32 v81, v10, v81
  v_mul_f32 v82, v10, v82
  v_mfma_f32_32x32x16_bf16 v[64:79], a[12:15], v[176:179], v[64:79]
  ds_read_b64_tr_b16 a[8:9], v3 offset:61440
  ds_read_b64_tr_b16 a[10:11], v3 offset:61952
  buffer_load_dwordx4 a[224:227], v12, s[88:91], s30 offen offset:0 sc1
  v_mul_f32 v83, v10, v83
  v_mul_f32 v84, v10, v84
  s_waitcnt lgkmcnt(6)
  v_mfma_f32_32x32x16_bf16 v[16:31], a[16:19], v[180:183], v[16:31]
  ds_read_b64_tr_b16 a[12:13], v3 offset:61696
  ds_read_b64_tr_b16 a[14:15], v3 offset:62208
  v_mul_f32 v85, v10, v85
  v_mul_f32 v86, v10, v86
  v_mul_f32 v87, v10, v87
  v_cvt_pk_bf16_f32 v184, v80, v81
  v_mfma_f32_32x32x16_bf16 v[32:47], a[20:23], v[180:183], v[32:47]
  ds_read_b64_tr_b16 a[16:17], v3 offset:47104
  ds_read_b64_tr_b16 a[18:19], v3 offset:47616
  v_cvt_pk_bf16_f32 v185, v82, v83
  v_cvt_pk_bf16_f32 v186, v84, v85
  v_cvt_pk_bf16_f32 v187, v86, v87
  v_accvgpr_read_b32 v88, a152
  v_mfma_f32_32x32x16_bf16 v[48:63], a[24:27], v[180:183], v[48:63]
  ds_read_b64_tr_b16 a[20:21], v3 offset:47360
  ds_read_b64_tr_b16 a[22:23], v3 offset:47872
  v_accvgpr_read_b32 v89, a153
  v_accvgpr_read_b32 v90, a154
  v_accvgpr_read_b32 v91, a155
  v_accvgpr_read_b32 v92, a156
  v_mfma_f32_32x32x16_bf16 v[64:79], a[28:31], v[180:183], v[64:79]
  ds_read_b64_tr_b16 a[24:25], v3 offset:63488
  ds_read_b64_tr_b16 a[26:27], v3 offset:64000
  buffer_load_dwordx4 a[228:231], v12, s[88:91], s30 offen offset:1024 sc1
  v_accvgpr_read_b32 v93, a157
  v_accvgpr_read_b32 v94, a158
  v_accvgpr_read_b32 v95, a159
  v_mul_f32 v88, v10, v88
  v_mul_f32 v89, v10, v89
  v_mul_f32 v90, v10, v90
  v_mul_f32 v91, v10, v91
  v_mul_f32 v92, v10, v92
  v_mul_f32 v93, v10, v93
  v_mul_f32 v94, v10, v94
  v_mul_f32 v95, v10, v95
  v_cvt_pk_bf16_f32 v188, v88, v89
  v_cvt_pk_bf16_f32 v189, v90, v91
  v_cvt_pk_bf16_f32 v190, v92, v93
  v_cvt_pk_bf16_f32 v191, v94, v95
  s_waitcnt lgkmcnt(6)
  v_mfma_f32_32x32x16_bf16 v[16:31], a[0:3], v[184:187], v[16:31]
  ds_read_b64_tr_b16 a[28:29], v3 offset:63744
  ds_read_b64_tr_b16 a[30:31], v3 offset:64256
  v_lshrrev_b32 v13, 2, v12
  v_and_b32 v13, 60, v13
  s_lshl_b32 s39, s20, 3
  s_add_u32 s39, s39, s28
  v_mfma_f32_32x32x16_bf16 v[32:47], a[4:7], v[184:187], v[32:47]
  s_lshl_b32 s37, 1, s96
  s_mov_b32 s42, 0
  v_mfma_f32_32x32x16_bf16 v[48:63], a[8:11], v[184:187], v[48:63]
  v_mfma_f32_32x32x16_bf16 v[64:79], a[12:15], v[184:187], v[64:79]
  s_waitcnt lgkmcnt(0)
  v_mfma_f32_32x32x16_bf16 v[16:31], a[16:19], v[188:191], v[16:31]
  s_add_u32 s30, s30, 16384
  v_mfma_f32_32x32x16_bf16 v[32:47], a[20:23], v[188:191], v[32:47]
  buffer_load_dwordx4 a[232:235], v12, s[88:91], s30 offen offset:0 sc1
  v_mfma_f32_32x32x16_bf16 v[48:63], a[24:27], v[188:191], v[48:63]
  v_mfma_f32_32x32x16_bf16 v[64:79], a[28:31], v[188:191], v[64:79]
  s_mul_i32 s7, s14, 65536
  s_add_u32 s7, s7, s9
  s_nop 4
  v_cvt_pk_bf16_f32 v16, v16, v17
  v_cvt_pk_bf16_f32 v17, v18, v19
  v_cvt_pk_bf16_f32 v18, v20, v21
  v_add_u32 v3, 0x00010000, v3
  v_mfma_f32_32x32x16_bf16 v[112:127], v[96:99], a[160:163], 0
  s_add_u32 m0, s31, 0
  s_waitcnt vmcnt(38)
  s_barrier
  ds_read_b64_tr_b16 a[0:1], v3 offset:0
  ds_read_b64_tr_b16 a[2:3], v3 offset:512
  buffer_load_dwordx4 v2, s[48:51], s19 offen offset:0 lds
  v_mfma_f32_32x32x16_bf16 v[112:127], v[100:103], a[164:167], v[112:127]
  ds_read_b64_tr_b16 a[4:5], v3 offset:2048
  ds_read_b64_tr_b16 a[6:7], v3 offset:2560
  buffer_load_dwordx4 a[236:239], v12, s[88:91], s30 offen offset:1024 sc1
  v_cvt_pk_bf16_f32 v19, v22, v23
  v_cvt_pk_bf16_f32 v20, v24, v25
  v_mfma_f32_32x32x16_bf16 v[112:127], v[96:99], a[168:171], v[112:127]
  ds_read_b64_tr_b16 a[8:9], v3 offset:4096
  ds_read_b64_tr_b16 a[10:11], v3 offset:4608
  buffer_load_dwordx4 v2, s[52:55], s19 offen offset:1024 lds
  v_cvt_pk_bf16_f32 v21, v26, v27
  v_mfma_f32_32x32x16_bf16 v[112:127], v[100:103], a[172:175], v[112:127]
  ds_read_b64_tr_b16 a[12:13], v3 offset:6144
  ds_read_b64_tr_b16 a[14:15], v3 offset:6656
  buffer_load_dword v14, v13, s[88:91], s39 offen offset:0 sc1
  v_cvt_pk_bf16_f32 v22, v28, v29
  v_cvt_pk_bf16_f32 v23, v30, v31
  v_mfma_f32_32x32x16_bf16 v[112:127], v[96:99], a[176:179], v[112:127]
  ds_read_b64_tr_b16 a[16:17], v3 offset:8192
  ds_read_b64_tr_b16 a[18:19], v3 offset:8704
  buffer_load_dwordx4 v2, s[56:59], s19 offen offset:2048 lds
  v_mfma_f32_32x32x16_bf16 v[112:127], v[100:103], a[180:183], v[112:127]
  ds_read_b64_tr_b16 a[20:21], v3 offset:10240
  ds_read_b64_tr_b16 a[22:23], v3 offset:10752
  buffer_store_dwordx4 v[16:19], v12, s[88:91], s7 offen offset:0 sc1
  v_mfma_f32_32x32x16_bf16 v[112:127], v[96:99], a[184:187], v[112:127]
  ds_read_b64_tr_b16 a[24:25], v3 offset:12288
  ds_read_b64_tr_b16 a[26:27], v3 offset:12800
  buffer_load_dwordx4 v2, s[60:63], s19 offen offset:3072 lds
  buffer_store_dwordx4 v[20:23], v12, s[88:91], s7 offen offset:1024 sc1
  s_waitcnt lgkmcnt(6)
  v_mfma_f32_32x32x16_bf16 v[224:239], a[0:3], v[128:131], 0
  ds_read_b64_tr_b16 a[28:29], v3 offset:14336
  ds_read_b64_tr_b16 a[30:31], v3 offset:14848
  s_mul_i32 s8, s14, 65536
  s_add_u32 s8, s8, s10
  v_cvt_pk_bf16_f32 v32, v32, v33
  v_cvt_pk_bf16_f32 v33, v34, v35
  v_mfma_f32_32x32x16_bf16 v[224:239], a[4:7], v[132:135], v[224:239]
  s_add_u32 m0, s31, 16384
  s_add_u32 s6, s19, 114688
  ds_read_b64_tr_b16 a[0:1], v3 offset:256
  ds_read_b64_tr_b16 a[2:3], v3 offset:768
  buffer_load_dwordx4 v2, s[48:51], s6 offen offset:0 lds
  v_mfma_f32_32x32x16_bf16 v[224:239], a[8:11], v[136:139], v[224:239]
  ds_read_b64_tr_b16 a[4:5], v3 offset:2304
  ds_read_b64_tr_b16 a[6:7], v3 offset:2816
  v_cvt_pk_bf16_f32 v34, v36, v37
  v_cvt_pk_bf16_f32 v35, v38, v39
  v_cvt_pk_bf16_f32 v36, v40, v41
  v_cvt_pk_bf16_f32 v37, v42, v43
  v_mfma_f32_32x32x16_bf16 v[224:239], a[12:15], v[140:143], v[224:239]
  ds_read_b64_tr_b16 a[8:9], v3 offset:4352
  ds_read_b64_tr_b16 a[10:11], v3 offset:4864
  buffer_load_dwordx4 v2, s[52:55], s6 offen offset:1024 lds
  v_cvt_pk_bf16_f32 v38, v44, v45
  v_cvt_pk_bf16_f32 v39, v46, v47
  buffer_store_dwordx4 v[32:35], v12, s[88:91], s8 offen offset:0 sc1
  buffer_store_dwordx4 v[36:39], v12, s[88:91], s8 offen offset:1024 sc1
  s_waitcnt lgkmcnt(6)
  v_mfma_f32_32x32x16_bf16 v[224:239], a[16:19], v[144:147], v[224:239]
  ds_read_b64_tr_b16 a[12:13], v3 offset:6400
  ds_read_b64_tr_b16 a[14:15], v3 offset:6912
  s_mul_i32 s7, s15, 65536
  s_add_u32 s7, s7, s9
  v_cvt_pk_bf16_f32 v48, v48, v49
  v_cvt_pk_bf16_f32 v49, v50, v51
  v_mfma_f32_32x32x16_bf16 v[224:239], a[20:23], v[148:151], v[224:239]
  ds_read_b64_tr_b16 a[16:17], v3 offset:8448
  ds_read_b64_tr_b16 a[18:19], v3 offset:8960
  buffer_load_dwordx4 v2, s[56:59], s6 offen offset:2048 lds
  v_cvt_pk_bf16_f32 v50, v52, v53
  v_mfma_f32_32x32x16_bf16 v[224:239], a[24:27], v[152:155], v[224:239]
  ds_read_b64_tr_b16 a[20:21], v3 offset:10496
  ds_read_b64_tr_b16 a[22:23], v3 offset:11008
  v_cvt_pk_bf16_f32 v51, v54, v55
  v_cvt_pk_bf16_f32 v52, v56, v57
  v_cvt_pk_bf16_f32 v53, v58, v59
  v_cvt_pk_bf16_f32 v54, v60, v61
  v_mfma_f32_32x32x16_bf16 v[224:239], a[28:31], v[156:159], v[224:239]
  ds_read_b64_tr_b16 a[24:25], v3 offset:12544
  ds_read_b64_tr_b16 a[26:27], v3 offset:13056
  buffer_load_dwordx4 v2, s[60:63], s6 offen offset:3072 lds
  v_cvt_pk_bf16_f32 v55, v62, v63
  buffer_store_dwordx4 v[48:51], v12, s[88:91], s7 offen offset:0 sc1
  buffer_store_dwordx4 v[52:55], v12, s[88:91], s7 offen offset:1024 sc1
  s_waitcnt lgkmcnt(6)
  v_mfma_f32_32x32x16_bf16 v[80:95], a[0:3], v[128:131], 0
  ds_read_b64_tr_b16 a[28:29], v3 offset:14592
  ds_read_b64_tr_b16 a[30:31], v3 offset:15104
  s_mul_i32 s8, s15, 65536
  s_add_u32 s8, s8, s10
  v_cvt_pk_bf16_f32 v64, v64, v65
  v_cvt_pk_bf16_f32 v65, v66, v67
  v_mfma_f32_32x32x16_bf16 v[80:95], a[4:7], v[132:135], v[80:95]
  s_add_u32 m0, s31, 32768
  ds_read_b64_tr_b16 a[0:1], v3 offset:16384
  ds_read_b64_tr_b16 a[2:3], v3 offset:16896
  buffer_load_dwordx4 v2, s[48:51], s20 offen offset:0 lds
  v_mfma_f32_32x32x16_bf16 v[80:95], a[8:11], v[136:139], v[80:95]
  ds_read_b64_tr_b16 a[4:5], v3 offset:18432
  ds_read_b64_tr_b16 a[6:7], v3 offset:18944
  v_cvt_pk_bf16_f32 v66, v68, v69
  v_cvt_pk_bf16_f32 v67, v70, v71
  v_cvt_pk_bf16_f32 v68, v72, v73
  v_cvt_pk_bf16_f32 v69, v74, v75
  v_mfma_f32_32x32x16_bf16 v[80:95], a[12:15], v[140:143], v[80:95]
  ds_read_b64_tr_b16 a[8:9], v3 offset:20480
  ds_read_b64_tr_b16 a[10:11], v3 offset:20992
  buffer_load_dwordx4 v2, s[52:55], s20 offen offset:1024 lds
  v_cvt_pk_bf16_f32 v70, v76, v77
  v_cvt_pk_bf16_f32 v71, v78, v79
  buffer_store_dwordx4 v[64:67], v12, s[88:91], s8 offen offset:0 sc1
  buffer_store_dwordx4 v[68:71], v12, s[88:91], s8 offen offset:1024 sc1
  s_waitcnt lgkmcnt(6)
  v_mfma_f32_32x32x16_bf16 v[80:95], a[16:19], v[144:147], v[80:95]
  ds_read_b64_tr_b16 a[12:13], v3 offset:22528
  ds_read_b64_tr_b16 a[14:15], v3 offset:23040
  s_waitcnt vmcnt(16)
  v_cmp_eq_u32 vcc, s26, v14
  s_nop 1
  s_mov_b32 s36, vcc_lo
  v_mfma_f32_32x32x16_bf16 v[80:95], a[20:23], v[148:151], v[80:95]
  ds_read_b64_tr_b16 a[16:17], v3 offset:24576
  ds_read_b64_tr_b16 a[18:19], v3 offset:25088
  buffer_load_dwordx4 v2, s[56:59], s20 offen offset:2048 lds
  s_mov_b32 s92, 0xc000
  v_mfma_f32_32x32x16_bf16 v[80:95], a[24:27], v[152:155], v[80:95]
  ds_read_b64_tr_b16 a[20:21], v3 offset:26624
  ds_read_b64_tr_b16 a[22:23], v3 offset:27136
  s_and_b32 s93, s36, s92
  s_cmp_eq_u32 s93, s92
  s_cselect_b32 s92, s92, 0
  s_cselect_b32 s38, 0, 0x7f000000
  v_mfma_f32_32x32x16_bf16 v[80:95], a[28:31], v[156:159], v[80:95]
  ds_read_b64_tr_b16 a[24:25], v3 offset:28672
  ds_read_b64_tr_b16 a[26:27], v3 offset:29184
  buffer_load_dwordx4 v2, s[60:63], s20 offen offset:3072 lds
  s_or_b32 s37, s37, s92
  s_waitcnt lgkmcnt(6)
  v_mfma_f32_32x32x16_bf16 v[224:239], a[0:3], v[160:163], v[224:239]
  ds_read_b64_tr_b16 a[28:29], v3 offset:30720
  ds_read_b64_tr_b16 a[30:31], v3 offset:31232
  s_or_b32 s42, s42, s92
  s_add_u32 s40, s29, 229376
  s_or_b32 s40, s40, s38
  s_add_u32 s41, s40, 16384
  v_mfma_f32_32x32x16_bf16 v[224:239], a[4:7], v[164:167], v[224:239]
  s_add_u32 m0, s31, 49152
  s_add_u32 s6, s20, 114688
  ds_read_b64_tr_b16 a[0:1], v3 offset:16640
L_padh12:
  s_cbranch_execz L_walk_done
  ds_read_b64_tr_b16 a[2:3], v3 offset:17152
  buffer_load_dwordx4 v2, s[48:51], s6 offen offset:0 lds
  v_mfma_f32_32x32x16_bf16 v[224:239], a[8:11], v[168:171], v[224:239]
  ds_read_b64_tr_b16 a[4:5], v3 offset:18688
  ds_read_b64_tr_b16 a[6:7], v3 offset:19200
  buffer_load_dwordx4 a[128:131], v12, s[88:91], s40 offen offset:0 sc1
  buffer_load_dwordx4 a[132:135], v12, s[88:91], s40 offen offset:1024 sc1
  buffer_load_dwordx4 a[136:139], v12, s[88:91], s41 offen offset:0 sc1
  buffer_load_dwordx4 a[140:143], v12, s[88:91], s41 offen offset:1024 sc1
  buffer_load_dword v14, v13, s[88:91], s39 offen offset:0 sc1
  v_mfma_f32_32x32x16_bf16 v[224:239], a[12:15], v[172:175], v[224:239]
  ds_read_b64_tr_b16 a[8:9], v3 offset:20736
  ds_read_b64_tr_b16 a[10:11], v3 offset:21248
  buffer_load_dwordx4 v2, s[52:55], s6 offen offset:1024 lds
  s_waitcnt lgkmcnt(6)
  v_mfma_f32_32x32x16_bf16 v[224:239], a[16:19], v[176:179], v[224:239]
  ds_read_b64_tr_b16 a[12:13], v3 offset:22784
  ds_read_b64_tr_b16 a[14:15], v3 offset:23296
  v_mfma_f32_32x32x16_bf16 v[224:239], a[20:23], v[180:183], v[224:239]
  ds_read_b64_tr_b16 a[16:17], v3 offset:24832
  ds_read_b64_tr_b16 a[18:19], v3 offset:25344
  buffer_load_dwordx4 v2, s[56:59], s6 offen offset:2048 lds
  v_mfma_f32_32x32x16_bf16 v[224:239], a[24:27], v[184:187], v[224:239]
  ds_read_b64_tr_b16 a[20:21], v3 offset:26880
  ds_read_b64_tr_b16 a[22:23], v3 offset:27392
  s_lshl_b32 s99, s14, 3
  s_lshl2_add_u32 s99, s96, s99
  s_add_u32 s99, s99, s28
  v_mfma_f32_32x32x16_bf16 v[224:239], a[28:31], v[188:191], v[224:239]
  ds_read_b64_tr_b16 a[24:25], v3 offset:28928
  ds_read_b64_tr_b16 a[26:27], v3 offset:29440
  buffer_load_dwordx4 v2, s[60:63], s6 offen offset:3072 lds
  s_waitcnt lgkmcnt(6)
  v_mfma_f32_32x32x16_bf16 v[80:95], a[0:3], v[160:163], v[80:95]
  ds_read_b64_tr_b16 a[28:29], v3 offset:30976
  ds_read_b64_tr_b16 a[30:31], v3 offset:31488
  s_waitcnt vmcnt(19)
  v_mfma_f32_32x32x16_bf16 v[80:95], a[4:7], v[164:167], v[80:95]
  buffer_store_dword v0, off, s[88:91], s99 sc1
  v_mfma_f32_32x32x16_bf16 v[80:95], a[8:11], v[168:171], v[80:95]
  s_mul_i32 s7, s16, 65536
  s_add_u32 s7, s7, s9
  v_cvt_pk_bf16_f32 v224, v224, v225
  v_cvt_pk_bf16_f32 v225, v226, v227
  v_cvt_pk_bf16_f32 v226, v228, v229
  v_cvt_pk_bf16_f32 v227, v230, v231
  v_mfma_f32_32x32x16_bf16 v[80:95], a[12:15], v[172:175], v[80:95]
  v_cvt_pk_bf16_f32 v228, v232, v233
  v_cvt_pk_bf16_f32 v229, v234, v235
  v_cvt_pk_bf16_f32 v230, v236, v237
  v_cvt_pk_bf16_f32 v231, v238, v239
  s_waitcnt lgkmcnt(0)
  v_mfma_f32_32x32x16_bf16 v[80:95], a[16:19], v[176:179], v[80:95]
  buffer_store_dwordx4 v[224:227], v12, s[88:91], s7 offen offset:0 sc1
  v_mfma_f32_32x32x16_bf16 v[80:95], a[20:23], v[180:183], v[80:95]
  buffer_store_dwordx4 v[228:231], v12, s[88:91], s7 offen offset:1024 sc1
  v_mfma_f32_32x32x16_bf16 v[80:95], a[24:27], v[184:187], v[80:95]
  s_lshl_b32 s99, s15, 3
  s_lshl2_add_u32 s99, s96, s99
  s_add_u32 s99, s99, s28
  s_waitcnt vmcnt(14)
  v_mfma_f32_32x32x16_bf16 v[80:95], a[28:31], v[188:191], v[80:95]
  buffer_store_dword v0, off, s[88:91], s99 sc1
  v_mfma_f32_32x32x16_bf16 v[112:127], v[100:103], a[188:191], v[112:127]
  s_barrier
  ds_read_b64_tr_b16 a[0:1], v3 offset:32768
  ds_read_b64_tr_b16 a[2:3], v3 offset:33280
  v_mfma_f32_32x32x16_bf16 v[112:127], v[96:99], a[192:195], v[112:127]
  ds_read_b64_tr_b16 a[4:5], v3 offset:34816
  ds_read_b64_tr_b16 a[6:7], v3 offset:35328
  v_mfma_f32_32x32x16_bf16 v[112:127], v[100:103], a[196:199], v[112:127]
  ds_read_b64_tr_b16 a[8:9], v3 offset:36864
  ds_read_b64_tr_b16 a[10:11], v3 offset:37376
  s_mul_i32 s8, s16, 65536
  s_add_u32 s8, s8, s10
  v_cvt_pk_bf16_f32 v80, v80, v81
  v_cvt_pk_bf16_f32 v81, v82, v83
  v_mfma_f32_32x32x16_bf16 v[112:127], v[96:99], a[200:203], v[112:127]
  ds_read_b64_tr_b16 a[12:13], v3 offset:38912
  ds_read_b64_tr_b16 a[14:15], v3 offset:39424
  v_cvt_pk_bf16_f32 v82, v84, v85
  v_cvt_pk_bf16_f32 v83, v86, v87
  v_cvt_pk_bf16_f32 v84, v88, v89
  v_cvt_pk_bf16_f32 v85, v90, v91
  v_mfma_f32_32x32x16_bf16 v[112:127], v[100:103], a[204:207], v[112:127]
  ds_read_b64_tr_b16 a[16:17], v3 offset:40960
  ds_read_b64_tr_b16 a[18:19], v3 offset:41472
  v_cvt_pk_bf16_f32 v86, v92, v93
  v_cvt_pk_bf16_f32 v87, v94, v95
  v_mfma_f32_32x32x16_bf16 v[112:127], v[96:99], a[208:211], v[112:127]
  ds_read_b64_tr_b16 a[20:21], v3 offset:43008
  ds_read_b64_tr_b16 a[22:23], v3 offset:43520
  buffer_store_dwordx4 v[80:83], v12, s[88:91], s8 offen offset:0 sc1
  v_mfma_f32_32x32x16_bf16 v[112:127], v[100:103], a[212:215], v[112:127]
  ds_read_b64_tr_b16 a[24:25], v3 offset:45056
  ds_read_b64_tr_b16 a[26:27], v3 offset:45568
  buffer_store_dwordx4 v[84:87], v12, s[88:91], s8 offen offset:1024 sc1
  s_waitcnt lgkmcnt(6)
  v_mfma_f32_32x32x16_bf16 v[16:31], a[0:3], v[128:131], 0
  ds_read_b64_tr_b16 a[28:29], v3 offset:47104
  ds_read_b64_tr_b16 a[30:31], v3 offset:47616
  v_mfma_f32_32x32x16_bf16 v[16:31], a[4:7], v[132:135], v[16:31]
  ds_read_b64_tr_b16 a[0:1], v3 offset:33024
  ds_read_b64_tr_b16 a[2:3], v3 offset:33536
  v_mfma_f32_32x32x16_bf16 v[16:31], a[8:11], v[136:139], v[16:31]
  ds_read_b64_tr_b16 a[4:5], v3 offset:35072
  ds_read_b64_tr_b16 a[6:7], v3 offset:35584
  v_mfma_f32_32x32x16_bf16 v[16:31], a[12:15], v[140:143], v[16:31]
  ds_read_b64_tr_b16 a[8:9], v3 offset:37120
  ds_read_b64_tr_b16 a[10:11], v3 offset:37632
  s_waitcnt lgkmcnt(6)
  v_mfma_f32_32x32x16_bf16 v[16:31], a[16:19], v[144:147], v[16:31]
  ds_read_b64_tr_b16 a[12:13], v3 offset:39168
  ds_read_b64_tr_b16 a[14:15], v3 offset:39680
  v_mfma_f32_32x32x16_bf16 v[16:31], a[20:23], v[148:151], v[16:31]
  ds_read_b64_tr_b16 a[16:17], v3 offset:41216
  ds_read_b64_tr_b16 a[18:19], v3 offset:41728
  v_mfma_f32_32x32x16_bf16 v[16:31], a[24:27], v[152:155], v[16:31]
  ds_read_b64_tr_b16 a[20:21], v3 offset:43264
  ds_read_b64_tr_b16 a[22:23], v3 offset:43776
  v_mfma_f32_32x32x16_bf16 v[16:31], a[28:31], v[156:159], v[16:31]
  ds_read_b64_tr_b16 a[24:25], v3 offset:45312
  ds_read_b64_tr_b16 a[26:27], v3 offset:45824
  s_waitcnt lgkmcnt(6)
  v_mfma_f32_32x32x16_bf16 v[32:47], a[0:3], v[128:131], 0
  ds_read_b64_tr_b16 a[28:29], v3 offset:47360
  ds_read_b64_tr_b16 a[30:31], v3 offset:47872
  v_mfma_f32_32x32x16_bf16 v[32:47], a[4:7], v[132:135], v[32:47]
  ds_read_b64_tr_b16 a[0:1], v3 offset:49152
  ds_read_b64_tr_b16 a[2:3], v3 offset:49664
  v_mfma_f32_32x32x16_bf16 v[32:47], a[8:11], v[136:139], v[32:47]
  ds_read_b64_tr_b16 a[4:5], v3 offset:51200
  ds_read_b64_tr_b16 a[6:7], v3 offset:51712
  v_mfma_f32_32x32x16_bf16 v[32:47], a[12:15], v[140:143], v[32:47]
  ds_read_b64_tr_b16 a[8:9], v3 offset:53248
  ds_read_b64_tr_b16 a[10:11], v3 offset:53760
  s_waitcnt lgkmcnt(6)
  v_mfma_f32_32x32x16_bf16 v[32:47], a[16:19], v[144:147], v[32:47]
  ds_read_b64_tr_b16 a[12:13], v3 offset:55296
  ds_read_b64_tr_b16 a[14:15], v3 offset:55808
  v_mfma_f32_32x32x16_bf16 v[32:47], a[20:23], v[148:151], v[32:47]
  ds_read_b64_tr_b16 a[16:17], v3 offset:57344
  ds_read_b64_tr_b16 a[18:19], v3 offset:57856
  v_mfma_f32_32x32x16_bf16 v[32:47], a[24:27], v[152:155], v[32:47]
  ds_read_b64_tr_b16 a[20:21], v3 offset:59392
  ds_read_b64_tr_b16 a[22:23], v3 offset:59904
  v_mfma_f32_32x32x16_bf16 v[32:47], a[28:31], v[156:159], v[32:47]
  ds_read_b64_tr_b16 a[24:25], v3 offset:61440
  ds_read_b64_tr_b16 a[26:27], v3 offset:61952
  s_waitcnt lgkmcnt(6)
  v_mfma_f32_32x32x16_bf16 v[16:31], a[0:3], v[160:163], v[16:31]
  ds_read_b64_tr_b16 a[28:29], v3 offset:63488
  ds_read_b64_tr_b16 a[30:31], v3 offset:64000
  v_mfma_f32_32x32x16_bf16 v[16:31], a[4:7], v[164:167], v[16:31]
  ds_read_b64_tr_b16 a[0:1], v3 offset:49408
  ds_read_b64_tr_b16 a[2:3], v3 offset:49920
  v_mfma_f32_32x32x16_bf16 v[16:31], a[8:11], v[168:171], v[16:31]
  ds_read_b64_tr_b16 a[4:5], v3 offset:51456
  ds_read_b64_tr_b16 a[6:7], v3 offset:51968
  v_mfma_f32_32x32x16_bf16 v[16:31], a[12:15], v[172:175], v[16:31]
  ds_read_b64_tr_b16 a[8:9], v3 offset:53504
  ds_read_b64_tr_b16 a[10:11], v3 offset:54016
  s_waitcnt lgkmcnt(6)
  v_mfma_f32_32x32x16_bf16 v[16:31], a[16:19], v[176:179], v[16:31]
  ds_read_b64_tr_b16 a[12:13], v3 offset:55552
  ds_read_b64_tr_b16 a[14:15], v3 offset:56064
  v_mfma_f32_32x32x16_bf16 v[16:31], a[20:23], v[180:183], v[16:31]
  ds_read_b64_tr_b16 a[16:17], v3 offset:57600
  ds_read_b64_tr_b16 a[18:19], v3 offset:58112
  s_lshl_b32 s99, s16, 3
  s_lshl2_add_u32 s99, s96, s99
  s_add_u32 s99, s99, s28
  v_mfma_f32_32x32x16_bf16 v[16:31], a[24:27], v[184:187], v[16:31]
  ds_read_b64_tr_b16 a[20:21], v3 offset:59648
  ds_read_b64_tr_b16 a[22:23], v3 offset:60160
  s_waitcnt vmcnt(0)
  v_mfma_f32_32x32x16_bf16 v[16:31], a[28:31], v[188:191], v[16:31]
  ds_read_b64_tr_b16 a[24:25], v3 offset:61696
  ds_read_b64_tr_b16 a[26:27], v3 offset:62208
  buffer_store_dword v0, off, s[88:91], s99 sc1
  s_waitcnt lgkmcnt(6)
  v_mfma_f32_32x32x16_bf16 v[32:47], a[0:3], v[160:163], v[32:47]
  ds_read_b64_tr_b16 a[28:29], v3 offset:63744
  ds_read_b64_tr_b16 a[30:31], v3 offset:64256
  v_cmp_eq_u32 vcc, s26, v14
  s_nop 1
  s_mov_b32 s36, vcc_lo
  v_mfma_f32_32x32x16_bf16 v[32:47], a[4:7], v[164:167], v[32:47]
  s_lshr_b32 s92, s19, 6
  s_lshl_b32 s92, 3, s92
  s_and_b32 s93, s36, s92
  s_cmp_eq_u32 s93, s92
  s_cselect_b32 s92, s92, 0
  s_cselect_b32 s38, 0, 0x7f000000
  v_mfma_f32_32x32x16_bf16 v[32:47], a[8:11], v[168:171], v[32:47]
  s_mul_i32 s7, s17, 65536
  s_add_u32 s7, s7, s9
  v_cvt_pk_bf16_f32 v16, v16, v17
  v_cvt_pk_bf16_f32 v17, v18, v19
  v_cvt_pk_bf16_f32 v18, v20, v21
  v_cvt_pk_bf16_f32 v19, v22, v23
  v_mfma_f32_32x32x16_bf16 v[32:47], a[12:15], v[172:175], v[32:47]
  v_cvt_pk_bf16_f32 v20, v24, v25
  v_cvt_pk_bf16_f32 v21, v26, v27
  v_cvt_pk_bf16_f32 v22, v28, v29
  v_cvt_pk_bf16_f32 v23, v30, v31
  s_or_b32 s37, s37, s92
  s_or_b32 s42, s42, s92
  s_waitcnt lgkmcnt(0)
  v_mfma_f32_32x32x16_bf16 v[32:47], a[16:19], v[176:179], v[32:47]
  buffer_store_dwordx4 v[16:19], v12, s[88:91], s7 offen offset:0 sc1
  s_mul_i32 s40, s19, 256
  s_add_u32 s40, s40, s29
  s_or_b32 s40, s40, s38
  s_add_u32 s41, s40, 16384
  v_mfma_f32_32x32x16_bf16 v[32:47], a[20:23], v[180:183], v[32:47]
  buffer_store_dwordx4 v[20:23], v12, s[88:91], s7 offen offset:1024 sc1
  v_mfma_f32_32x32x16_bf16 v[32:47], a[24:27], v[184:187], v[32:47]
  buffer_load_dwordx4 a[32:35], v12, s[88:91], s40 offen offset:0 sc1
  v_mfma_f32_32x32x16_bf16 v[32:47], a[28:31], v[188:191], v[32:47]
  buffer_load_dwordx4 a[36:39], v12, s[88:91], s40 offen offset:1024 sc1
  v_add_u32 v3, 0x00010000, v3
  v_mfma_f32_32x32x16_bf16 v[112:127], v[96:99], a[216:219], v[112:127]
  s_barrier
  ds_read_b64_tr_b16 a[0:1], v3 offset:0
  ds_read_b64_tr_b16 a[2:3], v3 offset:512
  buffer_load_dwordx4 a[40:43], v12, s[88:91], s41 offen offset:0 sc1
  v_mfma_f32_32x32x16_bf16 v[112:127], v[100:103], a[220:223], v[112:127]
  ds_read_b64_tr_b16 a[4:5], v3 offset:2048
  ds_read_b64_tr_b16 a[6:7], v3 offset:2560
  buffer_load_dwordx4 a[44:47], v12, s[88:91], s41 offen offset:1024 sc1
  s_lshr_b32 s92, s18, 6
  s_lshl_b32 s92, 3, s92
  v_mfma_f32_32x32x16_bf16 v[112:127], v[96:99], v[240:243], v[112:127]
  ds_read_b64_tr_b16 a[8:9], v3 offset:4096
  ds_read_b64_tr_b16 a[10:11], v3 offset:4608
  s_and_b32 s93, s36, s92
  s_cmp_eq_u32 s93, s92
  s_cselect_b32 s92, s92, 0
  s_cselect_b32 s38, 0, 0x7f000000
  s_or_b32 s37, s37, s92
  s_or_b32 s42, s42, s92
  s_mul_i32 s40, s18, 256
  s_add_u32 s40, s40, s29
  s_or_b32 s40, s40, s38
  s_add_u32 s41, s40, 16384
  buffer_load_dwordx4 a[48:51], v12, s[88:91], s40 offen offset:0 sc1
  buffer_load_dwordx4 a[52:55], v12, s[88:91], s40 offen offset:1024 sc1
  buffer_load_dwordx4 a[56:59], v12, s[88:91], s41 offen offset:0 sc1
  buffer_load_dwordx4 a[60:63], v12, s[88:91], s41 offen offset:1024 sc1
  buffer_load_dword v14, v13, s[88:91], s39 offen offset:0 sc1
  v_mfma_f32_32x32x16_bf16 v[112:127], v[100:103], v[244:247], v[112:127]
  ds_read_b64_tr_b16 a[12:13], v3 offset:6144
  ds_read_b64_tr_b16 a[14:15], v3 offset:6656
  s_mul_i32 s8, s17, 65536
  s_add_u32 s8, s8, s10
  v_cvt_pk_bf16_f32 v32, v32, v33
  v_cvt_pk_bf16_f32 v33, v34, v35
  v_mfma_f32_32x32x16_bf16 v[112:127], v[96:99], v[248:251], v[112:127]
  ds_read_b64_tr_b16 a[16:17], v3 offset:8192
  ds_read_b64_tr_b16 a[18:19], v3 offset:8704
  v_cvt_pk_bf16_f32 v34, v36, v37
  v_cvt_pk_bf16_f32 v35, v38, v39
  v_cvt_pk_bf16_f32 v36, v40, v41
  v_cvt_pk_bf16_f32 v37, v42, v43
  v_mfma_f32_32x32x16_bf16 v[112:127], v[100:103], v[252:255], v[112:127]
  ds_read_b64_tr_b16 a[20:21], v3 offset:10240
  ds_read_b64_tr_b16 a[22:23], v3 offset:10752
  v_cvt_pk_bf16_f32 v38, v44, v45
  v_cvt_pk_bf16_f32 v39, v46, v47
  v_mfma_f32_32x32x16_bf16 v[112:127], v[96:99], v[208:211], v[112:127]
  ds_read_b64_tr_b16 a[24:25], v3 offset:12288
  ds_read_b64_tr_b16 a[26:27], v3 offset:12800
  buffer_store_dwordx4 v[32:35], v12, s[88:91], s8 offen offset:0 sc1
  s_waitcnt lgkmcnt(6)
  v_mfma_f32_32x32x16_bf16 v[48:63], a[0:3], v[128:131], 0
  ds_read_b64_tr_b16 a[28:29], v3 offset:14336
  ds_read_b64_tr_b16 a[30:31], v3 offset:14848
  buffer_store_dwordx4 v[36:39], v12, s[88:91], s8 offen offset:1024 sc1
  v_mfma_f32_32x32x16_bf16 v[48:63], a[4:7], v[132:135], v[48:63]
  ds_read_b64_tr_b16 a[0:1], v3 offset:256
  ds_read_b64_tr_b16 a[2:3], v3 offset:768
  v_mfma_f32_32x32x16_bf16 v[48:63], a[8:11], v[136:139], v[48:63]
  ds_read_b64_tr_b16 a[4:5], v3 offset:2304
  ds_read_b64_tr_b16 a[6:7], v3 offset:2816
  v_mfma_f32_32x32x16_bf16 v[48:63], a[12:15], v[140:143], v[48:63]
  ds_read_b64_tr_b16 a[8:9], v3 offset:4352
  ds_read_b64_tr_b16 a[10:11], v3 offset:4864
  s_waitcnt lgkmcnt(6)
  v_mfma_f32_32x32x16_bf16 v[48:63], a[16:19], v[144:147], v[48:63]
  ds_read_b64_tr_b16 a[12:13], v3 offset:6400
  ds_read_b64_tr_b16 a[14:15], v3 offset:6912
  v_mfma_f32_32x32x16_bf16 v[48:63], a[20:23], v[148:151], v[48:63]
  ds_read_b64_tr_b16 a[16:17], v3 offset:8448
  ds_read_b64_tr_b16 a[18:19], v3 offset:8960
  v_mfma_f32_32x32x16_bf16 v[48:63], a[24:27], v[152:155], v[48:63]
  ds_read_b64_tr_b16 a[20:21], v3 offset:10496
  ds_read_b64_tr_b16 a[22:23], v3 offset:11008
  v_mfma_f32_32x32x16_bf16 v[48:63], a[28:31], v[156:159], v[48:63]
  ds_read_b64_tr_b16 a[24:25], v3 offset:12544
  ds_read_b64_tr_b16 a[26:27], v3 offset:13056
  s_waitcnt lgkmcnt(6)
  v_mfma_f32_32x32x16_bf16 v[64:79], a[0:3], v[128:131], 0
  ds_read_b64_tr_b16 a[28:29], v3 offset:14592
  ds_read_b64_tr_b16 a[30:31], v3 offset:15104
  v_mfma_f32_32x32x16_bf16 v[64:79], a[4:7], v[132:135], v[64:79]
  ds_read_b64_tr_b16 a[0:1], v3 offset:16384
  ds_read_b64_tr_b16 a[2:3], v3 offset:16896
  v_mfma_f32_32x32x16_bf16 v[64:79], a[8:11], v[136:139], v[64:79]
  ds_read_b64_tr_b16 a[4:5], v3 offset:18432
  ds_read_b64_tr_b16 a[6:7], v3 offset:18944
  v_mfma_f32_32x32x16_bf16 v[64:79], a[12:15], v[140:143], v[64:79]
  ds_read_b64_tr_b16 a[8:9], v3 offset:20480
  ds_read_b64_tr_b16 a[10:11], v3 offset:20992
  s_waitcnt lgkmcnt(6)
  v_mfma_f32_32x32x16_bf16 v[64:79], a[16:19], v[144:147], v[64:79]
  ds_read_b64_tr_b16 a[12:13], v3 offset:22528
  ds_read_b64_tr_b16 a[14:15], v3 offset:23040
  v_mfma_f32_32x32x16_bf16 v[64:79], a[20:23], v[148:151], v[64:79]
  ds_read_b64_tr_b16 a[16:17], v3 offset:24576
  ds_read_b64_tr_b16 a[18:19], v3 offset:25088
  v_mfma_f32_32x32x16_bf16 v[64:79], a[24:27], v[152:155], v[64:79]
  ds_read_b64_tr_b16 a[20:21], v3 offset:26624
  ds_read_b64_tr_b16 a[22:23], v3 offset:27136
  v_mfma_f32_32x32x16_bf16 v[64:79], a[28:31], v[156:159], v[64:79]
  ds_read_b64_tr_b16 a[24:25], v3 offset:28672
  ds_read_b64_tr_b16 a[26:27], v3 offset:29184
  s_waitcnt lgkmcnt(6)
  v_mfma_f32_32x32x16_bf16 v[48:63], a[0:3], v[160:163], v[48:63]
  ds_read_b64_tr_b16 a[28:29], v3 offset:30720
  ds_read_b64_tr_b16 a[30:31], v3 offset:31232
  v_mfma_f32_32x32x16_bf16 v[48:63], a[4:7], v[164:167], v[48:63]
  ds_read_b64_tr_b16 a[0:1], v3 offset:16640
  ds_read_b64_tr_b16 a[2:3], v3 offset:17152
  v_mfma_f32_32x32x16_bf16 v[48:63], a[8:11], v[168:171], v[48:63]
  ds_read_b64_tr_b16 a[4:5], v3 offset:18688
  ds_read_b64_tr_b16 a[6:7], v3 offset:19200
  v_mfma_f32_32x32x16_bf16 v[48:63], a[12:15], v[172:175], v[48:63]
  ds_read_b64_tr_b16 a[8:9], v3 offset:20736
  ds_read_b64_tr_b16 a[10:11], v3 offset:21248
  s_waitcnt lgkmcnt(6)
  v_mfma_f32_32x32x16_bf16 v[48:63], a[16:19], v[176:179], v[48:63]
  ds_read_b64_tr_b16 a[12:13], v3 offset:22784
  ds_read_b64_tr_b16 a[14:15], v3 offset:23296
  v_mfma_f32_32x32x16_bf16 v[48:63], a[20:23], v[180:183], v[48:63]
  ds_read_b64_tr_b16 a[16:17], v3 offset:24832
  ds_read_b64_tr_b16 a[18:19], v3 offset:25344
  s_lshl_b32 s99, s17, 3
  s_lshl2_add_u32 s99, s96, s99
  s_add_u32 s99, s99, s28
  v_mfma_f32_32x32x16_bf16 v[48:63], a[24:27], v[184:187], v[48:63]
  ds_read_b64_tr_b16 a[20:21], v3 offset:26880
  ds_read_b64_tr_b16 a[22:23], v3 offset:27392
  s_waitcnt vmcnt(0)
  v_mfma_f32_32x32x16_bf16 v[48:63], a[28:31], v[188:191], v[48:63]
  ds_read_b64_tr_b16 a[24:25], v3 offset:28928
  ds_read_b64_tr_b16 a[26:27], v3 offset:29440
  buffer_store_dword v0, off, s[88:91], s99 sc1
  s_waitcnt lgkmcnt(6)
  v_mfma_f32_32x32x16_bf16 v[64:79], a[0:3], v[160:163], v[64:79]
  ds_read_b64_tr_b16 a[28:29], v3 offset:30976
  ds_read_b64_tr_b16 a[30:31], v3 offset:31488
  v_cmp_eq_u32 vcc, s26, v14
  s_nop 1
  s_mov_b32 s36, vcc_lo
  v_mfma_f32_32x32x16_bf16 v[64:79], a[4:7], v[164:167], v[64:79]
  s_lshr_b32 s92, s17, 6
  s_lshl_b32 s92, 3, s92
  s_and_b32 s93, s36, s92
  s_cmp_eq_u32 s93, s92
  s_cselect_b32 s92, s92, 0
  s_cselect_b32 s38, 0, 0x7f000000
  v_mfma_f32_32x32x16_bf16 v[64:79], a[8:11], v[168:171], v[64:79]
  s_or_b32 s37, s37, s92
  s_or_b32 s42, s42, s92
  s_mul_i32 s40, s17, 256
  s_add_u32 s40, s40, s29
  s_or_b32 s40, s40, s38
  s_add_u32 s41, s40, 16384
  buffer_load_dwordx4 a[64:67], v12, s[88:91], s40 offen offset:0 sc1
  buffer_load_dwordx4 a[68:71], v12, s[88:91], s40 offen offset:1024 sc1
  buffer_load_dwordx4 a[72:75], v12, s[88:91], s41 offen offset:0 sc1
  buffer_load_dwordx4 a[76:79], v12, s[88:91], s41 offen offset:1024 sc1
  buffer_load_dword v14, v13, s[88:91], s39 offen offset:0 sc1
  v_mfma_f32_32x32x16_bf16 v[64:79], a[12:15], v[172:175], v[64:79]
  s_mul_i32 s7, s18, 65536
  s_add_u32 s7, s7, s9
  v_cvt_pk_bf16_f32 v48, v48, v49
  v_cvt_pk_bf16_f32 v49, v50, v51
  v_cvt_pk_bf16_f32 v50, v52, v53
  v_cvt_pk_bf16_f32 v51, v54, v55
  s_waitcnt lgkmcnt(0)
  v_mfma_f32_32x32x16_bf16 v[64:79], a[16:19], v[176:179], v[64:79]
  v_cvt_pk_bf16_f32 v52, v56, v57
  v_cvt_pk_bf16_f32 v53, v58, v59
  v_cvt_pk_bf16_f32 v54, v60, v61
  v_cvt_pk_bf16_f32 v55, v62, v63
  v_mfma_f32_32x32x16_bf16 v[64:79], a[20:23], v[180:183], v[64:79]
  buffer_store_dwordx4 v[48:51], v12, s[88:91], s7 offen offset:0 sc1
  v_mfma_f32_32x32x16_bf16 v[64:79], a[24:27], v[184:187], v[64:79]
  buffer_store_dwordx4 v[52:55], v12, s[88:91], s7 offen offset:1024 sc1
  v_mfma_f32_32x32x16_bf16 v[64:79], a[28:31], v[188:191], v[64:79]
  v_add_u32 v3, 0xfffe0000, v3
  v_mfma_f32_32x32x16_bf16 v[112:127], v[100:103], v[212:215], v[112:127]
  s_barrier
  ds_read_b64_tr_b16 a[0:1], v3 offset:0
  ds_read_b64_tr_b16 a[2:3], v3 offset:512
  v_mfma_f32_32x32x16_bf16 v[112:127], v[96:99], v[216:219], v[112:127]
  ds_read_b64_tr_b16 a[4:5], v3 offset:2048
  ds_read_b64_tr_b16 a[6:7], v3 offset:2560
  v_mfma_f32_32x32x16_bf16 v[112:127], v[100:103], v[220:223], v[112:127]
  ds_read_b64_tr_b16 a[8:9], v3 offset:4096
  ds_read_b64_tr_b16 a[10:11], v3 offset:4608
  s_mul_i32 s8, s18, 65536
  s_add_u32 s8, s8, s10
  v_cvt_pk_bf16_f32 v64, v64, v65
  v_cvt_pk_bf16_f32 v65, v66, v67
  v_mfma_f32_32x32x16_bf16 v[112:127], v[96:99], a[224:227], v[112:127]
  ds_read_b64_tr_b16 a[12:13], v3 offset:6144
  ds_read_b64_tr_b16 a[14:15], v3 offset:6656
  v_cvt_pk_bf16_f32 v66, v68, v69
  v_cvt_pk_bf16_f32 v67, v70, v71
  v_cvt_pk_bf16_f32 v68, v72, v73
  v_cvt_pk_bf16_f32 v69, v74, v75
  v_mfma_f32_32x32x16_bf16 v[112:127], v[100:103], a[228:231], v[112:127]
  ds_read_b64_tr_b16 a[16:17], v3 offset:8192
  ds_read_b64_tr_b16 a[18:19], v3 offset:8704
  v_cvt_pk_bf16_f32 v70, v76, v77
  v_cvt_pk_bf16_f32 v71, v78, v79
  v_mfma_f32_32x32x16_bf16 v[112:127], v[96:99], a[232:235], v[112:127]
  ds_read_b64_tr_b16 a[20:21], v3 offset:10240
  ds_read_b64_tr_b16 a[22:23], v3 offset:10752
  buffer_store_dwordx4 v[64:67], v12, s[88:91], s8 offen offset:0 sc1
  v_mfma_f32_32x32x16_bf16 v[112:127], v[100:103], a[236:239], v[112:127]
  ds_read_b64_tr_b16 a[24:25], v3 offset:12288
  ds_read_b64_tr_b16 a[26:27], v3 offset:12800
  buffer_store_dwordx4 v[68:71], v12, s[88:91], s8 offen offset:1024 sc1
  s_waitcnt lgkmcnt(6)
  v_mfma_f32_32x32x16_bf16 v[224:239], a[0:3], v[128:131], 0
  ds_read_b64_tr_b16 a[28:29], v3 offset:14336
  ds_read_b64_tr_b16 a[30:31], v3 offset:14848
  v_mfma_f32_32x32x16_bf16 v[224:239], a[4:7], v[132:135], v[224:239]
  ds_read_b64_tr_b16 a[0:1], v3 offset:256
  ds_read_b64_tr_b16 a[2:3], v3 offset:768
  v_mfma_f32_32x32x16_bf16 v[224:239], a[8:11], v[136:139], v[224:239]
  ds_read_b64_tr_b16 a[4:5], v3 offset:2304
  ds_read_b64_tr_b16 a[6:7], v3 offset:2816
  v_mov_b32 v106, 0xbede652a
  v_lshlrev_b32 v208, 16, v200
  v_and_b32 v209, 0xffff0000, v200
  v_lshlrev_b32 v210, 16, v201
  v_mfma_f32_32x32x16_bf16 v[224:239], a[12:15], v[140:143], v[224:239]
  ds_read_b64_tr_b16 a[8:9], v3 offset:4352
  ds_read_b64_tr_b16 a[10:11], v3 offset:4864
  v_and_b32 v211, 0xffff0000, v201
  v_fma_f32 v112, v112, v106, v208
  v_fma_f32 v113, v113, v106, v209
  v_fma_f32 v114, v114, v106, v210
  s_waitcnt lgkmcnt(6)
  v_mfma_f32_32x32x16_bf16 v[224:239], a[16:19], v[144:147], v[224:239]
  ds_read_b64_tr_b16 a[12:13], v3 offset:6400
  ds_read_b64_tr_b16 a[14:15], v3 offset:6912
  v_fma_f32 v115, v115, v106, v211
  v_mul_f32 v208, 0xbfb8aa3b, v112
  v_mul_f32 v209, 0xbfb8aa3b, v113
  v_mul_f32 v210, 0xbfb8aa3b, v114
  v_mfma_f32_32x32x16_bf16 v[224:239], a[20:23], v[148:151], v[224:239]
  ds_read_b64_tr_b16 a[16:17], v3 offset:8448
  ds_read_b64_tr_b16 a[18:19], v3 offset:8960
  v_mul_f32 v211, 0xbfb8aa3b, v115
  v_exp_f32 v208, v208
  v_mfma_f32_32x32x16_bf16 v[224:239], a[24:27], v[152:155], v[224:239]
  ds_read_b64_tr_b16 a[20:21], v3 offset:10496
  ds_read_b64_tr_b16 a[22:23], v3 offset:11008
  v_exp_f32 v209, v209
  v_exp_f32 v210, v210
  v_mfma_f32_32x32x16_bf16 v[224:239], a[28:31], v[156:159], v[224:239]
  ds_read_b64_tr_b16 a[24:25], v3 offset:12544
  ds_read_b64_tr_b16 a[26:27], v3 offset:13056
  v_exp_f32 v211, v211
  v_add_f32 v208, 1.0, v208
  v_add_f32 v209, 1.0, v209
  s_waitcnt lgkmcnt(6)
  v_mfma_f32_32x32x16_bf16 v[80:95], a[0:3], v[128:131], 0
  ds_read_b64_tr_b16 a[28:29], v3 offset:14592
  ds_read_b64_tr_b16 a[30:31], v3 offset:15104
  v_add_f32 v210, 1.0, v210
  v_add_f32 v211, 1.0, v211
  v_rcp_f32 v208, v208
  v_mfma_f32_32x32x16_bf16 v[80:95], a[4:7], v[132:135], v[80:95]
  ds_read_b64_tr_b16 a[0:1], v3 offset:16384
  ds_read_b64_tr_b16 a[2:3], v3 offset:16896
  v_rcp_f32 v209, v209
  v_rcp_f32 v210, v210
  v_mfma_f32_32x32x16_bf16 v[80:95], a[8:11], v[136:139], v[80:95]
  ds_read_b64_tr_b16 a[4:5], v3 offset:18432
  ds_read_b64_tr_b16 a[6:7], v3 offset:18944
  v_rcp_f32 v211, v211
  v_mul_f32 v112, v112, v208
  v_mul_f32 v113, v113, v209
  v_mfma_f32_32x32x16_bf16 v[80:95], a[12:15], v[140:143], v[80:95]
  ds_read_b64_tr_b16 a[8:9], v3 offset:20480
  ds_read_b64_tr_b16 a[10:11], v3 offset:20992
  v_mul_f32 v114, v114, v210
  v_mul_f32 v115, v115, v211
  v_lshlrev_b32 v212, 16, v202
  v_and_b32 v213, 0xffff0000, v202
  s_waitcnt lgkmcnt(6)
  v_mfma_f32_32x32x16_bf16 v[80:95], a[16:19], v[144:147], v[80:95]
  ds_read_b64_tr_b16 a[12:13], v3 offset:22528
  ds_read_b64_tr_b16 a[14:15], v3 offset:23040
  v_lshlrev_b32 v214, 16, v203
  v_and_b32 v215, 0xffff0000, v203
  v_fma_f32 v116, v116, v106, v212
  v_fma_f32 v117, v117, v106, v213
  v_mfma_f32_32x32x16_bf16 v[80:95], a[20:23], v[148:151], v[80:95]
  ds_read_b64_tr_b16 a[16:17], v3 offset:24576
  ds_read_b64_tr_b16 a[18:19], v3 offset:25088
  v_fma_f32 v118, v118, v106, v214
  v_fma_f32 v119, v119, v106, v215
  v_mul_f32 v212, 0xbfb8aa3b, v116
  v_mul_f32 v213, 0xbfb8aa3b, v117
  v_mfma_f32_32x32x16_bf16 v[80:95], a[24:27], v[152:155], v[80:95]
  ds_read_b64_tr_b16 a[20:21], v3 offset:26624
  ds_read_b64_tr_b16 a[22:23], v3 offset:27136
  v_mul_f32 v214, 0xbfb8aa3b, v118
  v_mul_f32 v215, 0xbfb8aa3b, v119
  v_exp_f32 v212, v212
  v_mfma_f32_32x32x16_bf16 v[80:95], a[28:31], v[156:159], v[80:95]
  ds_read_b64_tr_b16 a[24:25], v3 offset:28672
  ds_read_b64_tr_b16 a[26:27], v3 offset:29184
  v_exp_f32 v213, v213
  v_exp_f32 v214, v214
  s_waitcnt lgkmcnt(6)
  v_mfma_f32_32x32x16_bf16 v[224:239], a[0:3], v[160:163], v[224:239]
  ds_read_b64_tr_b16 a[28:29], v3 offset:30720
  ds_read_b64_tr_b16 a[30:31], v3 offset:31232
  s_waitcnt vmcnt(4)
  v_cmp_eq_u32 vcc, s26, v14
  s_nop 1
  s_mov_b32 s36, vcc_lo
  v_mfma_f32_32x32x16_bf16 v[224:239], a[4:7], v[164:167], v[224:239]
  ds_read_b64_tr_b16 a[0:1], v3 offset:16640
  ds_read_b64_tr_b16 a[2:3], v3 offset:17152
  s_lshr_b32 s92, s16, 6
  s_lshl_b32 s92, 3, s92
  s_and_b32 s93, s36, s92
  v_mfma_f32_32x32x16_bf16 v[224:239], a[8:11], v[168:171], v[224:239]
  ds_read_b64_tr_b16 a[4:5], v3 offset:18688
  ds_read_b64_tr_b16 a[6:7], v3 offset:19200
  s_cmp_eq_u32 s93, s92
  s_cselect_b32 s92, s92, 0
  s_cselect_b32 s38, 0, 0x7f000000
  s_or_b32 s37, s37, s92
  v_mfma_f32_32x32x16_bf16 v[224:239], a[12:15], v[172:175], v[224:239]
  ds_read_b64_tr_b16 a[8:9], v3 offset:20736
  ds_read_b64_tr_b16 a[10:11], v3 offset:21248
  s_or_b32 s42, s42, s92
  s_mul_i32 s40, s16, 256
  s_add_u32 s40, s40, s29
  s_or_b32 s40, s40, s38
  s_waitcnt lgkmcnt(6)
  v_mfma_f32_32x32x16_bf16 v[224:239], a[16:19], v[176:179], v[224:239]
  ds_read_b64_tr_b16 a[12:13], v3 offset:22784
  ds_read_b64_tr_b16 a[14:15], v3 offset:23296
  s_add_u32 s41, s40, 16384
  v_exp_f32 v215, v215
  v_add_f32 v212, 1.0, v212
  v_mfma_f32_32x32x16_bf16 v[224:239], a[20:23], v[180:183], v[224:239]
  ds_read_b64_tr_b16 a[16:17], v3 offset:24832
  ds_read_b64_tr_b16 a[18:19], v3 offset:25344
  buffer_load_dwordx4 a[80:83], v12, s[88:91], s40 offen offset:0 sc1
L_padh13:
  s_cbranch_execz L_walk_done
  v_add_f32 v213, 1.0, v213
  v_add_f32 v214, 1.0, v214
  v_mfma_f32_32x32x16_bf16 v[224:239], a[24:27], v[184:187], v[224:239]
  ds_read_b64_tr_b16 a[20:21], v3 offset:26880
  ds_read_b64_tr_b16 a[22:23], v3 offset:27392
  buffer_load_dwordx4 a[84:87], v12, s[88:91], s40 offen offset:1024 sc1
  v_add_f32 v215, 1.0, v215
  v_mfma_f32_32x32x16_bf16 v[224:239], a[28:31], v[188:191], v[224:239]
  ds_read_b64_tr_b16 a[24:25], v3 offset:28928
  ds_read_b64_tr_b16 a[26:27], v3 offset:29440
  buffer_load_dwordx4 a[88:91], v12, s[88:91], s41 offen offset:0 sc1
  v_rcp_f32 v212, v212
  buffer_load_dwordx4 a[92:95], v12, s[88:91], s41 offen offset:1024 sc1
  buffer_load_dword v14, v13, s[88:91], s39 offen offset:0 sc1
  s_waitcnt lgkmcnt(6)
  v_mfma_f32_32x32x16_bf16 v[80:95], a[0:3], v[160:163], v[80:95]
  ds_read_b64_tr_b16 a[28:29], v3 offset:30976
  ds_read_b64_tr_b16 a[30:31], v3 offset:31488
  s_lshl_b32 s99, s18, 3
  s_lshl2_add_u32 s99, s96, s99
  s_add_u32 s99, s99, s28
  s_waitcnt vmcnt(5)
  buffer_store_dword v0, off, s[88:91], s99 sc1
  v_mfma_f32_32x32x16_bf16 v[80:95], a[4:7], v[164:167], v[80:95]
  s_barrier
  ds_read_b64_tr_b16 a[0:1], v3 offset:32768
  ds_read_b64_tr_b16 a[2:3], v3 offset:33280
  v_rcp_f32 v213, v213
  v_mfma_f32_32x32x16_bf16 v[80:95], a[8:11], v[168:171], v[80:95]
  ds_read_b64_tr_b16 a[4:5], v3 offset:34816
  ds_read_b64_tr_b16 a[6:7], v3 offset:35328
  s_mul_i32 s7, s19, 65536
  s_add_u32 s7, s7, s9
  v_cvt_pk_bf16_f32 v224, v224, v225
  v_cvt_pk_bf16_f32 v225, v226, v227
  v_mfma_f32_32x32x16_bf16 v[80:95], a[12:15], v[172:175], v[80:95]
  ds_read_b64_tr_b16 a[8:9], v3 offset:36864
  ds_read_b64_tr_b16 a[10:11], v3 offset:37376
  v_cvt_pk_bf16_f32 v226, v228, v229
  v_cvt_pk_bf16_f32 v227, v230, v231
  v_cvt_pk_bf16_f32 v228, v232, v233
  v_cvt_pk_bf16_f32 v229, v234, v235
  s_waitcnt lgkmcnt(6)
  v_mfma_f32_32x32x16_bf16 v[80:95], a[16:19], v[176:179], v[80:95]
  ds_read_b64_tr_b16 a[12:13], v3 offset:38912
  ds_read_b64_tr_b16 a[14:15], v3 offset:39424
  v_cvt_pk_bf16_f32 v230, v236, v237
  v_cvt_pk_bf16_f32 v231, v238, v239
  v_rcp_f32 v214, v214
  v_mfma_f32_32x32x16_bf16 v[80:95], a[20:23], v[180:183], v[80:95]
  ds_read_b64_tr_b16 a[16:17], v3 offset:40960
  ds_read_b64_tr_b16 a[18:19], v3 offset:41472
  buffer_store_dwordx4 v[224:227], v12, s[88:91], s7 offen offset:0 sc1
  v_rcp_f32 v215, v215
  v_mfma_f32_32x32x16_bf16 v[80:95], a[24:27], v[184:187], v[80:95]
  ds_read_b64_tr_b16 a[20:21], v3 offset:43008
  ds_read_b64_tr_b16 a[22:23], v3 offset:43520
  buffer_store_dwordx4 v[228:231], v12, s[88:91], s7 offen offset:1024 sc1
  v_mul_f32 v116, v116, v212
  v_mul_f32 v117, v117, v213
  v_mfma_f32_32x32x16_bf16 v[80:95], a[28:31], v[188:191], v[80:95]
  ds_read_b64_tr_b16 a[24:25], v3 offset:45056
  ds_read_b64_tr_b16 a[26:27], v3 offset:45568
  v_mul_f32 v118, v118, v214
  v_mul_f32 v119, v119, v215
  v_lshlrev_b32 v208, 16, v204
  v_and_b32 v209, 0xffff0000, v204
  s_waitcnt lgkmcnt(6)
  v_mfma_f32_32x32x16_bf16 v[16:31], a[0:3], v[128:131], 0
  ds_read_b64_tr_b16 a[28:29], v3 offset:47104
  ds_read_b64_tr_b16 a[30:31], v3 offset:47616
  v_lshlrev_b32 v210, 16, v205
  v_and_b32 v211, 0xffff0000, v205
  v_fma_f32 v120, v120, v106, v208
  v_fma_f32 v121, v121, v106, v209
  v_mfma_f32_32x32x16_bf16 v[16:31], a[4:7], v[132:135], v[16:31]
  ds_read_b64_tr_b16 a[0:1], v3 offset:49152
  ds_read_b64_tr_b16 a[2:3], v3 offset:49664
  v_fma_f32 v122, v122, v106, v210
  v_fma_f32 v123, v123, v106, v211
  v_mul_f32 v208, 0xbfb8aa3b, v120
  v_mul_f32 v209, 0xbfb8aa3b, v121
  v_mfma_f32_32x32x16_bf16 v[16:31], a[8:11], v[136:139], v[16:31]
  ds_read_b64_tr_b16 a[4:5], v3 offset:51200
  ds_read_b64_tr_b16 a[6:7], v3 offset:51712
  s_mul_i32 s8, s19, 65536
  s_add_u32 s8, s8, s10
  v_cvt_pk_bf16_f32 v80, v80, v81
  v_cvt_pk_bf16_f32 v81, v82, v83
  v_mfma_f32_32x32x16_bf16 v[16:31], a[12:15], v[140:143], v[16:31]
  ds_read_b64_tr_b16 a[8:9], v3 offset:53248
  ds_read_b64_tr_b16 a[10:11], v3 offset:53760
  v_cvt_pk_bf16_f32 v82, v84, v85
  v_cvt_pk_bf16_f32 v83, v86, v87
  v_cvt_pk_bf16_f32 v84, v88, v89
  v_cvt_pk_bf16_f32 v85, v90, v91
  s_waitcnt lgkmcnt(6)
  v_mfma_f32_32x32x16_bf16 v[16:31], a[16:19], v[144:147], v[16:31]
  ds_read_b64_tr_b16 a[12:13], v3 offset:55296
  ds_read_b64_tr_b16 a[14:15], v3 offset:55808
  v_cvt_pk_bf16_f32 v86, v92, v93
  v_cvt_pk_bf16_f32 v87, v94, v95
  v_mul_f32 v210, 0xbfb8aa3b, v122
  v_mul_f32 v211, 0xbfb8aa3b, v123
  v_mfma_f32_32x32x16_bf16 v[16:31], a[20:23], v[148:151], v[16:31]
  ds_read_b64_tr_b16 a[16:17], v3 offset:57344
  ds_read_b64_tr_b16 a[18:19], v3 offset:57856
  buffer_store_dwordx4 v[80:83], v12, s[88:91], s8 offen offset:0 sc1
  v_exp_f32 v208, v208
  v_mfma_f32_32x32x16_bf16 v[16:31], a[24:27], v[152:155], v[16:31]
  ds_read_b64_tr_b16 a[20:21], v3 offset:59392
  ds_read_b64_tr_b16 a[22:23], v3 offset:59904
  buffer_store_dwordx4 v[84:87], v12, s[88:91], s8 offen offset:1024 sc1
  v_exp_f32 v209, v209
  v_mfma_f32_32x32x16_bf16 v[16:31], a[28:31], v[156:159], v[16:31]
  ds_read_b64_tr_b16 a[24:25], v3 offset:61440
  ds_read_b64_tr_b16 a[26:27], v3 offset:61952
  v_exp_f32 v210, v210
  v_exp_f32 v211, v211
  s_waitcnt lgkmcnt(6)
  v_mfma_f32_32x32x16_bf16 v[16:31], a[0:3], v[160:163], v[16:31]
  ds_read_b64_tr_b16 a[28:29], v3 offset:63488
  ds_read_b64_tr_b16 a[30:31], v3 offset:64000
  v_add_f32 v208, 1.0, v208
  v_add_f32 v209, 1.0, v209
  v_add_f32 v210, 1.0, v210
  v_add_f32 v211, 1.0, v211
  v_mfma_f32_32x32x16_bf16 v[16:31], a[4:7], v[164:167], v[16:31]
  ds_read_b64_tr_b16 a[0:1], v3 offset:33024
  ds_read_b64_tr_b16 a[2:3], v3 offset:33536
  v_rcp_f32 v208, v208
  v_rcp_f32 v209, v209
  v_mfma_f32_32x32x16_bf16 v[16:31], a[8:11], v[168:171], v[16:31]
  ds_read_b64_tr_b16 a[4:5], v3 offset:35072
  ds_read_b64_tr_b16 a[6:7], v3 offset:35584
  v_rcp_f32 v210, v210
  v_rcp_f32 v211, v211
  v_mfma_f32_32x32x16_bf16 v[16:31], a[12:15], v[172:175], v[16:31]
  ds_read_b64_tr_b16 a[8:9], v3 offset:37120
  ds_read_b64_tr_b16 a[10:11], v3 offset:37632
  v_mul_f32 v120, v120, v208
  v_mul_f32 v121, v121, v209
  v_mul_f32 v122, v122, v210
  v_mul_f32 v123, v123, v211
  s_waitcnt lgkmcnt(6)
  v_mfma_f32_32x32x16_bf16 v[16:31], a[16:19], v[176:179], v[16:31]
  ds_read_b64_tr_b16 a[12:13], v3 offset:39168
  ds_read_b64_tr_b16 a[14:15], v3 offset:39680
  v_lshlrev_b32 v212, 16, v206
  v_and_b32 v213, 0xffff0000, v206
  v_lshlrev_b32 v214, 16, v207
  v_and_b32 v215, 0xffff0000, v207
  v_mfma_f32_32x32x16_bf16 v[16:31], a[20:23], v[180:183], v[16:31]
  ds_read_b64_tr_b16 a[16:17], v3 offset:41216
  ds_read_b64_tr_b16 a[18:19], v3 offset:41728
  v_fma_f32 v124, v124, v106, v212
  v_fma_f32 v125, v125, v106, v213
  v_fma_f32 v126, v126, v106, v214
  v_fma_f32 v127, v127, v106, v215
  v_mfma_f32_32x32x16_bf16 v[16:31], a[24:27], v[184:187], v[16:31]
  ds_read_b64_tr_b16 a[20:21], v3 offset:43264
  ds_read_b64_tr_b16 a[22:23], v3 offset:43776
  v_mul_f32 v212, 0xbfb8aa3b, v124
  v_mul_f32 v213, 0xbfb8aa3b, v125
  v_mul_f32 v214, 0xbfb8aa3b, v126
  v_mul_f32 v215, 0xbfb8aa3b, v127
  v_mfma_f32_32x32x16_bf16 v[16:31], a[28:31], v[188:191], v[16:31]
  ds_read_b64_tr_b16 a[24:25], v3 offset:45312
  ds_read_b64_tr_b16 a[26:27], v3 offset:45824
  v_exp_f32 v212, v212
  v_exp_f32 v213, v213
  s_waitcnt lgkmcnt(6)
  v_mfma_f32_32x32x16_bf16 v[32:47], a[0:3], v[128:131], 0
  ds_read_b64_tr_b16 a[28:29], v3 offset:47360
  ds_read_b64_tr_b16 a[30:31], v3 offset:47872
  v_exp_f32 v214, v214
  v_exp_f32 v215, v215
  v_mfma_f32_32x32x16_bf16 v[32:47], a[4:7], v[132:135], v[32:47]
  ds_read_b64_tr_b16 a[0:1], v3 offset:49408
  ds_read_b64_tr_b16 a[2:3], v3 offset:49920
  v_add_f32 v212, 1.0, v212
  v_add_f32 v213, 1.0, v213
  v_add_f32 v214, 1.0, v214
  v_add_f32 v215, 1.0, v215
  v_mfma_f32_32x32x16_bf16 v[32:47], a[8:11], v[136:139], v[32:47]
  ds_read_b64_tr_b16 a[4:5], v3 offset:51456
  ds_read_b64_tr_b16 a[6:7], v3 offset:51968
  s_mul_i32 s7, s20, 65536
  s_add_u32 s7, s7, s9
  v_cvt_pk_bf16_f32 v16, v16, v17
  v_cvt_pk_bf16_f32 v17, v18, v19
  v_mfma_f32_32x32x16_bf16 v[32:47], a[12:15], v[140:143], v[32:47]
  ds_read_b64_tr_b16 a[8:9], v3 offset:53504
  ds_read_b64_tr_b16 a[10:11], v3 offset:54016
  v_cvt_pk_bf16_f32 v18, v20, v21
  v_cvt_pk_bf16_f32 v19, v22, v23
  v_cvt_pk_bf16_f32 v20, v24, v25
  v_cvt_pk_bf16_f32 v21, v26, v27
  s_waitcnt lgkmcnt(6)
  v_mfma_f32_32x32x16_bf16 v[32:47], a[16:19], v[144:147], v[32:47]
  ds_read_b64_tr_b16 a[12:13], v3 offset:55552
  ds_read_b64_tr_b16 a[14:15], v3 offset:56064
  v_cvt_pk_bf16_f32 v22, v28, v29
  v_cvt_pk_bf16_f32 v23, v30, v31
  v_rcp_f32 v212, v212
  v_mfma_f32_32x32x16_bf16 v[32:47], a[20:23], v[148:151], v[32:47]
  ds_read_b64_tr_b16 a[16:17], v3 offset:57600
  ds_read_b64_tr_b16 a[18:19], v3 offset:58112
  buffer_store_dwordx4 v[16:19], v12, s[88:91], s7 offen offset:0 sc1
  v_rcp_f32 v213, v213
  v_mfma_f32_32x32x16_bf16 v[32:47], a[24:27], v[152:155], v[32:47]
  ds_read_b64_tr_b16 a[20:21], v3 offset:59648
  ds_read_b64_tr_b16 a[22:23], v3 offset:60160
  buffer_store_dwordx4 v[20:23], v12, s[88:91], s7 offen offset:1024 sc1
  v_rcp_f32 v214, v214
  v_mfma_f32_32x32x16_bf16 v[32:47], a[28:31], v[156:159], v[32:47]
  ds_read_b64_tr_b16 a[24:25], v3 offset:61696
  ds_read_b64_tr_b16 a[26:27], v3 offset:62208
  s_waitcnt vmcnt(7)
  v_cmp_eq_u32 vcc, s26, v14
  s_nop 1
  s_mov_b32 s36, vcc_lo
  s_waitcnt lgkmcnt(6)
  v_mfma_f32_32x32x16_bf16 v[32:47], a[0:3], v[160:163], v[32:47]
  ds_read_b64_tr_b16 a[28:29], v3 offset:63744
  ds_read_b64_tr_b16 a[30:31], v3 offset:64256
  s_lshr_b32 s92, s15, 6
  s_lshl_b32 s92, 3, s92
  s_and_b32 s93, s36, s92
  v_lshlrev_b32 v224, 16, v192
  v_mfma_f32_32x32x16_bf16 v[32:47], a[4:7], v[164:167], v[32:47]
  s_cmp_eq_u32 s93, s92
  s_cselect_b32 s92, s92, 0
  s_cselect_b32 s38, 0, 0x7f000000
  s_or_b32 s37, s37, s92
  s_or_b32 s42, s42, s92
  s_mul_i32 s40, s15, 256
  s_add_u32 s40, s40, s29
  s_or_b32 s40, s40, s38
  s_add_u32 s41, s40, 16384
  buffer_load_dwordx4 a[96:99], v12, s[88:91], s40 offen offset:0 sc1
  buffer_load_dwordx4 a[100:103], v12, s[88:91], s40 offen offset:1024 sc1
  buffer_load_dwordx4 a[104:107], v12, s[88:91], s41 offen offset:0 sc1
  buffer_load_dwordx4 a[108:111], v12, s[88:91], s41 offen offset:1024 sc1
  s_lshl_b32 s99, s19, 3
  s_lshl2_add_u32 s99, s96, s99
  s_add_u32 s99, s99, s28
  s_waitcnt vmcnt(6)
  buffer_store_dword v0, off, s[88:91], s99 sc1
  v_mfma_f32_32x32x16_bf16 v[32:47], a[8:11], v[168:171], v[32:47]
  v_rcp_f32 v215, v215
  v_mul_f32 v124, v124, v212
  v_mul_f32 v125, v125, v213
  v_mul_f32 v126, v126, v214
  v_mul_f32 v127, v127, v215
  v_mfma_f32_32x32x16_bf16 v[32:47], a[12:15], v[172:175], v[32:47]
  v_and_b32 v225, 0xffff0000, v192
  v_lshlrev_b32 v226, 16, v193
  v_and_b32 v227, 0xffff0000, v193
  v_lshlrev_b32 v228, 16, v194
  v_and_b32 v229, 0xffff0000, v194
  v_lshlrev_b32 v230, 16, v195
  s_waitcnt lgkmcnt(0)
  v_mfma_f32_32x32x16_bf16 v[32:47], a[16:19], v[176:179], v[32:47]
  v_and_b32 v231, 0xffff0000, v195
  v_lshlrev_b32 v232, 16, v196
  v_and_b32 v233, 0xffff0000, v196
  v_lshlrev_b32 v234, 16, v197
  v_and_b32 v235, 0xffff0000, v197
  v_lshlrev_b32 v236, 16, v198
  v_mfma_f32_32x32x16_bf16 v[32:47], a[20:23], v[180:183], v[32:47]
  v_and_b32 v237, 0xffff0000, v198
  v_lshlrev_b32 v238, 16, v199
  v_and_b32 v239, 0xffff0000, v199
  v_mfma_f32_32x32x16_bf16 v[32:47], a[24:27], v[184:187], v[32:47]
  v_mfma_f32_32x32x16_bf16 v[32:47], a[28:31], v[188:191], v[32:47]
  s_lshl_b32 s99, s20, 3
  s_lshl2_add_u32 s99, s96, s99
  s_add_u32 s99, s99, s28
  s_waitcnt vmcnt(5)
  buffer_store_dword v0, off, s[88:91], s99 sc1
  buffer_load_dword v14, v13, s[88:91], s39 offen offset:0 sc1
  s_waitcnt vmcnt(0)
  v_cmp_eq_u32 vcc, s26, v14
  s_nop 1
  s_andn2_b32 s36, vcc_lo, s37
  s_mov_b32 s38, 0
  s_lshr_b32 s99, s19, 6
  s_lshl_b32 s99, 3, s99
  s_and_b32 s100, s36, s99
  s_cmp_eq_u32 s100, s99
  s_cbranch_scc0 L_pa0
  s_or_b32 s38, s38, s99
  s_mul_i32 s100, s19, 256
  s_add_u32 s100, s100, s29
  buffer_load_dwordx4 a[32:35], v12, s[88:91], s100 offen offset:0 sc1
  buffer_load_dwordx4 a[36:39], v12, s[88:91], s100 offen offset:1024 sc1
  s_add_u32 s100, s100, 16384
  buffer_load_dwordx4 a[40:43], v12, s[88:91], s100 offen offset:0 sc1
  buffer_load_dwordx4 a[44:47], v12, s[88:91], s100 offen offset:1024 sc1
  L_pa0:
  s_lshr_b32 s99, s18, 6
  s_lshl_b32 s99, 3, s99
  s_and_b32 s100, s36, s99
  s_cmp_eq_u32 s100, s99
  s_cbranch_scc0 L_pa1
  s_or_b32 s38, s38, s99
  s_mul_i32 s100, s18, 256
  s_add_u32 s100, s100, s29
  buffer_load_dwordx4 a[48:51], v12, s[88:91], s100 offen offset:0 sc1
  buffer_load_dwordx4 a[52:55], v12, s[88:91], s100 offen offset:1024 sc1
  s_add_u32 s100, s100, 16384
  buffer_load_dwordx4 a[56:59], v12, s[88:91], s100 offen offset:0 sc1
  buffer_load_dwordx4 a[60:63], v12, s[88:91], s100 offen offset:1024 sc1
  L_pa1:
  s_lshr_b32 s99, s17, 6
  s_lshl_b32 s99, 3, s99
  s_and_b32 s100, s36, s99
  s_cmp_eq_u32 s100, s99
  s_cbranch_scc0 L_pa2
  s_or_b32 s38, s38, s99
  s_mul_i32 s100, s17, 256
  s_add_u32 s100, s100, s29
  buffer_load_dwordx4 a[64:67], v12, s[88:91], s100 offen offset:0 sc1
  buffer_load_dwordx4 a[68:71], v12, s[88:91], s100 offen offset:1024 sc1
  s_add_u32 s100, s100, 16384
  buffer_load_dwordx4 a[72:75], v12, s[88:91], s100 offen offset:0 sc1
  buffer_load_dwordx4 a[76:79], v12, s[88:91], s100 offen offset:1024 sc1
  L_pa2:
  s_lshr_b32 s99, s16, 6
  s_lshl_b32 s99, 3, s99
  s_and_b32 s100, s36, s99
  s_cmp_eq_u32 s100, s99
  s_cbranch_scc0 L_pa3
  s_or_b32 s38, s38, s99
  s_mul_i32 s100, s16, 256
  s_add_u32 s100, s100, s29
  buffer_load_dwordx4 a[80:83], v12, s[88:91], s100 offen offset:0 sc1
  buffer_load_dwordx4 a[84:87], v12, s[88:91], s100 offen offset:1024 sc1
  s_add_u32 s100, s100, 16384
  buffer_load_dwordx4 a[88:91], v12, s[88:91], s100 offen offset:0 sc1
  buffer_load_dwordx4 a[92:95], v12, s[88:91], s100 offen offset:1024 sc1
  L_pa3:
  s_lshr_b32 s99, s15, 6
  s_lshl_b32 s99, 3, s99
  s_and_b32 s100, s36, s99
  s_cmp_eq_u32 s100, s99
  s_cbranch_scc0 L_pa4
  s_or_b32 s38, s38, s99
  s_mul_i32 s100, s15, 256
  s_add_u32 s100, s100, s29
  buffer_load_dwordx4 a[96:99], v12, s[88:91], s100 offen offset:0 sc1
  buffer_load_dwordx4 a[100:103], v12, s[88:91], s100 offen offset:1024 sc1
  s_add_u32 s100, s100, 16384
  buffer_load_dwordx4 a[104:107], v12, s[88:91], s100 offen offset:0 sc1
  buffer_load_dwordx4 a[108:111], v12, s[88:91], s100 offen offset:1024 sc1
  L_pa4:
  s_lshr_b32 s99, s14, 6
  s_lshl_b32 s99, 3, s99
  s_and_b32 s100, s36, s99
  s_cmp_eq_u32 s100, s99
  s_cbranch_scc0 L_pa5
  s_or_b32 s38, s38, s99
  s_mul_i32 s100, s14, 256
  s_add_u32 s100, s100, s29
  buffer_load_dwordx4 a[112:115], v12, s[88:91], s100 offen offset:0 sc1
  buffer_load_dwordx4 a[116:119], v12, s[88:91], s100 offen offset:1024 sc1
  s_add_u32 s100, s100, 16384
  buffer_load_dwordx4 a[120:123], v12, s[88:91], s100 offen offset:0 sc1
  buffer_load_dwordx4 a[124:127], v12, s[88:91], s100 offen offset:1024 sc1
  L_pa5:
  s_mov_b32 s99, 0xc000
  s_and_b32 s100, s36, s99
  s_cmp_eq_u32 s100, s99
  s_cbranch_scc0 L_pa6
  s_or_b32 s38, s38, s99
  s_add_u32 s100, s29, 229376
  buffer_load_dwordx4 a[128:131], v12, s[88:91], s100 offen offset:0 sc1
  buffer_load_dwordx4 a[132:135], v12, s[88:91], s100 offen offset:1024 sc1
  s_add_u32 s100, s100, 16384
  buffer_load_dwordx4 a[136:139], v12, s[88:91], s100 offen offset:0 sc1
  buffer_load_dwordx4 a[140:143], v12, s[88:91], s100 offen offset:1024 sc1
  L_pa6:
  s_xor_b32 s99, s96, 1
  s_lshl_b32 s99, 1, s99
  s_and_b32 s100, s36, s99
  s_cmp_eq_u32 s100, s99
  s_cbranch_scc0 L_pa7
  s_or_b32 s38, s38, s99
  s_xor_b32 s100, s96, 1
  s_mul_i32 s100, s100, 16384
  s_add_u32 s100, s100, s29
  buffer_load_dwordx4 a[144:147], v12, s[88:91], s100 offen offset:0 sc1
  buffer_load_dwordx4 a[148:151], v12, s[88:91], s100 offen offset:1024 sc1
  L_pa7:
  buffer_load_dword v14, v13, s[88:91], s39 offen sc1
  s_or_b32 s37, s37, s38
  s_mov_b32 s0, 0x40000
  s_mov_b32 s43, 0
  s_branch L_tacc
  L_tl:
  v_cmp_eq_u32 vcc, s26, v14
  s_nop 1
  s_andn2_b32 s36, vcc_lo, s37
  s_mov_b32 s38, 0
  s_lshr_b32 s99, s19, 6
  s_lshl_b32 s99, 3, s99
  s_and_b32 s100, s36, s99
  s_cmp_eq_u32 s100, s99
  s_cbranch_scc0 L_tn0
  s_or_b32 s38, s38, s99
  s_mul_i32 s100, s19, 256
  s_add_u32 s100, s100, s29
  buffer_load_dwordx4 a[32:35], v12, s[88:91], s100 offen offset:0 sc1
  buffer_load_dwordx4 a[36:39], v12, s[88:91], s100 offen offset:1024 sc1
  s_add_u32 s100, s100, 16384
  buffer_load_dwordx4 a[40:43], v12, s[88:91], s100 offen offset:0 sc1
  buffer_load_dwordx4 a[44:47], v12, s[88:91], s100 offen offset:1024 sc1
  L_tn0:
  s_lshr_b32 s99, s18, 6
  s_lshl_b32 s99, 3, s99
  s_and_b32 s100, s36, s99
  s_cmp_eq_u32 s100, s99
  s_cbranch_scc0 L_tn1
  s_or_b32 s38, s38, s99
  s_mul_i32 s100, s18, 256
  s_add_u32 s100, s100, s29
  buffer_load_dwordx4 a[48:51], v12, s[88:91], s100 offen offset:0 sc1
  buffer_load_dwordx4 a[52:55], v12, s[88:91], s100 offen offset:1024 sc1
  s_add_u32 s100, s100, 16384
  buffer_load_dwordx4 a[56:59], v12, s[88:91], s100 offen offset:0 sc1
  buffer_load_dwordx4 a[60:63], v12, s[88:91], s100 offen offset:1024 sc1
  L_tn1:
  s_lshr_b32 s99, s17, 6
  s_lshl_b32 s99, 3, s99
  s_and_b32 s100, s36, s99
  s_cmp_eq_u32 s100, s99
  s_cbranch_scc0 L_tn2
  s_or_b32 s38, s38, s99
  s_mul_i32 s100, s17, 256
  s_add_u32 s100, s100, s29
  buffer_load_dwordx4 a[64:67], v12, s[88:91], s100 offen offset:0 sc1
  buffer_load_dwordx4 a[68:71], v12, s[88:91], s100 offen offset:1024 sc1
  s_add_u32 s100, s100, 16384
  buffer_load_dwordx4 a[72:75], v12, s[88:91], s100 offen offset:0 sc1
  buffer_load_dwordx4 a[76:79], v12, s[88:91], s100 offen offset:1024 sc1
  L_tn2:
  s_lshr_b32 s99, s16, 6
  s_lshl_b32 s99, 3, s99
  s_and_b32 s100, s36, s99
  s_cmp_eq_u32 s100, s99
  s_cbranch_scc0 L_tn3
  s_or_b32 s38, s38, s99
  s_mul_i32 s100, s16, 256
  s_add_u32 s100, s100, s29
  buffer_load_dwordx4 a[80:83], v12, s[88:91], s100 offen offset:0 sc1
  buffer_load_dwordx4 a[84:87], v12, s[88:91], s100 offen offset:1024 sc1
  s_add_u32 s100, s100, 16384
  buffer_load_dwordx4 a[88:91], v12, s[88:91], s100 offen offset:0 sc1
  buffer_load_dwordx4 a[92:95], v12, s[88:91], s100 offen offset:1024 sc1
  L_tn3:
  s_lshr_b32 s99, s15, 6
  s_lshl_b32 s99, 3, s99
  s_and_b32 s100, s36, s99
  s_cmp_eq_u32 s100, s99
  s_cbranch_scc0 L_tn4
  s_or_b32 s38, s38, s99
  s_mul_i32 s100, s15, 256
  s_add_u32 s100, s100, s29
  buffer_load_dwordx4 a[96:99], v12, s[88:91], s100 offen offset:0 sc1
  buffer_load_dwordx4 a[100:103], v12, s[88:91], s100 offen offset:1024 sc1
  s_add_u32 s100, s100, 16384
  buffer_load_dwordx4 a[104:107], v12, s[88:91], s100 offen offset:0 sc1
  buffer_load_dwordx4 a[108:111], v12, s[88:91], s100 offen offset:1024 sc1
  L_tn4:
  s_lshr_b32 s99, s14, 6
  s_lshl_b32 s99, 3, s99
  s_and_b32 s100, s36, s99
  s_cmp_eq_u32 s100, s99
  s_cbranch_scc0 L_tn5
  s_or_b32 s38, s38, s99
  s_mul_i32 s100, s14, 256
  s_add_u32 s100, s100, s29
  buffer_load_dwordx4 a[112:115], v12, s[88:91], s100 offen offset:0 sc1
  buffer_load_dwordx4 a[116:119], v12, s[88:91], s100 offen offset:1024 sc1
  s_add_u32 s100, s100, 16384
  buffer_load_dwordx4 a[120:123], v12, s[88:91], s100 offen offset:0 sc1
  buffer_load_dwordx4 a[124:127], v12, s[88:91], s100 offen offset:1024 sc1
  L_tn5:
  s_mov_b32 s99, 0xc000
  s_and_b32 s100, s36, s99
  s_cmp_eq_u32 s100, s99
  s_cbranch_scc0 L_tn6
  s_or_b32 s38, s38, s99
  s_add_u32 s100, s29, 229376
  buffer_load_dwordx4 a[128:131], v12, s[88:91], s100 offen offset:0 sc1
  buffer_load_dwordx4 a[132:135], v12, s[88:91], s100 offen offset:1024 sc1
  s_add_u32 s100, s100, 16384
  buffer_load_dwordx4 a[136:139], v12, s[88:91], s100 offen offset:0 sc1
  buffer_load_dwordx4 a[140:143], v12, s[88:91], s100 offen offset:1024 sc1
  L_tn6:
  s_xor_b32 s99, s96, 1
  s_lshl_b32 s99, 1, s99
  s_and_b32 s100, s36, s99
  s_cmp_eq_u32 s100, s99
  s_cbranch_scc0 L_tn7
  s_or_b32 s38, s38, s99
  s_xor_b32 s100, s96, 1
  s_mul_i32 s100, s100, 16384
  s_add_u32 s100, s100, s29
  buffer_load_dwordx4 a[144:147], v12, s[88:91], s100 offen offset:0 sc1
  buffer_load_dwordx4 a[148:151], v12, s[88:91], s100 offen offset:1024 sc1
  L_tn7:
  buffer_load_dword v14, v13, s[88:91], s39 offen sc1
  s_or_b32 s37, s37, s38
  L_tacc:
  s_lshr_b32 s99, s19, 6
  s_lshl_b32 s99, 3, s99
  s_and_b32 s100, s42, s99
  s_cbranch_scc0 L_tm0
  v_mfma_f32_32x32x16_bf16 v[32:47], v[96:99], a[32:35], v[32:47]
  v_mfma_f32_32x32x16_bf16 v[32:47], v[100:103], a[36:39], v[32:47]
  v_mfma_f32_32x32x16_bf16 v[32:47], v[96:99], a[40:43], v[32:47]
  v_mfma_f32_32x32x16_bf16 v[32:47], v[100:103], a[44:47], v[32:47]
  L_tm0:
  s_lshr_b32 s99, s18, 6
  s_lshl_b32 s99, 3, s99
  s_and_b32 s100, s42, s99
  s_cbranch_scc0 L_tm1
  v_mfma_f32_32x32x16_bf16 v[32:47], v[96:99], a[48:51], v[32:47]
  v_mfma_f32_32x32x16_bf16 v[32:47], v[100:103], a[52:55], v[32:47]
  v_mfma_f32_32x32x16_bf16 v[32:47], v[96:99], a[56:59], v[32:47]
  v_mfma_f32_32x32x16_bf16 v[32:47], v[100:103], a[60:63], v[32:47]
  L_tm1:
  s_lshr_b32 s99, s17, 6
  s_lshl_b32 s99, 3, s99
  s_and_b32 s100, s42, s99
  s_cbranch_scc0 L_tm2
  v_mfma_f32_32x32x16_bf16 v[32:47], v[96:99], a[64:67], v[32:47]
  v_mfma_f32_32x32x16_bf16 v[32:47], v[100:103], a[68:71], v[32:47]
  v_mfma_f32_32x32x16_bf16 v[32:47], v[96:99], a[72:75], v[32:47]
  v_mfma_f32_32x32x16_bf16 v[32:47], v[100:103], a[76:79], v[32:47]
  L_tm2:
  s_lshr_b32 s99, s16, 6
  s_lshl_b32 s99, 3, s99
  s_and_b32 s100, s42, s99
  s_cbranch_scc0 L_tm3
  v_mfma_f32_32x32x16_bf16 v[32:47], v[96:99], a[80:83], v[32:47]
  v_mfma_f32_32x32x16_bf16 v[32:47], v[100:103], a[84:87], v[32:47]
  v_mfma_f32_32x32x16_bf16 v[32:47], v[96:99], a[88:91], v[32:47]
  v_mfma_f32_32x32x16_bf16 v[32:47], v[100:103], a[92:95], v[32:47]
  L_tm3:
  s_lshr_b32 s99, s15, 6
  s_lshl_b32 s99, 3, s99
  s_and_b32 s100, s42, s99
  s_cbranch_scc0 L_tm4
  v_mfma_f32_32x32x16_bf16 v[32:47], v[96:99], a[96:99], v[32:47]
  v_mfma_f32_32x32x16_bf16 v[32:47], v[100:103], a[100:103], v[32:47]
  v_mfma_f32_32x32x16_bf16 v[32:47], v[96:99], a[104:107], v[32:47]
  v_mfma_f32_32x32x16_bf16 v[32:47], v[100:103], a[108:111], v[32:47]
  L_tm4:
  s_lshr_b32 s99, s14, 6
  s_lshl_b32 s99, 3, s99
  s_and_b32 s100, s42, s99
  s_cbranch_scc0 L_tm5
  v_mfma_f32_32x32x16_bf16 v[32:47], v[96:99], a[112:115], v[32:47]
  v_mfma_f32_32x32x16_bf16 v[32:47], v[100:103], a[116:119], v[32:47]
  v_mfma_f32_32x32x16_bf16 v[32:47], v[96:99], a[120:123], v[32:47]
  v_mfma_f32_32x32x16_bf16 v[32:47], v[100:103], a[124:127], v[32:47]
  L_tm5:
  s_mov_b32 s99, 0xc000
  s_and_b32 s100, s42, s99
  s_cbranch_scc0 L_tm6
  v_mfma_f32_32x32x16_bf16 v[32:47], v[96:99], a[128:131], v[32:47]
  v_mfma_f32_32x32x16_bf16 v[32:47], v[100:103], a[132:135], v[32:47]
  v_mfma_f32_32x32x16_bf16 v[32:47], v[96:99], a[136:139], v[32:47]
  v_mfma_f32_32x32x16_bf16 v[32:47], v[100:103], a[140:143], v[32:47]
  L_tm6:
  s_xor_b32 s99, s96, 1
  s_lshl_b32 s99, 1, s99
  s_and_b32 s100, s42, s99
  s_cbranch_scc0 L_tm7
  v_mfma_f32_32x32x16_bf16 v[32:47], v[96:99], a[144:147], v[32:47]
  v_mfma_f32_32x32x16_bf16 v[32:47], v[100:103], a[148:151], v[32:47]
  L_tm7:
  s_cmp_eq_u32 s0, 0
  s_cbranch_scc1 L_tdone
  s_mov_b32 s42, s38
  s_and_b32 s100, s37, 0xffff
  s_cmp_eq_u32 s100, 0xffff
  s_cbranch_scc1 L_tlast
  s_waitcnt vmcnt(0)
  s_sub_u32 s0, s0, 1
  s_cmp_gt_u32 s0, 1
  s_cbranch_scc1 L_tl
  L_tlast:
  s_waitcnt vmcnt(1)
  s_mov_b32 s0, 0
  s_branch L_tacc
  L_tdone:
  s_nop 11
  s_nop 2
  v_fma_f32 v32, v32, v112, v224
  v_fma_f32 v33, v33, v113, v225
  v_fma_f32 v34, v34, v114, v226
  v_fma_f32 v35, v35, v115, v227
  v_fma_f32 v36, v36, v116, v228
  v_fma_f32 v37, v37, v117, v229
  v_fma_f32 v38, v38, v118, v230
  v_fma_f32 v39, v39, v119, v231
  v_fma_f32 v40, v40, v120, v232
  v_fma_f32 v41, v41, v121, v233
  v_fma_f32 v42, v42, v122, v234
  v_fma_f32 v43, v43, v123, v235
  v_fma_f32 v44, v44, v124, v236
  v_fma_f32 v45, v45, v125, v237
  v_fma_f32 v46, v46, v126, v238
  v_fma_f32 v47, v47, v127, v239
  v_cvt_pk_bf16_f32 v32, v32, v33
  v_cvt_pk_bf16_f32 v33, v34, v35
  v_cvt_pk_bf16_f32 v34, v36, v37
  v_cvt_pk_bf16_f32 v35, v38, v39
  v_cvt_pk_bf16_f32 v36, v40, v41
  v_cvt_pk_bf16_f32 v37, v42, v43
  v_cvt_pk_bf16_f32 v38, v44, v45
  v_cvt_pk_bf16_f32 v39, v46, v47
  buffer_store_dwordx4 v[32:35], v104, s[68:71], 0 offen offset:0
  buffer_store_dwordx4 v[36:39], v104, s[68:71], 0 offen offset:32
  s_endpgm
L_spinNh:
  s_mov_b32 s0, 0x40000
L_loopNh:
  s_sleep 1
  buffer_load_dwordx2 v[14:15], off, s[92:95], s26 sc1
  s_waitcnt vmcnt(0)
  v_and_b32 v0, -7, v15
  v_cmp_ne_u32 vcc, v0, v14
  v_cmp_eq_u32 s[44:45], 0, v14
  s_nop 1
  s_or_b64 vcc, vcc, s[44:45]
  s_cbranch_vccz L_backNh
  s_sub_u32 s0, s0, 1
  s_cmp_lg_u32 s0, 0
  s_cbranch_scc1 L_loopNh
  s_branch L_backNh
L_spin0:
  s_mov_b32 s0, 0x40000
L_loop0:
  s_sleep 1
  buffer_load_dword v14, v13, s[88:91], s1 offen offset:0 sc1
  s_waitcnt vmcnt(0)
  v_cmp_ne_u32 vcc, s26, v14
  s_cbranch_vccz L_back0
  s_sub_u32 s0, s0, 1
  s_cmp_lg_u32 s0, 0
  s_cbranch_scc1 L_loop0
  s_branch L_back0
.p2align 12
L_light:
L_padl0:
  s_cbranch_execz L_padl4
  s_waitcnt lgkmcnt(12)
  v_mfma_f32_32x32x16_bf16 v[128:143], a[0:3], v[16:19], 0
  s_add_u32 s26, s26, 1
  s_cmp_eq_u32 s26, 7
  s_cselect_b32 s26, 0, s26
  s_lshl_b32 s7, s26, 19
  s_mul_i32 s8, s26, 229376
  s_add_u32 m0, s31, 49152
  s_add_u32 s0, s7, 0
  ds_read_b64_tr_b16 a[28:29], v3 offset:1792
  ds_read_b64_tr_b16 a[30:31], v3 offset:5888
  buffer_load_dwordx4 v1, s[36:39], s0 offen offset:0 lds
  s_waitcnt lgkmcnt(12)
  v_mfma_f32_32x32x16_bf16 v[144:159], a[4:7], v[16:19], 0
  ds_read_b64_tr_b16 a[0:1], v3 offset:2048
  ds_read_b64_tr_b16 a[2:3], v3 offset:6144
  v_lshlrev_b32 v8, 16, v20
  v_and_b32 v9, 0xffff0000, v20
  v_sub_f32 v8, v8, v5
  v_sub_f32 v9, v9, v5
  s_waitcnt lgkmcnt(12)
  v_mfma_f32_32x32x16_bf16 v[160:175], a[8:11], v[16:19], 0
  ds_read_b64_tr_b16 a[4:5], v3 offset:2304
  ds_read_b64_tr_b16 a[6:7], v3 offset:6400
  buffer_load_dwordx4 v1, s[40:43], s0 offen offset:1024 lds
  v_cvt_pk_bf16_f32 v20, v8, v9
  s_waitcnt lgkmcnt(6)
  v_mfma_f32_32x32x16_bf16 v[176:191], a[12:15], v[16:19], 0
  ds_read_b64_tr_b16 a[8:9], v3 offset:2560
  ds_read_b64_tr_b16 a[10:11], v3 offset:6656
  v_fmac_f32 v6, v8, v8
  v_fmac_f32 v7, v9, v9
  v_lshlrev_b32 v10, 16, v21
  v_and_b32 v11, 0xffff0000, v21
  v_mfma_f32_32x32x16_bf16 v[192:207], a[16:19], v[16:19], 0
  s_add_u32 s0, s7, 129024
  ds_read_b64_tr_b16 a[12:13], v3 offset:2816
  ds_read_b64_tr_b16 a[14:15], v3 offset:6912
  buffer_load_dwordx4 v1, s[36:39], s0 offen offset:2048 lds
  v_mfma_f32_32x32x16_bf16 v[208:223], a[20:23], v[16:19], 0
  ds_read_b64_tr_b16 a[16:17], v3 offset:3072
  ds_read_b64_tr_b16 a[18:19], v3 offset:7168
  v_sub_f32 v10, v10, v5
  v_sub_f32 v11, v11, v5
  v_cvt_pk_bf16_f32 v21, v10, v11
  v_fmac_f32 v6, v10, v10
  v_mfma_f32_32x32x16_bf16 v[224:239], a[24:27], v[16:19], 0
  ds_read_b64_tr_b16 a[20:21], v3 offset:3328
  ds_read_b64_tr_b16 a[22:23], v3 offset:7424
  buffer_load_dwordx4 v1, s[40:43], s0 offen offset:3072 lds
  v_fmac_f32 v7, v11, v11
  s_waitcnt lgkmcnt(6)
  v_mfma_f32_32x32x16_bf16 v[240:255], a[28:31], v[16:19], 0
  ds_read_b64_tr_b16 a[24:25], v3 offset:3584
  ds_read_b64_tr_b16 a[26:27], v3 offset:7680
  v_lshlrev_b32 v12, 16, v22
  v_and_b32 v13, 0xffff0000, v22
  v_sub_f32 v12, v12, v5
  v_sub_f32 v13, v13, v5
  v_cvt_pk_bf16_f32 v22, v12, v13
  v_fmac_f32 v6, v12, v12
  v_fmac_f32 v7, v13, v13
  v_lshlrev_b32 v14, 16, v23
  v_and_b32 v15, 0xffff0000, v23
  v_sub_f32 v14, v14, v5
  v_sub_f32 v15, v15, v5
  v_cvt_pk_bf16_f32 v23, v14, v15
  v_fmac_f32 v6, v14, v14
  v_fmac_f32 v7, v15, v15
  v_mfma_f32_32x32x16_bf16 v[128:143], a[0:3], v[20:23], v[128:143]
  s_add_u32 m0, s31, 65536
  s_add_u32 s0, s7, 262144
  ds_read_b64_tr_b16 a[28:29], v3 offset:3840
  ds_read_b64_tr_b16 a[30:31], v3 offset:7936
  buffer_load_dwordx4 v1, s[36:39], s0 offen offset:0 lds
  v_mfma_f32_32x32x16_bf16 v[144:159], a[4:7], v[20:23], v[144:159]
  s_waitcnt vmcnt(14)
  s_barrier
  ds_read_b64_tr_b16 a[0:1], v3 offset:16384
  ds_read_b64_tr_b16 a[2:3], v3 offset:20480
  v_lshlrev_b32 v8, 16, v24
  v_and_b32 v9, 0xffff0000, v24
  v_mfma_f32_32x32x16_bf16 v[160:175], a[8:11], v[20:23], v[160:175]
  ds_read_b64_tr_b16 a[4:5], v3 offset:16640
  ds_read_b64_tr_b16 a[6:7], v3 offset:20736
  buffer_load_dwordx4 v1, s[40:43], s0 offen offset:1024 lds
  v_sub_f32 v8, v8, v5
  s_waitcnt lgkmcnt(6)
  v_mfma_f32_32x32x16_bf16 v[176:191], a[12:15], v[20:23], v[176:191]
  ds_read_b64_tr_b16 a[8:9], v3 offset:16896
  ds_read_b64_tr_b16 a[10:11], v3 offset:20992
  v_sub_f32 v9, v9, v5
  v_cvt_pk_bf16_f32 v24, v8, v9
  v_fmac_f32 v6, v8, v8
  v_fmac_f32 v7, v9, v9
  v_mfma_f32_32x32x16_bf16 v[192:207], a[16:19], v[20:23], v[192:207]
  s_add_u32 s0, s7, 391168
  ds_read_b64_tr_b16 a[12:13], v3 offset:17152
  ds_read_b64_tr_b16 a[14:15], v3 offset:21248
  buffer_load_dwordx4 v1, s[36:39], s0 offen offset:2048 lds
  v_mfma_f32_32x32x16_bf16 v[208:223], a[20:23], v[20:23], v[208:223]
  ds_read_b64_tr_b16 a[16:17], v3 offset:17408
  ds_read_b64_tr_b16 a[18:19], v3 offset:21504
  v_lshlrev_b32 v10, 16, v25
  v_and_b32 v11, 0xffff0000, v25
  v_sub_f32 v10, v10, v5
  v_sub_f32 v11, v11, v5
  v_mfma_f32_32x32x16_bf16 v[224:239], a[24:27], v[20:23], v[224:239]
  ds_read_b64_tr_b16 a[20:21], v3 offset:17664
  ds_read_b64_tr_b16 a[22:23], v3 offset:21760
  buffer_load_dwordx4 v1, s[40:43], s0 offen offset:3072 lds
  v_cvt_pk_bf16_f32 v25, v10, v11
  s_waitcnt lgkmcnt(6)
  v_mfma_f32_32x32x16_bf16 v[240:255], a[28:31], v[20:23], v[240:255]
  ds_read_b64_tr_b16 a[24:25], v3 offset:17920
  ds_read_b64_tr_b16 a[26:27], v3 offset:22016
  v_fmac_f32 v6, v10, v10
  v_fmac_f32 v7, v11, v11
  v_lshlrev_b32 v12, 16, v26
  v_and_b32 v13, 0xffff0000, v26
  v_sub_f32 v12, v12, v5
  v_sub_f32 v13, v13, v5
  v_cvt_pk_bf16_f32 v26, v12, v13
  v_fmac_f32 v6, v12, v12
  v_fmac_f32 v7, v13, v13
  v_lshlrev_b32 v14, 16, v27
  v_and_b32 v15, 0xffff0000, v27
  v_sub_f32 v14, v14, v5
  v_sub_f32 v15, v15, v5
  v_cvt_pk_bf16_f32 v27, v14, v15
  v_fmac_f32 v6, v14, v14
  v_fmac_f32 v7, v15, v15
  v_mfma_f32_32x32x16_bf16 v[128:143], a[0:3], v[24:27], v[128:143]
  s_add_u32 s26, s26, 1
  s_cmp_eq_u32 s26, 7
  s_cselect_b32 s26, 0, s26
  s_lshl_b32 s7, s26, 19
  s_mul_i32 s8, s26, 229376
  s_add_u32 m0, s31, 81920
  s_add_u32 s0, s7, 0
  ds_read_b64_tr_b16 a[28:29], v3 offset:18176
  ds_read_b64_tr_b16 a[30:31], v3 offset:22272
  buffer_load_dwordx4 v1, s[36:39], s0 offen offset:0 lds
  v_mfma_f32_32x32x16_bf16 v[144:159], a[4:7], v[24:27], v[144:159]
  ds_read_b64_tr_b16 a[0:1], v3 offset:18432
  ds_read_b64_tr_b16 a[2:3], v3 offset:22528
  v_lshlrev_b32 v8, 16, v28
  v_and_b32 v9, 0xffff0000, v28
  v_sub_f32 v8, v8, v5
  v_sub_f32 v9, v9, v5
  v_mfma_f32_32x32x16_bf16 v[160:175], a[8:11], v[24:27], v[160:175]
  ds_read_b64_tr_b16 a[4:5], v3 offset:18688
  ds_read_b64_tr_b16 a[6:7], v3 offset:22784
  buffer_load_dwordx4 v1, s[40:43], s0 offen offset:1024 lds
  v_cvt_pk_bf16_f32 v28, v8, v9
  s_waitcnt lgkmcnt(6)
  v_mfma_f32_32x32x16_bf16 v[176:191], a[12:15], v[24:27], v[176:191]
  ds_read_b64_tr_b16 a[8:9], v3 offset:18944
  ds_read_b64_tr_b16 a[10:11], v3 offset:23040
  v_fmac_f32 v6, v8, v8
  v_fmac_f32 v7, v9, v9
  v_lshlrev_b32 v10, 16, v29
  v_and_b32 v11, 0xffff0000, v29
  v_mfma_f32_32x32x16_bf16 v[192:207], a[16:19], v[24:27], v[192:207]
  s_add_u32 s0, s7, 129024
  ds_read_b64_tr_b16 a[12:13], v3 offset:19200
  ds_read_b64_tr_b16 a[14:15], v3 offset:23296
  buffer_load_dwordx4 v1, s[36:39], s0 offen offset:2048 lds
  v_mfma_f32_32x32x16_bf16 v[208:223], a[20:23], v[24:27], v[208:223]
  ds_read_b64_tr_b16 a[16:17], v3 offset:19456
  ds_read_b64_tr_b16 a[18:19], v3 offset:23552
  v_sub_f32 v10, v10, v5
  v_sub_f32 v11, v11, v5
  v_cvt_pk_bf16_f32 v29, v10, v11
  v_fmac_f32 v6, v10, v10
  v_mfma_f32_32x32x16_bf16 v[224:239], a[24:27], v[24:27], v[224:239]
  ds_read_b64_tr_b16 a[20:21], v3 offset:19712
  ds_read_b64_tr_b16 a[22:23], v3 offset:23808
  buffer_load_dwordx4 v1, s[40:43], s0 offen offset:3072 lds
  v_fmac_f32 v7, v11, v11
  s_waitcnt lgkmcnt(6)
  v_mfma_f32_32x32x16_bf16 v[240:255], a[28:31], v[24:27], v[240:255]
  ds_read_b64_tr_b16 a[24:25], v3 offset:19968
  ds_read_b64_tr_b16 a[26:27], v3 offset:24064
  v_lshlrev_b32 v12, 16, v30
  v_and_b32 v13, 0xffff0000, v30
  v_sub_f32 v12, v12, v5
  v_sub_f32 v13, v13, v5
  v_cvt_pk_bf16_f32 v30, v12, v13
  v_fmac_f32 v6, v12, v12
  v_fmac_f32 v7, v13, v13
  v_lshlrev_b32 v14, 16, v31
  v_and_b32 v15, 0xffff0000, v31
  v_sub_f32 v14, v14, v5
  v_sub_f32 v15, v15, v5
  v_cvt_pk_bf16_f32 v31, v14, v15
  v_fmac_f32 v6, v14, v14
  v_fmac_f32 v7, v15, v15
  v_mfma_f32_32x32x16_bf16 v[128:143], a[0:3], v[28:31], v[128:143]
  s_add_u32 m0, s31, 98304
  s_add_u32 s0, s7, 262144
  ds_read_b64_tr_b16 a[28:29], v3 offset:20224
  ds_read_b64_tr_b16 a[30:31], v3 offset:24320
  buffer_load_dwordx4 v1, s[36:39], s0 offen offset:0 lds
  v_mfma_f32_32x32x16_bf16 v[144:159], a[4:7], v[28:31], v[144:159]
  s_waitcnt vmcnt(5)
  s_barrier
  ds_read_b64_tr_b16 a[0:1], v3 offset:49152
  ds_read_b64_tr_b16 a[2:3], v3 offset:53248
  v_accvgpr_read_b32 v0, a250
  v_lshlrev_b32 v8, 16, v32
  v_mfma_f32_32x32x16_bf16 v[160:175], a[8:11], v[28:31], v[160:175]
  ds_read_b64_tr_b16 a[4:5], v3 offset:49408
  ds_read_b64_tr_b16 a[6:7], v3 offset:53504
  buffer_load_dwordx4 v1, s[40:43], s0 offen offset:1024 lds
  v_and_b32 v9, 0xffff0000, v32
  s_waitcnt lgkmcnt(6)
  v_mfma_f32_32x32x16_bf16 v[176:191], a[12:15], v[28:31], v[176:191]
  ds_read_b64_tr_b16 a[8:9], v3 offset:49664
  ds_read_b64_tr_b16 a[10:11], v3 offset:53760
  buffer_load_dword a252, v0, s[32:35], 0 offen offset:0
  v_sub_f32 v8, v8, v5
  v_sub_f32 v9, v9, v5
  v_mfma_f32_32x32x16_bf16 v[192:207], a[16:19], v[28:31], v[192:207]
  s_add_u32 s0, s7, 391168
  ds_read_b64_tr_b16 a[12:13], v3 offset:49920
  ds_read_b64_tr_b16 a[14:15], v3 offset:54016
  buffer_load_dwordx4 v1, s[36:39], s0 offen offset:2048 lds
  v_mfma_f32_32x32x16_bf16 v[208:223], a[20:23], v[28:31], v[208:223]
  ds_read_b64_tr_b16 a[16:17], v3 offset:50176
  ds_read_b64_tr_b16 a[18:19], v3 offset:54272
  v_cvt_pk_bf16_f32 v32, v8, v9
  v_fmac_f32 v6, v8, v8
  v_fmac_f32 v7, v9, v9
  v_lshlrev_b32 v10, 16, v33
  v_mfma_f32_32x32x16_bf16 v[224:239], a[24:27], v[28:31], v[224:239]
  ds_read_b64_tr_b16 a[20:21], v3 offset:50432
  ds_read_b64_tr_b16 a[22:23], v3 offset:54528
  buffer_load_dwordx4 v1, s[40:43], s0 offen offset:3072 lds
  v_and_b32 v11, 0xffff0000, v33
  s_waitcnt lgkmcnt(6)
  v_mfma_f32_32x32x16_bf16 v[240:255], a[28:31], v[28:31], v[240:255]
  ds_read_b64_tr_b16 a[24:25], v3 offset:50688
  ds_read_b64_tr_b16 a[26:27], v3 offset:54784
  v_sub_f32 v10, v10, v5
  v_sub_f32 v11, v11, v5
  v_cvt_pk_bf16_f32 v33, v10, v11
  v_fmac_f32 v6, v10, v10
  v_fmac_f32 v7, v11, v11
  v_lshlrev_b32 v12, 16, v34
  v_and_b32 v13, 0xffff0000, v34
  v_sub_f32 v12, v12, v5
  v_sub_f32 v13, v13, v5
  v_cvt_pk_bf16_f32 v34, v12, v13
  v_fmac_f32 v6, v12, v12
  v_fmac_f32 v7, v13, v13
  v_lshlrev_b32 v14, 16, v35
  v_and_b32 v15, 0xffff0000, v35
  v_sub_f32 v14, v14, v5
  v_sub_f32 v15, v15, v5
  v_cvt_pk_bf16_f32 v35, v14, v15
  v_fmac_f32 v6, v14, v14
  v_fmac_f32 v7, v15, v15
  v_mfma_f32_32x32x16_bf16 v[128:143], a[0:3], v[32:35], v[128:143]
  s_add_u32 s26, s26, 1
  s_cmp_eq_u32 s26, 7
  s_cselect_b32 s26, 0, s26
  s_lshl_b32 s7, s26, 19
  s_mul_i32 s8, s26, 229376
  s_add_u32 m0, s31, 114688
  s_add_u32 s0, s7, 0
  ds_read_b64_tr_b16 a[28:29], v3 offset:50944
  ds_read_b64_tr_b16 a[30:31], v3 offset:55040
  buffer_load_dwordx4 v1, s[36:39], s0 offen offset:0 lds
  v_mfma_f32_32x32x16_bf16 v[144:159], a[4:7], v[32:35], v[144:159]
  ds_read_b64_tr_b16 a[0:1], v3 offset:51200
  ds_read_b64_tr_b16 a[2:3], v3 offset:55296
  v_lshlrev_b32 v8, 16, v36
  v_and_b32 v9, 0xffff0000, v36
  v_sub_f32 v8, v8, v5
  v_sub_f32 v9, v9, v5
  v_mfma_f32_32x32x16_bf16 v[160:175], a[8:11], v[32:35], v[160:175]
  ds_read_b64_tr_b16 a[4:5], v3 offset:51456
  ds_read_b64_tr_b16 a[6:7], v3 offset:55552
  buffer_load_dwordx4 v1, s[40:43], s0 offen offset:1024 lds
  v_cvt_pk_bf16_f32 v36, v8, v9
  s_waitcnt lgkmcnt(6)
  v_mfma_f32_32x32x16_bf16 v[176:191], a[12:15], v[32:35], v[176:191]
  ds_read_b64_tr_b16 a[8:9], v3 offset:51712
  ds_read_b64_tr_b16 a[10:11], v3 offset:55808
  v_fmac_f32 v6, v8, v8
  v_fmac_f32 v7, v9, v9
  v_lshlrev_b32 v10, 16, v37
  v_and_b32 v11, 0xffff0000, v37
  v_mfma_f32_32x32x16_bf16 v[192:207], a[16:19], v[32:35], v[192:207]
  s_add_u32 s0, s7, 129024
  ds_read_b64_tr_b16 a[12:13], v3 offset:51968
  ds_read_b64_tr_b16 a[14:15], v3 offset:56064
  buffer_load_dwordx4 v1, s[36:39], s0 offen offset:2048 lds
  v_mfma_f32_32x32x16_bf16 v[208:223], a[20:23], v[32:35], v[208:223]
  ds_read_b64_tr_b16 a[16:17], v3 offset:52224
  ds_read_b64_tr_b16 a[18:19], v3 offset:56320
  v_sub_f32 v10, v10, v5
  v_sub_f32 v11, v11, v5
  v_cvt_pk_bf16_f32 v37, v10, v11
  v_fmac_f32 v6, v10, v10
  v_mfma_f32_32x32x16_bf16 v[224:239], a[24:27], v[32:35], v[224:239]
  ds_read_b64_tr_b16 a[20:21], v3 offset:52480
  ds_read_b64_tr_b16 a[22:23], v3 offset:56576
  buffer_load_dwordx4 v1, s[40:43], s0 offen offset:3072 lds
  v_fmac_f32 v7, v11, v11
  s_waitcnt lgkmcnt(6)
  v_mfma_f32_32x32x16_bf16 v[240:255], a[28:31], v[32:35], v[240:255]
  ds_read_b64_tr_b16 a[24:25], v3 offset:52736
  ds_read_b64_tr_b16 a[26:27], v3 offset:56832
  v_lshlrev_b32 v12, 16, v38
  v_and_b32 v13, 0xffff0000, v38
  v_sub_f32 v12, v12, v5
  v_sub_f32 v13, v13, v5
  v_cvt_pk_bf16_f32 v38, v12, v13
  v_fmac_f32 v6, v12, v12
  v_fmac_f32 v7, v13, v13
  v_lshlrev_b32 v14, 16, v39
  v_and_b32 v15, 0xffff0000, v39
  v_sub_f32 v14, v14, v5
  v_sub_f32 v15, v15, v5
  v_cvt_pk_bf16_f32 v39, v14, v15
  v_fmac_f32 v6, v14, v14
  v_fmac_f32 v7, v15, v15
  v_mfma_f32_32x32x16_bf16 v[128:143], a[0:3], v[36:39], v[128:143]
  s_add_u32 m0, s31, 131072
  s_add_u32 s0, s7, 262144
  ds_read_b64_tr_b16 a[28:29], v3 offset:52992
  ds_read_b64_tr_b16 a[30:31], v3 offset:57088
  buffer_load_dwordx4 v1, s[36:39], s0 offen offset:0 lds
  v_add_u32 v3, 0x00010000, v3
  v_mfma_f32_32x32x16_bf16 v[144:159], a[4:7], v[36:39], v[144:159]
  ds_read_b64_tr_b16 a[0:1], v3 offset:0
  ds_read_b64_tr_b16 a[2:3], v3 offset:4096
  v_lshlrev_b32 v8, 16, v40
  v_and_b32 v9, 0xffff0000, v40
  v_sub_f32 v8, v8, v5
  v_sub_f32 v9, v9, v5
  v_mfma_f32_32x32x16_bf16 v[160:175], a[8:11], v[36:39], v[160:175]
  ds_read_b64_tr_b16 a[4:5], v3 offset:256
  ds_read_b64_tr_b16 a[6:7], v3 offset:4352
  buffer_load_dwordx4 v1, s[40:43], s0 offen offset:1024 lds
  v_cvt_pk_bf16_f32 v40, v8, v9
  s_waitcnt lgkmcnt(6)
  v_mfma_f32_32x32x16_bf16 v[176:191], a[12:15], v[36:39], v[176:191]
  ds_read_b64_tr_b16 a[8:9], v3 offset:512
  ds_read_b64_tr_b16 a[10:11], v3 offset:4608
  v_fmac_f32 v6, v8, v8
  v_fmac_f32 v7, v9, v9
  v_lshlrev_b32 v10, 16, v41
  v_and_b32 v11, 0xffff0000, v41
  v_mfma_f32_32x32x16_bf16 v[192:207], a[16:19], v[36:39], v[192:207]
  s_add_u32 s0, s7, 391168
  ds_read_b64_tr_b16 a[12:13], v3 offset:768
  ds_read_b64_tr_b16 a[14:15], v3 offset:4864
  buffer_load_dwordx4 v1, s[36:39], s0 offen offset:2048 lds
  v_mfma_f32_32x32x16_bf16 v[208:223], a[20:23], v[36:39], v[208:223]
  ds_read_b64_tr_b16 a[16:17], v3 offset:1024
  ds_read_b64_tr_b16 a[18:19], v3 offset:5120
  v_sub_f32 v10, v10, v5
  v_sub_f32 v11, v11, v5
  v_cvt_pk_bf16_f32 v41, v10, v11
  v_fmac_f32 v6, v10, v10
  v_mfma_f32_32x32x16_bf16 v[224:239], a[24:27], v[36:39], v[224:239]
  ds_read_b64_tr_b16 a[20:21], v3 offset:1280
  ds_read_b64_tr_b16 a[22:23], v3 offset:5376
  buffer_load_dwordx4 v1, s[40:43], s0 offen offset:3072 lds
  v_fmac_f32 v7, v11, v11
  s_waitcnt lgkmcnt(6)
  v_mfma_f32_32x32x16_bf16 v[240:255], a[28:31], v[36:39], v[240:255]
  ds_read_b64_tr_b16 a[24:25], v3 offset:1536
  ds_read_b64_tr_b16 a[26:27], v3 offset:5632
  v_lshlrev_b32 v12, 16, v42
  v_and_b32 v13, 0xffff0000, v42
  v_sub_f32 v12, v12, v5
  v_sub_f32 v13, v13, v5
  v_cvt_pk_bf16_f32 v42, v12, v13
  v_fmac_f32 v6, v12, v12
  v_fmac_f32 v7, v13, v13
  v_lshlrev_b32 v14, 16, v43
  v_and_b32 v15, 0xffff0000, v43
  v_sub_f32 v14, v14, v5
  v_sub_f32 v15, v15, v5
  v_cvt_pk_bf16_f32 v43, v14, v15
  v_fmac_f32 v6, v14, v14
  v_fmac_f32 v7, v15, v15
  v_mfma_f32_32x32x16_bf16 v[128:143], a[0:3], v[40:43], v[128:143]
  s_add_u32 s26, s26, 1
  s_cmp_eq_u32 s26, 7
  s_cselect_b32 s26, 0, s26
  s_lshl_b32 s7, s26, 19
  s_mul_i32 s8, s26, 229376
  s_add_u32 m0, s31, 147456
  s_add_u32 s0, s7, 0
  ds_read_b64_tr_b16 a[28:29], v3 offset:1792
  ds_read_b64_tr_b16 a[30:31], v3 offset:5888
  buffer_load_dwordx4 v1, s[36:39], s0 offen offset:0 lds
  v_mfma_f32_32x32x16_bf16 v[144:159], a[4:7], v[40:43], v[144:159]
  ds_read_b64_tr_b16 a[0:1], v3 offset:2048
  ds_read_b64_tr_b16 a[2:3], v3 offset:6144
  v_lshlrev_b32 v8, 16, v44
  v_and_b32 v9, 0xffff0000, v44
  v_sub_f32 v8, v8, v5
  v_sub_f32 v9, v9, v5
  v_mfma_f32_32x32x16_bf16 v[160:175], a[8:11], v[40:43], v[160:175]
  ds_read_b64_tr_b16 a[4:5], v3 offset:2304
  ds_read_b64_tr_b16 a[6:7], v3 offset:6400
  buffer_load_dwordx4 v1, s[40:43], s0 offen offset:1024 lds
  v_cvt_pk_bf16_f32 v44, v8, v9
  s_waitcnt lgkmcnt(6)
  v_mfma_f32_32x32x16_bf16 v[176:191], a[12:15], v[40:43], v[176:191]
  ds_read_b64_tr_b16 a[8:9], v3 offset:2560
  ds_read_b64_tr_b16 a[10:11], v3 offset:6656
  v_fmac_f32 v6, v8, v8
  v_fmac_f32 v7, v9, v9
  v_lshlrev_b32 v10, 16, v45
  v_and_b32 v11, 0xffff0000, v45
  v_mfma_f32_32x32x16_bf16 v[192:207], a[16:19], v[40:43], v[192:207]
  s_add_u32 s0, s7, 129024
  ds_read_b64_tr_b16 a[12:13], v3 offset:2816
  ds_read_b64_tr_b16 a[14:15], v3 offset:6912
  buffer_load_dwordx4 v1, s[36:39], s0 offen offset:2048 lds
  v_mfma_f32_32x32x16_bf16 v[208:223], a[20:23], v[40:43], v[208:223]
  ds_read_b64_tr_b16 a[16:17], v3 offset:3072
  ds_read_b64_tr_b16 a[18:19], v3 offset:7168
  v_sub_f32 v10, v10, v5
  v_sub_f32 v11, v11, v5
  v_cvt_pk_bf16_f32 v45, v10, v11
  v_fmac_f32 v6, v10, v10
  v_mfma_f32_32x32x16_bf16 v[224:239], a[24:27], v[40:43], v[224:239]
  ds_read_b64_tr_b16 a[20:21], v3 offset:3328
  ds_read_b64_tr_b16 a[22:23], v3 offset:7424
  buffer_load_dwordx4 v1, s[40:43], s0 offen offset:3072 lds
  v_fmac_f32 v7, v11, v11
  s_waitcnt lgkmcnt(6)
  v_mfma_f32_32x32x16_bf16 v[240:255], a[28:31], v[40:43], v[240:255]
  ds_read_b64_tr_b16 a[24:25], v3 offset:3584
  ds_read_b64_tr_b16 a[26:27], v3 offset:7680
  v_lshlrev_b32 v12, 16, v46
  v_and_b32 v13, 0xffff0000, v46
  v_sub_f32 v12, v12, v5
  v_sub_f32 v13, v13, v5
  v_cvt_pk_bf16_f32 v46, v12, v13
  v_fmac_f32 v6, v12, v12
  v_fmac_f32 v7, v13, v13
  v_lshlrev_b32 v14, 16, v47
  v_and_b32 v15, 0xffff0000, v47
  v_sub_f32 v14, v14, v5
  v_sub_f32 v15, v15, v5
  v_cvt_pk_bf16_f32 v47, v14, v15
  v_fmac_f32 v6, v14, v14
  v_fmac_f32 v7, v15, v15
  v_mfma_f32_32x32x16_bf16 v[128:143], a[0:3], v[44:47], v[128:143]
  s_add_u32 m0, s31, 0
  s_add_u32 s0, s7, 262144
  ds_read_b64_tr_b16 a[28:29], v3 offset:3840
  ds_read_b64_tr_b16 a[30:31], v3 offset:7936
  buffer_load_dwordx4 v1, s[36:39], s0 offen offset:0 lds
  v_mfma_f32_32x32x16_bf16 v[144:159], a[4:7], v[44:47], v[144:159]
  s_waitcnt vmcnt(13)
  s_barrier
  ds_read_b64_tr_b16 a[0:1], v3 offset:16384
  ds_read_b64_tr_b16 a[2:3], v3 offset:20480
  v_accvgpr_read_b32 v0, a250
  v_lshlrev_b32 v8, 16, v48
  buffer_load_dword a253, v0, s[32:35], 0 offen offset:3584
  v_mfma_f32_32x32x16_bf16 v[160:175], a[8:11], v[44:47], v[160:175]
  ds_read_b64_tr_b16 a[4:5], v3 offset:16640
  ds_read_b64_tr_b16 a[6:7], v3 offset:20736
  buffer_load_dwordx4 v1, s[40:43], s0 offen offset:1024 lds
  v_and_b32 v9, 0xffff0000, v48
  s_waitcnt lgkmcnt(6)
  v_mfma_f32_32x32x16_bf16 v[176:191], a[12:15], v[44:47], v[176:191]
  ds_read_b64_tr_b16 a[8:9], v3 offset:16896
  ds_read_b64_tr_b16 a[10:11], v3 offset:20992
  v_sub_f32 v8, v8, v5
  v_sub_f32 v9, v9, v5
  v_cvt_pk_bf16_f32 v48, v8, v9
  v_fmac_f32 v6, v8, v8
  v_mfma_f32_32x32x16_bf16 v[192:207], a[16:19], v[44:47], v[192:207]
  s_add_u32 s0, s7, 391168
  ds_read_b64_tr_b16 a[12:13], v3 offset:17152
  ds_read_b64_tr_b16 a[14:15], v3 offset:21248
  buffer_load_dwordx4 v1, s[36:39], s0 offen offset:2048 lds
  v_mfma_f32_32x32x16_bf16 v[208:223], a[20:23], v[44:47], v[208:223]
  ds_read_b64_tr_b16 a[16:17], v3 offset:17408
  ds_read_b64_tr_b16 a[18:19], v3 offset:21504
  v_fmac_f32 v7, v9, v9
  v_lshlrev_b32 v10, 16, v49
  v_and_b32 v11, 0xffff0000, v49
  v_sub_f32 v10, v10, v5
  v_mfma_f32_32x32x16_bf16 v[224:239], a[24:27], v[44:47], v[224:239]
  ds_read_b64_tr_b16 a[20:21], v3 offset:17664
  ds_read_b64_tr_b16 a[22:23], v3 offset:21760
  buffer_load_dwordx4 v1, s[40:43], s0 offen offset:3072 lds
  v_sub_f32 v11, v11, v5
  s_waitcnt lgkmcnt(6)
  v_mfma_f32_32x32x16_bf16 v[240:255], a[28:31], v[44:47], v[240:255]
  ds_read_b64_tr_b16 a[24:25], v3 offset:17920
  ds_read_b64_tr_b16 a[26:27], v3 offset:22016
  v_cvt_pk_bf16_f32 v49, v10, v11
  v_fmac_f32 v6, v10, v10
  v_fmac_f32 v7, v11, v11
  v_lshlrev_b32 v12, 16, v50
  v_and_b32 v13, 0xffff0000, v50
  v_sub_f32 v12, v12, v5
  v_sub_f32 v13, v13, v5
  v_cvt_pk_bf16_f32 v50, v12, v13
  v_fmac_f32 v6, v12, v12
  v_fmac_f32 v7, v13, v13
  v_lshlrev_b32 v14, 16, v51
  v_and_b32 v15, 0xffff0000, v51
  v_sub_f32 v14, v14, v5
  v_sub_f32 v15, v15, v5
  v_cvt_pk_bf16_f32 v51, v14, v15
  v_fmac_f32 v6, v14, v14
  v_fmac_f32 v7, v15, v15
  v_mfma_f32_32x32x16_bf16 v[128:143], a[0:3], v[48:51], v[128:143]
  ds_read_b64_tr_b16 a[28:29], v3 offset:18176
  ds_read_b64_tr_b16 a[30:31], v3 offset:22272
  s_cmp_eq_u32 s96, 14
  s_cbranch_scc0 L_noprobe2
  s_waitcnt vmcnt(0) lgkmcnt(0)
  s_barrier
  s_cmp_eq_u32 s3, 0
  s_cbranch_scc0 L_noprobe
  s_mov_b32 s32, 1
  s_mov_b32 s33, 0xffff
  s_mov_b32 s34, 0xffff
  s_add_u32 s35, s28, 0xffbfc000
  v_accvgpr_read_b32 v0, a246
  s_add_u32 s99, s35, 0x2000
  v_lshlrev_b32 v0, 2, v0
  s_nop 0
  buffer_store_dword v0, v0, s[88:91], s35 offen sc1
  buffer_store_dword v0, v0, s[88:91], s99 offen sc1
  s_waitcnt vmcnt(0)
  L_pr0:
  s_add_u32 s35, s35, 256
  s_memtime s[100:101]
  s_waitcnt lgkmcnt(0)
  s_mov_b32 s99, s100
  buffer_load_dword a253, off, s[88:91], s35 sc1
  s_waitcnt vmcnt(0)
  s_memtime s[100:101]
  s_waitcnt lgkmcnt(0)
  s_sub_u32 s99, s100, s99
  s_min_u32 s33, s33, s99
  s_xor_b32 s35, s35, 0x2000
  s_memtime s[100:101]
  s_waitcnt lgkmcnt(0)
  s_mov_b32 s99, s100
  buffer_load_dword a253, off, s[88:91], s35 sc1
  s_waitcnt vmcnt(0)
  s_memtime s[100:101]
  s_waitcnt lgkmcnt(0)
  s_sub_u32 s99, s100, s99
  s_min_u32 s34, s34, s99
  s_xor_b32 s35, s35, 0x2000
  s_sub_i32 s99, s33, s34
  s_abs_i32 s99, s99
  s_bfe_u32 s100, s35, 0x50008
  s_cmp_ge_u32 s99, 50
  s_cselect_b32 s99, 4, 8
  s_cmp_lt_u32 s100, s99
  s_cbranch_scc1 L_pr0
  s_cmp_lt_u32 s34, s33
  s_cselect_b32 s99, 6, 0
  s_or_b32 s32, s32, s99
  v_accvgpr_read_b32 v0, a251
  s_lshl_b32 s99, s97, 4
  v_or_b32 v0, s32, v0
  s_nop 0
  buffer_store_dword v0, off, s[92:95], s99 offset:4 sc1
  L_noprobe:
  s_barrier
  L_noprobe2:
  v_mfma_f32_32x32x16_bf16 v[144:159], a[4:7], v[48:51], v[144:159]
  ds_read_b64_tr_b16 a[0:1], v3 offset:18432
  ds_read_b64_tr_b16 a[2:3], v3 offset:22528
  v_lshlrev_b32 v8, 16, v52
  v_and_b32 v9, 0xffff0000, v52
  v_sub_f32 v8, v8, v5
  v_sub_f32 v9, v9, v5
  v_mfma_f32_32x32x16_bf16 v[160:175], a[8:11], v[48:51], v[160:175]
  s_add_u32 s26, s26, 1
  s_cmp_eq_u32 s26, 7
  s_cselect_b32 s26, 0, s26
  s_lshl_b32 s7, s26, 19
  s_mul_i32 s8, s26, 229376
  s_add_u32 m0, s31, 16384
  s_add_u32 s0, s7, 0
  ds_read_b64_tr_b16 a[4:5], v3 offset:18688
  ds_read_b64_tr_b16 a[6:7], v3 offset:22784
  buffer_load_dwordx4 v1, s[36:39], s0 offen offset:0 lds
  s_waitcnt lgkmcnt(6)
  v_mfma_f32_32x32x16_bf16 v[176:191], a[12:15], v[48:51], v[176:191]
  ds_read_b64_tr_b16 a[8:9], v3 offset:18944
  ds_read_b64_tr_b16 a[10:11], v3 offset:23040
  v_cvt_pk_bf16_f32 v52, v8, v9
  v_fmac_f32 v6, v8, v8
  v_fmac_f32 v7, v9, v9
  v_lshlrev_b32 v10, 16, v53
  v_mfma_f32_32x32x16_bf16 v[192:207], a[16:19], v[48:51], v[192:207]
  ds_read_b64_tr_b16 a[12:13], v3 offset:19200
  ds_read_b64_tr_b16 a[14:15], v3 offset:23296
  v_and_b32 v11, 0xffff0000, v53
  v_sub_f32 v10, v10, v5
  v_sub_f32 v11, v11, v5
  v_cvt_pk_bf16_f32 v53, v10, v11
  v_mfma_f32_32x32x16_bf16 v[208:223], a[20:23], v[48:51], v[208:223]
  ds_read_b64_tr_b16 a[16:17], v3 offset:19456
  ds_read_b64_tr_b16 a[18:19], v3 offset:23552
  v_fmac_f32 v6, v10, v10
  v_fmac_f32 v7, v11, v11
  v_lshlrev_b32 v12, 16, v54
  v_and_b32 v13, 0xffff0000, v54
  v_mfma_f32_32x32x16_bf16 v[224:239], a[24:27], v[48:51], v[224:239]
  ds_read_b64_tr_b16 a[20:21], v3 offset:19712
  ds_read_b64_tr_b16 a[22:23], v3 offset:23808
  buffer_load_dwordx4 v1, s[40:43], s0 offen offset:1024 lds
  v_sub_f32 v12, v12, v5
  s_waitcnt lgkmcnt(6)
  v_mfma_f32_32x32x16_bf16 v[240:255], a[28:31], v[48:51], v[240:255]
  ds_read_b64_tr_b16 a[24:25], v3 offset:19968
  ds_read_b64_tr_b16 a[26:27], v3 offset:24064
  v_sub_f32 v13, v13, v5
  v_cvt_pk_bf16_f32 v54, v12, v13
  v_fmac_f32 v6, v12, v12
  v_fmac_f32 v7, v13, v13
  v_lshlrev_b32 v14, 16, v55
  v_and_b32 v15, 0xffff0000, v55
  v_sub_f32 v14, v14, v5
  v_sub_f32 v15, v15, v5
  v_cvt_pk_bf16_f32 v55, v14, v15
  v_fmac_f32 v6, v14, v14
  v_fmac_f32 v7, v15, v15
  v_mfma_f32_32x32x16_bf16 v[128:143], a[0:3], v[52:55], v[128:143]
  ds_read_b64_tr_b16 a[28:29], v3 offset:20224
  ds_read_b64_tr_b16 a[30:31], v3 offset:24320
  v_lshlrev_b32 v8, 16, v56
  v_and_b32 v9, 0xffff0000, v56
  v_sub_f32 v8, v8, v5
  v_sub_f32 v9, v9, v5
  v_mfma_f32_32x32x16_bf16 v[144:159], a[4:7], v[52:55], v[144:159]
L_padl1:
  s_cbranch_execz L_padl5
  ds_read_b64_tr_b16 a[0:1], v3 offset:32768
  ds_read_b64_tr_b16 a[2:3], v3 offset:36864
  v_cvt_pk_bf16_f32 v56, v8, v9
  v_fmac_f32 v6, v8, v8
  v_fmac_f32 v7, v9, v9
  v_lshlrev_b32 v10, 16, v57
  v_mfma_f32_32x32x16_bf16 v[160:175], a[8:11], v[52:55], v[160:175]
  s_add_u32 s0, s7, 129024
  ds_read_b64_tr_b16 a[4:5], v3 offset:33024
  ds_read_b64_tr_b16 a[6:7], v3 offset:37120
  buffer_load_dwordx4 v1, s[36:39], s0 offen offset:2048 lds
  s_waitcnt lgkmcnt(6)
  v_mfma_f32_32x32x16_bf16 v[176:191], a[12:15], v[52:55], v[176:191]
  ds_read_b64_tr_b16 a[8:9], v3 offset:33280
  ds_read_b64_tr_b16 a[10:11], v3 offset:37376
  v_and_b32 v11, 0xffff0000, v57
  v_sub_f32 v10, v10, v5
  v_sub_f32 v11, v11, v5
  v_cvt_pk_bf16_f32 v57, v10, v11
  v_mfma_f32_32x32x16_bf16 v[192:207], a[16:19], v[52:55], v[192:207]
  ds_read_b64_tr_b16 a[12:13], v3 offset:33536
  ds_read_b64_tr_b16 a[14:15], v3 offset:37632
  v_fmac_f32 v6, v10, v10
  v_fmac_f32 v7, v11, v11
  v_lshlrev_b32 v12, 16, v58
  v_and_b32 v13, 0xffff0000, v58
  v_mfma_f32_32x32x16_bf16 v[208:223], a[20:23], v[52:55], v[208:223]
  ds_read_b64_tr_b16 a[16:17], v3 offset:33792
  ds_read_b64_tr_b16 a[18:19], v3 offset:37888
  v_sub_f32 v12, v12, v5
  v_sub_f32 v13, v13, v5
  v_cvt_pk_bf16_f32 v58, v12, v13
  v_fmac_f32 v6, v12, v12
  v_mfma_f32_32x32x16_bf16 v[224:239], a[24:27], v[52:55], v[224:239]
  ds_read_b64_tr_b16 a[20:21], v3 offset:34048
  ds_read_b64_tr_b16 a[22:23], v3 offset:38144
  buffer_load_dwordx4 v1, s[40:43], s0 offen offset:3072 lds
  v_fmac_f32 v7, v13, v13
  s_waitcnt lgkmcnt(6)
  v_mfma_f32_32x32x16_bf16 v[240:255], a[28:31], v[52:55], v[240:255]
  ds_read_b64_tr_b16 a[24:25], v3 offset:34304
  ds_read_b64_tr_b16 a[26:27], v3 offset:38400
  v_lshlrev_b32 v14, 16, v59
  v_and_b32 v15, 0xffff0000, v59
  v_sub_f32 v14, v14, v5
  v_sub_f32 v15, v15, v5
  v_cvt_pk_bf16_f32 v59, v14, v15
  v_fmac_f32 v6, v14, v14
  v_fmac_f32 v7, v15, v15
  v_mfma_f32_32x32x16_bf16 v[128:143], a[0:3], v[56:59], v[128:143]
  s_add_u32 m0, s31, 32768
  s_add_u32 s0, s7, 262144
  ds_read_b64_tr_b16 a[28:29], v3 offset:34560
  ds_read_b64_tr_b16 a[30:31], v3 offset:38656
  buffer_load_dwordx4 v1, s[36:39], s0 offen offset:0 lds
  v_mfma_f32_32x32x16_bf16 v[144:159], a[4:7], v[56:59], v[144:159]
  ds_read_b64_tr_b16 a[0:1], v3 offset:34816
  ds_read_b64_tr_b16 a[2:3], v3 offset:38912
  v_lshlrev_b32 v8, 16, v60
  v_and_b32 v9, 0xffff0000, v60
  v_sub_f32 v8, v8, v5
  v_sub_f32 v9, v9, v5
  v_mfma_f32_32x32x16_bf16 v[160:175], a[8:11], v[56:59], v[160:175]
  ds_read_b64_tr_b16 a[4:5], v3 offset:35072
  ds_read_b64_tr_b16 a[6:7], v3 offset:39168
  buffer_load_dwordx4 v1, s[40:43], s0 offen offset:1024 lds
  v_cvt_pk_bf16_f32 v60, v8, v9
  s_waitcnt lgkmcnt(6)
  v_mfma_f32_32x32x16_bf16 v[176:191], a[12:15], v[56:59], v[176:191]
  ds_read_b64_tr_b16 a[8:9], v3 offset:35328
  ds_read_b64_tr_b16 a[10:11], v3 offset:39424
  v_fmac_f32 v6, v8, v8
  v_fmac_f32 v7, v9, v9
  v_lshlrev_b32 v10, 16, v61
  v_and_b32 v11, 0xffff0000, v61
  v_mfma_f32_32x32x16_bf16 v[192:207], a[16:19], v[56:59], v[192:207]
  s_add_u32 s0, s7, 391168
  ds_read_b64_tr_b16 a[12:13], v3 offset:35584
  ds_read_b64_tr_b16 a[14:15], v3 offset:39680
  buffer_load_dwordx4 v1, s[36:39], s0 offen offset:2048 lds
  v_mfma_f32_32x32x16_bf16 v[208:223], a[20:23], v[56:59], v[208:223]
  ds_read_b64_tr_b16 a[16:17], v3 offset:35840
  ds_read_b64_tr_b16 a[18:19], v3 offset:39936
  v_sub_f32 v10, v10, v5
  v_sub_f32 v11, v11, v5
  v_cvt_pk_bf16_f32 v61, v10, v11
  v_fmac_f32 v6, v10, v10
  v_mfma_f32_32x32x16_bf16 v[224:239], a[24:27], v[56:59], v[224:239]
  ds_read_b64_tr_b16 a[20:21], v3 offset:36096
  ds_read_b64_tr_b16 a[22:23], v3 offset:40192
  buffer_load_dwordx4 v1, s[40:43], s0 offen offset:3072 lds
  v_fmac_f32 v7, v11, v11
  s_waitcnt lgkmcnt(6)
  v_mfma_f32_32x32x16_bf16 v[240:255], a[28:31], v[56:59], v[240:255]
  ds_read_b64_tr_b16 a[24:25], v3 offset:36352
  ds_read_b64_tr_b16 a[26:27], v3 offset:40448
  v_lshlrev_b32 v12, 16, v62
  v_and_b32 v13, 0xffff0000, v62
  v_sub_f32 v12, v12, v5
  v_sub_f32 v13, v13, v5
  v_cvt_pk_bf16_f32 v62, v12, v13
  v_fmac_f32 v6, v12, v12
  v_fmac_f32 v7, v13, v13
  v_lshlrev_b32 v14, 16, v63
  v_and_b32 v15, 0xffff0000, v63
  v_sub_f32 v14, v14, v5
  v_sub_f32 v15, v15, v5
  v_cvt_pk_bf16_f32 v63, v14, v15
  v_fmac_f32 v6, v14, v14
  v_fmac_f32 v7, v15, v15
  v_mfma_f32_32x32x16_bf16 v[128:143], a[0:3], v[60:63], v[128:143]
  s_add_u32 s26, s26, 1
  s_cmp_eq_u32 s26, 7
  s_cselect_b32 s26, 0, s26
  s_lshl_b32 s7, s26, 19
  s_mul_i32 s8, s26, 229376
  s_add_u32 m0, s31, 49152
  s_add_u32 s0, s7, 0
  ds_read_b64_tr_b16 a[28:29], v3 offset:36608
  ds_read_b64_tr_b16 a[30:31], v3 offset:40704
  buffer_load_dwordx4 v1, s[36:39], s0 offen offset:0 lds
  v_mfma_f32_32x32x16_bf16 v[144:159], a[4:7], v[60:63], v[144:159]
  s_waitcnt vmcnt(18)
  s_barrier
  ds_read_b64_tr_b16 a[0:1], v3 offset:49152
  ds_read_b64_tr_b16 a[2:3], v3 offset:53248
  v_lshlrev_b32 v8, 16, v64
  v_and_b32 v9, 0xffff0000, v64
  v_mfma_f32_32x32x16_bf16 v[160:175], a[8:11], v[60:63], v[160:175]
  ds_read_b64_tr_b16 a[4:5], v3 offset:49408
  ds_read_b64_tr_b16 a[6:7], v3 offset:53504
  buffer_load_dwordx4 v1, s[40:43], s0 offen offset:1024 lds
  v_sub_f32 v8, v8, v5
  s_waitcnt lgkmcnt(6)
  v_mfma_f32_32x32x16_bf16 v[176:191], a[12:15], v[60:63], v[176:191]
  ds_read_b64_tr_b16 a[8:9], v3 offset:49664
  ds_read_b64_tr_b16 a[10:11], v3 offset:53760
  v_sub_f32 v9, v9, v5
  v_cvt_pk_bf16_f32 v64, v8, v9
  v_fmac_f32 v6, v8, v8
  v_fmac_f32 v7, v9, v9
  v_mfma_f32_32x32x16_bf16 v[192:207], a[16:19], v[60:63], v[192:207]
  s_add_u32 s0, s7, 129024
  ds_read_b64_tr_b16 a[12:13], v3 offset:49920
  ds_read_b64_tr_b16 a[14:15], v3 offset:54016
  buffer_load_dwordx4 v1, s[36:39], s0 offen offset:2048 lds
  v_mfma_f32_32x32x16_bf16 v[208:223], a[20:23], v[60:63], v[208:223]
  ds_read_b64_tr_b16 a[16:17], v3 offset:50176
  ds_read_b64_tr_b16 a[18:19], v3 offset:54272
  v_lshlrev_b32 v10, 16, v65
  v_and_b32 v11, 0xffff0000, v65
  v_sub_f32 v10, v10, v5
  v_sub_f32 v11, v11, v5
  v_mfma_f32_32x32x16_bf16 v[224:239], a[24:27], v[60:63], v[224:239]
  ds_read_b64_tr_b16 a[20:21], v3 offset:50432
  ds_read_b64_tr_b16 a[22:23], v3 offset:54528
  buffer_load_dwordx4 v1, s[40:43], s0 offen offset:3072 lds
  v_cvt_pk_bf16_f32 v65, v10, v11
  s_waitcnt lgkmcnt(6)
  v_mfma_f32_32x32x16_bf16 v[240:255], a[28:31], v[60:63], v[240:255]
  ds_read_b64_tr_b16 a[24:25], v3 offset:50688
  ds_read_b64_tr_b16 a[26:27], v3 offset:54784
  v_fmac_f32 v6, v10, v10
  v_fmac_f32 v7, v11, v11
  v_lshlrev_b32 v12, 16, v66
  v_and_b32 v13, 0xffff0000, v66
  v_sub_f32 v12, v12, v5
  v_sub_f32 v13, v13, v5
  v_cvt_pk_bf16_f32 v66, v12, v13
  v_fmac_f32 v6, v12, v12
  v_fmac_f32 v7, v13, v13
  v_lshlrev_b32 v14, 16, v67
  v_and_b32 v15, 0xffff0000, v67
  v_sub_f32 v14, v14, v5
  v_sub_f32 v15, v15, v5
  v_cvt_pk_bf16_f32 v67, v14, v15
  v_fmac_f32 v6, v14, v14
  v_fmac_f32 v7, v15, v15
  v_mfma_f32_32x32x16_bf16 v[128:143], a[0:3], v[64:67], v[128:143]
  ds_read_b64_tr_b16 a[28:29], v3 offset:50944
  ds_read_b64_tr_b16 a[30:31], v3 offset:55040
  v_lshlrev_b32 v8, 16, v68
  v_and_b32 v9, 0xffff0000, v68
  v_sub_f32 v8, v8, v5
  v_sub_f32 v9, v9, v5
  v_mfma_f32_32x32x16_bf16 v[144:159], a[4:7], v[64:67], v[144:159]
  ds_read_b64_tr_b16 a[0:1], v3 offset:51200
  ds_read_b64_tr_b16 a[2:3], v3 offset:55296
  v_cvt_pk_bf16_f32 v68, v8, v9
  v_fmac_f32 v6, v8, v8
  v_fmac_f32 v7, v9, v9
  v_lshlrev_b32 v10, 16, v69
  v_mfma_f32_32x32x16_bf16 v[160:175], a[8:11], v[64:67], v[160:175]
  s_add_u32 m0, s31, 65536
  s_add_u32 s0, s7, 262144
  ds_read_b64_tr_b16 a[4:5], v3 offset:51456
  ds_read_b64_tr_b16 a[6:7], v3 offset:55552
  buffer_load_dwordx4 v1, s[36:39], s0 offen offset:0 lds
  s_waitcnt lgkmcnt(6)
  v_mfma_f32_32x32x16_bf16 v[176:191], a[12:15], v[64:67], v[176:191]
  ds_read_b64_tr_b16 a[8:9], v3 offset:51712
  ds_read_b64_tr_b16 a[10:11], v3 offset:55808
  v_and_b32 v11, 0xffff0000, v69
  v_sub_f32 v10, v10, v5
  v_sub_f32 v11, v11, v5
  v_cvt_pk_bf16_f32 v69, v10, v11
  v_mfma_f32_32x32x16_bf16 v[192:207], a[16:19], v[64:67], v[192:207]
  ds_read_b64_tr_b16 a[12:13], v3 offset:51968
  ds_read_b64_tr_b16 a[14:15], v3 offset:56064
  v_fmac_f32 v6, v10, v10
  v_fmac_f32 v7, v11, v11
  v_lshlrev_b32 v12, 16, v70
  v_and_b32 v13, 0xffff0000, v70
  v_mfma_f32_32x32x16_bf16 v[208:223], a[20:23], v[64:67], v[208:223]
  ds_read_b64_tr_b16 a[16:17], v3 offset:52224
  ds_read_b64_tr_b16 a[18:19], v3 offset:56320
  v_sub_f32 v12, v12, v5
  v_sub_f32 v13, v13, v5
  v_cvt_pk_bf16_f32 v70, v12, v13
  v_fmac_f32 v6, v12, v12
  v_mfma_f32_32x32x16_bf16 v[224:239], a[24:27], v[64:67], v[224:239]
  ds_read_b64_tr_b16 a[20:21], v3 offset:52480
  ds_read_b64_tr_b16 a[22:23], v3 offset:56576
  buffer_load_dwordx4 v1, s[40:43], s0 offen offset:1024 lds
  v_fmac_f32 v7, v13, v13
  s_waitcnt lgkmcnt(6)
  v_mfma_f32_32x32x16_bf16 v[240:255], a[28:31], v[64:67], v[240:255]
  ds_read_b64_tr_b16 a[24:25], v3 offset:52736
  ds_read_b64_tr_b16 a[26:27], v3 offset:56832
  v_lshlrev_b32 v14, 16, v71
  v_and_b32 v15, 0xffff0000, v71
  v_sub_f32 v14, v14, v5
  v_sub_f32 v15, v15, v5
  v_cvt_pk_bf16_f32 v71, v14, v15
  v_fmac_f32 v6, v14, v14
  v_fmac_f32 v7, v15, v15
  v_mfma_f32_32x32x16_bf16 v[128:143], a[0:3], v[68:71], v[128:143]
  ds_read_b64_tr_b16 a[28:29], v3 offset:52992
  ds_read_b64_tr_b16 a[30:31], v3 offset:57088
  v_lshlrev_b32 v8, 16, v72
  v_and_b32 v9, 0xffff0000, v72
  v_sub_f32 v8, v8, v5
  v_add_u32 v3, 0x00010000, v3
  v_mfma_f32_32x32x16_bf16 v[144:159], a[4:7], v[68:71], v[144:159]
  ds_read_b64_tr_b16 a[0:1], v3 offset:0
  ds_read_b64_tr_b16 a[2:3], v3 offset:4096
  v_sub_f32 v9, v9, v5
  v_cvt_pk_bf16_f32 v72, v8, v9
  v_fmac_f32 v6, v8, v8
  v_fmac_f32 v7, v9, v9
  v_mfma_f32_32x32x16_bf16 v[160:175], a[8:11], v[68:71], v[160:175]
  s_add_u32 s0, s7, 391168
  ds_read_b64_tr_b16 a[4:5], v3 offset:256
  ds_read_b64_tr_b16 a[6:7], v3 offset:4352
  buffer_load_dwordx4 v1, s[36:39], s0 offen offset:2048 lds
  s_waitcnt lgkmcnt(6)
  v_mfma_f32_32x32x16_bf16 v[176:191], a[12:15], v[68:71], v[176:191]
  ds_read_b64_tr_b16 a[8:9], v3 offset:512
  ds_read_b64_tr_b16 a[10:11], v3 offset:4608
  v_lshlrev_b32 v10, 16, v73
  v_and_b32 v11, 0xffff0000, v73
  v_sub_f32 v10, v10, v5
  v_sub_f32 v11, v11, v5
  v_mfma_f32_32x32x16_bf16 v[192:207], a[16:19], v[68:71], v[192:207]
  ds_read_b64_tr_b16 a[12:13], v3 offset:768
  ds_read_b64_tr_b16 a[14:15], v3 offset:4864
  v_cvt_pk_bf16_f32 v73, v10, v11
  v_fmac_f32 v6, v10, v10
  v_fmac_f32 v7, v11, v11
  v_lshlrev_b32 v12, 16, v74
  v_mfma_f32_32x32x16_bf16 v[208:223], a[20:23], v[68:71], v[208:223]
  ds_read_b64_tr_b16 a[16:17], v3 offset:1024
  ds_read_b64_tr_b16 a[18:19], v3 offset:5120
  v_and_b32 v13, 0xffff0000, v74
  v_sub_f32 v12, v12, v5
  v_sub_f32 v13, v13, v5
  v_cvt_pk_bf16_f32 v74, v12, v13
  v_mfma_f32_32x32x16_bf16 v[224:239], a[24:27], v[68:71], v[224:239]
  ds_read_b64_tr_b16 a[20:21], v3 offset:1280
  ds_read_b64_tr_b16 a[22:23], v3 offset:5376
  buffer_load_dwordx4 v1, s[40:43], s0 offen offset:3072 lds
  v_fmac_f32 v6, v12, v12
  s_waitcnt lgkmcnt(6)
  v_mfma_f32_32x32x16_bf16 v[240:255], a[28:31], v[68:71], v[240:255]
  ds_read_b64_tr_b16 a[24:25], v3 offset:1536
  ds_read_b64_tr_b16 a[26:27], v3 offset:5632
  v_fmac_f32 v7, v13, v13
  v_lshlrev_b32 v14, 16, v75
  v_and_b32 v15, 0xffff0000, v75
  v_sub_f32 v14, v14, v5
  v_sub_f32 v15, v15, v5
  v_cvt_pk_bf16_f32 v75, v14, v15
  v_fmac_f32 v6, v14, v14
  v_fmac_f32 v7, v15, v15
  v_mfma_f32_32x32x16_bf16 v[128:143], a[0:3], v[72:75], v[128:143]
  ds_read_b64_tr_b16 a[28:29], v3 offset:1792
  ds_read_b64_tr_b16 a[30:31], v3 offset:5888
  v_lshlrev_b32 v8, 16, v76
  v_and_b32 v9, 0xffff0000, v76
  v_sub_f32 v8, v8, v5
  v_sub_f32 v9, v9, v5
  v_mfma_f32_32x32x16_bf16 v[144:159], a[4:7], v[72:75], v[144:159]
  ds_read_b64_tr_b16 a[0:1], v3 offset:2048
  ds_read_b64_tr_b16 a[2:3], v3 offset:6144
  v_cvt_pk_bf16_f32 v76, v8, v9
  v_fmac_f32 v6, v8, v8
  v_fmac_f32 v7, v9, v9
  v_lshlrev_b32 v10, 16, v77
  v_mfma_f32_32x32x16_bf16 v[160:175], a[8:11], v[72:75], v[160:175]
  s_add_u32 m0, s31, 81920
  s_add_u32 s6, s2, 0
  s_and_b32 s6, s6, 0x3ffff
  ds_read_b64_tr_b16 a[4:5], v3 offset:2304
  ds_read_b64_tr_b16 a[6:7], v3 offset:6400
  buffer_load_dwordx4 v4, s[48:51], s6 offen offset:0 lds
  s_waitcnt lgkmcnt(6)
  v_mfma_f32_32x32x16_bf16 v[176:191], a[12:15], v[72:75], v[176:191]
  ds_read_b64_tr_b16 a[8:9], v3 offset:2560
  ds_read_b64_tr_b16 a[10:11], v3 offset:6656
  v_and_b32 v11, 0xffff0000, v77
  v_sub_f32 v10, v10, v5
  v_sub_f32 v11, v11, v5
  v_cvt_pk_bf16_f32 v77, v10, v11
  v_mfma_f32_32x32x16_bf16 v[192:207], a[16:19], v[72:75], v[192:207]
  ds_read_b64_tr_b16 a[12:13], v3 offset:2816
  ds_read_b64_tr_b16 a[14:15], v3 offset:6912
  v_fmac_f32 v6, v10, v10
  v_fmac_f32 v7, v11, v11
  v_lshlrev_b32 v12, 16, v78
  v_and_b32 v13, 0xffff0000, v78
  v_mfma_f32_32x32x16_bf16 v[208:223], a[20:23], v[72:75], v[208:223]
  ds_read_b64_tr_b16 a[16:17], v3 offset:3072
  ds_read_b64_tr_b16 a[18:19], v3 offset:7168
  v_sub_f32 v12, v12, v5
  v_sub_f32 v13, v13, v5
  v_cvt_pk_bf16_f32 v78, v12, v13
  v_fmac_f32 v6, v12, v12
  v_mfma_f32_32x32x16_bf16 v[224:239], a[24:27], v[72:75], v[224:239]
  ds_read_b64_tr_b16 a[20:21], v3 offset:3328
  ds_read_b64_tr_b16 a[22:23], v3 offset:7424
  buffer_load_dwordx4 v4, s[52:55], s6 offen offset:1024 lds
  v_fmac_f32 v7, v13, v13
  s_waitcnt lgkmcnt(6)
  v_mfma_f32_32x32x16_bf16 v[240:255], a[28:31], v[72:75], v[240:255]
  ds_read_b64_tr_b16 a[24:25], v3 offset:3584
  ds_read_b64_tr_b16 a[26:27], v3 offset:7680
  v_lshlrev_b32 v14, 16, v79
  v_and_b32 v15, 0xffff0000, v79
  v_sub_f32 v14, v14, v5
  v_sub_f32 v15, v15, v5
  v_cvt_pk_bf16_f32 v79, v14, v15
  v_fmac_f32 v6, v14, v14
  v_fmac_f32 v7, v15, v15
  v_mfma_f32_32x32x16_bf16 v[128:143], a[0:3], v[76:79], v[128:143]
  ds_read_b64_tr_b16 a[28:29], v3 offset:3840
  ds_read_b64_tr_b16 a[30:31], v3 offset:7936
  buffer_load_dwordx4 v4, s[56:59], s6 offen offset:2048 lds
  v_lshlrev_b32 v8, 16, v80
  v_mfma_f32_32x32x16_bf16 v[144:159], a[4:7], v[76:79], v[144:159]
  s_waitcnt vmcnt(19)
  s_barrier
  ds_read_b64_tr_b16 a[0:1], v3 offset:16384
  ds_read_b64_tr_b16 a[2:3], v3 offset:20480
  v_and_b32 v9, 0xffff0000, v80
  v_sub_f32 v8, v8, v5
  v_mfma_f32_32x32x16_bf16 v[160:175], a[8:11], v[76:79], v[160:175]
  ds_read_b64_tr_b16 a[4:5], v3 offset:16640
  ds_read_b64_tr_b16 a[6:7], v3 offset:20736
  buffer_load_dwordx4 v4, s[60:63], s6 offen offset:3072 lds
  v_sub_f32 v9, v9, v5
  s_waitcnt lgkmcnt(6)
  v_mfma_f32_32x32x16_bf16 v[176:191], a[12:15], v[76:79], v[176:191]
  ds_read_b64_tr_b16 a[8:9], v3 offset:16896
  ds_read_b64_tr_b16 a[10:11], v3 offset:20992
  v_cvt_pk_bf16_f32 v80, v8, v9
  v_fmac_f32 v6, v8, v8
  v_fmac_f32 v7, v9, v9
  v_lshlrev_b32 v10, 16, v81
  v_mfma_f32_32x32x16_bf16 v[192:207], a[16:19], v[76:79], v[192:207]
  ds_read_b64_tr_b16 a[12:13], v3 offset:17152
  ds_read_b64_tr_b16 a[14:15], v3 offset:21248
  v_and_b32 v11, 0xffff0000, v81
  v_sub_f32 v10, v10, v5
  v_sub_f32 v11, v11, v5
  v_cvt_pk_bf16_f32 v81, v10, v11
  v_mfma_f32_32x32x16_bf16 v[208:223], a[20:23], v[76:79], v[208:223]
  ds_read_b64_tr_b16 a[16:17], v3 offset:17408
  ds_read_b64_tr_b16 a[18:19], v3 offset:21504
  v_fmac_f32 v6, v10, v10
  v_fmac_f32 v7, v11, v11
  v_lshlrev_b32 v12, 16, v82
  v_and_b32 v13, 0xffff0000, v82
  v_mfma_f32_32x32x16_bf16 v[224:239], a[24:27], v[76:79], v[224:239]
  s_add_u32 m0, s31, 98304
  s_add_u32 s6, s2, 16384
  s_and_b32 s6, s6, 0x3ffff
  ds_read_b64_tr_b16 a[20:21], v3 offset:17664
  ds_read_b64_tr_b16 a[22:23], v3 offset:21760
  buffer_load_dwordx4 v4, s[48:51], s6 offen offset:0 lds
  s_waitcnt lgkmcnt(6)
  v_mfma_f32_32x32x16_bf16 v[240:255], a[28:31], v[76:79], v[240:255]
  ds_read_b64_tr_b16 a[24:25], v3 offset:17920
  ds_read_b64_tr_b16 a[26:27], v3 offset:22016
  v_sub_f32 v12, v12, v5
  v_sub_f32 v13, v13, v5
  v_cvt_pk_bf16_f32 v82, v12, v13
  v_fmac_f32 v6, v12, v12
  v_fmac_f32 v7, v13, v13
  v_lshlrev_b32 v14, 16, v83
  v_and_b32 v15, 0xffff0000, v83
  v_sub_f32 v14, v14, v5
  v_sub_f32 v15, v15, v5
  v_cvt_pk_bf16_f32 v83, v14, v15
  v_fmac_f32 v6, v14, v14
  v_fmac_f32 v7, v15, v15
  v_mfma_f32_32x32x16_bf16 v[128:143], a[0:3], v[80:83], v[128:143]
  ds_read_b64_tr_b16 a[28:29], v3 offset:18176
  ds_read_b64_tr_b16 a[30:31], v3 offset:22272
  v_lshlrev_b32 v8, 16, v84
  v_and_b32 v9, 0xffff0000, v84
  v_sub_f32 v8, v8, v5
  v_sub_f32 v9, v9, v5
  v_mfma_f32_32x32x16_bf16 v[144:159], a[4:7], v[80:83], v[144:159]
  ds_read_b64_tr_b16 a[0:1], v3 offset:18432
  ds_read_b64_tr_b16 a[2:3], v3 offset:22528
  v_cvt_pk_bf16_f32 v84, v8, v9
  v_fmac_f32 v6, v8, v8
  v_fmac_f32 v7, v9, v9
  v_lshlrev_b32 v10, 16, v85
  v_mfma_f32_32x32x16_bf16 v[160:175], a[8:11], v[80:83], v[160:175]
  ds_read_b64_tr_b16 a[4:5], v3 offset:18688
  ds_read_b64_tr_b16 a[6:7], v3 offset:22784
  buffer_load_dwordx4 v4, s[52:55], s6 offen offset:1024 lds
  v_and_b32 v11, 0xffff0000, v85
  s_waitcnt lgkmcnt(6)
  v_mfma_f32_32x32x16_bf16 v[176:191], a[12:15], v[80:83], v[176:191]
  ds_read_b64_tr_b16 a[8:9], v3 offset:18944
  ds_read_b64_tr_b16 a[10:11], v3 offset:23040
  v_sub_f32 v10, v10, v5
  v_sub_f32 v11, v11, v5
  v_cvt_pk_bf16_f32 v85, v10, v11
  v_fmac_f32 v6, v10, v10
  v_mfma_f32_32x32x16_bf16 v[192:207], a[16:19], v[80:83], v[192:207]
  ds_read_b64_tr_b16 a[12:13], v3 offset:19200
  ds_read_b64_tr_b16 a[14:15], v3 offset:23296
  v_fmac_f32 v7, v11, v11
  v_lshlrev_b32 v12, 16, v86
  v_and_b32 v13, 0xffff0000, v86
  v_sub_f32 v12, v12, v5
  v_mfma_f32_32x32x16_bf16 v[208:223], a[20:23], v[80:83], v[208:223]
  ds_read_b64_tr_b16 a[16:17], v3 offset:19456
  ds_read_b64_tr_b16 a[18:19], v3 offset:23552
  v_sub_f32 v13, v13, v5
  v_cvt_pk_bf16_f32 v86, v12, v13
  v_fmac_f32 v6, v12, v12
  v_fmac_f32 v7, v13, v13
  v_mfma_f32_32x32x16_bf16 v[224:239], a[24:27], v[80:83], v[224:239]
  ds_read_b64_tr_b16 a[20:21], v3 offset:19712
  ds_read_b64_tr_b16 a[22:23], v3 offset:23808
  buffer_load_dwordx4 v4, s[56:59], s6 offen offset:2048 lds
  v_lshlrev_b32 v14, 16, v87
  s_waitcnt lgkmcnt(6)
  v_mfma_f32_32x32x16_bf16 v[240:255], a[28:31], v[80:83], v[240:255]
  ds_read_b64_tr_b16 a[24:25], v3 offset:19968
  ds_read_b64_tr_b16 a[26:27], v3 offset:24064
  v_and_b32 v15, 0xffff0000, v87
  v_sub_f32 v14, v14, v5
  v_sub_f32 v15, v15, v5
  v_cvt_pk_bf16_f32 v87, v14, v15
  v_fmac_f32 v6, v14, v14
  v_fmac_f32 v7, v15, v15
  v_mfma_f32_32x32x16_bf16 v[128:143], a[0:3], v[84:87], v[128:143]
  ds_read_b64_tr_b16 a[28:29], v3 offset:20224
  ds_read_b64_tr_b16 a[30:31], v3 offset:24320
  v_lshlrev_b32 v8, 16, v88
  v_and_b32 v9, 0xffff0000, v88
  v_sub_f32 v8, v8, v5
  v_add_u32 v3, 0xfffe0000, v3
  v_mfma_f32_32x32x16_bf16 v[144:159], a[4:7], v[84:87], v[144:159]
  ds_read_b64_tr_b16 a[0:1], v3 offset:0
  ds_read_b64_tr_b16 a[2:3], v3 offset:4096
  v_sub_f32 v9, v9, v5
  v_cvt_pk_bf16_f32 v88, v8, v9
  v_fmac_f32 v6, v8, v8
  v_fmac_f32 v7, v9, v9
  v_mfma_f32_32x32x16_bf16 v[160:175], a[8:11], v[84:87], v[160:175]
  ds_read_b64_tr_b16 a[4:5], v3 offset:256
  ds_read_b64_tr_b16 a[6:7], v3 offset:4352
  buffer_load_dwordx4 v4, s[60:63], s6 offen offset:3072 lds
  v_lshlrev_b32 v10, 16, v89
  s_waitcnt lgkmcnt(6)
  v_mfma_f32_32x32x16_bf16 v[176:191], a[12:15], v[84:87], v[176:191]
  ds_read_b64_tr_b16 a[8:9], v3 offset:512
  ds_read_b64_tr_b16 a[10:11], v3 offset:4608
  v_and_b32 v11, 0xffff0000, v89
  v_sub_f32 v10, v10, v5
  v_sub_f32 v11, v11, v5
  v_cvt_pk_bf16_f32 v89, v10, v11
  v_mfma_f32_32x32x16_bf16 v[192:207], a[16:19], v[84:87], v[192:207]
  ds_read_b64_tr_b16 a[12:13], v3 offset:768
  ds_read_b64_tr_b16 a[14:15], v3 offset:4864
  v_fmac_f32 v6, v10, v10
  v_fmac_f32 v7, v11, v11
  v_lshlrev_b32 v12, 16, v90
  v_and_b32 v13, 0xffff0000, v90
  v_mfma_f32_32x32x16_bf16 v[208:223], a[20:23], v[84:87], v[208:223]
  ds_read_b64_tr_b16 a[16:17], v3 offset:1024
  ds_read_b64_tr_b16 a[18:19], v3 offset:5120
  v_sub_f32 v12, v12, v5
  v_sub_f32 v13, v13, v5
  v_cvt_pk_bf16_f32 v90, v12, v13
  v_fmac_f32 v6, v12, v12
  v_mfma_f32_32x32x16_bf16 v[224:239], a[24:27], v[84:87], v[224:239]
  s_add_u32 m0, s31, 114688
  s_add_u32 s6, s2, 32768
  s_and_b32 s6, s6, 0x3ffff
  ds_read_b64_tr_b16 a[20:21], v3 offset:1280
  ds_read_b64_tr_b16 a[22:23], v3 offset:5376
  buffer_load_dwordx4 v4, s[48:51], s6 offen offset:0 lds
  s_waitcnt lgkmcnt(6)
  v_mfma_f32_32x32x16_bf16 v[240:255], a[28:31], v[84:87], v[240:255]
  ds_read_b64_tr_b16 a[24:25], v3 offset:1536
  ds_read_b64_tr_b16 a[26:27], v3 offset:5632
  v_fmac_f32 v7, v13, v13
  v_lshlrev_b32 v14, 16, v91
  v_and_b32 v15, 0xffff0000, v91
  v_sub_f32 v14, v14, v5
  v_sub_f32 v15, v15, v5
  v_cvt_pk_bf16_f32 v91, v14, v15
  v_fmac_f32 v6, v14, v14
  v_fmac_f32 v7, v15, v15
  v_mfma_f32_32x32x16_bf16 v[128:143], a[0:3], v[88:91], v[128:143]
  ds_read_b64_tr_b16 a[28:29], v3 offset:1792
  ds_read_b64_tr_b16 a[30:31], v3 offset:5888
  v_lshlrev_b32 v8, 16, v92
  v_and_b32 v9, 0xffff0000, v92
  v_sub_f32 v8, v8, v5
  v_sub_f32 v9, v9, v5
  v_mfma_f32_32x32x16_bf16 v[144:159], a[4:7], v[88:91], v[144:159]
  ds_read_b64_tr_b16 a[0:1], v3 offset:2048
  ds_read_b64_tr_b16 a[2:3], v3 offset:6144
  v_cvt_pk_bf16_f32 v92, v8, v9
  v_fmac_f32 v6, v8, v8
  v_fmac_f32 v7, v9, v9
  v_lshlrev_b32 v10, 16, v93
  v_mfma_f32_32x32x16_bf16 v[160:175], a[8:11], v[88:91], v[160:175]
  ds_read_b64_tr_b16 a[4:5], v3 offset:2304
  ds_read_b64_tr_b16 a[6:7], v3 offset:6400
  buffer_load_dwordx4 v4, s[52:55], s6 offen offset:1024 lds
  v_and_b32 v11, 0xffff0000, v93
  s_waitcnt lgkmcnt(6)
  v_mfma_f32_32x32x16_bf16 v[176:191], a[12:15], v[88:91], v[176:191]
  ds_read_b64_tr_b16 a[8:9], v3 offset:2560
  ds_read_b64_tr_b16 a[10:11], v3 offset:6656
  v_sub_f32 v10, v10, v5
  v_sub_f32 v11, v11, v5
  v_cvt_pk_bf16_f32 v93, v10, v11
  v_fmac_f32 v6, v10, v10
  v_mfma_f32_32x32x16_bf16 v[192:207], a[16:19], v[88:91], v[192:207]
  ds_read_b64_tr_b16 a[12:13], v3 offset:2816
  ds_read_b64_tr_b16 a[14:15], v3 offset:6912
  v_fmac_f32 v7, v11, v11
  v_lshlrev_b32 v12, 16, v94
  v_and_b32 v13, 0xffff0000, v94
  v_sub_f32 v12, v12, v5
  v_mfma_f32_32x32x16_bf16 v[208:223], a[20:23], v[88:91], v[208:223]
  ds_read_b64_tr_b16 a[16:17], v3 offset:3072
  ds_read_b64_tr_b16 a[18:19], v3 offset:7168
  v_sub_f32 v13, v13, v5
  v_cvt_pk_bf16_f32 v94, v12, v13
  v_fmac_f32 v6, v12, v12
  v_fmac_f32 v7, v13, v13
  v_mfma_f32_32x32x16_bf16 v[224:239], a[24:27], v[88:91], v[224:239]
  ds_read_b64_tr_b16 a[20:21], v3 offset:3328
  ds_read_b64_tr_b16 a[22:23], v3 offset:7424
  buffer_load_dwordx4 v4, s[56:59], s6 offen offset:2048 lds
  v_lshlrev_b32 v14, 16, v95
  s_waitcnt lgkmcnt(6)
  v_mfma_f32_32x32x16_bf16 v[240:255], a[28:31], v[88:91], v[240:255]
  ds_read_b64_tr_b16 a[24:25], v3 offset:3584
  ds_read_b64_tr_b16 a[26:27], v3 offset:7680
  v_and_b32 v15, 0xffff0000, v95
  v_sub_f32 v14, v14, v5
  v_sub_f32 v15, v15, v5
  v_cvt_pk_bf16_f32 v95, v14, v15
  v_fmac_f32 v6, v14, v14
  v_fmac_f32 v7, v15, v15
  v_mfma_f32_32x32x16_bf16 v[128:143], a[0:3], v[92:95], v[128:143]
  ds_read_b64_tr_b16 a[28:29], v3 offset:3840
  ds_read_b64_tr_b16 a[30:31], v3 offset:7936
  buffer_load_dwordx4 v4, s[60:63], s6 offen offset:3072 lds
  v_lshlrev_b32 v8, 16, v96
  v_mfma_f32_32x32x16_bf16 v[144:159], a[4:7], v[92:95], v[144:159]
  s_waitcnt vmcnt(20)
  s_barrier
  ds_read_b64_tr_b16 a[0:1], v3 offset:16384
  ds_read_b64_tr_b16 a[2:3], v3 offset:20480
  v_and_b32 v9, 0xffff0000, v96
  v_sub_f32 v8, v8, v5
  v_mfma_f32_32x32x16_bf16 v[160:175], a[8:11], v[92:95], v[160:175]
  ds_read_b64_tr_b16 a[4:5], v3 offset:16640
  ds_read_b64_tr_b16 a[6:7], v3 offset:20736
  v_sub_f32 v9, v9, v5
  v_cvt_pk_bf16_f32 v96, v8, v9
  v_fmac_f32 v6, v8, v8
  v_fmac_f32 v7, v9, v9
  s_waitcnt lgkmcnt(6)
  v_mfma_f32_32x32x16_bf16 v[176:191], a[12:15], v[92:95], v[176:191]
  ds_read_b64_tr_b16 a[8:9], v3 offset:16896
  ds_read_b64_tr_b16 a[10:11], v3 offset:20992
  v_lshlrev_b32 v10, 16, v97
  v_and_b32 v11, 0xffff0000, v97
  v_sub_f32 v10, v10, v5
  v_sub_f32 v11, v11, v5
  v_mfma_f32_32x32x16_bf16 v[192:207], a[16:19], v[92:95], v[192:207]
  s_add_u32 m0, s31, 131072
  s_add_u32 s6, s2, 49152
  s_and_b32 s6, s6, 0x3ffff
  ds_read_b64_tr_b16 a[12:13], v3 offset:17152
  ds_read_b64_tr_b16 a[14:15], v3 offset:21248
  buffer_load_dwordx4 v4, s[48:51], s6 offen offset:0 lds
  v_mfma_f32_32x32x16_bf16 v[208:223], a[20:23], v[92:95], v[208:223]
  ds_read_b64_tr_b16 a[16:17], v3 offset:17408
  ds_read_b64_tr_b16 a[18:19], v3 offset:21504
  v_cvt_pk_bf16_f32 v97, v10, v11
  v_fmac_f32 v6, v10, v10
  v_fmac_f32 v7, v11, v11
  v_lshlrev_b32 v12, 16, v98
  v_mfma_f32_32x32x16_bf16 v[224:239], a[24:27], v[92:95], v[224:239]
  ds_read_b64_tr_b16 a[20:21], v3 offset:17664
  ds_read_b64_tr_b16 a[22:23], v3 offset:21760
  v_and_b32 v13, 0xffff0000, v98
L_padl2:
  s_cbranch_execz L_padl6
  v_sub_f32 v12, v12, v5
  v_sub_f32 v13, v13, v5
  v_cvt_pk_bf16_f32 v98, v12, v13
  s_waitcnt lgkmcnt(6)
  v_mfma_f32_32x32x16_bf16 v[240:255], a[28:31], v[92:95], v[240:255]
  ds_read_b64_tr_b16 a[24:25], v3 offset:17920
  ds_read_b64_tr_b16 a[26:27], v3 offset:22016
  v_fmac_f32 v6, v12, v12
  v_fmac_f32 v7, v13, v13
  v_lshlrev_b32 v14, 16, v99
  v_and_b32 v15, 0xffff0000, v99
  v_sub_f32 v14, v14, v5
  v_sub_f32 v15, v15, v5
  v_cvt_pk_bf16_f32 v99, v14, v15
  v_fmac_f32 v6, v14, v14
  v_fmac_f32 v7, v15, v15
  v_mfma_f32_32x32x16_bf16 v[128:143], a[0:3], v[96:99], v[128:143]
  ds_read_b64_tr_b16 a[28:29], v3 offset:18176
  ds_read_b64_tr_b16 a[30:31], v3 offset:22272
  buffer_load_dwordx4 v4, s[52:55], s6 offen offset:1024 lds
  v_lshlrev_b32 v8, 16, v100
  v_mfma_f32_32x32x16_bf16 v[144:159], a[4:7], v[96:99], v[144:159]
  ds_read_b64_tr_b16 a[0:1], v3 offset:18432
  ds_read_b64_tr_b16 a[2:3], v3 offset:22528
  v_and_b32 v9, 0xffff0000, v100
  v_sub_f32 v8, v8, v5
  v_sub_f32 v9, v9, v5
  v_cvt_pk_bf16_f32 v100, v8, v9
  v_mfma_f32_32x32x16_bf16 v[160:175], a[8:11], v[96:99], v[160:175]
  ds_read_b64_tr_b16 a[4:5], v3 offset:18688
  ds_read_b64_tr_b16 a[6:7], v3 offset:22784
  v_fmac_f32 v6, v8, v8
  v_fmac_f32 v7, v9, v9
  v_lshlrev_b32 v10, 16, v101
  v_and_b32 v11, 0xffff0000, v101
  s_waitcnt lgkmcnt(6)
  v_mfma_f32_32x32x16_bf16 v[176:191], a[12:15], v[96:99], v[176:191]
  ds_read_b64_tr_b16 a[8:9], v3 offset:18944
  ds_read_b64_tr_b16 a[10:11], v3 offset:23040
  v_sub_f32 v10, v10, v5
  v_sub_f32 v11, v11, v5
  v_cvt_pk_bf16_f32 v101, v10, v11
  v_fmac_f32 v6, v10, v10
  v_mfma_f32_32x32x16_bf16 v[192:207], a[16:19], v[96:99], v[192:207]
  ds_read_b64_tr_b16 a[12:13], v3 offset:19200
  ds_read_b64_tr_b16 a[14:15], v3 offset:23296
  buffer_load_dwordx4 v4, s[56:59], s6 offen offset:2048 lds
  v_fmac_f32 v7, v11, v11
  v_mfma_f32_32x32x16_bf16 v[208:223], a[20:23], v[96:99], v[208:223]
  ds_read_b64_tr_b16 a[16:17], v3 offset:19456
  ds_read_b64_tr_b16 a[18:19], v3 offset:23552
  v_lshlrev_b32 v12, 16, v102
  v_and_b32 v13, 0xffff0000, v102
  v_sub_f32 v12, v12, v5
  v_sub_f32 v13, v13, v5
  v_mfma_f32_32x32x16_bf16 v[224:239], a[24:27], v[96:99], v[224:239]
  ds_read_b64_tr_b16 a[20:21], v3 offset:19712
  ds_read_b64_tr_b16 a[22:23], v3 offset:23808
  v_cvt_pk_bf16_f32 v102, v12, v13
  v_fmac_f32 v6, v12, v12
  v_fmac_f32 v7, v13, v13
  v_lshlrev_b32 v14, 16, v103
  s_waitcnt lgkmcnt(6)
  v_mfma_f32_32x32x16_bf16 v[240:255], a[28:31], v[96:99], v[240:255]
  ds_read_b64_tr_b16 a[24:25], v3 offset:19968
  ds_read_b64_tr_b16 a[26:27], v3 offset:24064
  v_and_b32 v15, 0xffff0000, v103
  v_sub_f32 v14, v14, v5
  v_sub_f32 v15, v15, v5
  v_cvt_pk_bf16_f32 v103, v14, v15
  v_fmac_f32 v6, v14, v14
  v_fmac_f32 v7, v15, v15
  v_mfma_f32_32x32x16_bf16 v[128:143], a[0:3], v[100:103], v[128:143]
  ds_read_b64_tr_b16 a[28:29], v3 offset:20224
  ds_read_b64_tr_b16 a[30:31], v3 offset:24320
  buffer_load_dwordx4 v4, s[60:63], s6 offen offset:3072 lds
  v_lshlrev_b32 v8, 16, v104
  v_mfma_f32_32x32x16_bf16 v[144:159], a[4:7], v[100:103], v[144:159]
  ds_read_b64_tr_b16 a[0:1], v3 offset:32768
  ds_read_b64_tr_b16 a[2:3], v3 offset:36864
  v_and_b32 v9, 0xffff0000, v104
  v_sub_f32 v8, v8, v5
  v_sub_f32 v9, v9, v5
  v_cvt_pk_bf16_f32 v104, v8, v9
  v_mfma_f32_32x32x16_bf16 v[160:175], a[8:11], v[100:103], v[160:175]
  ds_read_b64_tr_b16 a[4:5], v3 offset:33024
  ds_read_b64_tr_b16 a[6:7], v3 offset:37120
  v_fmac_f32 v6, v8, v8
  v_fmac_f32 v7, v9, v9
  v_lshlrev_b32 v10, 16, v105
  v_and_b32 v11, 0xffff0000, v105
  s_waitcnt lgkmcnt(6)
  v_mfma_f32_32x32x16_bf16 v[176:191], a[12:15], v[100:103], v[176:191]
  ds_read_b64_tr_b16 a[8:9], v3 offset:33280
  ds_read_b64_tr_b16 a[10:11], v3 offset:37376
  v_sub_f32 v10, v10, v5
  v_sub_f32 v11, v11, v5
  v_cvt_pk_bf16_f32 v105, v10, v11
  v_fmac_f32 v6, v10, v10
  v_mfma_f32_32x32x16_bf16 v[192:207], a[16:19], v[100:103], v[192:207]
  s_add_u32 m0, s31, 147456
  s_add_u32 s6, s2, 65536
  s_and_b32 s6, s6, 0x3ffff
  ds_read_b64_tr_b16 a[12:13], v3 offset:33536
  ds_read_b64_tr_b16 a[14:15], v3 offset:37632
  buffer_load_dwordx4 v4, s[48:51], s6 offen offset:0 lds
  v_mfma_f32_32x32x16_bf16 v[208:223], a[20:23], v[100:103], v[208:223]
  ds_read_b64_tr_b16 a[16:17], v3 offset:33792
  ds_read_b64_tr_b16 a[18:19], v3 offset:37888
  v_fmac_f32 v7, v11, v11
  v_lshlrev_b32 v12, 16, v106
  v_and_b32 v13, 0xffff0000, v106
  v_sub_f32 v12, v12, v5
  v_mfma_f32_32x32x16_bf16 v[224:239], a[24:27], v[100:103], v[224:239]
  ds_read_b64_tr_b16 a[20:21], v3 offset:34048
  ds_read_b64_tr_b16 a[22:23], v3 offset:38144
  v_sub_f32 v13, v13, v5
  v_cvt_pk_bf16_f32 v106, v12, v13
  v_fmac_f32 v6, v12, v12
  v_fmac_f32 v7, v13, v13
  s_waitcnt lgkmcnt(6)
  v_mfma_f32_32x32x16_bf16 v[240:255], a[28:31], v[100:103], v[240:255]
  ds_read_b64_tr_b16 a[24:25], v3 offset:34304
  ds_read_b64_tr_b16 a[26:27], v3 offset:38400
  v_lshlrev_b32 v14, 16, v107
  v_and_b32 v15, 0xffff0000, v107
  v_sub_f32 v14, v14, v5
  v_sub_f32 v15, v15, v5
  v_cvt_pk_bf16_f32 v107, v14, v15
  v_fmac_f32 v6, v14, v14
  v_fmac_f32 v7, v15, v15
  v_mfma_f32_32x32x16_bf16 v[128:143], a[0:3], v[104:107], v[128:143]
  ds_read_b64_tr_b16 a[28:29], v3 offset:34560
  ds_read_b64_tr_b16 a[30:31], v3 offset:38656
  buffer_load_dwordx4 v4, s[52:55], s6 offen offset:1024 lds
  v_lshlrev_b32 v8, 16, v108
  v_mfma_f32_32x32x16_bf16 v[144:159], a[4:7], v[104:107], v[144:159]
  ds_read_b64_tr_b16 a[0:1], v3 offset:34816
  ds_read_b64_tr_b16 a[2:3], v3 offset:38912
  v_and_b32 v9, 0xffff0000, v108
  v_sub_f32 v8, v8, v5
  v_sub_f32 v9, v9, v5
  v_cvt_pk_bf16_f32 v108, v8, v9
  v_mfma_f32_32x32x16_bf16 v[160:175], a[8:11], v[104:107], v[160:175]
  ds_read_b64_tr_b16 a[4:5], v3 offset:35072
  ds_read_b64_tr_b16 a[6:7], v3 offset:39168
  v_fmac_f32 v6, v8, v8
  v_fmac_f32 v7, v9, v9
  v_lshlrev_b32 v10, 16, v109
  v_and_b32 v11, 0xffff0000, v109
  s_waitcnt lgkmcnt(6)
  v_mfma_f32_32x32x16_bf16 v[176:191], a[12:15], v[104:107], v[176:191]
  ds_read_b64_tr_b16 a[8:9], v3 offset:35328
  ds_read_b64_tr_b16 a[10:11], v3 offset:39424
  v_sub_f32 v10, v10, v5
  v_sub_f32 v11, v11, v5
  v_cvt_pk_bf16_f32 v109, v10, v11
  v_fmac_f32 v6, v10, v10
  v_mfma_f32_32x32x16_bf16 v[192:207], a[16:19], v[104:107], v[192:207]
  ds_read_b64_tr_b16 a[12:13], v3 offset:35584
  ds_read_b64_tr_b16 a[14:15], v3 offset:39680
  buffer_load_dwordx4 v4, s[56:59], s6 offen offset:2048 lds
  v_fmac_f32 v7, v11, v11
  v_mfma_f32_32x32x16_bf16 v[208:223], a[20:23], v[104:107], v[208:223]
  ds_read_b64_tr_b16 a[16:17], v3 offset:35840
  ds_read_b64_tr_b16 a[18:19], v3 offset:39936
  v_lshlrev_b32 v12, 16, v110
  v_and_b32 v13, 0xffff0000, v110
  v_sub_f32 v12, v12, v5
  v_sub_f32 v13, v13, v5
  v_mfma_f32_32x32x16_bf16 v[224:239], a[24:27], v[104:107], v[224:239]
  ds_read_b64_tr_b16 a[20:21], v3 offset:36096
  ds_read_b64_tr_b16 a[22:23], v3 offset:40192
  v_cvt_pk_bf16_f32 v110, v12, v13
  v_fmac_f32 v6, v12, v12
  v_fmac_f32 v7, v13, v13
  v_lshlrev_b32 v14, 16, v111
  s_waitcnt lgkmcnt(6)
  v_mfma_f32_32x32x16_bf16 v[240:255], a[28:31], v[104:107], v[240:255]
  ds_read_b64_tr_b16 a[24:25], v3 offset:36352
  ds_read_b64_tr_b16 a[26:27], v3 offset:40448
  buffer_load_dwordx4 v4, s[60:63], s6 offen offset:3072 lds
  v_and_b32 v15, 0xffff0000, v111
  v_sub_f32 v14, v14, v5
  v_sub_f32 v15, v15, v5
  v_cvt_pk_bf16_f32 v111, v14, v15
  v_fmac_f32 v6, v14, v14
  v_fmac_f32 v7, v15, v15
  v_mfma_f32_32x32x16_bf16 v[128:143], a[0:3], v[108:111], v[128:143]
  ds_read_b64_tr_b16 a[28:29], v3 offset:36608
  ds_read_b64_tr_b16 a[30:31], v3 offset:40704
  v_lshlrev_b32 v8, 16, v112
  v_and_b32 v9, 0xffff0000, v112
  v_sub_f32 v8, v8, v5
  v_sub_f32 v9, v9, v5
  v_mfma_f32_32x32x16_bf16 v[144:159], a[4:7], v[108:111], v[144:159]
  s_waitcnt vmcnt(20)
  s_barrier
  ds_read_b64_tr_b16 a[0:1], v3 offset:49152
  ds_read_b64_tr_b16 a[2:3], v3 offset:53248
  v_cvt_pk_bf16_f32 v112, v8, v9
  v_fmac_f32 v6, v8, v8
  v_mfma_f32_32x32x16_bf16 v[160:175], a[8:11], v[108:111], v[160:175]
  ds_read_b64_tr_b16 a[4:5], v3 offset:49408
  ds_read_b64_tr_b16 a[6:7], v3 offset:53504
  v_fmac_f32 v7, v9, v9
  v_lshlrev_b32 v10, 16, v113
  v_and_b32 v11, 0xffff0000, v113
  v_sub_f32 v10, v10, v5
  s_waitcnt lgkmcnt(6)
  v_mfma_f32_32x32x16_bf16 v[176:191], a[12:15], v[108:111], v[176:191]
  s_add_u32 m0, s31, 0
  s_add_u32 s6, s2, 81920
  s_and_b32 s6, s6, 0x3ffff
  ds_read_b64_tr_b16 a[8:9], v3 offset:49664
  ds_read_b64_tr_b16 a[10:11], v3 offset:53760
  buffer_load_dwordx4 v4, s[48:51], s6 offen offset:0 lds
  v_mfma_f32_32x32x16_bf16 v[192:207], a[16:19], v[108:111], v[192:207]
  ds_read_b64_tr_b16 a[12:13], v3 offset:49920
  ds_read_b64_tr_b16 a[14:15], v3 offset:54016
  v_sub_f32 v11, v11, v5
  v_cvt_pk_bf16_f32 v113, v10, v11
  v_fmac_f32 v6, v10, v10
  v_fmac_f32 v7, v11, v11
  v_mfma_f32_32x32x16_bf16 v[208:223], a[20:23], v[108:111], v[208:223]
  ds_read_b64_tr_b16 a[16:17], v3 offset:50176
  ds_read_b64_tr_b16 a[18:19], v3 offset:54272
  v_lshlrev_b32 v12, 16, v114
  v_and_b32 v13, 0xffff0000, v114
  v_sub_f32 v12, v12, v5
  v_sub_f32 v13, v13, v5
  v_mfma_f32_32x32x16_bf16 v[224:239], a[24:27], v[108:111], v[224:239]
  ds_read_b64_tr_b16 a[20:21], v3 offset:50432
  ds_read_b64_tr_b16 a[22:23], v3 offset:54528
  v_cvt_pk_bf16_f32 v114, v12, v13
  v_fmac_f32 v6, v12, v12
  v_fmac_f32 v7, v13, v13
  v_lshlrev_b32 v14, 16, v115
  s_waitcnt lgkmcnt(6)
  v_mfma_f32_32x32x16_bf16 v[240:255], a[28:31], v[108:111], v[240:255]
  ds_read_b64_tr_b16 a[24:25], v3 offset:50688
  ds_read_b64_tr_b16 a[26:27], v3 offset:54784
  buffer_load_dwordx4 v4, s[52:55], s6 offen offset:1024 lds
  v_and_b32 v15, 0xffff0000, v115
  v_sub_f32 v14, v14, v5
  v_sub_f32 v15, v15, v5
  v_cvt_pk_bf16_f32 v115, v14, v15
  v_fmac_f32 v6, v14, v14
  v_fmac_f32 v7, v15, v15
  v_mfma_f32_32x32x16_bf16 v[128:143], a[0:3], v[112:115], v[128:143]
  ds_read_b64_tr_b16 a[28:29], v3 offset:50944
  ds_read_b64_tr_b16 a[30:31], v3 offset:55040
  v_lshlrev_b32 v8, 16, v116
  v_and_b32 v9, 0xffff0000, v116
  v_sub_f32 v8, v8, v5
  v_sub_f32 v9, v9, v5
  v_mfma_f32_32x32x16_bf16 v[144:159], a[4:7], v[112:115], v[144:159]
  ds_read_b64_tr_b16 a[0:1], v3 offset:51200
  ds_read_b64_tr_b16 a[2:3], v3 offset:55296
  v_cvt_pk_bf16_f32 v116, v8, v9
  v_fmac_f32 v6, v8, v8
  v_fmac_f32 v7, v9, v9
  v_lshlrev_b32 v10, 16, v117
  v_mfma_f32_32x32x16_bf16 v[160:175], a[8:11], v[112:115], v[160:175]
  ds_read_b64_tr_b16 a[4:5], v3 offset:51456
  ds_read_b64_tr_b16 a[6:7], v3 offset:55552
  v_and_b32 v11, 0xffff0000, v117
  v_sub_f32 v10, v10, v5
  v_sub_f32 v11, v11, v5
  v_cvt_pk_bf16_f32 v117, v10, v11
  s_waitcnt lgkmcnt(6)
  v_mfma_f32_32x32x16_bf16 v[176:191], a[12:15], v[112:115], v[176:191]
  ds_read_b64_tr_b16 a[8:9], v3 offset:51712
  ds_read_b64_tr_b16 a[10:11], v3 offset:55808
  buffer_load_dwordx4 v4, s[56:59], s6 offen offset:2048 lds
  v_fmac_f32 v6, v10, v10
  v_mfma_f32_32x32x16_bf16 v[192:207], a[16:19], v[112:115], v[192:207]
  ds_read_b64_tr_b16 a[12:13], v3 offset:51968
  ds_read_b64_tr_b16 a[14:15], v3 offset:56064
  v_fmac_f32 v7, v11, v11
  v_lshlrev_b32 v12, 16, v118
  v_and_b32 v13, 0xffff0000, v118
  v_sub_f32 v12, v12, v5
  v_mfma_f32_32x32x16_bf16 v[208:223], a[20:23], v[112:115], v[208:223]
  ds_read_b64_tr_b16 a[16:17], v3 offset:52224
  ds_read_b64_tr_b16 a[18:19], v3 offset:56320
  v_sub_f32 v13, v13, v5
  v_cvt_pk_bf16_f32 v118, v12, v13
  v_fmac_f32 v6, v12, v12
  v_fmac_f32 v7, v13, v13
  v_mfma_f32_32x32x16_bf16 v[224:239], a[24:27], v[112:115], v[224:239]
  ds_read_b64_tr_b16 a[20:21], v3 offset:52480
  ds_read_b64_tr_b16 a[22:23], v3 offset:56576
  v_lshlrev_b32 v14, 16, v119
  v_and_b32 v15, 0xffff0000, v119
  v_sub_f32 v14, v14, v5
  v_sub_f32 v15, v15, v5
  s_waitcnt lgkmcnt(6)
  v_mfma_f32_32x32x16_bf16 v[240:255], a[28:31], v[112:115], v[240:255]
  ds_read_b64_tr_b16 a[24:25], v3 offset:52736
  ds_read_b64_tr_b16 a[26:27], v3 offset:56832
  buffer_load_dwordx4 v4, s[60:63], s6 offen offset:3072 lds
  v_cvt_pk_bf16_f32 v119, v14, v15
  v_fmac_f32 v6, v14, v14
  v_fmac_f32 v7, v15, v15
  v_mfma_f32_32x32x16_bf16 v[128:143], a[0:3], v[116:119], v[128:143]
  ds_read_b64_tr_b16 a[28:29], v3 offset:52992
  ds_read_b64_tr_b16 a[30:31], v3 offset:57088
  v_lshlrev_b32 v8, 16, v120
  v_and_b32 v9, 0xffff0000, v120
  v_sub_f32 v8, v8, v5
  v_add_u32 v3, 0x00010000, v3
  v_mfma_f32_32x32x16_bf16 v[144:159], a[4:7], v[116:119], v[144:159]
  ds_read_b64_tr_b16 a[0:1], v3 offset:0
  ds_read_b64_tr_b16 a[2:3], v3 offset:4096
  v_sub_f32 v9, v9, v5
  v_cvt_pk_bf16_f32 v120, v8, v9
  v_fmac_f32 v6, v8, v8
  v_fmac_f32 v7, v9, v9
  v_mfma_f32_32x32x16_bf16 v[160:175], a[8:11], v[116:119], v[160:175]
  ds_read_b64_tr_b16 a[4:5], v3 offset:256
  ds_read_b64_tr_b16 a[6:7], v3 offset:4352
  v_lshlrev_b32 v10, 16, v121
  v_and_b32 v11, 0xffff0000, v121
  v_sub_f32 v10, v10, v5
  v_sub_f32 v11, v11, v5
  s_waitcnt lgkmcnt(6)
  v_mfma_f32_32x32x16_bf16 v[176:191], a[12:15], v[116:119], v[176:191]
  s_add_u32 m0, s31, 16384
  s_add_u32 s6, s2, 98304
  s_and_b32 s6, s6, 0x3ffff
  ds_read_b64_tr_b16 a[8:9], v3 offset:512
  ds_read_b64_tr_b16 a[10:11], v3 offset:4608
  buffer_load_dwordx4 v4, s[48:51], s6 offen offset:0 lds
  v_mfma_f32_32x32x16_bf16 v[192:207], a[16:19], v[116:119], v[192:207]
  ds_read_b64_tr_b16 a[12:13], v3 offset:768
  ds_read_b64_tr_b16 a[14:15], v3 offset:4864
  v_cvt_pk_bf16_f32 v121, v10, v11
  v_fmac_f32 v6, v10, v10
  v_fmac_f32 v7, v11, v11
  v_lshlrev_b32 v12, 16, v122
  v_mfma_f32_32x32x16_bf16 v[208:223], a[20:23], v[116:119], v[208:223]
  ds_read_b64_tr_b16 a[16:17], v3 offset:1024
  ds_read_b64_tr_b16 a[18:19], v3 offset:5120
  v_and_b32 v13, 0xffff0000, v122
  v_sub_f32 v12, v12, v5
  v_sub_f32 v13, v13, v5
  v_cvt_pk_bf16_f32 v122, v12, v13
  v_mfma_f32_32x32x16_bf16 v[224:239], a[24:27], v[116:119], v[224:239]
  ds_read_b64_tr_b16 a[20:21], v3 offset:1280
  ds_read_b64_tr_b16 a[22:23], v3 offset:5376
  v_fmac_f32 v6, v12, v12
  v_fmac_f32 v7, v13, v13
  v_lshlrev_b32 v14, 16, v123
  v_and_b32 v15, 0xffff0000, v123
  s_waitcnt lgkmcnt(6)
  v_mfma_f32_32x32x16_bf16 v[240:255], a[28:31], v[116:119], v[240:255]
  ds_read_b64_tr_b16 a[24:25], v3 offset:1536
  ds_read_b64_tr_b16 a[26:27], v3 offset:5632
  buffer_load_dwordx4 v4, s[52:55], s6 offen offset:1024 lds
  v_sub_f32 v14, v14, v5
  v_sub_f32 v15, v15, v5
  v_cvt_pk_bf16_f32 v123, v14, v15
  v_fmac_f32 v6, v14, v14
  v_fmac_f32 v7, v15, v15
  v_mfma_f32_32x32x16_bf16 v[128:143], a[0:3], v[120:123], v[128:143]
  ds_read_b64_tr_b16 a[28:29], v3 offset:1792
  ds_read_b64_tr_b16 a[30:31], v3 offset:5888
  v_lshlrev_b32 v8, 16, v124
  v_and_b32 v9, 0xffff0000, v124
  v_sub_f32 v8, v8, v5
  v_sub_f32 v9, v9, v5
  v_mfma_f32_32x32x16_bf16 v[144:159], a[4:7], v[120:123], v[144:159]
  ds_read_b64_tr_b16 a[0:1], v3 offset:2048
  ds_read_b64_tr_b16 a[2:3], v3 offset:6144
  v_cvt_pk_bf16_f32 v124, v8, v9
  v_fmac_f32 v6, v8, v8
  v_fmac_f32 v7, v9, v9
  v_lshlrev_b32 v10, 16, v125
  v_mfma_f32_32x32x16_bf16 v[160:175], a[8:11], v[120:123], v[160:175]
  ds_read_b64_tr_b16 a[4:5], v3 offset:2304
  ds_read_b64_tr_b16 a[6:7], v3 offset:6400
  v_and_b32 v11, 0xffff0000, v125
  v_sub_f32 v10, v10, v5
  v_sub_f32 v11, v11, v5
  v_cvt_pk_bf16_f32 v125, v10, v11
  s_waitcnt lgkmcnt(6)
  v_mfma_f32_32x32x16_bf16 v[176:191], a[12:15], v[120:123], v[176:191]
  ds_read_b64_tr_b16 a[8:9], v3 offset:2560
  ds_read_b64_tr_b16 a[10:11], v3 offset:6656
  buffer_load_dwordx4 v4, s[56:59], s6 offen offset:2048 lds
  v_fmac_f32 v6, v10, v10
  v_mfma_f32_32x32x16_bf16 v[192:207], a[16:19], v[120:123], v[192:207]
  ds_read_b64_tr_b16 a[12:13], v3 offset:2816
  ds_read_b64_tr_b16 a[14:15], v3 offset:6912
  v_fmac_f32 v7, v11, v11
  v_lshlrev_b32 v12, 16, v126
  v_and_b32 v13, 0xffff0000, v126
  v_sub_f32 v12, v12, v5
  v_mfma_f32_32x32x16_bf16 v[208:223], a[20:23], v[120:123], v[208:223]
  ds_read_b64_tr_b16 a[16:17], v3 offset:3072
  ds_read_b64_tr_b16 a[18:19], v3 offset:7168
  v_sub_f32 v13, v13, v5
  v_cvt_pk_bf16_f32 v126, v12, v13
  v_fmac_f32 v6, v12, v12
  v_fmac_f32 v7, v13, v13
  v_mfma_f32_32x32x16_bf16 v[224:239], a[24:27], v[120:123], v[224:239]
  ds_read_b64_tr_b16 a[20:21], v3 offset:3328
  ds_read_b64_tr_b16 a[22:23], v3 offset:7424
  v_lshlrev_b32 v14, 16, v127
  v_and_b32 v15, 0xffff0000, v127
  v_sub_f32 v14, v14, v5
  v_sub_f32 v15, v15, v5
  s_waitcnt lgkmcnt(6)
  v_mfma_f32_32x32x16_bf16 v[240:255], a[28:31], v[120:123], v[240:255]
  ds_read_b64_tr_b16 a[24:25], v3 offset:3584
  ds_read_b64_tr_b16 a[26:27], v3 offset:7680
  buffer_load_dwordx4 v4, s[60:63], s6 offen offset:3072 lds
  v_cvt_pk_bf16_f32 v127, v14, v15
  v_fmac_f32 v6, v14, v14
  v_fmac_f32 v7, v15, v15
  v_accvgpr_read_b32 v8, a244
  v_accvgpr_read_b32 v9, a245
  v_mfma_f32_32x32x16_bf16 v[128:143], a[0:3], v[124:127], v[128:143]
  ds_read_b64_tr_b16 a[28:29], v3 offset:3840
  ds_read_b64_tr_b16 a[30:31], v3 offset:7936
  v_accvgpr_read_b32 v1, a242
  v_accvgpr_read_b32 v2, a243
  v_add_u32 v8, 0x00010000, v8
  v_mfma_f32_32x32x16_bf16 v[144:159], a[4:7], v[124:127], v[144:159]
  s_waitcnt vmcnt(20)
  s_barrier
  ds_read_b128 a[0:3], v8 offset:16384
  v_add_u32 v9, 0x00010000, v9
  v_mfma_f32_32x32x16_bf16 v[160:175], a[8:11], v[124:127], v[160:175]
  ds_read_b128 a[4:7], v9 offset:16384
  s_waitcnt lgkmcnt(4)
  v_mfma_f32_32x32x16_bf16 v[176:191], a[12:15], v[124:127], v[176:191]
  s_add_u32 m0, s31, 32768
  s_add_u32 s6, s2, 114688
  s_and_b32 s6, s6, 0x3ffff
  ds_read_b128 a[8:11], v8 offset:16640
  buffer_load_dwordx4 v4, s[48:51], s6 offen offset:0 lds
  v_mfma_f32_32x32x16_bf16 v[192:207], a[16:19], v[124:127], v[192:207]
  ds_read_b128 a[12:15], v9 offset:16640
  v_cvt_pk_bf16_f32 v128, v128, v129
  v_cvt_pk_bf16_f32 v129, v130, v131
  v_cvt_pk_bf16_f32 v130, v132, v133
  v_cvt_pk_bf16_f32 v131, v134, v135
  v_cvt_pk_bf16_f32 v132, v136, v137
  v_mfma_f32_32x32x16_bf16 v[208:223], a[20:23], v[124:127], v[208:223]
  ds_read_b128 a[16:19], v8 offset:17408
  v_cvt_pk_bf16_f32 v133, v138, v139
  v_cvt_pk_bf16_f32 v134, v140, v141
  v_cvt_pk_bf16_f32 v135, v142, v143
  v_accvgpr_write_b32 a96, v128
  v_accvgpr_write_b32 a97, v129
  v_mfma_f32_32x32x16_bf16 v[224:239], a[24:27], v[124:127], v[224:239]
  ds_read_b128 a[20:23], v9 offset:17408
  v_accvgpr_write_b32 a98, v130
  v_accvgpr_write_b32 a99, v131
  v_accvgpr_write_b32 a100, v132
  v_accvgpr_write_b32 a101, v133
  v_accvgpr_write_b32 a102, v134
  s_waitcnt lgkmcnt(3)
  v_mfma_f32_32x32x16_bf16 v[240:255], a[28:31], v[124:127], v[240:255]
  ds_read_b128 a[24:27], v8 offset:17664
  buffer_load_dwordx4 v4, s[52:55], s6 offen offset:1024 lds
  v_accvgpr_write_b32 a103, v135
  v_cvt_pk_bf16_f32 v144, v144, v145
  v_mfma_f32_32x32x16_bf16 v[16:31], a[0:3], a[96:99], 0
  ds_read_b128 a[28:31], v9 offset:17664
  v_cvt_pk_bf16_f32 v145, v146, v147
  v_cvt_pk_bf16_f32 v146, v148, v149
  v_cvt_pk_bf16_f32 v147, v150, v151
  v_cvt_pk_bf16_f32 v148, v152, v153
  v_cvt_pk_bf16_f32 v149, v154, v155
  v_mfma_f32_32x32x16_bf16 v[16:31], a[4:7], a[100:103], v[16:31]
  ds_read_b128 a[0:3], v8 offset:18432
  v_cvt_pk_bf16_f32 v150, v156, v157
  v_cvt_pk_bf16_f32 v151, v158, v159
  v_accvgpr_write_b32 a104, v144
  v_accvgpr_write_b32 a105, v145
  v_accvgpr_write_b32 a106, v146
  v_accvgpr_write_b32 a107, v147
  v_accvgpr_write_b32 a108, v148
  v_accvgpr_write_b32 a109, v149
  v_accvgpr_write_b32 a110, v150
  v_accvgpr_write_b32 a111, v151
  v_mfma_f32_32x32x16_bf16 v[16:31], a[8:11], a[104:107], v[16:31]
  ds_read_b128 a[4:7], v9 offset:18432
  v_cvt_pk_bf16_f32 v160, v160, v161
  v_cvt_pk_bf16_f32 v161, v162, v163
  v_cvt_pk_bf16_f32 v162, v164, v165
  v_cvt_pk_bf16_f32 v163, v166, v167
  v_cvt_pk_bf16_f32 v164, v168, v169
  s_waitcnt lgkmcnt(3)
  v_mfma_f32_32x32x16_bf16 v[16:31], a[12:15], a[108:111], v[16:31]
  ds_read_b128 a[8:11], v8 offset:18688
  buffer_load_dwordx4 v4, s[56:59], s6 offen offset:2048 lds
  v_cvt_pk_bf16_f32 v165, v170, v171
  v_cvt_pk_bf16_f32 v166, v172, v173
  v_cvt_pk_bf16_f32 v167, v174, v175
  v_accvgpr_write_b32 a112, v160
  v_accvgpr_write_b32 a113, v161
  v_accvgpr_write_b32 a114, v162
  v_accvgpr_write_b32 a115, v163
  v_accvgpr_write_b32 a116, v164
  v_accvgpr_write_b32 a117, v165
  v_accvgpr_write_b32 a118, v166
  v_accvgpr_write_b32 a119, v167
  v_mfma_f32_32x32x16_bf16 v[16:31], a[16:19], a[112:115], v[16:31]
  ds_read_b128 a[12:15], v9 offset:18688
  v_cvt_pk_bf16_f32 v176, v176, v177
  v_cvt_pk_bf16_f32 v177, v178, v179
  v_cvt_pk_bf16_f32 v178, v180, v181
  v_cvt_pk_bf16_f32 v179, v182, v183
  v_cvt_pk_bf16_f32 v180, v184, v185
  v_mfma_f32_32x32x16_bf16 v[16:31], a[20:23], a[116:119], v[16:31]
  ds_read_b128 a[16:19], v8 offset:19456
  v_cvt_pk_bf16_f32 v181, v186, v187
  v_cvt_pk_bf16_f32 v182, v188, v189
  v_cvt_pk_bf16_f32 v183, v190, v191
  v_accvgpr_write_b32 a120, v176
  v_accvgpr_write_b32 a121, v177
  v_accvgpr_write_b32 a122, v178
  v_accvgpr_write_b32 a123, v179
  v_accvgpr_write_b32 a124, v180
  v_accvgpr_write_b32 a125, v181
  v_accvgpr_write_b32 a126, v182
  v_accvgpr_write_b32 a127, v183
  v_mfma_f32_32x32x16_bf16 v[16:31], a[24:27], a[120:123], v[16:31]
  ds_read_b128 a[20:23], v9 offset:19456
  v_cvt_pk_bf16_f32 v192, v192, v193
  v_cvt_pk_bf16_f32 v193, v194, v195
  v_cvt_pk_bf16_f32 v194, v196, v197
  v_cvt_pk_bf16_f32 v195, v198, v199
  v_cvt_pk_bf16_f32 v196, v200, v201
  s_waitcnt lgkmcnt(3)
  v_mfma_f32_32x32x16_bf16 v[16:31], a[28:31], a[124:127], v[16:31]
  ds_read_b128 a[24:27], v8 offset:19712
  buffer_load_dwordx4 v4, s[60:63], s6 offen offset:3072 lds
  v_cvt_pk_bf16_f32 v197, v202, v203
  v_cvt_pk_bf16_f32 v198, v204, v205
  v_cvt_pk_bf16_f32 v199, v206, v207
  v_accvgpr_write_b32 a128, v192
  v_accvgpr_write_b32 a129, v193
  v_accvgpr_write_b32 a130, v194
  v_accvgpr_write_b32 a131, v195
  v_accvgpr_write_b32 a132, v196
  v_accvgpr_write_b32 a133, v197
  v_accvgpr_write_b32 a134, v198
  v_accvgpr_write_b32 a135, v199
  v_mfma_f32_32x32x16_bf16 v[16:31], a[0:3], a[128:131], v[16:31]
  ds_read_b128 a[28:31], v9 offset:19712
  v_cvt_pk_bf16_f32 v208, v208, v209
  v_cvt_pk_bf16_f32 v209, v210, v211
  v_cvt_pk_bf16_f32 v210, v212, v213
  v_cvt_pk_bf16_f32 v211, v214, v215
  v_cvt_pk_bf16_f32 v212, v216, v217
  v_mfma_f32_32x32x16_bf16 v[16:31], a[4:7], a[132:135], v[16:31]
  ds_read_b128 a[0:3], v8 offset:32768
  v_cvt_pk_bf16_f32 v213, v218, v219
  v_cvt_pk_bf16_f32 v214, v220, v221
  v_cvt_pk_bf16_f32 v215, v222, v223
  v_accvgpr_write_b32 a136, v208
  v_accvgpr_write_b32 a137, v209
  v_accvgpr_write_b32 a138, v210
  v_accvgpr_write_b32 a139, v211
  v_accvgpr_write_b32 a140, v212
  v_accvgpr_write_b32 a141, v213
  v_accvgpr_write_b32 a142, v214
  v_accvgpr_write_b32 a143, v215
  v_mfma_f32_32x32x16_bf16 v[16:31], a[8:11], a[136:139], v[16:31]
  ds_read_b128 a[4:7], v9 offset:32768
  v_add_f32 v10, v6, v7
  v_mov_b32 v11, v10
  s_nop 1
  v_permlane32_swap_b32 v10, v11
  v_add_f32 v10, v10, v11
  v_mul_f32 v10, 0x3b124925, v10
  s_waitcnt lgkmcnt(3)
  v_mfma_f32_32x32x16_bf16 v[16:31], a[12:15], a[140:143], v[16:31]
  s_add_u32 m0, s31, 49152
  s_add_u32 s6, s2, 131072
  s_and_b32 s6, s6, 0x3ffff
  ds_read_b128 a[8:11], v8 offset:33024
  buffer_load_dwordx4 v4, s[48:51], s6 offen offset:0 lds
  v_cvt_pk_bf16_f32 v10, v10, v10
  v_and_b32 v10, 0xffff0000, v10
  v_add_f32 v10, 0x3727c5ac, v10
  v_cvt_pk_bf16_f32 v10, v10, v10
  v_and_b32 v10, 0xffff0000, v10
  v_sqrt_f32 v10, v10
  s_nop 0
  v_cvt_pk_bf16_f32 v12, v10, v10
  v_and_b32 v10, 0xffff0000, v12
  v_rcp_f32 v10, v10
  v_mov_b32 v13, v12
  v_mov_b32 v14, v12
  v_mov_b32 v15, v12
  v_mul_f32 v5, 0x3db8aa3b, v10
  v_mul_f32 v6, 0xc0135761, v10
  v_mov_b32 v7, 0xff800000
L_padl3:
  s_cbranch_execz L_padl7
  v_cvt_pk_bf16_f32 v224, v224, v225
  v_cvt_pk_bf16_f32 v225, v226, v227
  v_cvt_pk_bf16_f32 v226, v228, v229
  v_cvt_pk_bf16_f32 v227, v230, v231
  v_cvt_pk_bf16_f32 v228, v232, v233
  v_cvt_pk_bf16_f32 v229, v234, v235
  v_cvt_pk_bf16_f32 v230, v236, v237
  v_cvt_pk_bf16_f32 v231, v238, v239
  v_accvgpr_write_b32 a144, v224
  v_accvgpr_write_b32 a145, v225
  v_accvgpr_write_b32 a146, v226
  v_accvgpr_write_b32 a147, v227
  v_accvgpr_write_b32 a148, v228
  v_accvgpr_write_b32 a149, v229
  v_accvgpr_write_b32 a150, v230
  v_accvgpr_write_b32 a151, v231
  v_mfma_f32_32x32x16_bf16 v[16:31], a[16:19], a[144:147], v[16:31]
  ds_read_b128 a[12:15], v9 offset:33024
  v_cvt_pk_bf16_f32 v240, v240, v241
  v_cvt_pk_bf16_f32 v241, v242, v243
  v_cvt_pk_bf16_f32 v242, v244, v245
  v_cvt_pk_bf16_f32 v243, v246, v247
  v_cvt_pk_bf16_f32 v244, v248, v249
  v_mfma_f32_32x32x16_bf16 v[16:31], a[20:23], a[148:151], v[16:31]
  ds_read_b128 a[16:19], v8 offset:33792
  v_cvt_pk_bf16_f32 v245, v250, v251
  v_cvt_pk_bf16_f32 v246, v252, v253
  v_cvt_pk_bf16_f32 v247, v254, v255
  v_accvgpr_write_b32 a152, v240
  v_accvgpr_write_b32 a153, v241
  v_accvgpr_write_b32 a154, v242
  v_accvgpr_write_b32 a155, v243
  v_accvgpr_write_b32 a156, v244
  v_accvgpr_write_b32 a157, v245
  v_accvgpr_write_b32 a158, v246
  v_accvgpr_write_b32 a159, v247
  v_mfma_f32_32x32x16_bf16 v[16:31], a[24:27], a[152:155], v[16:31]
  ds_read_b128 a[20:23], v9 offset:33792
  v_accvgpr_read_b32 v12, a246
  v_accvgpr_read_b32 v3, a241
  s_waitcnt lgkmcnt(3)
  v_mfma_f32_32x32x16_bf16 v[16:31], a[28:31], a[156:159], v[16:31]
  ds_read_b128 a[24:27], v8 offset:34048
  buffer_load_dwordx4 v4, s[52:55], s6 offen offset:1024 lds
  v_mfma_f32_32x32x16_bf16 v[32:47], a[0:3], a[96:99], 0
  ds_read_b128 a[28:31], v9 offset:34048
  v_mfma_f32_32x32x16_bf16 v[32:47], a[4:7], a[100:103], v[32:47]
  ds_read_b128 a[0:3], v8 offset:34816
  v_mfma_f32_32x32x16_bf16 v[32:47], a[8:11], a[104:107], v[32:47]
  ds_read_b128 a[4:7], v9 offset:34816
  s_nop 3
  v_max3_f32 v7, v7, v16, v17
  v_max3_f32 v7, v7, v18, v19
  v_max3_f32 v7, v7, v20, v21
  v_max3_f32 v7, v7, v22, v23
  v_max3_f32 v7, v7, v24, v25
  s_waitcnt lgkmcnt(3)
  v_mfma_f32_32x32x16_bf16 v[32:47], a[12:15], a[108:111], v[32:47]
  ds_read_b128 a[8:11], v8 offset:35072
  buffer_load_dwordx4 v4, s[56:59], s6 offen offset:2048 lds
  v_max3_f32 v7, v7, v26, v27
  v_max3_f32 v7, v7, v28, v29
  v_mfma_f32_32x32x16_bf16 v[32:47], a[16:19], a[112:115], v[32:47]
  ds_read_b128 a[12:15], v9 offset:35072
  v_max3_f32 v7, v7, v30, v31
  v_mfma_f32_32x32x16_bf16 v[32:47], a[20:23], a[116:119], v[32:47]
  ds_read_b128 a[16:19], v8 offset:35840
  v_mfma_f32_32x32x16_bf16 v[32:47], a[24:27], a[120:123], v[32:47]
  ds_read_b128 a[20:23], v9 offset:35840
  s_waitcnt lgkmcnt(3)
  v_mfma_f32_32x32x16_bf16 v[32:47], a[28:31], a[124:127], v[32:47]
  ds_read_b128 a[24:27], v8 offset:36096
  buffer_load_dwordx4 v4, s[60:63], s6 offen offset:3072 lds
  v_mfma_f32_32x32x16_bf16 v[32:47], a[0:3], a[128:131], v[32:47]
  ds_read_b128 a[28:31], v9 offset:36096
  v_mfma_f32_32x32x16_bf16 v[32:47], a[4:7], a[132:135], v[32:47]
  s_waitcnt vmcnt(20)
  s_barrier
  ds_read_b128 a[0:3], v8 offset:49152
  v_mfma_f32_32x32x16_bf16 v[32:47], a[8:11], a[136:139], v[32:47]
  ds_read_b128 a[4:7], v9 offset:49152
  s_waitcnt lgkmcnt(3)
  v_mfma_f32_32x32x16_bf16 v[32:47], a[12:15], a[140:143], v[32:47]
  s_add_u32 m0, s31, 65536
  s_add_u32 s6, s2, 147456
  s_and_b32 s6, s6, 0x3ffff
  ds_read_b128 a[8:11], v8 offset:49408
  buffer_load_dwordx4 v4, s[48:51], s6 offen offset:0 lds
  v_mfma_f32_32x32x16_bf16 v[32:47], a[16:19], a[144:147], v[32:47]
  ds_read_b128 a[12:15], v9 offset:49408
  v_mfma_f32_32x32x16_bf16 v[32:47], a[20:23], a[148:151], v[32:47]
  ds_read_b128 a[16:19], v8 offset:50176
  v_mfma_f32_32x32x16_bf16 v[32:47], a[24:27], a[152:155], v[32:47]
  ds_read_b128 a[20:23], v9 offset:50176
  s_waitcnt lgkmcnt(3)
  v_mfma_f32_32x32x16_bf16 v[32:47], a[28:31], a[156:159], v[32:47]
  ds_read_b128 a[24:27], v8 offset:50432
  buffer_load_dwordx4 v4, s[52:55], s6 offen offset:1024 lds
  v_mfma_f32_32x32x16_bf16 v[48:63], a[0:3], a[96:99], 0
  ds_read_b128 a[28:31], v9 offset:50432
  s_lshl_b32 s26, s97, 4
  v_mfma_f32_32x32x16_bf16 v[48:63], a[4:7], a[100:103], v[48:63]
  ds_read_b128 a[0:3], v8 offset:51200
  buffer_load_dwordx2 v[14:15], off, s[92:95], s26 sc1
  v_mfma_f32_32x32x16_bf16 v[48:63], a[8:11], a[104:107], v[48:63]
  ds_read_b128 a[4:7], v9 offset:51200
  s_nop 1
  v_max3_f32 v7, v7, v32, v33
  v_max3_f32 v7, v7, v34, v35
  v_max3_f32 v7, v7, v36, v37
  v_max3_f32 v7, v7, v38, v39
  v_max3_f32 v7, v7, v40, v41
  s_waitcnt lgkmcnt(3)
  v_mfma_f32_32x32x16_bf16 v[48:63], a[12:15], a[108:111], v[48:63]
  ds_read_b128 a[8:11], v8 offset:51456
  buffer_load_dwordx4 v4, s[56:59], s6 offen offset:2048 lds
  v_max3_f32 v7, v7, v42, v43
  v_max3_f32 v7, v7, v44, v45
  v_mfma_f32_32x32x16_bf16 v[48:63], a[16:19], a[112:115], v[48:63]
  ds_read_b128 a[12:15], v9 offset:51456
  v_max3_f32 v7, v7, v46, v47
  v_mfma_f32_32x32x16_bf16 v[48:63], a[20:23], a[116:119], v[48:63]
  ds_read_b128 a[16:19], v8 offset:52224
  v_mfma_f32_32x32x16_bf16 v[48:63], a[24:27], a[120:123], v[48:63]
  ds_read_b128 a[20:23], v9 offset:52224
  s_waitcnt lgkmcnt(3)
  v_mfma_f32_32x32x16_bf16 v[48:63], a[28:31], a[124:127], v[48:63]
  ds_read_b128 a[24:27], v8 offset:52480
  buffer_load_dwordx4 v4, s[60:63], s6 offen offset:3072 lds
  v_mfma_f32_32x32x16_bf16 v[48:63], a[0:3], a[128:131], v[48:63]
  ds_read_b128 a[28:31], v9 offset:52480
  v_add_u32 v8, 0x00010000, v8
  v_mfma_f32_32x32x16_bf16 v[48:63], a[4:7], a[132:135], v[48:63]
  ds_read_b128 a[0:3], v8 offset:0
  v_add_u32 v9, 0x00010000, v9
  v_mfma_f32_32x32x16_bf16 v[48:63], a[8:11], a[136:139], v[48:63]
  ds_read_b128 a[4:7], v9 offset:0
  s_waitcnt lgkmcnt(3)
  v_mfma_f32_32x32x16_bf16 v[48:63], a[12:15], a[140:143], v[48:63]
  s_add_u32 m0, s31, 81920
  s_add_u32 s6, s2, 163840
  s_and_b32 s6, s6, 0x3ffff
  ds_read_b128 a[8:11], v8 offset:256
  buffer_load_dwordx4 v4, s[48:51], s6 offen offset:0 lds
  v_mfma_f32_32x32x16_bf16 v[48:63], a[16:19], a[144:147], v[48:63]
  ds_read_b128 a[12:15], v9 offset:256
  v_mfma_f32_32x32x16_bf16 v[48:63], a[20:23], a[148:151], v[48:63]
  ds_read_b128 a[16:19], v8 offset:1024
  v_mfma_f32_32x32x16_bf16 v[48:63], a[24:27], a[152:155], v[48:63]
  ds_read_b128 a[20:23], v9 offset:1024
  s_waitcnt lgkmcnt(3)
  v_mfma_f32_32x32x16_bf16 v[48:63], a[28:31], a[156:159], v[48:63]
  ds_read_b128 a[24:27], v8 offset:1280
  buffer_load_dwordx4 v4, s[52:55], s6 offen offset:1024 lds
  v_mfma_f32_32x32x16_bf16 v[64:79], a[0:3], a[96:99], 0
  ds_read_b128 a[28:31], v9 offset:1280
  v_mfma_f32_32x32x16_bf16 v[64:79], a[4:7], a[100:103], v[64:79]
  ds_read_b128 a[0:3], v8 offset:2048
  v_mfma_f32_32x32x16_bf16 v[64:79], a[8:11], a[104:107], v[64:79]
  ds_read_b128 a[4:7], v9 offset:2048
  s_nop 3
  v_max3_f32 v7, v7, v48, v49
  v_max3_f32 v7, v7, v50, v51
  v_max3_f32 v7, v7, v52, v53
  v_max3_f32 v7, v7, v54, v55
  v_max3_f32 v7, v7, v56, v57
  s_waitcnt lgkmcnt(3)
  v_mfma_f32_32x32x16_bf16 v[64:79], a[12:15], a[108:111], v[64:79]
  ds_read_b128 a[8:11], v8 offset:2304
  buffer_load_dwordx4 v4, s[56:59], s6 offen offset:2048 lds
  v_max3_f32 v7, v7, v58, v59
  v_max3_f32 v7, v7, v60, v61
  v_mfma_f32_32x32x16_bf16 v[64:79], a[16:19], a[112:115], v[64:79]
  ds_read_b128 a[12:15], v9 offset:2304
  v_max3_f32 v7, v7, v62, v63
  v_mfma_f32_32x32x16_bf16 v[64:79], a[20:23], a[116:119], v[64:79]
  ds_read_b128 a[16:19], v8 offset:3072
  v_mfma_f32_32x32x16_bf16 v[64:79], a[24:27], a[120:123], v[64:79]
  ds_read_b128 a[20:23], v9 offset:3072
  s_waitcnt lgkmcnt(3)
  v_mfma_f32_32x32x16_bf16 v[64:79], a[28:31], a[124:127], v[64:79]
  ds_read_b128 a[24:27], v8 offset:3328
  buffer_load_dwordx4 v4, s[60:63], s6 offen offset:3072 lds
  v_mfma_f32_32x32x16_bf16 v[64:79], a[0:3], a[128:131], v[64:79]
  ds_read_b128 a[28:31], v9 offset:3328
  v_mfma_f32_32x32x16_bf16 v[64:79], a[4:7], a[132:135], v[64:79]
  s_waitcnt vmcnt(21)
  s_barrier
  ds_read_b128 a[0:3], v8 offset:16384
  v_mfma_f32_32x32x16_bf16 v[64:79], a[8:11], a[136:139], v[64:79]
  ds_read_b128 a[4:7], v9 offset:16384
  s_waitcnt lgkmcnt(3)
  v_mfma_f32_32x32x16_bf16 v[64:79], a[12:15], a[140:143], v[64:79]
  s_add_u32 m0, s31, 98304
  s_add_u32 s6, s2, 180224
  s_and_b32 s6, s6, 0x3ffff
  ds_read_b128 a[8:11], v8 offset:16640
  buffer_load_dwordx4 v4, s[48:51], s6 offen offset:0 lds
  v_mfma_f32_32x32x16_bf16 v[64:79], a[16:19], a[144:147], v[64:79]
  ds_read_b128 a[12:15], v9 offset:16640
  v_mfma_f32_32x32x16_bf16 v[64:79], a[20:23], a[148:151], v[64:79]
  ds_read_b128 a[16:19], v8 offset:17408
  v_mfma_f32_32x32x16_bf16 v[64:79], a[24:27], a[152:155], v[64:79]
  ds_read_b128 a[20:23], v9 offset:17408
  s_waitcnt lgkmcnt(3)
  v_mfma_f32_32x32x16_bf16 v[64:79], a[28:31], a[156:159], v[64:79]
  ds_read_b128 a[24:27], v8 offset:17664
  buffer_load_dwordx4 v4, s[52:55], s6 offen offset:1024 lds
  v_mfma_f32_32x32x16_bf16 v[80:95], a[0:3], a[96:99], 0
  ds_read_b128 a[28:31], v9 offset:17664
  v_mfma_f32_32x32x16_bf16 v[80:95], a[4:7], a[100:103], v[80:95]
  ds_read_b128 a[0:3], v8 offset:18432
  v_mfma_f32_32x32x16_bf16 v[80:95], a[8:11], a[104:107], v[80:95]
  ds_read_b128 a[4:7], v9 offset:18432
  s_nop 3
  v_max3_f32 v7, v7, v64, v65
  v_max3_f32 v7, v7, v66, v67
  v_max3_f32 v7, v7, v68, v69
  v_max3_f32 v7, v7, v70, v71
  v_max3_f32 v7, v7, v72, v73
  s_waitcnt lgkmcnt(3)
  v_mfma_f32_32x32x16_bf16 v[80:95], a[12:15], a[108:111], v[80:95]
  ds_read_b128 a[8:11], v8 offset:18688
  buffer_load_dwordx4 v4, s[56:59], s6 offen offset:2048 lds
  v_max3_f32 v7, v7, v74, v75
  v_max3_f32 v7, v7, v76, v77
  v_mfma_f32_32x32x16_bf16 v[80:95], a[16:19], a[112:115], v[80:95]
  ds_read_b128 a[12:15], v9 offset:18688
  v_max3_f32 v7, v7, v78, v79
  v_mfma_f32_32x32x16_bf16 v[80:95], a[20:23], a[116:119], v[80:95]
  ds_read_b128 a[16:19], v8 offset:19456
  v_mfma_f32_32x32x16_bf16 v[80:95], a[24:27], a[120:123], v[80:95]
  ds_read_b128 a[20:23], v9 offset:19456
  s_waitcnt lgkmcnt(3)
  v_mfma_f32_32x32x16_bf16 v[80:95], a[28:31], a[124:127], v[80:95]
  ds_read_b128 a[24:27], v8 offset:19712
  buffer_load_dwordx4 v4, s[60:63], s6 offen offset:3072 lds
  v_mfma_f32_32x32x16_bf16 v[80:95], a[0:3], a[128:131], v[80:95]
  ds_read_b128 a[28:31], v9 offset:19712
  v_add_u32 v8, 0xfffe0000, v8
  v_mfma_f32_32x32x16_bf16 v[80:95], a[4:7], a[132:135], v[80:95]
  ds_read_b128 a[0:3], v8 offset:0
  v_add_u32 v9, 0xfffe0000, v9
  v_mfma_f32_32x32x16_bf16 v[80:95], a[8:11], a[136:139], v[80:95]
  ds_read_b128 a[4:7], v9 offset:0
  s_waitcnt lgkmcnt(3)
  v_mfma_f32_32x32x16_bf16 v[80:95], a[12:15], a[140:143], v[80:95]
  s_add_u32 m0, s31, 114688
  s_add_u32 s6, s2, 196608
  s_and_b32 s6, s6, 0x3ffff
  ds_read_b128 a[8:11], v8 offset:256
  buffer_load_dwordx4 v4, s[48:51], s6 offen offset:0 lds
  v_mfma_f32_32x32x16_bf16 v[80:95], a[16:19], a[144:147], v[80:95]
  ds_read_b128 a[12:15], v9 offset:256
  v_mfma_f32_32x32x16_bf16 v[80:95], a[20:23], a[148:151], v[80:95]
  ds_read_b128 a[16:19], v8 offset:1024
  v_mfma_f32_32x32x16_bf16 v[80:95], a[24:27], a[152:155], v[80:95]
  ds_read_b128 a[20:23], v9 offset:1024
  s_waitcnt lgkmcnt(3)
  v_mfma_f32_32x32x16_bf16 v[80:95], a[28:31], a[156:159], v[80:95]
  ds_read_b128 a[24:27], v8 offset:1280
  buffer_load_dwordx4 v4, s[52:55], s6 offen offset:1024 lds
  v_mfma_f32_32x32x16_bf16 v[96:111], a[0:3], a[96:99], 0
  ds_read_b128 a[28:31], v9 offset:1280
  v_mfma_f32_32x32x16_bf16 v[96:111], a[4:7], a[100:103], v[96:111]
  ds_read_b128 a[0:3], v8 offset:2048
  v_mfma_f32_32x32x16_bf16 v[96:111], a[8:11], a[104:107], v[96:111]
  ds_read_b128 a[4:7], v9 offset:2048
  s_nop 3
  v_max3_f32 v7, v7, v80, v81
  v_max3_f32 v7, v7, v82, v83
  v_max3_f32 v7, v7, v84, v85
  v_max3_f32 v7, v7, v86, v87
  v_max3_f32 v7, v7, v88, v89
  s_waitcnt lgkmcnt(3)
  v_mfma_f32_32x32x16_bf16 v[96:111], a[12:15], a[108:111], v[96:111]
  ds_read_b128 a[8:11], v8 offset:2304
  buffer_load_dwordx4 v4, s[56:59], s6 offen offset:2048 lds
  v_max3_f32 v7, v7, v90, v91
  v_max3_f32 v7, v7, v92, v93
  v_mfma_f32_32x32x16_bf16 v[96:111], a[16:19], a[112:115], v[96:111]
  ds_read_b128 a[12:15], v9 offset:2304
  v_max3_f32 v7, v7, v94, v95
  v_mfma_f32_32x32x16_bf16 v[96:111], a[20:23], a[116:119], v[96:111]
  ds_read_b128 a[16:19], v8 offset:3072
  v_mfma_f32_32x32x16_bf16 v[96:111], a[24:27], a[120:123], v[96:111]
  ds_read_b128 a[20:23], v9 offset:3072
  s_waitcnt lgkmcnt(3)
  v_mfma_f32_32x32x16_bf16 v[96:111], a[28:31], a[124:127], v[96:111]
  ds_read_b128 a[24:27], v8 offset:3328
  buffer_load_dwordx4 v4, s[60:63], s6 offen offset:3072 lds
  v_mfma_f32_32x32x16_bf16 v[96:111], a[0:3], a[128:131], v[96:111]
  ds_read_b128 a[28:31], v9 offset:3328
  v_mfma_f32_32x32x16_bf16 v[96:111], a[4:7], a[132:135], v[96:111]
  s_waitcnt vmcnt(21)
  s_barrier
  ds_read_b128 a[0:3], v8 offset:16384
  v_mfma_f32_32x32x16_bf16 v[96:111], a[8:11], a[136:139], v[96:111]
  ds_read_b128 a[4:7], v9 offset:16384
  s_waitcnt lgkmcnt(3)
  v_mfma_f32_32x32x16_bf16 v[96:111], a[12:15], a[140:143], v[96:111]
  s_add_u32 m0, s31, 131072
  s_add_u32 s6, s2, 212992
  s_and_b32 s6, s6, 0x3ffff
  ds_read_b128 a[8:11], v8 offset:16640
  buffer_load_dwordx4 v4, s[48:51], s6 offen offset:0 lds
  v_mfma_f32_32x32x16_bf16 v[96:111], a[16:19], a[144:147], v[96:111]
  ds_read_b128 a[12:15], v9 offset:16640
  v_mfma_f32_32x32x16_bf16 v[96:111], a[20:23], a[148:151], v[96:111]
  ds_read_b128 a[16:19], v8 offset:17408
  v_mfma_f32_32x32x16_bf16 v[96:111], a[24:27], a[152:155], v[96:111]
  ds_read_b128 a[20:23], v9 offset:17408
  s_waitcnt lgkmcnt(3)
  v_mfma_f32_32x32x16_bf16 v[96:111], a[28:31], a[156:159], v[96:111]
  ds_read_b128 a[24:27], v8 offset:17664
  buffer_load_dwordx4 v4, s[52:55], s6 offen offset:1024 lds
  s_waitcnt vmcnt(16)
  v_and_b32 v0, -7, v15
  v_cmp_ne_u32 vcc, v0, v14
  v_cmp_eq_u32 s[44:45], 0, v14
  s_nop 1
  s_or_b64 vcc, vcc, s[44:45]
  s_cbranch_vccnz L_spinNl
L_backNl:
  v_readfirstlane_b32 s26, v15
  v_mov_b32 v0, v15
  s_nop 0
  s_bfe_u32 s44, s26, 0x10001
  s_lshl_b32 s44, s44, 13
  s_add_u32 s9, s9, s44
  s_add_u32 s10, s10, s44
  s_add_u32 s29, s29, s44
  s_add_u32 s28, s28, s44
  s_bfe_u32 s44, s26, 0x10002
  s_lshl_b32 s44, s44, 13
  s_add_u32 s21, s21, s44
  s_add_u32 s27, s27, s44
  s_add_u32 s30, s30, s44
  v_mfma_f32_32x32x16_bf16 v[112:127], a[0:3], a[96:99], 0
  ds_read_b128 a[28:31], v9 offset:17664
  v_mfma_f32_32x32x16_bf16 v[112:127], a[4:7], a[100:103], v[112:127]
  ds_read_b128 a[0:3], v8 offset:18432
  v_mfma_f32_32x32x16_bf16 v[112:127], a[8:11], a[104:107], v[112:127]
  ds_read_b128 a[4:7], v9 offset:18432
  v_max3_f32 v7, v7, v96, v97
  v_max3_f32 v7, v7, v98, v99
  v_max3_f32 v7, v7, v100, v101
  v_max3_f32 v7, v7, v102, v103
  v_max3_f32 v7, v7, v104, v105
  s_waitcnt lgkmcnt(3)
  v_mfma_f32_32x32x16_bf16 v[112:127], a[12:15], a[108:111], v[112:127]
  ds_read_b128 a[8:11], v8 offset:18688
  buffer_load_dwordx4 v4, s[56:59], s6 offen offset:2048 lds
  v_max3_f32 v7, v7, v106, v107
  v_max3_f32 v7, v7, v108, v109
  v_mfma_f32_32x32x16_bf16 v[112:127], a[16:19], a[112:115], v[112:127]
  ds_read_b128 a[12:15], v9 offset:18688
  v_max3_f32 v7, v7, v110, v111
  v_mfma_f32_32x32x16_bf16 v[112:127], a[20:23], a[116:119], v[112:127]
  ds_read_b128 a[16:19], v8 offset:19456
  v_mfma_f32_32x32x16_bf16 v[112:127], a[24:27], a[120:123], v[112:127]
  ds_read_b128 a[20:23], v9 offset:19456
  s_waitcnt lgkmcnt(3)
  v_mfma_f32_32x32x16_bf16 v[112:127], a[28:31], a[124:127], v[112:127]
  ds_read_b128 a[24:27], v8 offset:19712
  buffer_load_dwordx4 v4, s[60:63], s6 offen offset:3072 lds
  v_mfma_f32_32x32x16_bf16 v[112:127], a[0:3], a[128:131], v[112:127]
  ds_read_b128 a[28:31], v9 offset:19712
  v_mfma_f32_32x32x16_bf16 v[112:127], a[4:7], a[132:135], v[112:127]
  ds_read_b128 a[0:3], v8 offset:32768
  v_mfma_f32_32x32x16_bf16 v[112:127], a[8:11], a[136:139], v[112:127]
  ds_read_b128 a[4:7], v9 offset:32768
  s_waitcnt lgkmcnt(3)
  v_mfma_f32_32x32x16_bf16 v[112:127], a[12:15], a[140:143], v[112:127]
  s_add_u32 m0, s31, 147456
  s_add_u32 s6, s2, 229376
  s_and_b32 s6, s6, 0x3ffff
  ds_read_b128 a[8:11], v8 offset:33024
  buffer_load_dwordx4 v4, s[48:51], s6 offen offset:0 lds
  v_mfma_f32_32x32x16_bf16 v[112:127], a[16:19], a[144:147], v[112:127]
  ds_read_b128 a[12:15], v9 offset:33024
  v_mfma_f32_32x32x16_bf16 v[112:127], a[20:23], a[148:151], v[112:127]
  ds_read_b128 a[16:19], v8 offset:33792
  v_mfma_f32_32x32x16_bf16 v[112:127], a[24:27], a[152:155], v[112:127]
  ds_read_b128 a[20:23], v9 offset:33792
  s_waitcnt lgkmcnt(3)
  v_mfma_f32_32x32x16_bf16 v[112:127], a[28:31], a[156:159], v[112:127]
  ds_read_b128 a[24:27], v8 offset:34048
  buffer_load_dwordx4 v4, s[52:55], s6 offen offset:1024 lds
  v_mfma_f32_32x32x16_bf16 a[192:207], a[0:3], a[96:99], 0
  ds_read_b128 a[28:31], v9 offset:34048
  v_mfma_f32_32x32x16_bf16 a[192:207], a[4:7], a[100:103], a[192:207]
  ds_read_b128 a[0:3], v8 offset:34816
  v_mfma_f32_32x32x16_bf16 a[192:207], a[8:11], a[104:107], a[192:207]
  ds_read_b128 a[4:7], v9 offset:34816
  s_nop 3
  v_max3_f32 v7, v7, v112, v113
  v_max3_f32 v7, v7, v114, v115
  v_max3_f32 v7, v7, v116, v117
  v_max3_f32 v7, v7, v118, v119
  v_max3_f32 v7, v7, v120, v121
  s_waitcnt lgkmcnt(3)
  v_mfma_f32_32x32x16_bf16 a[192:207], a[12:15], a[108:111], a[192:207]
  ds_read_b128 a[8:11], v8 offset:35072
  buffer_load_dwordx4 v4, s[56:59], s6 offen offset:2048 lds
  v_max3_f32 v7, v7, v122, v123
  v_max3_f32 v7, v7, v124, v125
  v_mfma_f32_32x32x16_bf16 a[192:207], a[16:19], a[112:115], a[192:207]
  ds_read_b128 a[12:15], v9 offset:35072
  v_max3_f32 v7, v7, v126, v127
  v_mfma_f32_32x32x16_bf16 a[192:207], a[20:23], a[116:119], a[192:207]
  ds_read_b128 a[16:19], v8 offset:35840
  v_mfma_f32_32x32x16_bf16 a[192:207], a[24:27], a[120:123], a[192:207]
  ds_read_b128 a[20:23], v9 offset:35840
  s_waitcnt lgkmcnt(3)
  v_mfma_f32_32x32x16_bf16 a[192:207], a[28:31], a[124:127], a[192:207]
  ds_read_b128 a[24:27], v8 offset:36096
  buffer_load_dwordx4 v4, s[60:63], s6 offen offset:3072 lds
  v_mfma_f32_32x32x16_bf16 a[192:207], a[0:3], a[128:131], a[192:207]
  ds_read_b128 a[28:31], v9 offset:36096
  v_mfma_f32_32x32x16_bf16 a[192:207], a[4:7], a[132:135], a[192:207]
  s_waitcnt vmcnt(20)
  s_barrier
  ds_read_b128 a[0:3], v8 offset:49152
  v_mfma_f32_32x32x16_bf16 a[192:207], a[8:11], a[136:139], a[192:207]
  ds_read_b128 a[4:7], v9 offset:49152
  s_waitcnt lgkmcnt(3)
  v_mfma_f32_32x32x16_bf16 a[192:207], a[12:15], a[140:143], a[192:207]
  s_add_u32 m0, s31, 0
  s_add_u32 s6, s2, 245760
  s_and_b32 s6, s6, 0x3ffff
  ds_read_b128 a[8:11], v8 offset:49408
  buffer_load_dwordx4 v4, s[48:51], s6 offen offset:0 lds
  v_mfma_f32_32x32x16_bf16 a[192:207], a[16:19], a[144:147], a[192:207]
  ds_read_b128 a[12:15], v9 offset:49408
  v_mfma_f32_32x32x16_bf16 a[192:207], a[20:23], a[148:151], a[192:207]
  ds_read_b128 a[16:19], v8 offset:50176
  v_mfma_f32_32x32x16_bf16 a[192:207], a[24:27], a[152:155], a[192:207]
  ds_read_b128 a[20:23], v9 offset:50176
  s_waitcnt lgkmcnt(3)
  v_mfma_f32_32x32x16_bf16 a[192:207], a[28:31], a[156:159], a[192:207]
  ds_read_b128 a[24:27], v8 offset:50432
  buffer_load_dwordx4 v4, s[52:55], s6 offen offset:1024 lds
  v_mfma_f32_32x32x16_bf16 a[208:223], a[0:3], a[96:99], 0
  ds_read_b128 a[28:31], v9 offset:50432
  v_mfma_f32_32x32x16_bf16 a[208:223], a[4:7], a[100:103], a[208:223]
  ds_read_b128 a[0:3], v8 offset:51200
  v_mfma_f32_32x32x16_bf16 a[208:223], a[8:11], a[104:107], a[208:223]
  ds_read_b128 a[4:7], v9 offset:51200
  s_nop 3
  v_accvgpr_read_b32 v13, a192
  v_accvgpr_read_b32 v14, a193
  v_accvgpr_read_b32 v15, a194
  v_accvgpr_read_b32 v11, a195
  v_max3_f32 v7, v7, v13, v14
  s_waitcnt lgkmcnt(3)
  v_mfma_f32_32x32x16_bf16 a[208:223], a[12:15], a[108:111], a[208:223]
  ds_read_b128 a[8:11], v8 offset:51456
  buffer_load_dwordx4 v4, s[56:59], s6 offen offset:2048 lds
  v_max3_f32 v7, v7, v15, v11
  v_accvgpr_read_b32 v13, a196
  v_mfma_f32_32x32x16_bf16 a[208:223], a[16:19], a[112:115], a[208:223]
  ds_read_b128 a[12:15], v9 offset:51456
  v_accvgpr_read_b32 v14, a197
  v_accvgpr_read_b32 v15, a198
  v_accvgpr_read_b32 v11, a199
  v_max3_f32 v7, v7, v13, v14
  v_max3_f32 v7, v7, v15, v11
  v_mfma_f32_32x32x16_bf16 a[208:223], a[20:23], a[116:119], a[208:223]
  ds_read_b128 a[16:19], v8 offset:52224
  v_accvgpr_read_b32 v13, a200
  v_accvgpr_read_b32 v14, a201
  v_accvgpr_read_b32 v15, a202
  v_accvgpr_read_b32 v11, a203
  v_max3_f32 v7, v7, v13, v14
  v_mfma_f32_32x32x16_bf16 a[208:223], a[24:27], a[120:123], a[208:223]
  ds_read_b128 a[20:23], v9 offset:52224
  v_max3_f32 v7, v7, v15, v11
  v_accvgpr_read_b32 v13, a204
  v_accvgpr_read_b32 v14, a205
  v_accvgpr_read_b32 v15, a206
  v_accvgpr_read_b32 v11, a207
  s_waitcnt lgkmcnt(3)
  v_mfma_f32_32x32x16_bf16 a[208:223], a[28:31], a[124:127], a[208:223]
  ds_read_b128 a[24:27], v8 offset:52480
  buffer_load_dwordx4 v4, s[60:63], s6 offen offset:3072 lds
  v_max3_f32 v7, v7, v13, v14
  v_max3_f32 v7, v7, v15, v11
  v_mfma_f32_32x32x16_bf16 a[208:223], a[0:3], a[128:131], a[208:223]
  ds_read_b128 a[28:31], v9 offset:52480
  v_add_u32 v8, 0x00010000, v8
  v_mfma_f32_32x32x16_bf16 a[208:223], a[4:7], a[132:135], a[208:223]
  ds_read_b128 a[0:3], v8 offset:0
  v_add_u32 v9, 0x00010000, v9
  v_mfma_f32_32x32x16_bf16 a[208:223], a[8:11], a[136:139], a[208:223]
  ds_read_b128 a[4:7], v9 offset:0
  s_waitcnt lgkmcnt(3)
  v_mfma_f32_32x32x16_bf16 a[208:223], a[12:15], a[140:143], a[208:223]
  s_add_u32 m0, s31, 16384
  s_add_u32 s6, s2, 0
  s_and_b32 s6, s6, 0x3ffff
  ds_read_b128 a[8:11], v8 offset:256
  buffer_load_dwordx4 v1, s[64:67], s6 offen offset:0 lds
  v_mfma_f32_32x32x16_bf16 a[208:223], a[16:19], a[144:147], a[208:223]
  ds_read_b128 a[12:15], v9 offset:256
  v_mfma_f32_32x32x16_bf16 a[208:223], a[20:23], a[148:151], a[208:223]
  ds_read_b128 a[16:19], v8 offset:1024
  v_mfma_f32_32x32x16_bf16 a[208:223], a[24:27], a[152:155], a[208:223]
  ds_read_b128 a[20:23], v9 offset:1024
  s_waitcnt lgkmcnt(3)
  v_mfma_f32_32x32x16_bf16 a[208:223], a[28:31], a[156:159], a[208:223]
  ds_read_b128 a[24:27], v8 offset:1280
  buffer_load_dwordx4 v1, s[68:71], s6 offen offset:1024 lds
  v_mfma_f32_32x32x16_bf16 v[128:143], a[0:3], a[96:99], 0
  ds_read_b128 a[28:31], v9 offset:1280
  v_mfma_f32_32x32x16_bf16 v[128:143], a[4:7], a[100:103], v[128:143]
  ds_read_b128 a[0:3], v8 offset:2048
  v_mfma_f32_32x32x16_bf16 v[128:143], a[8:11], a[104:107], v[128:143]
  ds_read_b128 a[4:7], v9 offset:2048
  s_nop 3
  v_accvgpr_read_b32 v13, a208
  v_accvgpr_read_b32 v14, a209
  v_accvgpr_read_b32 v15, a210
  v_accvgpr_read_b32 v11, a211
  v_max3_f32 v7, v7, v13, v14
  s_waitcnt lgkmcnt(3)
  v_mfma_f32_32x32x16_bf16 v[128:143], a[12:15], a[108:111], v[128:143]
  ds_read_b128 a[8:11], v8 offset:2304
  buffer_load_dwordx4 v1, s[64:67], s6 offen offset:2048 lds
  v_max3_f32 v7, v7, v15, v11
  v_accvgpr_read_b32 v13, a212
  v_mfma_f32_32x32x16_bf16 v[128:143], a[16:19], a[112:115], v[128:143]
  ds_read_b128 a[12:15], v9 offset:2304
  v_accvgpr_read_b32 v14, a213
  v_accvgpr_read_b32 v15, a214
  v_accvgpr_read_b32 v11, a215
  v_max3_f32 v7, v7, v13, v14
  v_max3_f32 v7, v7, v15, v11
  v_mfma_f32_32x32x16_bf16 v[128:143], a[20:23], a[116:119], v[128:143]
  ds_read_b128 a[16:19], v8 offset:3072
  v_accvgpr_read_b32 v13, a216
  v_accvgpr_read_b32 v14, a217
  v_accvgpr_read_b32 v15, a218
  v_accvgpr_read_b32 v11, a219
  v_max3_f32 v7, v7, v13, v14
  v_mfma_f32_32x32x16_bf16 v[128:143], a[24:27], a[120:123], v[128:143]
  ds_read_b128 a[20:23], v9 offset:3072
  v_max3_f32 v7, v7, v15, v11
L_padl4:
  s_cbranch_execz L_padl8
  v_accvgpr_read_b32 v13, a220
  v_accvgpr_read_b32 v14, a221
  v_accvgpr_read_b32 v15, a222
  v_accvgpr_read_b32 v11, a223
  s_waitcnt lgkmcnt(3)
  v_mfma_f32_32x32x16_bf16 v[128:143], a[28:31], a[124:127], v[128:143]
  ds_read_b128 a[24:27], v8 offset:3328
  buffer_load_dwordx4 v1, s[68:71], s6 offen offset:3072 lds
  v_max3_f32 v7, v7, v13, v14
  v_max3_f32 v7, v7, v15, v11
  v_mfma_f32_32x32x16_bf16 v[128:143], a[0:3], a[128:131], v[128:143]
  ds_read_b128 a[28:31], v9 offset:3328
  v_mfma_f32_32x32x16_bf16 v[128:143], a[4:7], a[132:135], v[128:143]
  s_waitcnt vmcnt(20)
  s_barrier
  ds_read_b128 a[0:3], v8 offset:16384
  v_mfma_f32_32x32x16_bf16 v[128:143], a[8:11], a[136:139], v[128:143]
  ds_read_b128 a[4:7], v9 offset:16384
  s_waitcnt lgkmcnt(3)
  v_mfma_f32_32x32x16_bf16 v[128:143], a[12:15], a[140:143], v[128:143]
  s_add_u32 m0, s31, 32768
  s_add_u32 s6, s2, 16384
  s_and_b32 s6, s6, 0x3ffff
  ds_read_b128 a[8:11], v8 offset:16640
  buffer_load_dwordx4 v1, s[64:67], s6 offen offset:0 lds
  v_mfma_f32_32x32x16_bf16 v[128:143], a[16:19], a[144:147], v[128:143]
  ds_read_b128 a[12:15], v9 offset:16640
  s_mov_b32 s48, s12
  s_mov_b32 s49, s13
  s_mov_b32 s50, 0x00038000
  s_mov_b32 s51, 0x00020000
  v_accvgpr_read_b32 v4, a240
  v_mfma_f32_32x32x16_bf16 v[128:143], a[20:23], a[148:151], v[128:143]
  ds_read_b128 a[16:19], v8 offset:17408
  s_add_u32 s52, s48, 0x00001800
  s_addc_u32 s53, s49, 0
  s_sub_u32 s54, s50, 0x00001800
  s_mov_b32 s55, 0x00020000
  v_mfma_f32_32x32x16_bf16 v[128:143], a[24:27], a[152:155], v[128:143]
  ds_read_b128 a[20:23], v9 offset:17408
  s_add_u32 s56, s48, 0x00003000
  s_addc_u32 s57, s49, 0
  s_sub_u32 s58, s50, 0x00003000
  s_mov_b32 s59, 0x00020000
  s_waitcnt lgkmcnt(3)
  v_mfma_f32_32x32x16_bf16 v[128:143], a[28:31], a[156:159], v[128:143]
  ds_read_b128 a[24:27], v8 offset:17664
  buffer_load_dwordx4 v1, s[68:71], s6 offen offset:1024 lds
  s_add_u32 s60, s48, 0x00004800
  s_addc_u32 s61, s49, 0
  v_mfma_f32_32x32x16_bf16 v[144:159], a[0:3], a[96:99], 0
  ds_read_b128 a[28:31], v9 offset:17664
  s_sub_u32 s62, s50, 0x00004800
  s_mov_b32 s63, 0x00020000
  v_mfma_f32_32x32x16_bf16 v[144:159], a[4:7], a[100:103], v[144:159]
  ds_read_b128 a[0:3], v8 offset:18432
  v_mfma_f32_32x32x16_bf16 v[144:159], a[8:11], a[104:107], v[144:159]
  ds_read_b128 a[4:7], v9 offset:18432
  s_nop 0
  v_max3_f32 v7, v7, v128, v129
  v_max3_f32 v7, v7, v130, v131
  v_max3_f32 v7, v7, v132, v133
  v_max3_f32 v7, v7, v134, v135
  v_max3_f32 v7, v7, v136, v137
  s_waitcnt lgkmcnt(3)
  v_mfma_f32_32x32x16_bf16 v[144:159], a[12:15], a[108:111], v[144:159]
  ds_read_b128 a[8:11], v8 offset:18688
  buffer_load_dwordx4 v1, s[64:67], s6 offen offset:2048 lds
  v_max3_f32 v7, v7, v138, v139
  v_max3_f32 v7, v7, v140, v141
  v_mfma_f32_32x32x16_bf16 v[144:159], a[16:19], a[112:115], v[144:159]
  ds_read_b128 a[12:15], v9 offset:18688
  v_max3_f32 v7, v7, v142, v143
  v_mfma_f32_32x32x16_bf16 v[144:159], a[20:23], a[116:119], v[144:159]
  ds_read_b128 a[16:19], v8 offset:19456
  v_mfma_f32_32x32x16_bf16 v[144:159], a[24:27], a[120:123], v[144:159]
  ds_read_b128 a[20:23], v9 offset:19456
  s_waitcnt lgkmcnt(3)
  v_mfma_f32_32x32x16_bf16 v[144:159], a[28:31], a[124:127], v[144:159]
  ds_read_b128 a[24:27], v8 offset:19712
  buffer_load_dwordx4 v1, s[68:71], s6 offen offset:3072 lds
  v_mfma_f32_32x32x16_bf16 v[144:159], a[0:3], a[128:131], v[144:159]
  ds_read_b128 a[28:31], v9 offset:19712
  v_mfma_f32_32x32x16_bf16 v[144:159], a[4:7], a[132:135], v[144:159]
  ds_read_b128 a[0:3], v8 offset:32768
  v_mfma_f32_32x32x16_bf16 v[144:159], a[8:11], a[136:139], v[144:159]
  ds_read_b128 a[4:7], v9 offset:32768
  s_waitcnt lgkmcnt(3)
  v_mfma_f32_32x32x16_bf16 v[144:159], a[12:15], a[140:143], v[144:159]
  s_add_u32 m0, s31, 49152
  s_add_u32 s6, s2, 32768
  s_and_b32 s6, s6, 0x3ffff
  ds_read_b128 a[8:11], v8 offset:33024
  buffer_load_dwordx4 v1, s[64:67], s6 offen offset:0 lds
  v_mfma_f32_32x32x16_bf16 v[144:159], a[16:19], a[144:147], v[144:159]
  ds_read_b128 a[12:15], v9 offset:33024
  v_mfma_f32_32x32x16_bf16 v[144:159], a[20:23], a[148:151], v[144:159]
  ds_read_b128 a[16:19], v8 offset:33792
  v_mfma_f32_32x32x16_bf16 v[144:159], a[24:27], a[152:155], v[144:159]
  ds_read_b128 a[20:23], v9 offset:33792
  s_waitcnt lgkmcnt(3)
  v_mfma_f32_32x32x16_bf16 v[144:159], a[28:31], a[156:159], v[144:159]
  ds_read_b128 a[24:27], v8 offset:34048
  buffer_load_dwordx4 v1, s[68:71], s6 offen offset:1024 lds
  v_mfma_f32_32x32x16_bf16 v[160:175], a[0:3], a[96:99], 0
  ds_read_b128 a[28:31], v9 offset:34048
  v_mfma_f32_32x32x16_bf16 v[160:175], a[4:7], a[100:103], v[160:175]
  ds_read_b128 a[0:3], v8 offset:34816
  v_mfma_f32_32x32x16_bf16 v[160:175], a[8:11], a[104:107], v[160:175]
  ds_read_b128 a[4:7], v9 offset:34816
  s_nop 3
  v_max3_f32 v7, v7, v144, v145
  v_max3_f32 v7, v7, v146, v147
  v_max3_f32 v7, v7, v148, v149
  v_max3_f32 v7, v7, v150, v151
  v_max3_f32 v7, v7, v152, v153
  s_waitcnt lgkmcnt(3)
  v_mfma_f32_32x32x16_bf16 v[160:175], a[12:15], a[108:111], v[160:175]
  ds_read_b128 a[8:11], v8 offset:35072
  buffer_load_dwordx4 v1, s[64:67], s6 offen offset:2048 lds
  v_max3_f32 v7, v7, v154, v155
  v_max3_f32 v7, v7, v156, v157
  v_mfma_f32_32x32x16_bf16 v[160:175], a[16:19], a[112:115], v[160:175]
  ds_read_b128 a[12:15], v9 offset:35072
  v_max3_f32 v7, v7, v158, v159
  v_mfma_f32_32x32x16_bf16 v[160:175], a[20:23], a[116:119], v[160:175]
  ds_read_b128 a[16:19], v8 offset:35840
  v_mfma_f32_32x32x16_bf16 v[160:175], a[24:27], a[120:123], v[160:175]
  ds_read_b128 a[20:23], v9 offset:35840
  s_waitcnt lgkmcnt(3)
  v_mfma_f32_32x32x16_bf16 v[160:175], a[28:31], a[124:127], v[160:175]
  ds_read_b128 a[24:27], v8 offset:36096
  buffer_load_dwordx4 v1, s[68:71], s6 offen offset:3072 lds
  v_mfma_f32_32x32x16_bf16 v[160:175], a[0:3], a[128:131], v[160:175]
  ds_read_b128 a[28:31], v9 offset:36096
  v_mfma_f32_32x32x16_bf16 v[160:175], a[4:7], a[132:135], v[160:175]
  s_waitcnt vmcnt(20)
  s_barrier
  ds_read_b128 a[0:3], v8 offset:49152
  v_mfma_f32_32x32x16_bf16 v[160:175], a[8:11], a[136:139], v[160:175]
  ds_read_b128 a[4:7], v9 offset:49152
  s_waitcnt lgkmcnt(3)
  v_mfma_f32_32x32x16_bf16 v[160:175], a[12:15], a[140:143], v[160:175]
  s_add_u32 m0, s31, 65536
  s_add_u32 s6, s2, 49152
  s_and_b32 s6, s6, 0x3ffff
  ds_read_b128 a[8:11], v8 offset:49408
  buffer_load_dwordx4 v1, s[64:67], s6 offen offset:0 lds
  v_mfma_f32_32x32x16_bf16 v[160:175], a[16:19], a[144:147], v[160:175]
  ds_read_b128 a[12:15], v9 offset:49408
  v_mfma_f32_32x32x16_bf16 v[160:175], a[20:23], a[148:151], v[160:175]
  ds_read_b128 a[16:19], v8 offset:50176
  v_mfma_f32_32x32x16_bf16 v[160:175], a[24:27], a[152:155], v[160:175]
  ds_read_b128 a[20:23], v9 offset:50176
  s_waitcnt lgkmcnt(3)
  v_mfma_f32_32x32x16_bf16 v[160:175], a[28:31], a[156:159], v[160:175]
  ds_read_b128 a[24:27], v8 offset:50432
  buffer_load_dwordx4 v1, s[68:71], s6 offen offset:1024 lds
  v_mfma_f32_32x32x16_bf16 v[176:191], a[0:3], a[96:99], 0
  ds_read_b128 a[28:31], v9 offset:50432
  v_mfma_f32_32x32x16_bf16 v[176:191], a[4:7], a[100:103], v[176:191]
  ds_read_b128 a[0:3], v8 offset:51200
  v_mfma_f32_32x32x16_bf16 v[176:191], a[8:11], a[104:107], v[176:191]
  ds_read_b128 a[4:7], v9 offset:51200
  s_nop 3
  v_max3_f32 v7, v7, v160, v161
  v_max3_f32 v7, v7, v162, v163
  v_max3_f32 v7, v7, v164, v165
  v_max3_f32 v7, v7, v166, v167
  v_max3_f32 v7, v7, v168, v169
  s_waitcnt lgkmcnt(3)
  v_mfma_f32_32x32x16_bf16 v[176:191], a[12:15], a[108:111], v[176:191]
  ds_read_b128 a[8:11], v8 offset:51456
  buffer_load_dwordx4 v1, s[64:67], s6 offen offset:2048 lds
  v_max3_f32 v7, v7, v170, v171
  v_max3_f32 v7, v7, v172, v173
  v_mfma_f32_32x32x16_bf16 v[176:191], a[16:19], a[112:115], v[176:191]
  ds_read_b128 a[12:15], v9 offset:51456
  v_max3_f32 v7, v7, v174, v175
  v_mfma_f32_32x32x16_bf16 v[176:191], a[20:23], a[116:119], v[176:191]
  ds_read_b128 a[16:19], v8 offset:52224
  v_mfma_f32_32x32x16_bf16 v[176:191], a[24:27], a[120:123], v[176:191]
  ds_read_b128 a[20:23], v9 offset:52224
  s_waitcnt lgkmcnt(3)
  v_mfma_f32_32x32x16_bf16 v[176:191], a[28:31], a[124:127], v[176:191]
  ds_read_b128 a[24:27], v8 offset:52480
  buffer_load_dwordx4 v1, s[68:71], s6 offen offset:3072 lds
  v_mfma_f32_32x32x16_bf16 v[176:191], a[0:3], a[128:131], v[176:191]
  ds_read_b128 a[28:31], v9 offset:52480
  v_add_u32 v8, 0x00010000, v8
  v_mfma_f32_32x32x16_bf16 v[176:191], a[4:7], a[132:135], v[176:191]
  ds_read_b128 a[0:3], v8 offset:0
  v_add_u32 v9, 0x00010000, v9
  v_mfma_f32_32x32x16_bf16 v[176:191], a[8:11], a[136:139], v[176:191]
  ds_read_b128 a[4:7], v9 offset:0
  s_waitcnt lgkmcnt(3)
  v_mfma_f32_32x32x16_bf16 v[176:191], a[12:15], a[140:143], v[176:191]
  s_add_u32 m0, s31, 81920
  s_add_u32 s6, s2, 65536
  s_and_b32 s6, s6, 0x3ffff
  ds_read_b128 a[8:11], v8 offset:256
  buffer_load_dwordx4 v1, s[64:67], s6 offen offset:0 lds
  v_mfma_f32_32x32x16_bf16 v[176:191], a[16:19], a[144:147], v[176:191]
  ds_read_b128 a[12:15], v9 offset:256
  v_mfma_f32_32x32x16_bf16 v[176:191], a[20:23], a[148:151], v[176:191]
  ds_read_b128 a[16:19], v8 offset:1024
  v_mfma_f32_32x32x16_bf16 v[176:191], a[24:27], a[152:155], v[176:191]
  ds_read_b128 a[20:23], v9 offset:1024
  s_waitcnt lgkmcnt(3)
  v_mfma_f32_32x32x16_bf16 v[176:191], a[28:31], a[156:159], v[176:191]
  ds_read_b128 a[24:27], v8 offset:1280
  buffer_load_dwordx4 v1, s[68:71], s6 offen offset:1024 lds
  v_mfma_f32_32x32x16_bf16 v[192:207], a[0:3], a[96:99], 0
  ds_read_b128 a[28:31], v9 offset:1280
  v_mfma_f32_32x32x16_bf16 v[192:207], a[4:7], a[100:103], v[192:207]
  ds_read_b128 a[0:3], v8 offset:2048
  v_mfma_f32_32x32x16_bf16 v[192:207], a[8:11], a[104:107], v[192:207]
  ds_read_b128 a[4:7], v9 offset:2048
  s_nop 3
  v_max3_f32 v7, v7, v176, v177
  v_max3_f32 v7, v7, v178, v179
  v_max3_f32 v7, v7, v180, v181
  v_max3_f32 v7, v7, v182, v183
  v_max3_f32 v7, v7, v184, v185
  s_waitcnt lgkmcnt(3)
  v_mfma_f32_32x32x16_bf16 v[192:207], a[12:15], a[108:111], v[192:207]
  ds_read_b128 a[8:11], v8 offset:2304
  buffer_load_dwordx4 v1, s[64:67], s6 offen offset:2048 lds
  v_max3_f32 v7, v7, v186, v187
  v_max3_f32 v7, v7, v188, v189
  v_mfma_f32_32x32x16_bf16 v[192:207], a[16:19], a[112:115], v[192:207]
  ds_read_b128 a[12:15], v9 offset:2304
  v_max3_f32 v7, v7, v190, v191
  v_mfma_f32_32x32x16_bf16 v[192:207], a[20:23], a[116:119], v[192:207]
  ds_read_b128 a[16:19], v8 offset:3072
  v_mfma_f32_32x32x16_bf16 v[192:207], a[24:27], a[120:123], v[192:207]
  ds_read_b128 a[20:23], v9 offset:3072
  s_waitcnt lgkmcnt(3)
  v_mfma_f32_32x32x16_bf16 v[192:207], a[28:31], a[124:127], v[192:207]
  ds_read_b128 a[24:27], v8 offset:3328
  buffer_load_dwordx4 v1, s[68:71], s6 offen offset:3072 lds
  v_mfma_f32_32x32x16_bf16 v[192:207], a[0:3], a[128:131], v[192:207]
  ds_read_b128 a[28:31], v9 offset:3328
  v_mfma_f32_32x32x16_bf16 v[192:207], a[4:7], a[132:135], v[192:207]
  s_waitcnt vmcnt(20)
  s_barrier
  ds_read_b128 a[0:3], v8 offset:16384
  v_mfma_f32_32x32x16_bf16 v[192:207], a[8:11], a[136:139], v[192:207]
  ds_read_b128 a[4:7], v9 offset:16384
  s_waitcnt lgkmcnt(3)
  v_mfma_f32_32x32x16_bf16 v[192:207], a[12:15], a[140:143], v[192:207]
  s_add_u32 m0, s31, 98304
  s_add_u32 s6, s2, 81920
  s_and_b32 s6, s6, 0x3ffff
  ds_read_b128 a[8:11], v8 offset:16640
  buffer_load_dwordx4 v1, s[64:67], s6 offen offset:0 lds
  v_mfma_f32_32x32x16_bf16 v[192:207], a[16:19], a[144:147], v[192:207]
  ds_read_b128 a[12:15], v9 offset:16640
  v_mfma_f32_32x32x16_bf16 v[192:207], a[20:23], a[148:151], v[192:207]
  ds_read_b128 a[16:19], v8 offset:17408
  v_mfma_f32_32x32x16_bf16 v[192:207], a[24:27], a[152:155], v[192:207]
  ds_read_b128 a[20:23], v9 offset:17408
  s_waitcnt lgkmcnt(3)
  v_mfma_f32_32x32x16_bf16 v[192:207], a[28:31], a[156:159], v[192:207]
  ds_read_b128 a[24:27], v8 offset:17664
  buffer_load_dwordx4 v1, s[68:71], s6 offen offset:1024 lds
  v_mfma_f32_32x32x16_bf16 v[208:223], a[0:3], a[96:99], 0
  ds_read_b128 a[28:31], v9 offset:17664
  v_mfma_f32_32x32x16_bf16 v[208:223], a[4:7], a[100:103], v[208:223]
  ds_read_b128 a[0:3], v8 offset:18432
  v_mfma_f32_32x32x16_bf16 v[208:223], a[8:11], a[104:107], v[208:223]
  ds_read_b128 a[4:7], v9 offset:18432
  s_nop 3
  v_max3_f32 v7, v7, v192, v193
  v_max3_f32 v7, v7, v194, v195
  v_max3_f32 v7, v7, v196, v197
  v_max3_f32 v7, v7, v198, v199
  v_max3_f32 v7, v7, v200, v201
  s_waitcnt lgkmcnt(3)
  v_mfma_f32_32x32x16_bf16 v[208:223], a[12:15], a[108:111], v[208:223]
  ds_read_b128 a[8:11], v8 offset:18688
  buffer_load_dwordx4 v1, s[64:67], s6 offen offset:2048 lds
  v_max3_f32 v7, v7, v202, v203
  v_max3_f32 v7, v7, v204, v205
  v_mfma_f32_32x32x16_bf16 v[208:223], a[16:19], a[112:115], v[208:223]
  ds_read_b128 a[12:15], v9 offset:18688
  v_max3_f32 v7, v7, v206, v207
  v_mfma_f32_32x32x16_bf16 v[208:223], a[20:23], a[116:119], v[208:223]
  ds_read_b128 a[16:19], v8 offset:19456
  v_mfma_f32_32x32x16_bf16 v[208:223], a[24:27], a[120:123], v[208:223]
  ds_read_b128 a[20:23], v9 offset:19456
  s_waitcnt lgkmcnt(3)
  v_mfma_f32_32x32x16_bf16 v[208:223], a[28:31], a[124:127], v[208:223]
  ds_read_b128 a[24:27], v8 offset:19712
  buffer_load_dwordx4 v1, s[68:71], s6 offen offset:3072 lds
  v_mfma_f32_32x32x16_bf16 v[208:223], a[0:3], a[128:131], v[208:223]
  ds_read_b128 a[28:31], v9 offset:19712
  v_add_u32 v8, 0xfffe0000, v8
  v_mfma_f32_32x32x16_bf16 v[208:223], a[4:7], a[132:135], v[208:223]
  ds_read_b128 a[0:3], v8 offset:0
  v_add_u32 v9, 0xfffe0000, v9
  v_mfma_f32_32x32x16_bf16 v[208:223], a[8:11], a[136:139], v[208:223]
  ds_read_b128 a[4:7], v9 offset:0
  s_waitcnt lgkmcnt(3)
  v_mfma_f32_32x32x16_bf16 v[208:223], a[12:15], a[140:143], v[208:223]
  s_add_u32 m0, s31, 114688
  s_add_u32 s6, s2, 98304
  s_and_b32 s6, s6, 0x3ffff
  ds_read_b128 a[8:11], v8 offset:256
  buffer_load_dwordx4 v1, s[64:67], s6 offen offset:0 lds
  v_mfma_f32_32x32x16_bf16 v[208:223], a[16:19], a[144:147], v[208:223]
  ds_read_b128 a[12:15], v9 offset:256
  v_mfma_f32_32x32x16_bf16 v[208:223], a[20:23], a[148:151], v[208:223]
  ds_read_b128 a[16:19], v8 offset:1024
  v_mfma_f32_32x32x16_bf16 v[208:223], a[24:27], a[152:155], v[208:223]
  ds_read_b128 a[20:23], v9 offset:1024
  s_waitcnt lgkmcnt(3)
  v_mfma_f32_32x32x16_bf16 v[208:223], a[28:31], a[156:159], v[208:223]
  ds_read_b128 a[24:27], v8 offset:1280
  buffer_load_dwordx4 v1, s[68:71], s6 offen offset:1024 lds
  v_mfma_f32_32x32x16_bf16 v[224:239], a[0:3], a[96:99], 0
  ds_read_b128 a[28:31], v9 offset:1280
  v_mfma_f32_32x32x16_bf16 v[224:239], a[4:7], a[100:103], v[224:239]
  ds_read_b128 a[0:3], v8 offset:2048
  v_mfma_f32_32x32x16_bf16 v[224:239], a[8:11], a[104:107], v[224:239]
  ds_read_b128 a[4:7], v9 offset:2048
  s_nop 3
  v_max3_f32 v7, v7, v208, v209
  v_max3_f32 v7, v7, v210, v211
  v_max3_f32 v7, v7, v212, v213
  v_max3_f32 v7, v7, v214, v215
  v_max3_f32 v7, v7, v216, v217
  s_waitcnt lgkmcnt(3)
  v_mfma_f32_32x32x16_bf16 v[224:239], a[12:15], a[108:111], v[224:239]
  ds_read_b128 a[8:11], v8 offset:2304
  buffer_load_dwordx4 v1, s[64:67], s6 offen offset:2048 lds
  v_max3_f32 v7, v7, v218, v219
  v_max3_f32 v7, v7, v220, v221
  v_mfma_f32_32x32x16_bf16 v[224:239], a[16:19], a[112:115], v[224:239]
  ds_read_b128 a[12:15], v9 offset:2304
  v_max3_f32 v7, v7, v222, v223
  v_mfma_f32_32x32x16_bf16 v[224:239], a[20:23], a[116:119], v[224:239]
  ds_read_b128 a[16:19], v8 offset:3072
  v_mfma_f32_32x32x16_bf16 v[224:239], a[24:27], a[120:123], v[224:239]
  ds_read_b128 a[20:23], v9 offset:3072
  s_waitcnt lgkmcnt(3)
  v_mfma_f32_32x32x16_bf16 v[224:239], a[28:31], a[124:127], v[224:239]
  ds_read_b128 a[24:27], v8 offset:3328
  buffer_load_dwordx4 v1, s[68:71], s6 offen offset:3072 lds
  v_mfma_f32_32x32x16_bf16 v[224:239], a[0:3], a[128:131], v[224:239]
  ds_read_b128 a[28:31], v9 offset:3328
  v_mfma_f32_32x32x16_bf16 v[224:239], a[4:7], a[132:135], v[224:239]
  s_waitcnt vmcnt(20)
  s_barrier
  ds_read_b64_tr_b16 a[0:1], v4 offset:16384
  ds_read_b64_tr_b16 a[2:3], v4 offset:20480
  v_mfma_f32_32x32x16_bf16 v[224:239], a[8:11], a[136:139], v[224:239]
  ds_read_b64_tr_b16 a[4:5], v4 offset:16640
  ds_read_b64_tr_b16 a[6:7], v4 offset:20736
  s_waitcnt lgkmcnt(5)
  v_mfma_f32_32x32x16_bf16 v[224:239], a[12:15], a[140:143], v[224:239]
  s_add_u32 m0, s31, 131072
  s_add_u32 s6, s2, 114688
  s_and_b32 s6, s6, 0x3ffff
  ds_read_b64_tr_b16 a[8:9], v4 offset:16896
  ds_read_b64_tr_b16 a[10:11], v4 offset:20992
  buffer_load_dwordx4 v1, s[64:67], s6 offen offset:0 lds
  v_mfma_f32_32x32x16_bf16 v[224:239], a[16:19], a[144:147], v[224:239]
  ds_read_b64_tr_b16 a[12:13], v4 offset:17152
  ds_read_b64_tr_b16 a[14:15], v4 offset:21248
  v_mfma_f32_32x32x16_bf16 v[224:239], a[20:23], a[148:151], v[224:239]
  ds_read_b64_tr_b16 a[16:17], v4 offset:17408
  ds_read_b64_tr_b16 a[18:19], v4 offset:21504
  v_mfma_f32_32x32x16_bf16 v[224:239], a[24:27], a[152:155], v[224:239]
  ds_read_b64_tr_b16 a[20:21], v4 offset:17664
  ds_read_b64_tr_b16 a[22:23], v4 offset:21760
  s_waitcnt lgkmcnt(6)
  v_mfma_f32_32x32x16_bf16 v[224:239], a[28:31], a[156:159], v[224:239]
  ds_read_b64_tr_b16 a[24:25], v4 offset:17920
  ds_read_b64_tr_b16 a[26:27], v4 offset:22016
  buffer_load_dwordx4 v1, s[68:71], s6 offen offset:1024 lds
  s_mov_b32 s46, 0x3f803f80
  s_nop 7
  v_max3_f32 v7, v7, v224, v225
  v_max3_f32 v7, v7, v226, v227
  v_max3_f32 v7, v7, v228, v229
  v_max3_f32 v7, v7, v230, v231
  v_max3_f32 v7, v7, v232, v233
  v_max3_f32 v7, v7, v234, v235
  v_max3_f32 v7, v7, v236, v237
  v_max3_f32 v7, v7, v238, v239
  v_mov_b32 v13, v7
  s_nop 1
  v_permlane32_swap_b32 v13, v7
  v_max_f32 v7, v7, v13
  v_mul_f32 v7, v7, v5
  v_sub_f32 v7, 0, v7
  s_mov_b32 s45, 0x33803380
  v_accvgpr_write_b32 a232, s46
  v_accvgpr_write_b32 a233, s46
  v_fma_f32 v16, v16, v5, v7
  v_fma_f32 v17, v17, v5, v7
  v_fma_f32 v18, v18, v5, v7
  v_fma_f32 v19, v19, v5, v7
  v_fma_f32 v20, v20, v5, v7
  v_fma_f32 v21, v21, v5, v7
  v_fma_f32 v22, v22, v5, v7
  v_fma_f32 v23, v23, v5, v7
  v_exp_f32 v16, v16
  v_exp_f32 v17, v17
  v_exp_f32 v18, v18
  v_exp_f32 v19, v19
  v_exp_f32 v20, v20
  v_exp_f32 v21, v21
  v_exp_f32 v22, v22
  v_exp_f32 v23, v23
  v_cvt_pk_bf16_f32 v16, v16, v17
  v_cvt_pk_bf16_f32 v17, v18, v19
  v_cvt_pk_bf16_f32 v18, v20, v21
  v_cvt_pk_bf16_f32 v19, v22, v23
  v_pk_max_u16 v16, v16, s45
  v_pk_max_u16 v17, v17, s45
  v_pk_max_u16 v18, v18, s45
  v_pk_max_u16 v19, v19, s45
  v_mfma_f32_4x4x4_16b_bf16 a[224:227], a[232:233], v[16:17], 0
  s_nop 0
  v_mfma_f32_4x4x4_16b_bf16 a[228:231], a[232:233], v[18:19], 0
  v_mfma_f32_32x32x16_bf16 a[32:47], a[0:3], v[16:19], 0
  ds_read_b64_tr_b16 a[28:29], v4 offset:18176
  ds_read_b64_tr_b16 a[30:31], v4 offset:22272
  v_fma_f32 v24, v24, v5, v7
  v_fma_f32 v25, v25, v5, v7
  v_fma_f32 v26, v26, v5, v7
  v_fma_f32 v27, v27, v5, v7
  v_mfma_f32_32x32x16_bf16 a[48:63], a[4:7], v[16:19], 0
  ds_read_b64_tr_b16 a[0:1], v4 offset:24576
  ds_read_b64_tr_b16 a[2:3], v4 offset:28672
  v_fma_f32 v28, v28, v5, v7
  v_fma_f32 v29, v29, v5, v7
  v_fma_f32 v30, v30, v5, v7
  v_fma_f32 v31, v31, v5, v7
  v_mfma_f32_32x32x16_bf16 a[64:79], a[8:11], v[16:19], 0
  ds_read_b64_tr_b16 a[4:5], v4 offset:24832
  ds_read_b64_tr_b16 a[6:7], v4 offset:28928
  v_exp_f32 v24, v24
  v_exp_f32 v25, v25
  s_waitcnt lgkmcnt(6)
  v_mfma_f32_32x32x16_bf16 a[80:95], a[12:15], v[16:19], 0
  ds_read_b64_tr_b16 a[8:9], v4 offset:25088
  ds_read_b64_tr_b16 a[10:11], v4 offset:29184
  buffer_load_dwordx4 v1, s[64:67], s6 offen offset:2048 lds
  v_mfma_f32_32x32x16_bf16 a[96:111], a[16:19], v[16:19], 0
  ds_read_b64_tr_b16 a[12:13], v4 offset:25344
  ds_read_b64_tr_b16 a[14:15], v4 offset:29440
  v_exp_f32 v26, v26
  v_exp_f32 v27, v27
  v_mfma_f32_32x32x16_bf16 a[112:127], a[20:23], v[16:19], 0
  ds_read_b64_tr_b16 a[16:17], v4 offset:25600
  ds_read_b64_tr_b16 a[18:19], v4 offset:29696
  v_exp_f32 v28, v28
  v_exp_f32 v29, v29
  v_mfma_f32_32x32x16_bf16 a[128:143], a[24:27], v[16:19], 0
  ds_read_b64_tr_b16 a[20:21], v4 offset:25856
  ds_read_b64_tr_b16 a[22:23], v4 offset:29952
  v_exp_f32 v30, v30
  v_exp_f32 v31, v31
  s_waitcnt lgkmcnt(6)
  v_mfma_f32_32x32x16_bf16 a[144:159], a[28:31], v[16:19], 0
  ds_read_b64_tr_b16 a[24:25], v4 offset:26112
  ds_read_b64_tr_b16 a[26:27], v4 offset:30208
  buffer_load_dwordx4 v1, s[68:71], s6 offen offset:3072 lds
  v_cvt_pk_bf16_f32 v20, v24, v25
  v_cvt_pk_bf16_f32 v21, v26, v27
  v_cvt_pk_bf16_f32 v22, v28, v29
  v_cvt_pk_bf16_f32 v23, v30, v31
  v_pk_max_u16 v20, v20, s45
  v_pk_max_u16 v21, v21, s45
  v_pk_max_u16 v22, v22, s45
  v_pk_max_u16 v23, v23, s45
  v_mfma_f32_4x4x4_16b_bf16 a[224:227], a[232:233], v[20:21], a[224:227]
  s_nop 0
  v_mfma_f32_4x4x4_16b_bf16 a[228:231], a[232:233], v[22:23], a[228:231]
  v_mfma_f32_32x32x16_bf16 a[32:47], a[0:3], v[20:23], a[32:47]
  ds_read_b64_tr_b16 a[28:29], v4 offset:26368
  ds_read_b64_tr_b16 a[30:31], v4 offset:30464
  v_fma_f32 v32, v32, v5, v7
  v_fma_f32 v33, v33, v5, v7
  v_fma_f32 v34, v34, v5, v7
  v_fma_f32 v35, v35, v5, v7
  v_mfma_f32_32x32x16_bf16 a[48:63], a[4:7], v[20:23], a[48:63]
  ds_read_b64_tr_b16 a[0:1], v4 offset:32768
  ds_read_b64_tr_b16 a[2:3], v4 offset:36864
  v_fma_f32 v36, v36, v5, v7
  v_fma_f32 v37, v37, v5, v7
  v_fma_f32 v38, v38, v5, v7
  v_fma_f32 v39, v39, v5, v7
  v_mfma_f32_32x32x16_bf16 a[64:79], a[8:11], v[20:23], a[64:79]
  ds_read_b64_tr_b16 a[4:5], v4 offset:33024
  ds_read_b64_tr_b16 a[6:7], v4 offset:37120
  v_exp_f32 v32, v32
  v_exp_f32 v33, v33
  s_waitcnt lgkmcnt(6)
  v_mfma_f32_32x32x16_bf16 a[80:95], a[12:15], v[20:23], a[80:95]
  s_add_u32 m0, s31, 147456
  s_add_u32 s6, s2, 131072
  s_and_b32 s6, s6, 0x3ffff
  ds_read_b64_tr_b16 a[8:9], v4 offset:33280
  ds_read_b64_tr_b16 a[10:11], v4 offset:37376
  buffer_load_dwordx4 v1, s[64:67], s6 offen offset:0 lds
  v_mfma_f32_32x32x16_bf16 a[96:111], a[16:19], v[20:23], a[96:111]
  ds_read_b64_tr_b16 a[12:13], v4 offset:33536
  ds_read_b64_tr_b16 a[14:15], v4 offset:37632
  v_exp_f32 v34, v34
  v_exp_f32 v35, v35
  v_mfma_f32_32x32x16_bf16 a[112:127], a[20:23], v[20:23], a[112:127]
  ds_read_b64_tr_b16 a[16:17], v4 offset:33792
  ds_read_b64_tr_b16 a[18:19], v4 offset:37888
  v_exp_f32 v36, v36
  v_exp_f32 v37, v37
  v_mfma_f32_32x32x16_bf16 a[128:143], a[24:27], v[20:23], a[128:143]
  ds_read_b64_tr_b16 a[20:21], v4 offset:34048
  ds_read_b64_tr_b16 a[22:23], v4 offset:38144
  v_exp_f32 v38, v38
  v_exp_f32 v39, v39
  s_waitcnt lgkmcnt(6)
  v_mfma_f32_32x32x16_bf16 a[144:159], a[28:31], v[20:23], a[144:159]
  ds_read_b64_tr_b16 a[24:25], v4 offset:34304
  ds_read_b64_tr_b16 a[26:27], v4 offset:38400
  buffer_load_dwordx4 v1, s[68:71], s6 offen offset:1024 lds
  v_cvt_pk_bf16_f32 v32, v32, v33
  v_cvt_pk_bf16_f32 v33, v34, v35
  v_cvt_pk_bf16_f32 v34, v36, v37
  v_cvt_pk_bf16_f32 v35, v38, v39
  v_pk_max_u16 v32, v32, s45
  v_pk_max_u16 v33, v33, s45
  v_pk_max_u16 v34, v34, s45
  v_pk_max_u16 v35, v35, s45
  v_mfma_f32_4x4x4_16b_bf16 a[224:227], a[232:233], v[32:33], a[224:227]
  s_nop 0
  v_mfma_f32_4x4x4_16b_bf16 a[228:231], a[232:233], v[34:35], a[228:231]
  v_mfma_f32_32x32x16_bf16 a[32:47], a[0:3], v[32:35], a[32:47]
  ds_read_b64_tr_b16 a[28:29], v4 offset:34560
  ds_read_b64_tr_b16 a[30:31], v4 offset:38656
  v_fma_f32 v40, v40, v5, v7
  v_fma_f32 v41, v41, v5, v7
  v_fma_f32 v42, v42, v5, v7
  v_fma_f32 v43, v43, v5, v7
  v_mfma_f32_32x32x16_bf16 a[48:63], a[4:7], v[32:35], a[48:63]
  ds_read_b64_tr_b16 a[0:1], v4 offset:40960
  ds_read_b64_tr_b16 a[2:3], v4 offset:45056
  v_fma_f32 v44, v44, v5, v7
  v_fma_f32 v45, v45, v5, v7
  v_fma_f32 v46, v46, v5, v7
  v_fma_f32 v47, v47, v5, v7
L_padl5:
  s_cbranch_execz L_padl9
  v_mfma_f32_32x32x16_bf16 a[64:79], a[8:11], v[32:35], a[64:79]
  ds_read_b64_tr_b16 a[4:5], v4 offset:41216
  ds_read_b64_tr_b16 a[6:7], v4 offset:45312
  v_exp_f32 v40, v40
  v_exp_f32 v41, v41
  s_waitcnt lgkmcnt(6)
  v_mfma_f32_32x32x16_bf16 a[80:95], a[12:15], v[32:35], a[80:95]
  ds_read_b64_tr_b16 a[8:9], v4 offset:41472
  ds_read_b64_tr_b16 a[10:11], v4 offset:45568
  buffer_load_dwordx4 v1, s[64:67], s6 offen offset:2048 lds
  v_mfma_f32_32x32x16_bf16 a[96:111], a[16:19], v[32:35], a[96:111]
  ds_read_b64_tr_b16 a[12:13], v4 offset:41728
  ds_read_b64_tr_b16 a[14:15], v4 offset:45824
  v_exp_f32 v42, v42
  v_exp_f32 v43, v43
  v_mfma_f32_32x32x16_bf16 a[112:127], a[20:23], v[32:35], a[112:127]
  ds_read_b64_tr_b16 a[16:17], v4 offset:41984
  ds_read_b64_tr_b16 a[18:19], v4 offset:46080
  v_exp_f32 v44, v44
  v_exp_f32 v45, v45
  v_mfma_f32_32x32x16_bf16 a[128:143], a[24:27], v[32:35], a[128:143]
  ds_read_b64_tr_b16 a[20:21], v4 offset:42240
  ds_read_b64_tr_b16 a[22:23], v4 offset:46336
  v_exp_f32 v46, v46
  v_exp_f32 v47, v47
  s_waitcnt lgkmcnt(6)
  v_mfma_f32_32x32x16_bf16 a[144:159], a[28:31], v[32:35], a[144:159]
  ds_read_b64_tr_b16 a[24:25], v4 offset:42496
  ds_read_b64_tr_b16 a[26:27], v4 offset:46592
  buffer_load_dwordx4 v1, s[68:71], s6 offen offset:3072 lds
  v_cvt_pk_bf16_f32 v36, v40, v41
  v_cvt_pk_bf16_f32 v37, v42, v43
  v_cvt_pk_bf16_f32 v38, v44, v45
  v_cvt_pk_bf16_f32 v39, v46, v47
  v_pk_max_u16 v36, v36, s45
  v_pk_max_u16 v37, v37, s45
  v_pk_max_u16 v38, v38, s45
  v_pk_max_u16 v39, v39, s45
  v_mfma_f32_4x4x4_16b_bf16 a[224:227], a[232:233], v[36:37], a[224:227]
  s_nop 0
  v_mfma_f32_4x4x4_16b_bf16 a[228:231], a[232:233], v[38:39], a[228:231]
  v_mfma_f32_32x32x16_bf16 a[32:47], a[0:3], v[36:39], a[32:47]
  ds_read_b64_tr_b16 a[28:29], v4 offset:42752
  ds_read_b64_tr_b16 a[30:31], v4 offset:46848
  v_fma_f32 v48, v48, v5, v7
  v_fma_f32 v49, v49, v5, v7
  v_fma_f32 v50, v50, v5, v7
  v_fma_f32 v51, v51, v5, v7
  v_mfma_f32_32x32x16_bf16 a[48:63], a[4:7], v[36:39], a[48:63]
  s_waitcnt vmcnt(20)
  s_barrier
  ds_read_b64_tr_b16 a[0:1], v4 offset:49152
  ds_read_b64_tr_b16 a[2:3], v4 offset:53248
  v_fma_f32 v52, v52, v5, v7
  v_fma_f32 v53, v53, v5, v7
  v_mfma_f32_32x32x16_bf16 a[64:79], a[8:11], v[36:39], a[64:79]
  ds_read_b64_tr_b16 a[4:5], v4 offset:49408
  ds_read_b64_tr_b16 a[6:7], v4 offset:53504
  v_fma_f32 v54, v54, v5, v7
  v_fma_f32 v55, v55, v5, v7
  v_exp_f32 v48, v48
  s_waitcnt lgkmcnt(6)
  v_mfma_f32_32x32x16_bf16 a[80:95], a[12:15], v[36:39], a[80:95]
  s_add_u32 m0, s31, 0
  s_add_u32 s6, s2, 147456
  s_and_b32 s6, s6, 0x3ffff
  ds_read_b64_tr_b16 a[8:9], v4 offset:49664
  ds_read_b64_tr_b16 a[10:11], v4 offset:53760
  buffer_load_dwordx4 v1, s[64:67], s6 offen offset:0 lds
  v_mfma_f32_32x32x16_bf16 a[96:111], a[16:19], v[36:39], a[96:111]
  ds_read_b64_tr_b16 a[12:13], v4 offset:49920
  ds_read_b64_tr_b16 a[14:15], v4 offset:54016
  v_exp_f32 v49, v49
  v_exp_f32 v50, v50
  v_mfma_f32_32x32x16_bf16 a[112:127], a[20:23], v[36:39], a[112:127]
  ds_read_b64_tr_b16 a[16:17], v4 offset:50176
  ds_read_b64_tr_b16 a[18:19], v4 offset:54272
  v_exp_f32 v51, v51
  v_exp_f32 v52, v52
  v_mfma_f32_32x32x16_bf16 a[128:143], a[24:27], v[36:39], a[128:143]
  ds_read_b64_tr_b16 a[20:21], v4 offset:50432
  ds_read_b64_tr_b16 a[22:23], v4 offset:54528
  v_exp_f32 v53, v53
  v_exp_f32 v54, v54
  s_waitcnt lgkmcnt(6)
  v_mfma_f32_32x32x16_bf16 a[144:159], a[28:31], v[36:39], a[144:159]
  ds_read_b64_tr_b16 a[24:25], v4 offset:50688
  ds_read_b64_tr_b16 a[26:27], v4 offset:54784
  buffer_load_dwordx4 v1, s[68:71], s6 offen offset:1024 lds
  v_exp_f32 v55, v55
  v_cvt_pk_bf16_f32 v48, v48, v49
  v_cvt_pk_bf16_f32 v49, v50, v51
  v_cvt_pk_bf16_f32 v50, v52, v53
  v_cvt_pk_bf16_f32 v51, v54, v55
  v_pk_max_u16 v48, v48, s45
  v_pk_max_u16 v49, v49, s45
  v_pk_max_u16 v50, v50, s45
  v_pk_max_u16 v51, v51, s45
  v_mfma_f32_4x4x4_16b_bf16 a[224:227], a[232:233], v[48:49], a[224:227]
  s_nop 0
  v_mfma_f32_4x4x4_16b_bf16 a[228:231], a[232:233], v[50:51], a[228:231]
  v_mfma_f32_32x32x16_bf16 a[32:47], a[0:3], v[48:51], a[32:47]
  ds_read_b64_tr_b16 a[28:29], v4 offset:50944
  ds_read_b64_tr_b16 a[30:31], v4 offset:55040
  v_fma_f32 v56, v56, v5, v7
  v_fma_f32 v57, v57, v5, v7
  v_fma_f32 v58, v58, v5, v7
  v_fma_f32 v59, v59, v5, v7
  v_mfma_f32_32x32x16_bf16 a[48:63], a[4:7], v[48:51], a[48:63]
  ds_read_b64_tr_b16 a[0:1], v4 offset:57344
  ds_read_b64_tr_b16 a[2:3], v4 offset:61440
  v_fma_f32 v60, v60, v5, v7
  v_fma_f32 v61, v61, v5, v7
  v_fma_f32 v62, v62, v5, v7
  v_fma_f32 v63, v63, v5, v7
  v_mfma_f32_32x32x16_bf16 a[64:79], a[8:11], v[48:51], a[64:79]
  ds_read_b64_tr_b16 a[4:5], v4 offset:57600
  ds_read_b64_tr_b16 a[6:7], v4 offset:61696
  v_exp_f32 v56, v56
  v_exp_f32 v57, v57
  s_waitcnt lgkmcnt(6)
  v_mfma_f32_32x32x16_bf16 a[80:95], a[12:15], v[48:51], a[80:95]
  ds_read_b64_tr_b16 a[8:9], v4 offset:57856
  ds_read_b64_tr_b16 a[10:11], v4 offset:61952
  buffer_load_dwordx4 v1, s[64:67], s6 offen offset:2048 lds
  v_mfma_f32_32x32x16_bf16 a[96:111], a[16:19], v[48:51], a[96:111]
  ds_read_b64_tr_b16 a[12:13], v4 offset:58112
  ds_read_b64_tr_b16 a[14:15], v4 offset:62208
  v_exp_f32 v58, v58
  v_exp_f32 v59, v59
  v_mfma_f32_32x32x16_bf16 a[112:127], a[20:23], v[48:51], a[112:127]
  ds_read_b64_tr_b16 a[16:17], v4 offset:58368
  ds_read_b64_tr_b16 a[18:19], v4 offset:62464
  v_exp_f32 v60, v60
  v_exp_f32 v61, v61
  v_mfma_f32_32x32x16_bf16 a[128:143], a[24:27], v[48:51], a[128:143]
  ds_read_b64_tr_b16 a[20:21], v4 offset:58624
  ds_read_b64_tr_b16 a[22:23], v4 offset:62720
  v_exp_f32 v62, v62
  v_exp_f32 v63, v63
  s_waitcnt lgkmcnt(6)
  v_mfma_f32_32x32x16_bf16 a[144:159], a[28:31], v[48:51], a[144:159]
  ds_read_b64_tr_b16 a[24:25], v4 offset:58880
  ds_read_b64_tr_b16 a[26:27], v4 offset:62976
  buffer_load_dwordx4 v1, s[68:71], s6 offen offset:3072 lds
  v_cvt_pk_bf16_f32 v52, v56, v57
  v_cvt_pk_bf16_f32 v53, v58, v59
  v_cvt_pk_bf16_f32 v54, v60, v61
  v_cvt_pk_bf16_f32 v55, v62, v63
  v_pk_max_u16 v52, v52, s45
  v_pk_max_u16 v53, v53, s45
  v_pk_max_u16 v54, v54, s45
  v_pk_max_u16 v55, v55, s45
  v_mfma_f32_4x4x4_16b_bf16 a[224:227], a[232:233], v[52:53], a[224:227]
  s_nop 0
  v_mfma_f32_4x4x4_16b_bf16 a[228:231], a[232:233], v[54:55], a[228:231]
  v_mfma_f32_32x32x16_bf16 a[32:47], a[0:3], v[52:55], a[32:47]
  ds_read_b64_tr_b16 a[28:29], v4 offset:59136
  ds_read_b64_tr_b16 a[30:31], v4 offset:63232
  v_fma_f32 v64, v64, v5, v7
  v_fma_f32 v65, v65, v5, v7
  v_fma_f32 v66, v66, v5, v7
  v_add_u32 v4, 0x00010000, v4
  v_mfma_f32_32x32x16_bf16 a[48:63], a[4:7], v[52:55], a[48:63]
  ds_read_b64_tr_b16 a[0:1], v4 offset:0
  ds_read_b64_tr_b16 a[2:3], v4 offset:4096
  v_fma_f32 v67, v67, v5, v7
  v_fma_f32 v68, v68, v5, v7
  v_fma_f32 v69, v69, v5, v7
  v_fma_f32 v70, v70, v5, v7
  v_mfma_f32_32x32x16_bf16 a[64:79], a[8:11], v[52:55], a[64:79]
  ds_read_b64_tr_b16 a[4:5], v4 offset:256
  ds_read_b64_tr_b16 a[6:7], v4 offset:4352
  v_fma_f32 v71, v71, v5, v7
  v_exp_f32 v64, v64
  s_waitcnt lgkmcnt(6)
  v_mfma_f32_32x32x16_bf16 a[80:95], a[12:15], v[52:55], a[80:95]
  s_add_u32 m0, s31, 16384
  s_add_u32 s6, s2, 163840
  s_and_b32 s6, s6, 0x3ffff
  ds_read_b64_tr_b16 a[8:9], v4 offset:512
  ds_read_b64_tr_b16 a[10:11], v4 offset:4608
  buffer_load_dwordx4 v1, s[64:67], s6 offen offset:0 lds
  v_mfma_f32_32x32x16_bf16 a[96:111], a[16:19], v[52:55], a[96:111]
  ds_read_b64_tr_b16 a[12:13], v4 offset:768
  ds_read_b64_tr_b16 a[14:15], v4 offset:4864
  v_exp_f32 v65, v65
  v_exp_f32 v66, v66
  v_mfma_f32_32x32x16_bf16 a[112:127], a[20:23], v[52:55], a[112:127]
  ds_read_b64_tr_b16 a[16:17], v4 offset:1024
  ds_read_b64_tr_b16 a[18:19], v4 offset:5120
  v_exp_f32 v67, v67
  v_exp_f32 v68, v68
  v_mfma_f32_32x32x16_bf16 a[128:143], a[24:27], v[52:55], a[128:143]
  ds_read_b64_tr_b16 a[20:21], v4 offset:1280
  ds_read_b64_tr_b16 a[22:23], v4 offset:5376
  v_exp_f32 v69, v69
  v_exp_f32 v70, v70
  s_waitcnt lgkmcnt(6)
  v_mfma_f32_32x32x16_bf16 a[144:159], a[28:31], v[52:55], a[144:159]
  ds_read_b64_tr_b16 a[24:25], v4 offset:1536
  ds_read_b64_tr_b16 a[26:27], v4 offset:5632
  buffer_load_dwordx4 v1, s[68:71], s6 offen offset:1024 lds
  v_exp_f32 v71, v71
  v_cvt_pk_bf16_f32 v64, v64, v65
  v_cvt_pk_bf16_f32 v65, v66, v67
  v_cvt_pk_bf16_f32 v66, v68, v69
  v_cvt_pk_bf16_f32 v67, v70, v71
  v_pk_max_u16 v64, v64, s45
  v_pk_max_u16 v65, v65, s45
  v_pk_max_u16 v66, v66, s45
  v_pk_max_u16 v67, v67, s45
  v_mfma_f32_4x4x4_16b_bf16 a[224:227], a[232:233], v[64:65], a[224:227]
  s_nop 0
  v_mfma_f32_4x4x4_16b_bf16 a[228:231], a[232:233], v[66:67], a[228:231]
  v_mfma_f32_32x32x16_bf16 a[32:47], a[0:3], v[64:67], a[32:47]
  ds_read_b64_tr_b16 a[28:29], v4 offset:1792
  ds_read_b64_tr_b16 a[30:31], v4 offset:5888
  v_fma_f32 v72, v72, v5, v7
  v_fma_f32 v73, v73, v5, v7
  v_fma_f32 v74, v74, v5, v7
  v_fma_f32 v75, v75, v5, v7
  v_mfma_f32_32x32x16_bf16 a[48:63], a[4:7], v[64:67], a[48:63]
  ds_read_b64_tr_b16 a[0:1], v4 offset:8192
  ds_read_b64_tr_b16 a[2:3], v4 offset:12288
  v_fma_f32 v76, v76, v5, v7
  v_fma_f32 v77, v77, v5, v7
  v_fma_f32 v78, v78, v5, v7
  v_fma_f32 v79, v79, v5, v7
  v_mfma_f32_32x32x16_bf16 a[64:79], a[8:11], v[64:67], a[64:79]
  ds_read_b64_tr_b16 a[4:5], v4 offset:8448
  ds_read_b64_tr_b16 a[6:7], v4 offset:12544
  v_exp_f32 v72, v72
  v_exp_f32 v73, v73
  s_waitcnt lgkmcnt(6)
  v_mfma_f32_32x32x16_bf16 a[80:95], a[12:15], v[64:67], a[80:95]
  ds_read_b64_tr_b16 a[8:9], v4 offset:8704
  ds_read_b64_tr_b16 a[10:11], v4 offset:12800
  buffer_load_dwordx4 v1, s[64:67], s6 offen offset:2048 lds
  v_mfma_f32_32x32x16_bf16 a[96:111], a[16:19], v[64:67], a[96:111]
  ds_read_b64_tr_b16 a[12:13], v4 offset:8960
  ds_read_b64_tr_b16 a[14:15], v4 offset:13056
  v_exp_f32 v74, v74
  v_exp_f32 v75, v75
  v_mfma_f32_32x32x16_bf16 a[112:127], a[20:23], v[64:67], a[112:127]
  ds_read_b64_tr_b16 a[16:17], v4 offset:9216
  ds_read_b64_tr_b16 a[18:19], v4 offset:13312
  v_exp_f32 v76, v76
  v_exp_f32 v77, v77
  v_mfma_f32_32x32x16_bf16 a[128:143], a[24:27], v[64:67], a[128:143]
  ds_read_b64_tr_b16 a[20:21], v4 offset:9472
  ds_read_b64_tr_b16 a[22:23], v4 offset:13568
  v_exp_f32 v78, v78
  v_exp_f32 v79, v79
  s_waitcnt lgkmcnt(6)
  v_mfma_f32_32x32x16_bf16 a[144:159], a[28:31], v[64:67], a[144:159]
  ds_read_b64_tr_b16 a[24:25], v4 offset:9728
  ds_read_b64_tr_b16 a[26:27], v4 offset:13824
  buffer_load_dwordx4 v1, s[68:71], s6 offen offset:3072 lds
  v_cvt_pk_bf16_f32 v68, v72, v73
  v_cvt_pk_bf16_f32 v69, v74, v75
  v_cvt_pk_bf16_f32 v70, v76, v77
  v_cvt_pk_bf16_f32 v71, v78, v79
  v_pk_max_u16 v68, v68, s45
  v_pk_max_u16 v69, v69, s45
  v_pk_max_u16 v70, v70, s45
  v_pk_max_u16 v71, v71, s45
  v_mfma_f32_4x4x4_16b_bf16 a[224:227], a[232:233], v[68:69], a[224:227]
  s_nop 0
  v_mfma_f32_4x4x4_16b_bf16 a[228:231], a[232:233], v[70:71], a[228:231]
  v_mfma_f32_32x32x16_bf16 a[32:47], a[0:3], v[68:71], a[32:47]
  ds_read_b64_tr_b16 a[28:29], v4 offset:9984
  ds_read_b64_tr_b16 a[30:31], v4 offset:14080
  v_fma_f32 v80, v80, v5, v7
  v_fma_f32 v81, v81, v5, v7
  v_fma_f32 v82, v82, v5, v7
  v_fma_f32 v83, v83, v5, v7
  v_mfma_f32_32x32x16_bf16 a[48:63], a[4:7], v[68:71], a[48:63]
  s_waitcnt vmcnt(20)
  s_barrier
  ds_read_b64_tr_b16 a[0:1], v4 offset:16384
  ds_read_b64_tr_b16 a[2:3], v4 offset:20480
  v_fma_f32 v84, v84, v5, v7
  v_fma_f32 v85, v85, v5, v7
  v_mfma_f32_32x32x16_bf16 a[64:79], a[8:11], v[68:71], a[64:79]
  ds_read_b64_tr_b16 a[4:5], v4 offset:16640
  ds_read_b64_tr_b16 a[6:7], v4 offset:20736
  v_fma_f32 v86, v86, v5, v7
  v_fma_f32 v87, v87, v5, v7
  v_exp_f32 v80, v80
  s_waitcnt lgkmcnt(6)
  v_mfma_f32_32x32x16_bf16 a[80:95], a[12:15], v[68:71], a[80:95]
  s_add_u32 m0, s31, 32768
  s_add_u32 s6, s2, 180224
  s_and_b32 s6, s6, 0x3ffff
  ds_read_b64_tr_b16 a[8:9], v4 offset:16896
  ds_read_b64_tr_b16 a[10:11], v4 offset:20992
  buffer_load_dwordx4 v1, s[64:67], s6 offen offset:0 lds
  v_mfma_f32_32x32x16_bf16 a[96:111], a[16:19], v[68:71], a[96:111]
  ds_read_b64_tr_b16 a[12:13], v4 offset:17152
  ds_read_b64_tr_b16 a[14:15], v4 offset:21248
  v_exp_f32 v81, v81
  v_exp_f32 v82, v82
  v_mfma_f32_32x32x16_bf16 a[112:127], a[20:23], v[68:71], a[112:127]
  ds_read_b64_tr_b16 a[16:17], v4 offset:17408
  ds_read_b64_tr_b16 a[18:19], v4 offset:21504
  v_exp_f32 v83, v83
  v_exp_f32 v84, v84
  v_mfma_f32_32x32x16_bf16 a[128:143], a[24:27], v[68:71], a[128:143]
  ds_read_b64_tr_b16 a[20:21], v4 offset:17664
  ds_read_b64_tr_b16 a[22:23], v4 offset:21760
  v_exp_f32 v85, v85
  v_exp_f32 v86, v86
  s_waitcnt lgkmcnt(6)
  v_mfma_f32_32x32x16_bf16 a[144:159], a[28:31], v[68:71], a[144:159]
  ds_read_b64_tr_b16 a[24:25], v4 offset:17920
  ds_read_b64_tr_b16 a[26:27], v4 offset:22016
  buffer_load_dwordx4 v1, s[68:71], s6 offen offset:1024 lds
  v_exp_f32 v87, v87
  v_cvt_pk_bf16_f32 v80, v80, v81
  v_cvt_pk_bf16_f32 v81, v82, v83
  v_cvt_pk_bf16_f32 v82, v84, v85
  v_cvt_pk_bf16_f32 v83, v86, v87
  v_pk_max_u16 v80, v80, s45
  v_pk_max_u16 v81, v81, s45
  v_pk_max_u16 v82, v82, s45
  v_pk_max_u16 v83, v83, s45
  v_mfma_f32_4x4x4_16b_bf16 a[224:227], a[232:233], v[80:81], a[224:227]
  s_nop 0
  v_mfma_f32_4x4x4_16b_bf16 a[228:231], a[232:233], v[82:83], a[228:231]
  v_mfma_f32_32x32x16_bf16 a[32:47], a[0:3], v[80:83], a[32:47]
  ds_read_b64_tr_b16 a[28:29], v4 offset:18176
  ds_read_b64_tr_b16 a[30:31], v4 offset:22272
  v_fma_f32 v88, v88, v5, v7
  v_fma_f32 v89, v89, v5, v7
  v_fma_f32 v90, v90, v5, v7
  v_fma_f32 v91, v91, v5, v7
  v_mfma_f32_32x32x16_bf16 a[48:63], a[4:7], v[80:83], a[48:63]
  ds_read_b64_tr_b16 a[0:1], v4 offset:24576
  ds_read_b64_tr_b16 a[2:3], v4 offset:28672
  v_fma_f32 v92, v92, v5, v7
  v_fma_f32 v93, v93, v5, v7
  v_fma_f32 v94, v94, v5, v7
  v_fma_f32 v95, v95, v5, v7
  v_mfma_f32_32x32x16_bf16 a[64:79], a[8:11], v[80:83], a[64:79]
  ds_read_b64_tr_b16 a[4:5], v4 offset:24832
  ds_read_b64_tr_b16 a[6:7], v4 offset:28928
  v_exp_f32 v88, v88
  v_exp_f32 v89, v89
  s_waitcnt lgkmcnt(6)
  v_mfma_f32_32x32x16_bf16 a[80:95], a[12:15], v[80:83], a[80:95]
  ds_read_b64_tr_b16 a[8:9], v4 offset:25088
  ds_read_b64_tr_b16 a[10:11], v4 offset:29184
  buffer_load_dwordx4 v1, s[64:67], s6 offen offset:2048 lds
  v_mfma_f32_32x32x16_bf16 a[96:111], a[16:19], v[80:83], a[96:111]
  ds_read_b64_tr_b16 a[12:13], v4 offset:25344
  ds_read_b64_tr_b16 a[14:15], v4 offset:29440
  v_exp_f32 v90, v90
  v_exp_f32 v91, v91
  v_mfma_f32_32x32x16_bf16 a[112:127], a[20:23], v[80:83], a[112:127]
  ds_read_b64_tr_b16 a[16:17], v4 offset:25600
  ds_read_b64_tr_b16 a[18:19], v4 offset:29696
  v_exp_f32 v92, v92
  v_exp_f32 v93, v93
  v_mfma_f32_32x32x16_bf16 a[128:143], a[24:27], v[80:83], a[128:143]
  ds_read_b64_tr_b16 a[20:21], v4 offset:25856
  ds_read_b64_tr_b16 a[22:23], v4 offset:29952
  v_exp_f32 v94, v94
  v_exp_f32 v95, v95
  s_waitcnt lgkmcnt(6)
  v_mfma_f32_32x32x16_bf16 a[144:159], a[28:31], v[80:83], a[144:159]
  ds_read_b64_tr_b16 a[24:25], v4 offset:26112
  ds_read_b64_tr_b16 a[26:27], v4 offset:30208
  buffer_load_dwordx4 v1, s[68:71], s6 offen offset:3072 lds
  v_cvt_pk_bf16_f32 v84, v88, v89
  v_cvt_pk_bf16_f32 v85, v90, v91
  v_cvt_pk_bf16_f32 v86, v92, v93
  v_cvt_pk_bf16_f32 v87, v94, v95
  v_pk_max_u16 v84, v84, s45
  v_pk_max_u16 v85, v85, s45
  v_pk_max_u16 v86, v86, s45
  v_pk_max_u16 v87, v87, s45
  v_mfma_f32_4x4x4_16b_bf16 a[224:227], a[232:233], v[84:85], a[224:227]
  s_nop 0
  v_mfma_f32_4x4x4_16b_bf16 a[228:231], a[232:233], v[86:87], a[228:231]
  v_mfma_f32_32x32x16_bf16 a[32:47], a[0:3], v[84:87], a[32:47]
  ds_read_b64_tr_b16 a[28:29], v4 offset:26368
  ds_read_b64_tr_b16 a[30:31], v4 offset:30464
  v_fma_f32 v96, v96, v5, v7
  v_fma_f32 v97, v97, v5, v7
  v_fma_f32 v98, v98, v5, v7
  v_fma_f32 v99, v99, v5, v7
  v_mfma_f32_32x32x16_bf16 a[48:63], a[4:7], v[84:87], a[48:63]
  ds_read_b64_tr_b16 a[0:1], v4 offset:32768
  ds_read_b64_tr_b16 a[2:3], v4 offset:36864
  v_fma_f32 v100, v100, v5, v7
  v_fma_f32 v101, v101, v5, v7
  v_fma_f32 v102, v102, v5, v7
  v_fma_f32 v103, v103, v5, v7
  v_mfma_f32_32x32x16_bf16 a[64:79], a[8:11], v[84:87], a[64:79]
  ds_read_b64_tr_b16 a[4:5], v4 offset:33024
  ds_read_b64_tr_b16 a[6:7], v4 offset:37120
  v_exp_f32 v96, v96
  v_exp_f32 v97, v97
  s_waitcnt lgkmcnt(6)
  v_mfma_f32_32x32x16_bf16 a[80:95], a[12:15], v[84:87], a[80:95]
  s_add_u32 m0, s31, 49152
  s_add_u32 s6, s2, 196608
  s_and_b32 s6, s6, 0x3ffff
  ds_read_b64_tr_b16 a[8:9], v4 offset:33280
  ds_read_b64_tr_b16 a[10:11], v4 offset:37376
  buffer_load_dwordx4 v1, s[64:67], s6 offen offset:0 lds
  v_mfma_f32_32x32x16_bf16 a[96:111], a[16:19], v[84:87], a[96:111]
  ds_read_b64_tr_b16 a[12:13], v4 offset:33536
  ds_read_b64_tr_b16 a[14:15], v4 offset:37632
  v_exp_f32 v98, v98
  v_exp_f32 v99, v99
  v_mfma_f32_32x32x16_bf16 a[112:127], a[20:23], v[84:87], a[112:127]
  ds_read_b64_tr_b16 a[16:17], v4 offset:33792
  ds_read_b64_tr_b16 a[18:19], v4 offset:37888
  v_exp_f32 v100, v100
  v_exp_f32 v101, v101
  v_mfma_f32_32x32x16_bf16 a[128:143], a[24:27], v[84:87], a[128:143]
  ds_read_b64_tr_b16 a[20:21], v4 offset:34048
  ds_read_b64_tr_b16 a[22:23], v4 offset:38144
  v_exp_f32 v102, v102
  v_exp_f32 v103, v103
  s_waitcnt lgkmcnt(6)
  v_mfma_f32_32x32x16_bf16 a[144:159], a[28:31], v[84:87], a[144:159]
  ds_read_b64_tr_b16 a[24:25], v4 offset:34304
  ds_read_b64_tr_b16 a[26:27], v4 offset:38400
  buffer_load_dwordx4 v1, s[68:71], s6 offen offset:1024 lds
  v_cvt_pk_bf16_f32 v96, v96, v97
  v_cvt_pk_bf16_f32 v97, v98, v99
  v_cvt_pk_bf16_f32 v98, v100, v101
  v_cvt_pk_bf16_f32 v99, v102, v103
  v_pk_max_u16 v96, v96, s45
  v_pk_max_u16 v97, v97, s45
  v_pk_max_u16 v98, v98, s45
  v_pk_max_u16 v99, v99, s45
  v_mfma_f32_4x4x4_16b_bf16 a[224:227], a[232:233], v[96:97], a[224:227]
  s_nop 0
  v_mfma_f32_4x4x4_16b_bf16 a[228:231], a[232:233], v[98:99], a[228:231]
  v_mfma_f32_32x32x16_bf16 a[32:47], a[0:3], v[96:99], a[32:47]
  ds_read_b64_tr_b16 a[28:29], v4 offset:34560
  ds_read_b64_tr_b16 a[30:31], v4 offset:38656
  v_fma_f32 v104, v104, v5, v7
  v_fma_f32 v105, v105, v5, v7
  v_fma_f32 v106, v106, v5, v7
  v_fma_f32 v107, v107, v5, v7
  v_mfma_f32_32x32x16_bf16 a[48:63], a[4:7], v[96:99], a[48:63]
  ds_read_b64_tr_b16 a[0:1], v4 offset:40960
  ds_read_b64_tr_b16 a[2:3], v4 offset:45056
  v_fma_f32 v108, v108, v5, v7
  v_fma_f32 v109, v109, v5, v7
  v_fma_f32 v110, v110, v5, v7
  v_fma_f32 v111, v111, v5, v7
  v_mfma_f32_32x32x16_bf16 a[64:79], a[8:11], v[96:99], a[64:79]
  ds_read_b64_tr_b16 a[4:5], v4 offset:41216
  ds_read_b64_tr_b16 a[6:7], v4 offset:45312
  v_exp_f32 v104, v104
  v_exp_f32 v105, v105
  s_waitcnt lgkmcnt(6)
  v_mfma_f32_32x32x16_bf16 a[80:95], a[12:15], v[96:99], a[80:95]
  ds_read_b64_tr_b16 a[8:9], v4 offset:41472
  ds_read_b64_tr_b16 a[10:11], v4 offset:45568
  buffer_load_dwordx4 v1, s[64:67], s6 offen offset:2048 lds
  v_mfma_f32_32x32x16_bf16 a[96:111], a[16:19], v[96:99], a[96:111]
  ds_read_b64_tr_b16 a[12:13], v4 offset:41728
  ds_read_b64_tr_b16 a[14:15], v4 offset:45824
  v_exp_f32 v106, v106
  v_exp_f32 v107, v107
  v_mfma_f32_32x32x16_bf16 a[112:127], a[20:23], v[96:99], a[112:127]
  ds_read_b64_tr_b16 a[16:17], v4 offset:41984
  ds_read_b64_tr_b16 a[18:19], v4 offset:46080
  v_exp_f32 v108, v108
  v_exp_f32 v109, v109
  v_mfma_f32_32x32x16_bf16 a[128:143], a[24:27], v[96:99], a[128:143]
  ds_read_b64_tr_b16 a[20:21], v4 offset:42240
  ds_read_b64_tr_b16 a[22:23], v4 offset:46336
  v_exp_f32 v110, v110
  v_exp_f32 v111, v111
  s_waitcnt lgkmcnt(6)
  v_mfma_f32_32x32x16_bf16 a[144:159], a[28:31], v[96:99], a[144:159]
  ds_read_b64_tr_b16 a[24:25], v4 offset:42496
  ds_read_b64_tr_b16 a[26:27], v4 offset:46592
  buffer_load_dwordx4 v1, s[68:71], s6 offen offset:3072 lds
  v_cvt_pk_bf16_f32 v100, v104, v105
  v_cvt_pk_bf16_f32 v101, v106, v107
  v_cvt_pk_bf16_f32 v102, v108, v109
  v_cvt_pk_bf16_f32 v103, v110, v111
  v_pk_max_u16 v100, v100, s45
  v_pk_max_u16 v101, v101, s45
  v_pk_max_u16 v102, v102, s45
  v_pk_max_u16 v103, v103, s45
  v_mfma_f32_4x4x4_16b_bf16 a[224:227], a[232:233], v[100:101], a[224:227]
  s_nop 0
  v_mfma_f32_4x4x4_16b_bf16 a[228:231], a[232:233], v[102:103], a[228:231]
  v_mfma_f32_32x32x16_bf16 a[32:47], a[0:3], v[100:103], a[32:47]
  ds_read_b64_tr_b16 a[28:29], v4 offset:42752
  ds_read_b64_tr_b16 a[30:31], v4 offset:46848
  v_fma_f32 v112, v112, v5, v7
  v_fma_f32 v113, v113, v5, v7
  v_fma_f32 v114, v114, v5, v7
  v_fma_f32 v115, v115, v5, v7
  v_mfma_f32_32x32x16_bf16 a[48:63], a[4:7], v[100:103], a[48:63]
  s_waitcnt vmcnt(20)
  s_barrier
  ds_read_b64_tr_b16 a[0:1], v4 offset:49152
  ds_read_b64_tr_b16 a[2:3], v4 offset:53248
  v_fma_f32 v116, v116, v5, v7
  v_fma_f32 v117, v117, v5, v7
  v_mfma_f32_32x32x16_bf16 a[64:79], a[8:11], v[100:103], a[64:79]
  ds_read_b64_tr_b16 a[4:5], v4 offset:49408
  ds_read_b64_tr_b16 a[6:7], v4 offset:53504
  v_fma_f32 v118, v118, v5, v7
  v_fma_f32 v119, v119, v5, v7
  v_exp_f32 v112, v112
  s_waitcnt lgkmcnt(6)
  v_mfma_f32_32x32x16_bf16 a[80:95], a[12:15], v[100:103], a[80:95]
  s_add_u32 m0, s31, 65536
  s_add_u32 s6, s2, 212992
  s_and_b32 s6, s6, 0x3ffff
  ds_read_b64_tr_b16 a[8:9], v4 offset:49664
  ds_read_b64_tr_b16 a[10:11], v4 offset:53760
  buffer_load_dwordx4 v1, s[64:67], s6 offen offset:0 lds
  v_mfma_f32_32x32x16_bf16 a[96:111], a[16:19], v[100:103], a[96:111]
  ds_read_b64_tr_b16 a[12:13], v4 offset:49920
  ds_read_b64_tr_b16 a[14:15], v4 offset:54016
  v_exp_f32 v113, v113
  v_exp_f32 v114, v114
  v_mfma_f32_32x32x16_bf16 a[112:127], a[20:23], v[100:103], a[112:127]
  ds_read_b64_tr_b16 a[16:17], v4 offset:50176
  ds_read_b64_tr_b16 a[18:19], v4 offset:54272
  v_exp_f32 v115, v115
  v_exp_f32 v116, v116
  v_mfma_f32_32x32x16_bf16 a[128:143], a[24:27], v[100:103], a[128:143]
  ds_read_b64_tr_b16 a[20:21], v4 offset:50432
  ds_read_b64_tr_b16 a[22:23], v4 offset:54528
  v_exp_f32 v117, v117
  v_exp_f32 v118, v118
  s_waitcnt lgkmcnt(6)
  v_mfma_f32_32x32x16_bf16 a[144:159], a[28:31], v[100:103], a[144:159]
  ds_read_b64_tr_b16 a[24:25], v4 offset:50688
  ds_read_b64_tr_b16 a[26:27], v4 offset:54784
  buffer_load_dwordx4 v1, s[68:71], s6 offen offset:1024 lds
  v_exp_f32 v119, v119
  v_cvt_pk_bf16_f32 v112, v112, v113
  v_cvt_pk_bf16_f32 v113, v114, v115
  v_cvt_pk_bf16_f32 v114, v116, v117
  v_cvt_pk_bf16_f32 v115, v118, v119
  v_pk_max_u16 v112, v112, s45
  v_pk_max_u16 v113, v113, s45
  v_pk_max_u16 v114, v114, s45
  v_pk_max_u16 v115, v115, s45
  v_mfma_f32_4x4x4_16b_bf16 a[224:227], a[232:233], v[112:113], a[224:227]
  s_nop 0
  v_mfma_f32_4x4x4_16b_bf16 a[228:231], a[232:233], v[114:115], a[228:231]
  v_mfma_f32_32x32x16_bf16 a[32:47], a[0:3], v[112:115], a[32:47]
  ds_read_b64_tr_b16 a[28:29], v4 offset:50944
  ds_read_b64_tr_b16 a[30:31], v4 offset:55040
  v_fma_f32 v120, v120, v5, v7
  v_fma_f32 v121, v121, v5, v7
  v_fma_f32 v122, v122, v5, v7
  v_fma_f32 v123, v123, v5, v7
  v_mfma_f32_32x32x16_bf16 a[48:63], a[4:7], v[112:115], a[48:63]
  ds_read_b64_tr_b16 a[0:1], v4 offset:57344
  ds_read_b64_tr_b16 a[2:3], v4 offset:61440
  v_fma_f32 v124, v124, v5, v7
  v_fma_f32 v125, v125, v5, v7
L_padl6:
  s_cbranch_execz L_padl10
  v_fma_f32 v126, v126, v5, v7
  v_fma_f32 v127, v127, v5, v7
  v_mfma_f32_32x32x16_bf16 a[64:79], a[8:11], v[112:115], a[64:79]
  ds_read_b64_tr_b16 a[4:5], v4 offset:57600
  ds_read_b64_tr_b16 a[6:7], v4 offset:61696
  v_exp_f32 v120, v120
  v_exp_f32 v121, v121
  s_waitcnt lgkmcnt(6)
  v_mfma_f32_32x32x16_bf16 a[80:95], a[12:15], v[112:115], a[80:95]
  ds_read_b64_tr_b16 a[8:9], v4 offset:57856
  ds_read_b64_tr_b16 a[10:11], v4 offset:61952
  buffer_load_dwordx4 v1, s[64:67], s6 offen offset:2048 lds
  v_mfma_f32_32x32x16_bf16 a[96:111], a[16:19], v[112:115], a[96:111]
  ds_read_b64_tr_b16 a[12:13], v4 offset:58112
  ds_read_b64_tr_b16 a[14:15], v4 offset:62208
  v_exp_f32 v122, v122
  v_exp_f32 v123, v123
  v_mfma_f32_32x32x16_bf16 a[112:127], a[20:23], v[112:115], a[112:127]
  ds_read_b64_tr_b16 a[16:17], v4 offset:58368
  ds_read_b64_tr_b16 a[18:19], v4 offset:62464
  v_exp_f32 v124, v124
  v_exp_f32 v125, v125
  v_mfma_f32_32x32x16_bf16 a[128:143], a[24:27], v[112:115], a[128:143]
  ds_read_b64_tr_b16 a[20:21], v4 offset:58624
  ds_read_b64_tr_b16 a[22:23], v4 offset:62720
  v_exp_f32 v126, v126
  v_exp_f32 v127, v127
  s_waitcnt lgkmcnt(6)
  v_mfma_f32_32x32x16_bf16 a[144:159], a[28:31], v[112:115], a[144:159]
  ds_read_b64_tr_b16 a[24:25], v4 offset:58880
  ds_read_b64_tr_b16 a[26:27], v4 offset:62976
  buffer_load_dwordx4 v1, s[68:71], s6 offen offset:3072 lds
  v_cvt_pk_bf16_f32 v116, v120, v121
  v_cvt_pk_bf16_f32 v117, v122, v123
  v_cvt_pk_bf16_f32 v118, v124, v125
  v_cvt_pk_bf16_f32 v119, v126, v127
  v_pk_max_u16 v116, v116, s45
  v_pk_max_u16 v117, v117, s45
  v_pk_max_u16 v118, v118, s45
  v_pk_max_u16 v119, v119, s45
  v_mfma_f32_4x4x4_16b_bf16 a[224:227], a[232:233], v[116:117], a[224:227]
  s_nop 0
  v_mfma_f32_4x4x4_16b_bf16 a[228:231], a[232:233], v[118:119], a[228:231]
  v_mfma_f32_32x32x16_bf16 a[32:47], a[0:3], v[116:119], a[32:47]
  ds_read_b64_tr_b16 a[28:29], v4 offset:59136
  ds_read_b64_tr_b16 a[30:31], v4 offset:63232
  v_accvgpr_read_b32 v48, a192
  v_accvgpr_read_b32 v49, a193
  v_accvgpr_read_b32 v50, a194
  v_add_u32 v4, 0x00010000, v4
  v_mfma_f32_32x32x16_bf16 a[48:63], a[4:7], v[116:119], a[48:63]
  ds_read_b64_tr_b16 a[0:1], v4 offset:0
  ds_read_b64_tr_b16 a[2:3], v4 offset:4096
  v_accvgpr_read_b32 v51, a195
  v_accvgpr_read_b32 v52, a196
  v_accvgpr_read_b32 v53, a197
  v_accvgpr_read_b32 v54, a198
  v_mfma_f32_32x32x16_bf16 a[64:79], a[8:11], v[116:119], a[64:79]
  ds_read_b64_tr_b16 a[4:5], v4 offset:256
  ds_read_b64_tr_b16 a[6:7], v4 offset:4352
  v_accvgpr_read_b32 v55, a199
  v_fma_f32 v48, v48, v5, v7
  v_fma_f32 v49, v49, v5, v7
  v_fma_f32 v50, v50, v5, v7
  s_waitcnt lgkmcnt(6)
  v_mfma_f32_32x32x16_bf16 a[80:95], a[12:15], v[116:119], a[80:95]
  s_add_u32 m0, s31, 81920
  s_add_u32 s6, s2, 229376
  s_and_b32 s6, s6, 0x3ffff
  ds_read_b64_tr_b16 a[8:9], v4 offset:512
  ds_read_b64_tr_b16 a[10:11], v4 offset:4608
  buffer_load_dwordx4 v1, s[64:67], s6 offen offset:0 lds
  v_mfma_f32_32x32x16_bf16 a[96:111], a[16:19], v[116:119], a[96:111]
  ds_read_b64_tr_b16 a[12:13], v4 offset:768
  ds_read_b64_tr_b16 a[14:15], v4 offset:4864
  v_fma_f32 v51, v51, v5, v7
  v_fma_f32 v52, v52, v5, v7
  v_fma_f32 v53, v53, v5, v7
  v_fma_f32 v54, v54, v5, v7
  v_mfma_f32_32x32x16_bf16 a[112:127], a[20:23], v[116:119], a[112:127]
  ds_read_b64_tr_b16 a[16:17], v4 offset:1024
  ds_read_b64_tr_b16 a[18:19], v4 offset:5120
  v_fma_f32 v55, v55, v5, v7
  v_exp_f32 v48, v48
  v_mfma_f32_32x32x16_bf16 a[128:143], a[24:27], v[116:119], a[128:143]
  ds_read_b64_tr_b16 a[20:21], v4 offset:1280
  ds_read_b64_tr_b16 a[22:23], v4 offset:5376
  v_exp_f32 v49, v49
  v_exp_f32 v50, v50
  s_waitcnt lgkmcnt(6)
  v_mfma_f32_32x32x16_bf16 a[144:159], a[28:31], v[116:119], a[144:159]
  ds_read_b64_tr_b16 a[24:25], v4 offset:1536
  ds_read_b64_tr_b16 a[26:27], v4 offset:5632
  buffer_load_dwordx4 v1, s[68:71], s6 offen offset:1024 lds
  v_exp_f32 v51, v51
  v_exp_f32 v52, v52
  v_exp_f32 v53, v53
  v_exp_f32 v54, v54
  v_exp_f32 v55, v55
  v_cvt_pk_bf16_f32 v48, v48, v49
  v_cvt_pk_bf16_f32 v49, v50, v51
  v_cvt_pk_bf16_f32 v50, v52, v53
  v_cvt_pk_bf16_f32 v51, v54, v55
  v_pk_max_u16 v48, v48, s45
  v_pk_max_u16 v49, v49, s45
  v_pk_max_u16 v50, v50, s45
  v_pk_max_u16 v51, v51, s45
  v_mfma_f32_4x4x4_16b_bf16 a[224:227], a[232:233], v[48:49], a[224:227]
  s_nop 0
  v_mfma_f32_4x4x4_16b_bf16 a[228:231], a[232:233], v[50:51], a[228:231]
  v_mfma_f32_32x32x16_bf16 a[32:47], a[0:3], v[48:51], a[32:47]
  ds_read_b64_tr_b16 a[28:29], v4 offset:1792
  ds_read_b64_tr_b16 a[30:31], v4 offset:5888
  v_accvgpr_read_b32 v56, a200
  v_accvgpr_read_b32 v57, a201
  v_accvgpr_read_b32 v58, a202
  v_accvgpr_read_b32 v59, a203
  v_mfma_f32_32x32x16_bf16 a[48:63], a[4:7], v[48:51], a[48:63]
  ds_read_b64_tr_b16 a[0:1], v4 offset:8192
  ds_read_b64_tr_b16 a[2:3], v4 offset:12288
  v_accvgpr_read_b32 v60, a204
  v_accvgpr_read_b32 v61, a205
  v_accvgpr_read_b32 v62, a206
  v_accvgpr_read_b32 v63, a207
  v_mfma_f32_32x32x16_bf16 a[64:79], a[8:11], v[48:51], a[64:79]
  ds_read_b64_tr_b16 a[4:5], v4 offset:8448
  ds_read_b64_tr_b16 a[6:7], v4 offset:12544
  v_fma_f32 v56, v56, v5, v7
  v_fma_f32 v57, v57, v5, v7
  v_fma_f32 v58, v58, v5, v7
  v_fma_f32 v59, v59, v5, v7
  s_waitcnt lgkmcnt(6)
  v_mfma_f32_32x32x16_bf16 a[80:95], a[12:15], v[48:51], a[80:95]
  ds_read_b64_tr_b16 a[8:9], v4 offset:8704
  ds_read_b64_tr_b16 a[10:11], v4 offset:12800
  buffer_load_dwordx4 v1, s[64:67], s6 offen offset:2048 lds
  v_fma_f32 v60, v60, v5, v7
  v_mfma_f32_32x32x16_bf16 a[96:111], a[16:19], v[48:51], a[96:111]
  ds_read_b64_tr_b16 a[12:13], v4 offset:8960
  ds_read_b64_tr_b16 a[14:15], v4 offset:13056
  v_fma_f32 v61, v61, v5, v7
  v_fma_f32 v62, v62, v5, v7
  v_fma_f32 v63, v63, v5, v7
  v_mfma_f32_32x32x16_bf16 a[112:127], a[20:23], v[48:51], a[112:127]
  ds_read_b64_tr_b16 a[16:17], v4 offset:9216
  ds_read_b64_tr_b16 a[18:19], v4 offset:13312
  v_exp_f32 v56, v56
  v_exp_f32 v57, v57
  v_mfma_f32_32x32x16_bf16 a[128:143], a[24:27], v[48:51], a[128:143]
  ds_read_b64_tr_b16 a[20:21], v4 offset:9472
  ds_read_b64_tr_b16 a[22:23], v4 offset:13568
  v_exp_f32 v58, v58
  v_exp_f32 v59, v59
  s_waitcnt lgkmcnt(6)
  v_mfma_f32_32x32x16_bf16 a[144:159], a[28:31], v[48:51], a[144:159]
  ds_read_b64_tr_b16 a[24:25], v4 offset:9728
  ds_read_b64_tr_b16 a[26:27], v4 offset:13824
  buffer_load_dwordx4 v1, s[68:71], s6 offen offset:3072 lds
  v_exp_f32 v60, v60
  v_exp_f32 v61, v61
  v_exp_f32 v62, v62
  v_exp_f32 v63, v63
  v_cvt_pk_bf16_f32 v52, v56, v57
  v_cvt_pk_bf16_f32 v53, v58, v59
  v_cvt_pk_bf16_f32 v54, v60, v61
  v_cvt_pk_bf16_f32 v55, v62, v63
  v_pk_max_u16 v52, v52, s45
  v_pk_max_u16 v53, v53, s45
  v_pk_max_u16 v54, v54, s45
  v_pk_max_u16 v55, v55, s45
  v_mfma_f32_4x4x4_16b_bf16 a[224:227], a[232:233], v[52:53], a[224:227]
  s_nop 0
  v_mfma_f32_4x4x4_16b_bf16 a[228:231], a[232:233], v[54:55], a[228:231]
  v_mfma_f32_32x32x16_bf16 a[32:47], a[0:3], v[52:55], a[32:47]
  ds_read_b64_tr_b16 a[28:29], v4 offset:9984
  ds_read_b64_tr_b16 a[30:31], v4 offset:14080
  v_accvgpr_read_b32 v64, a208
  v_accvgpr_read_b32 v65, a209
  v_accvgpr_read_b32 v66, a210
  v_accvgpr_read_b32 v67, a211
  v_mfma_f32_32x32x16_bf16 a[48:63], a[4:7], v[52:55], a[48:63]
  s_waitcnt vmcnt(20)
  s_barrier
  ds_read_b64_tr_b16 a[0:1], v4 offset:16384
  ds_read_b64_tr_b16 a[2:3], v4 offset:20480
  v_accvgpr_read_b32 v68, a212
  v_accvgpr_read_b32 v69, a213
  v_mfma_f32_32x32x16_bf16 a[64:79], a[8:11], v[52:55], a[64:79]
  ds_read_b64_tr_b16 a[4:5], v4 offset:16640
  ds_read_b64_tr_b16 a[6:7], v4 offset:20736
  v_accvgpr_read_b32 v70, a214
  v_accvgpr_read_b32 v71, a215
  v_fma_f32 v64, v64, v5, v7
  v_fma_f32 v65, v65, v5, v7
  s_waitcnt lgkmcnt(6)
  v_mfma_f32_32x32x16_bf16 a[80:95], a[12:15], v[52:55], a[80:95]
  s_add_u32 m0, s31, 98304
  s_add_u32 s6, s2, 245760
  s_and_b32 s6, s6, 0x3ffff
  ds_read_b64_tr_b16 a[8:9], v4 offset:16896
  ds_read_b64_tr_b16 a[10:11], v4 offset:20992
  buffer_load_dwordx4 v1, s[64:67], s6 offen offset:0 lds
  v_mfma_f32_32x32x16_bf16 a[96:111], a[16:19], v[52:55], a[96:111]
  ds_read_b64_tr_b16 a[12:13], v4 offset:17152
  ds_read_b64_tr_b16 a[14:15], v4 offset:21248
  v_fma_f32 v66, v66, v5, v7
  v_fma_f32 v67, v67, v5, v7
  v_fma_f32 v68, v68, v5, v7
  v_fma_f32 v69, v69, v5, v7
  v_mfma_f32_32x32x16_bf16 a[112:127], a[20:23], v[52:55], a[112:127]
  ds_read_b64_tr_b16 a[16:17], v4 offset:17408
  ds_read_b64_tr_b16 a[18:19], v4 offset:21504
  v_fma_f32 v70, v70, v5, v7
  v_fma_f32 v71, v71, v5, v7
  v_exp_f32 v64, v64
  v_mfma_f32_32x32x16_bf16 a[128:143], a[24:27], v[52:55], a[128:143]
  ds_read_b64_tr_b16 a[20:21], v4 offset:17664
  ds_read_b64_tr_b16 a[22:23], v4 offset:21760
  v_exp_f32 v65, v65
  v_exp_f32 v66, v66
  s_waitcnt lgkmcnt(6)
  v_mfma_f32_32x32x16_bf16 a[144:159], a[28:31], v[52:55], a[144:159]
  ds_read_b64_tr_b16 a[24:25], v4 offset:17920
  ds_read_b64_tr_b16 a[26:27], v4 offset:22016
  buffer_load_dwordx4 v1, s[68:71], s6 offen offset:1024 lds
  v_exp_f32 v67, v67
  v_exp_f32 v68, v68
  v_exp_f32 v69, v69
  v_exp_f32 v70, v70
  v_exp_f32 v71, v71
  v_cvt_pk_bf16_f32 v64, v64, v65
  v_cvt_pk_bf16_f32 v65, v66, v67
  v_cvt_pk_bf16_f32 v66, v68, v69
  v_cvt_pk_bf16_f32 v67, v70, v71
  v_pk_max_u16 v64, v64, s45
  v_pk_max_u16 v65, v65, s45
  v_pk_max_u16 v66, v66, s45
  v_pk_max_u16 v67, v67, s45
  v_mfma_f32_4x4x4_16b_bf16 a[224:227], a[232:233], v[64:65], a[224:227]
  s_nop 0
  v_mfma_f32_4x4x4_16b_bf16 a[228:231], a[232:233], v[66:67], a[228:231]
  v_mfma_f32_32x32x16_bf16 a[32:47], a[0:3], v[64:67], a[32:47]
  ds_read_b64_tr_b16 a[28:29], v4 offset:18176
  ds_read_b64_tr_b16 a[30:31], v4 offset:22272
  v_accvgpr_read_b32 v72, a216
  v_accvgpr_read_b32 v73, a217
  v_accvgpr_read_b32 v74, a218
  v_accvgpr_read_b32 v75, a219
  v_mfma_f32_32x32x16_bf16 a[48:63], a[4:7], v[64:67], a[48:63]
  ds_read_b64_tr_b16 a[0:1], v4 offset:24576
  ds_read_b64_tr_b16 a[2:3], v4 offset:28672
  v_accvgpr_read_b32 v76, a220
  v_accvgpr_read_b32 v77, a221
  v_accvgpr_read_b32 v78, a222
  v_accvgpr_read_b32 v79, a223
  v_mfma_f32_32x32x16_bf16 a[64:79], a[8:11], v[64:67], a[64:79]
  ds_read_b64_tr_b16 a[4:5], v4 offset:24832
  ds_read_b64_tr_b16 a[6:7], v4 offset:28928
  v_fma_f32 v72, v72, v5, v7
  v_fma_f32 v73, v73, v5, v7
  v_fma_f32 v74, v74, v5, v7
  v_fma_f32 v75, v75, v5, v7
  s_waitcnt lgkmcnt(6)
  v_mfma_f32_32x32x16_bf16 a[80:95], a[12:15], v[64:67], a[80:95]
  ds_read_b64_tr_b16 a[8:9], v4 offset:25088
  ds_read_b64_tr_b16 a[10:11], v4 offset:29184
  buffer_load_dwordx4 v1, s[64:67], s6 offen offset:2048 lds
  v_fma_f32 v76, v76, v5, v7
  v_mfma_f32_32x32x16_bf16 a[96:111], a[16:19], v[64:67], a[96:111]
  ds_read_b64_tr_b16 a[12:13], v4 offset:25344
  ds_read_b64_tr_b16 a[14:15], v4 offset:29440
  v_fma_f32 v77, v77, v5, v7
  v_fma_f32 v78, v78, v5, v7
  v_fma_f32 v79, v79, v5, v7
  v_mfma_f32_32x32x16_bf16 a[112:127], a[20:23], v[64:67], a[112:127]
  ds_read_b64_tr_b16 a[16:17], v4 offset:25600
  ds_read_b64_tr_b16 a[18:19], v4 offset:29696
  v_exp_f32 v72, v72
  v_exp_f32 v73, v73
  v_mfma_f32_32x32x16_bf16 a[128:143], a[24:27], v[64:67], a[128:143]
  ds_read_b64_tr_b16 a[20:21], v4 offset:25856
  ds_read_b64_tr_b16 a[22:23], v4 offset:29952
  v_exp_f32 v74, v74
  v_exp_f32 v75, v75
  s_waitcnt lgkmcnt(6)
  v_mfma_f32_32x32x16_bf16 a[144:159], a[28:31], v[64:67], a[144:159]
  ds_read_b64_tr_b16 a[24:25], v4 offset:26112
  ds_read_b64_tr_b16 a[26:27], v4 offset:30208
  buffer_load_dwordx4 v1, s[68:71], s6 offen offset:3072 lds
  v_exp_f32 v76, v76
  v_exp_f32 v77, v77
  v_exp_f32 v78, v78
  v_exp_f32 v79, v79
  v_cvt_pk_bf16_f32 v68, v72, v73
  v_cvt_pk_bf16_f32 v69, v74, v75
  v_cvt_pk_bf16_f32 v70, v76, v77
  v_cvt_pk_bf16_f32 v71, v78, v79
  v_pk_max_u16 v68, v68, s45
  v_pk_max_u16 v69, v69, s45
  v_pk_max_u16 v70, v70, s45
  v_pk_max_u16 v71, v71, s45
  v_mfma_f32_4x4x4_16b_bf16 a[224:227], a[232:233], v[68:69], a[224:227]
  s_nop 0
  v_mfma_f32_4x4x4_16b_bf16 a[228:231], a[232:233], v[70:71], a[228:231]
  v_mfma_f32_32x32x16_bf16 a[32:47], a[0:3], v[68:71], a[32:47]
  ds_read_b64_tr_b16 a[28:29], v4 offset:26368
  ds_read_b64_tr_b16 a[30:31], v4 offset:30464
  v_fma_f32 v128, v128, v5, v7
  v_fma_f32 v129, v129, v5, v7
  v_fma_f32 v130, v130, v5, v7
  v_add_u32 v4, 0xfffe0000, v4
  v_mfma_f32_32x32x16_bf16 a[48:63], a[4:7], v[68:71], a[48:63]
  ds_read_b64_tr_b16 a[0:1], v4 offset:0
  ds_read_b64_tr_b16 a[2:3], v4 offset:4096
  v_fma_f32 v131, v131, v5, v7
  v_fma_f32 v132, v132, v5, v7
  v_fma_f32 v133, v133, v5, v7
  v_fma_f32 v134, v134, v5, v7
  v_mfma_f32_32x32x16_bf16 a[64:79], a[8:11], v[68:71], a[64:79]
  ds_read_b64_tr_b16 a[4:5], v4 offset:256
  ds_read_b64_tr_b16 a[6:7], v4 offset:4352
  v_fma_f32 v135, v135, v5, v7
  v_exp_f32 v128, v128
  s_waitcnt lgkmcnt(6)
  v_mfma_f32_32x32x16_bf16 a[80:95], a[12:15], v[68:71], a[80:95]
  s_add_u32 m0, s31, 114688
  ds_read_b64_tr_b16 a[8:9], v4 offset:512
  ds_read_b64_tr_b16 a[10:11], v4 offset:4608
  buffer_load_dwordx4 v2, s[48:51], s14 offen offset:0 lds
  v_mfma_f32_32x32x16_bf16 a[96:111], a[16:19], v[68:71], a[96:111]
  ds_read_b64_tr_b16 a[12:13], v4 offset:768
  ds_read_b64_tr_b16 a[14:15], v4 offset:4864
  v_exp_f32 v129, v129
  v_exp_f32 v130, v130
  v_mfma_f32_32x32x16_bf16 a[112:127], a[20:23], v[68:71], a[112:127]
  ds_read_b64_tr_b16 a[16:17], v4 offset:1024
  ds_read_b64_tr_b16 a[18:19], v4 offset:5120
  v_exp_f32 v131, v131
  v_exp_f32 v132, v132
  v_mfma_f32_32x32x16_bf16 a[128:143], a[24:27], v[68:71], a[128:143]
  ds_read_b64_tr_b16 a[20:21], v4 offset:1280
  ds_read_b64_tr_b16 a[22:23], v4 offset:5376
  v_exp_f32 v133, v133
  v_exp_f32 v134, v134
  s_waitcnt lgkmcnt(6)
  v_mfma_f32_32x32x16_bf16 a[144:159], a[28:31], v[68:71], a[144:159]
  ds_read_b64_tr_b16 a[24:25], v4 offset:1536
  ds_read_b64_tr_b16 a[26:27], v4 offset:5632
  buffer_load_dwordx4 v2, s[52:55], s14 offen offset:1024 lds
  v_exp_f32 v135, v135
  v_cvt_pk_bf16_f32 v128, v128, v129
  v_cvt_pk_bf16_f32 v129, v130, v131
  v_cvt_pk_bf16_f32 v130, v132, v133
  v_cvt_pk_bf16_f32 v131, v134, v135
  v_pk_max_u16 v128, v128, s45
  v_pk_max_u16 v129, v129, s45
  v_pk_max_u16 v130, v130, s45
  v_pk_max_u16 v131, v131, s45
  v_mfma_f32_4x4x4_16b_bf16 a[224:227], a[232:233], v[128:129], a[224:227]
  s_nop 0
  v_mfma_f32_4x4x4_16b_bf16 a[228:231], a[232:233], v[130:131], a[228:231]
  v_mfma_f32_32x32x16_bf16 a[32:47], a[0:3], v[128:131], a[32:47]
  ds_read_b64_tr_b16 a[28:29], v4 offset:1792
  ds_read_b64_tr_b16 a[30:31], v4 offset:5888
  v_fma_f32 v136, v136, v5, v7
  v_fma_f32 v137, v137, v5, v7
  v_fma_f32 v138, v138, v5, v7
  v_fma_f32 v139, v139, v5, v7
  v_mfma_f32_32x32x16_bf16 a[48:63], a[4:7], v[128:131], a[48:63]
  ds_read_b64_tr_b16 a[0:1], v4 offset:8192
  ds_read_b64_tr_b16 a[2:3], v4 offset:12288
  v_fma_f32 v140, v140, v5, v7
  v_fma_f32 v141, v141, v5, v7
  v_fma_f32 v142, v142, v5, v7
  v_fma_f32 v143, v143, v5, v7
  v_mfma_f32_32x32x16_bf16 a[64:79], a[8:11], v[128:131], a[64:79]
  ds_read_b64_tr_b16 a[4:5], v4 offset:8448
  ds_read_b64_tr_b16 a[6:7], v4 offset:12544
  v_exp_f32 v136, v136
  v_exp_f32 v137, v137
  s_waitcnt lgkmcnt(6)
  v_mfma_f32_32x32x16_bf16 a[80:95], a[12:15], v[128:131], a[80:95]
  ds_read_b64_tr_b16 a[8:9], v4 offset:8704
  ds_read_b64_tr_b16 a[10:11], v4 offset:12800
  buffer_load_dwordx4 v2, s[56:59], s14 offen offset:2048 lds
  v_mfma_f32_32x32x16_bf16 a[96:111], a[16:19], v[128:131], a[96:111]
  ds_read_b64_tr_b16 a[12:13], v4 offset:8960
  ds_read_b64_tr_b16 a[14:15], v4 offset:13056
  v_exp_f32 v138, v138
  v_exp_f32 v139, v139
  v_mfma_f32_32x32x16_bf16 a[112:127], a[20:23], v[128:131], a[112:127]
  ds_read_b64_tr_b16 a[16:17], v4 offset:9216
  ds_read_b64_tr_b16 a[18:19], v4 offset:13312
  v_exp_f32 v140, v140
  v_exp_f32 v141, v141
  v_mfma_f32_32x32x16_bf16 a[128:143], a[24:27], v[128:131], a[128:143]
  ds_read_b64_tr_b16 a[20:21], v4 offset:9472
  ds_read_b64_tr_b16 a[22:23], v4 offset:13568
  v_exp_f32 v142, v142
  v_exp_f32 v143, v143
  s_waitcnt lgkmcnt(6)
  v_mfma_f32_32x32x16_bf16 a[144:159], a[28:31], v[128:131], a[144:159]
  ds_read_b64_tr_b16 a[24:25], v4 offset:9728
  ds_read_b64_tr_b16 a[26:27], v4 offset:13824
  buffer_load_dwordx4 v2, s[60:63], s14 offen offset:3072 lds
  v_cvt_pk_bf16_f32 v132, v136, v137
  v_cvt_pk_bf16_f32 v133, v138, v139
  v_cvt_pk_bf16_f32 v134, v140, v141
  v_cvt_pk_bf16_f32 v135, v142, v143
  v_pk_max_u16 v132, v132, s45
  v_pk_max_u16 v133, v133, s45
  v_pk_max_u16 v134, v134, s45
  v_pk_max_u16 v135, v135, s45
  v_mfma_f32_4x4x4_16b_bf16 a[224:227], a[232:233], v[132:133], a[224:227]
  s_nop 0
  v_mfma_f32_4x4x4_16b_bf16 a[228:231], a[232:233], v[134:135], a[228:231]
  v_mfma_f32_32x32x16_bf16 a[32:47], a[0:3], v[132:135], a[32:47]
  ds_read_b64_tr_b16 a[28:29], v4 offset:9984
  ds_read_b64_tr_b16 a[30:31], v4 offset:14080
  v_fma_f32 v144, v144, v5, v7
  v_fma_f32 v145, v145, v5, v7
  v_fma_f32 v146, v146, v5, v7
  v_fma_f32 v147, v147, v5, v7
  v_mfma_f32_32x32x16_bf16 a[48:63], a[4:7], v[132:135], a[48:63]
  s_waitcnt vmcnt(20)
  s_barrier
  ds_read_b64_tr_b16 a[0:1], v4 offset:16384
  ds_read_b64_tr_b16 a[2:3], v4 offset:20480
  v_fma_f32 v148, v148, v5, v7
  v_fma_f32 v149, v149, v5, v7
  v_mfma_f32_32x32x16_bf16 a[64:79], a[8:11], v[132:135], a[64:79]
  ds_read_b64_tr_b16 a[4:5], v4 offset:16640
  ds_read_b64_tr_b16 a[6:7], v4 offset:20736
  v_fma_f32 v150, v150, v5, v7
  v_fma_f32 v151, v151, v5, v7
  v_exp_f32 v144, v144
  s_waitcnt lgkmcnt(6)
  v_mfma_f32_32x32x16_bf16 a[80:95], a[12:15], v[132:135], a[80:95]
  s_add_u32 m0, s31, 131072
  ds_read_b64_tr_b16 a[8:9], v4 offset:16896
  ds_read_b64_tr_b16 a[10:11], v4 offset:20992
  buffer_load_dwordx4 v2, s[48:51], s15 offen offset:0 lds
  v_mfma_f32_32x32x16_bf16 a[96:111], a[16:19], v[132:135], a[96:111]
  ds_read_b64_tr_b16 a[12:13], v4 offset:17152
  ds_read_b64_tr_b16 a[14:15], v4 offset:21248
  v_exp_f32 v145, v145
  v_exp_f32 v146, v146
  v_mfma_f32_32x32x16_bf16 a[112:127], a[20:23], v[132:135], a[112:127]
  ds_read_b64_tr_b16 a[16:17], v4 offset:17408
  ds_read_b64_tr_b16 a[18:19], v4 offset:21504
  v_exp_f32 v147, v147
  v_exp_f32 v148, v148
  v_mfma_f32_32x32x16_bf16 a[128:143], a[24:27], v[132:135], a[128:143]
  ds_read_b64_tr_b16 a[20:21], v4 offset:17664
  ds_read_b64_tr_b16 a[22:23], v4 offset:21760
  v_exp_f32 v149, v149
  v_exp_f32 v150, v150
  s_waitcnt lgkmcnt(6)
  v_mfma_f32_32x32x16_bf16 a[144:159], a[28:31], v[132:135], a[144:159]
  ds_read_b64_tr_b16 a[24:25], v4 offset:17920
  ds_read_b64_tr_b16 a[26:27], v4 offset:22016
  buffer_load_dwordx4 v2, s[52:55], s15 offen offset:1024 lds
  v_exp_f32 v151, v151
  v_cvt_pk_bf16_f32 v144, v144, v145
  v_cvt_pk_bf16_f32 v145, v146, v147
  v_cvt_pk_bf16_f32 v146, v148, v149
  v_cvt_pk_bf16_f32 v147, v150, v151
  v_pk_max_u16 v144, v144, s45
  v_pk_max_u16 v145, v145, s45
  v_pk_max_u16 v146, v146, s45
  v_pk_max_u16 v147, v147, s45
  v_mfma_f32_4x4x4_16b_bf16 a[224:227], a[232:233], v[144:145], a[224:227]
  s_nop 0
  v_mfma_f32_4x4x4_16b_bf16 a[228:231], a[232:233], v[146:147], a[228:231]
  v_mfma_f32_32x32x16_bf16 a[32:47], a[0:3], v[144:147], a[32:47]
  ds_read_b64_tr_b16 a[28:29], v4 offset:18176
  ds_read_b64_tr_b16 a[30:31], v4 offset:22272
  v_fma_f32 v152, v152, v5, v7
  v_fma_f32 v153, v153, v5, v7
  v_fma_f32 v154, v154, v5, v7
  v_fma_f32 v155, v155, v5, v7
  v_mfma_f32_32x32x16_bf16 a[48:63], a[4:7], v[144:147], a[48:63]
  ds_read_b64_tr_b16 a[0:1], v4 offset:24576
  ds_read_b64_tr_b16 a[2:3], v4 offset:28672
  v_fma_f32 v156, v156, v5, v7
  v_fma_f32 v157, v157, v5, v7
  v_fma_f32 v158, v158, v5, v7
  v_fma_f32 v159, v159, v5, v7
  v_mfma_f32_32x32x16_bf16 a[64:79], a[8:11], v[144:147], a[64:79]
  ds_read_b64_tr_b16 a[4:5], v4 offset:24832
  ds_read_b64_tr_b16 a[6:7], v4 offset:28928
  v_exp_f32 v152, v152
  v_exp_f32 v153, v153
  s_waitcnt lgkmcnt(6)
  v_mfma_f32_32x32x16_bf16 a[80:95], a[12:15], v[144:147], a[80:95]
  ds_read_b64_tr_b16 a[8:9], v4 offset:25088
  ds_read_b64_tr_b16 a[10:11], v4 offset:29184
  buffer_load_dwordx4 v2, s[56:59], s15 offen offset:2048 lds
  v_mfma_f32_32x32x16_bf16 a[96:111], a[16:19], v[144:147], a[96:111]
  ds_read_b64_tr_b16 a[12:13], v4 offset:25344
  ds_read_b64_tr_b16 a[14:15], v4 offset:29440
  v_exp_f32 v154, v154
  v_exp_f32 v155, v155
  v_mfma_f32_32x32x16_bf16 a[112:127], a[20:23], v[144:147], a[112:127]
  ds_read_b64_tr_b16 a[16:17], v4 offset:25600
  ds_read_b64_tr_b16 a[18:19], v4 offset:29696
  v_exp_f32 v156, v156
  v_exp_f32 v157, v157
  v_mfma_f32_32x32x16_bf16 a[128:143], a[24:27], v[144:147], a[128:143]
  ds_read_b64_tr_b16 a[20:21], v4 offset:25856
  ds_read_b64_tr_b16 a[22:23], v4 offset:29952
  v_exp_f32 v158, v158
  v_exp_f32 v159, v159
  s_waitcnt lgkmcnt(6)
  v_mfma_f32_32x32x16_bf16 a[144:159], a[28:31], v[144:147], a[144:159]
  ds_read_b64_tr_b16 a[24:25], v4 offset:26112
  ds_read_b64_tr_b16 a[26:27], v4 offset:30208
  buffer_load_dwordx4 v2, s[60:63], s15 offen offset:3072 lds
  v_cvt_pk_bf16_f32 v148, v152, v153
  v_cvt_pk_bf16_f32 v149, v154, v155
  v_cvt_pk_bf16_f32 v150, v156, v157
  v_cvt_pk_bf16_f32 v151, v158, v159
  v_pk_max_u16 v148, v148, s45
  v_pk_max_u16 v149, v149, s45
  v_pk_max_u16 v150, v150, s45
  v_pk_max_u16 v151, v151, s45
  v_mfma_f32_4x4x4_16b_bf16 a[224:227], a[232:233], v[148:149], a[224:227]
  s_nop 0
  v_mfma_f32_4x4x4_16b_bf16 a[228:231], a[232:233], v[150:151], a[228:231]
  v_mfma_f32_32x32x16_bf16 a[32:47], a[0:3], v[148:151], a[32:47]
  ds_read_b64_tr_b16 a[28:29], v4 offset:26368
  ds_read_b64_tr_b16 a[30:31], v4 offset:30464
  v_fma_f32 v160, v160, v5, v7
  v_fma_f32 v161, v161, v5, v7
  v_fma_f32 v162, v162, v5, v7
  v_fma_f32 v163, v163, v5, v7
  v_mfma_f32_32x32x16_bf16 a[48:63], a[4:7], v[148:151], a[48:63]
  ds_read_b64_tr_b16 a[0:1], v4 offset:32768
  ds_read_b64_tr_b16 a[2:3], v4 offset:36864
  v_fma_f32 v164, v164, v5, v7
  v_fma_f32 v165, v165, v5, v7
  v_fma_f32 v166, v166, v5, v7
  v_fma_f32 v167, v167, v5, v7
  v_mfma_f32_32x32x16_bf16 a[64:79], a[8:11], v[148:151], a[64:79]
  ds_read_b64_tr_b16 a[4:5], v4 offset:33024
  ds_read_b64_tr_b16 a[6:7], v4 offset:37120
  v_exp_f32 v160, v160
  v_exp_f32 v161, v161
  s_waitcnt lgkmcnt(6)
  v_mfma_f32_32x32x16_bf16 a[80:95], a[12:15], v[148:151], a[80:95]
  s_add_u32 m0, s31, 147456
  s_add_u32 s6, s14, 114688
  ds_read_b64_tr_b16 a[8:9], v4 offset:33280
  ds_read_b64_tr_b16 a[10:11], v4 offset:37376
  buffer_load_dwordx4 v2, s[48:51], s6 offen offset:0 lds
  v_mfma_f32_32x32x16_bf16 a[96:111], a[16:19], v[148:151], a[96:111]
  ds_read_b64_tr_b16 a[12:13], v4 offset:33536
  ds_read_b64_tr_b16 a[14:15], v4 offset:37632
  v_exp_f32 v162, v162
  v_exp_f32 v163, v163
  v_mfma_f32_32x32x16_bf16 a[112:127], a[20:23], v[148:151], a[112:127]
  ds_read_b64_tr_b16 a[16:17], v4 offset:33792
  ds_read_b64_tr_b16 a[18:19], v4 offset:37888
  v_exp_f32 v164, v164
  v_exp_f32 v165, v165
  v_mfma_f32_32x32x16_bf16 a[128:143], a[24:27], v[148:151], a[128:143]
L_padl7:
  s_cbranch_execz L_walk_done
  ds_read_b64_tr_b16 a[20:21], v4 offset:34048
  ds_read_b64_tr_b16 a[22:23], v4 offset:38144
  v_exp_f32 v166, v166
  v_exp_f32 v167, v167
  s_waitcnt lgkmcnt(6)
  v_mfma_f32_32x32x16_bf16 a[144:159], a[28:31], v[148:151], a[144:159]
  ds_read_b64_tr_b16 a[24:25], v4 offset:34304
  ds_read_b64_tr_b16 a[26:27], v4 offset:38400
  buffer_load_dwordx4 v2, s[52:55], s6 offen offset:1024 lds
  v_cvt_pk_bf16_f32 v160, v160, v161
  v_cvt_pk_bf16_f32 v161, v162, v163
  v_cvt_pk_bf16_f32 v162, v164, v165
  v_cvt_pk_bf16_f32 v163, v166, v167
  v_pk_max_u16 v160, v160, s45
  v_pk_max_u16 v161, v161, s45
  v_pk_max_u16 v162, v162, s45
  v_pk_max_u16 v163, v163, s45
  v_mfma_f32_4x4x4_16b_bf16 a[224:227], a[232:233], v[160:161], a[224:227]
  s_nop 0
  v_mfma_f32_4x4x4_16b_bf16 a[228:231], a[232:233], v[162:163], a[228:231]
  v_mfma_f32_32x32x16_bf16 a[32:47], a[0:3], v[160:163], a[32:47]
  ds_read_b64_tr_b16 a[28:29], v4 offset:34560
  ds_read_b64_tr_b16 a[30:31], v4 offset:38656
  v_fma_f32 v168, v168, v5, v7
  v_fma_f32 v169, v169, v5, v7
  v_fma_f32 v170, v170, v5, v7
  v_fma_f32 v171, v171, v5, v7
  v_mfma_f32_32x32x16_bf16 a[48:63], a[4:7], v[160:163], a[48:63]
  ds_read_b64_tr_b16 a[0:1], v4 offset:40960
  ds_read_b64_tr_b16 a[2:3], v4 offset:45056
  v_fma_f32 v172, v172, v5, v7
  v_fma_f32 v173, v173, v5, v7
  v_fma_f32 v174, v174, v5, v7
  v_fma_f32 v175, v175, v5, v7
  v_mfma_f32_32x32x16_bf16 a[64:79], a[8:11], v[160:163], a[64:79]
  ds_read_b64_tr_b16 a[4:5], v4 offset:41216
  ds_read_b64_tr_b16 a[6:7], v4 offset:45312
  v_exp_f32 v168, v168
  v_exp_f32 v169, v169
  s_waitcnt lgkmcnt(6)
  v_mfma_f32_32x32x16_bf16 a[80:95], a[12:15], v[160:163], a[80:95]
  ds_read_b64_tr_b16 a[8:9], v4 offset:41472
  ds_read_b64_tr_b16 a[10:11], v4 offset:45568
  buffer_load_dwordx4 v2, s[56:59], s6 offen offset:2048 lds
  v_mfma_f32_32x32x16_bf16 a[96:111], a[16:19], v[160:163], a[96:111]
  ds_read_b64_tr_b16 a[12:13], v4 offset:41728
  ds_read_b64_tr_b16 a[14:15], v4 offset:45824
  v_exp_f32 v170, v170
  v_exp_f32 v171, v171
  v_mfma_f32_32x32x16_bf16 a[112:127], a[20:23], v[160:163], a[112:127]
  ds_read_b64_tr_b16 a[16:17], v4 offset:41984
  ds_read_b64_tr_b16 a[18:19], v4 offset:46080
  v_exp_f32 v172, v172
  v_exp_f32 v173, v173
  v_mfma_f32_32x32x16_bf16 a[128:143], a[24:27], v[160:163], a[128:143]
  ds_read_b64_tr_b16 a[20:21], v4 offset:42240
  ds_read_b64_tr_b16 a[22:23], v4 offset:46336
  v_exp_f32 v174, v174
  v_exp_f32 v175, v175
  s_waitcnt lgkmcnt(6)
  v_mfma_f32_32x32x16_bf16 a[144:159], a[28:31], v[160:163], a[144:159]
  ds_read_b64_tr_b16 a[24:25], v4 offset:42496
  ds_read_b64_tr_b16 a[26:27], v4 offset:46592
  buffer_load_dwordx4 v2, s[60:63], s6 offen offset:3072 lds
  v_cvt_pk_bf16_f32 v164, v168, v169
  v_cvt_pk_bf16_f32 v165, v170, v171
  v_cvt_pk_bf16_f32 v166, v172, v173
  v_cvt_pk_bf16_f32 v167, v174, v175
  v_pk_max_u16 v164, v164, s45
  v_pk_max_u16 v165, v165, s45
  v_pk_max_u16 v166, v166, s45
  v_pk_max_u16 v167, v167, s45
  v_mfma_f32_4x4x4_16b_bf16 a[224:227], a[232:233], v[164:165], a[224:227]
  s_nop 0
  v_mfma_f32_4x4x4_16b_bf16 a[228:231], a[232:233], v[166:167], a[228:231]
  v_mfma_f32_32x32x16_bf16 a[32:47], a[0:3], v[164:167], a[32:47]
  ds_read_b64_tr_b16 a[28:29], v4 offset:42752
  ds_read_b64_tr_b16 a[30:31], v4 offset:46848
  v_fma_f32 v176, v176, v5, v7
  v_fma_f32 v177, v177, v5, v7
  v_fma_f32 v178, v178, v5, v7
  v_fma_f32 v179, v179, v5, v7
  v_mfma_f32_32x32x16_bf16 a[48:63], a[4:7], v[164:167], a[48:63]
  s_waitcnt vmcnt(20)
  s_barrier
  ds_read_b64_tr_b16 a[0:1], v4 offset:49152
  ds_read_b64_tr_b16 a[2:3], v4 offset:53248
  v_fma_f32 v180, v180, v5, v7
  v_fma_f32 v181, v181, v5, v7
  v_mfma_f32_32x32x16_bf16 a[64:79], a[8:11], v[164:167], a[64:79]
  ds_read_b64_tr_b16 a[4:5], v4 offset:49408
  ds_read_b64_tr_b16 a[6:7], v4 offset:53504
  v_fma_f32 v182, v182, v5, v7
  v_fma_f32 v183, v183, v5, v7
  v_exp_f32 v176, v176
  s_waitcnt lgkmcnt(6)
  v_mfma_f32_32x32x16_bf16 a[80:95], a[12:15], v[164:167], a[80:95]
  s_add_u32 m0, s31, 0
  s_add_u32 s6, s15, 114688
  ds_read_b64_tr_b16 a[8:9], v4 offset:49664
  ds_read_b64_tr_b16 a[10:11], v4 offset:53760
  buffer_load_dwordx4 v2, s[48:51], s6 offen offset:0 lds
  v_mfma_f32_32x32x16_bf16 a[96:111], a[16:19], v[164:167], a[96:111]
  ds_read_b64_tr_b16 a[12:13], v4 offset:49920
  ds_read_b64_tr_b16 a[14:15], v4 offset:54016
  v_exp_f32 v177, v177
  v_exp_f32 v178, v178
  v_mfma_f32_32x32x16_bf16 a[112:127], a[20:23], v[164:167], a[112:127]
  ds_read_b64_tr_b16 a[16:17], v4 offset:50176
  ds_read_b64_tr_b16 a[18:19], v4 offset:54272
  v_exp_f32 v179, v179
  v_exp_f32 v180, v180
  v_mfma_f32_32x32x16_bf16 a[128:143], a[24:27], v[164:167], a[128:143]
  ds_read_b64_tr_b16 a[20:21], v4 offset:50432
  ds_read_b64_tr_b16 a[22:23], v4 offset:54528
  v_exp_f32 v181, v181
  v_exp_f32 v182, v182
  s_waitcnt lgkmcnt(6)
  v_mfma_f32_32x32x16_bf16 a[144:159], a[28:31], v[164:167], a[144:159]
  ds_read_b64_tr_b16 a[24:25], v4 offset:50688
  ds_read_b64_tr_b16 a[26:27], v4 offset:54784
  buffer_load_dwordx4 v2, s[52:55], s6 offen offset:1024 lds
  v_exp_f32 v183, v183
  v_cvt_pk_bf16_f32 v176, v176, v177
  v_cvt_pk_bf16_f32 v177, v178, v179
  v_cvt_pk_bf16_f32 v178, v180, v181
  v_cvt_pk_bf16_f32 v179, v182, v183
  v_pk_max_u16 v176, v176, s45
  v_pk_max_u16 v177, v177, s45
  v_pk_max_u16 v178, v178, s45
  v_pk_max_u16 v179, v179, s45
  v_mfma_f32_4x4x4_16b_bf16 a[224:227], a[232:233], v[176:177], a[224:227]
  s_nop 0
  v_mfma_f32_4x4x4_16b_bf16 a[228:231], a[232:233], v[178:179], a[228:231]
  v_mfma_f32_32x32x16_bf16 a[32:47], a[0:3], v[176:179], a[32:47]
  ds_read_b64_tr_b16 a[28:29], v4 offset:50944
  ds_read_b64_tr_b16 a[30:31], v4 offset:55040
  v_fma_f32 v184, v184, v5, v7
  v_fma_f32 v185, v185, v5, v7
  v_fma_f32 v186, v186, v5, v7
  v_fma_f32 v187, v187, v5, v7
  v_mfma_f32_32x32x16_bf16 a[48:63], a[4:7], v[176:179], a[48:63]
  ds_read_b64_tr_b16 a[0:1], v4 offset:57344
  ds_read_b64_tr_b16 a[2:3], v4 offset:61440
  v_fma_f32 v188, v188, v5, v7
  v_fma_f32 v189, v189, v5, v7
  v_fma_f32 v190, v190, v5, v7
  v_fma_f32 v191, v191, v5, v7
  v_mfma_f32_32x32x16_bf16 a[64:79], a[8:11], v[176:179], a[64:79]
  ds_read_b64_tr_b16 a[4:5], v4 offset:57600
  ds_read_b64_tr_b16 a[6:7], v4 offset:61696
  v_exp_f32 v184, v184
  v_exp_f32 v185, v185
  s_waitcnt lgkmcnt(6)
  v_mfma_f32_32x32x16_bf16 a[80:95], a[12:15], v[176:179], a[80:95]
  ds_read_b64_tr_b16 a[8:9], v4 offset:57856
  ds_read_b64_tr_b16 a[10:11], v4 offset:61952
  buffer_load_dwordx4 v2, s[56:59], s6 offen offset:2048 lds
  v_mfma_f32_32x32x16_bf16 a[96:111], a[16:19], v[176:179], a[96:111]
  ds_read_b64_tr_b16 a[12:13], v4 offset:58112
  ds_read_b64_tr_b16 a[14:15], v4 offset:62208
  v_exp_f32 v186, v186
  v_exp_f32 v187, v187
  v_mfma_f32_32x32x16_bf16 a[112:127], a[20:23], v[176:179], a[112:127]
  ds_read_b64_tr_b16 a[16:17], v4 offset:58368
  ds_read_b64_tr_b16 a[18:19], v4 offset:62464
  v_exp_f32 v188, v188
  v_exp_f32 v189, v189
  v_mfma_f32_32x32x16_bf16 a[128:143], a[24:27], v[176:179], a[128:143]
  ds_read_b64_tr_b16 a[20:21], v4 offset:58624
  ds_read_b64_tr_b16 a[22:23], v4 offset:62720
  v_exp_f32 v190, v190
  v_exp_f32 v191, v191
  s_waitcnt lgkmcnt(6)
  v_mfma_f32_32x32x16_bf16 a[144:159], a[28:31], v[176:179], a[144:159]
  ds_read_b64_tr_b16 a[24:25], v4 offset:58880
  ds_read_b64_tr_b16 a[26:27], v4 offset:62976
  buffer_load_dwordx4 v2, s[60:63], s6 offen offset:3072 lds
  v_cvt_pk_bf16_f32 v180, v184, v185
  v_cvt_pk_bf16_f32 v181, v186, v187
  v_cvt_pk_bf16_f32 v182, v188, v189
  v_cvt_pk_bf16_f32 v183, v190, v191
  v_pk_max_u16 v180, v180, s45
  v_pk_max_u16 v181, v181, s45
  v_pk_max_u16 v182, v182, s45
  v_pk_max_u16 v183, v183, s45
  v_mfma_f32_4x4x4_16b_bf16 a[224:227], a[232:233], v[180:181], a[224:227]
  s_nop 0
  v_mfma_f32_4x4x4_16b_bf16 a[228:231], a[232:233], v[182:183], a[228:231]
  v_mfma_f32_32x32x16_bf16 a[32:47], a[0:3], v[180:183], a[32:47]
  ds_read_b64_tr_b16 a[28:29], v4 offset:59136
  ds_read_b64_tr_b16 a[30:31], v4 offset:63232
  v_fma_f32 v192, v192, v5, v7
  v_fma_f32 v193, v193, v5, v7
  v_fma_f32 v194, v194, v5, v7
  v_add_u32 v4, 0x00010000, v4
  v_mfma_f32_32x32x16_bf16 a[48:63], a[4:7], v[180:183], a[48:63]
  ds_read_b64_tr_b16 a[0:1], v4 offset:0
  ds_read_b64_tr_b16 a[2:3], v4 offset:4096
  v_fma_f32 v195, v195, v5, v7
  v_fma_f32 v196, v196, v5, v7
  v_fma_f32 v197, v197, v5, v7
  v_fma_f32 v198, v198, v5, v7
  v_mfma_f32_32x32x16_bf16 a[64:79], a[8:11], v[180:183], a[64:79]
  ds_read_b64_tr_b16 a[4:5], v4 offset:256
  ds_read_b64_tr_b16 a[6:7], v4 offset:4352
  v_fma_f32 v199, v199, v5, v7
  v_exp_f32 v192, v192
  s_waitcnt lgkmcnt(6)
  v_mfma_f32_32x32x16_bf16 a[80:95], a[12:15], v[180:183], a[80:95]
  s_add_u32 m0, s31, 16384
  ds_read_b64_tr_b16 a[8:9], v4 offset:512
  ds_read_b64_tr_b16 a[10:11], v4 offset:4608
  buffer_load_dwordx4 v2, s[48:51], s16 offen offset:0 lds
  v_mfma_f32_32x32x16_bf16 a[96:111], a[16:19], v[180:183], a[96:111]
  ds_read_b64_tr_b16 a[12:13], v4 offset:768
  ds_read_b64_tr_b16 a[14:15], v4 offset:4864
  v_exp_f32 v193, v193
  v_exp_f32 v194, v194
  v_mfma_f32_32x32x16_bf16 a[112:127], a[20:23], v[180:183], a[112:127]
  ds_read_b64_tr_b16 a[16:17], v4 offset:1024
  ds_read_b64_tr_b16 a[18:19], v4 offset:5120
  v_exp_f32 v195, v195
  v_exp_f32 v196, v196
  v_mfma_f32_32x32x16_bf16 a[128:143], a[24:27], v[180:183], a[128:143]
  ds_read_b64_tr_b16 a[20:21], v4 offset:1280
  ds_read_b64_tr_b16 a[22:23], v4 offset:5376
  v_exp_f32 v197, v197
  v_exp_f32 v198, v198
  s_waitcnt lgkmcnt(6)
  v_mfma_f32_32x32x16_bf16 a[144:159], a[28:31], v[180:183], a[144:159]
  ds_read_b64_tr_b16 a[24:25], v4 offset:1536
  ds_read_b64_tr_b16 a[26:27], v4 offset:5632
  buffer_load_dwordx4 v2, s[52:55], s16 offen offset:1024 lds
  v_exp_f32 v199, v199
  v_cvt_pk_bf16_f32 v192, v192, v193
  v_cvt_pk_bf16_f32 v193, v194, v195
  v_cvt_pk_bf16_f32 v194, v196, v197
  v_cvt_pk_bf16_f32 v195, v198, v199
  v_pk_max_u16 v192, v192, s45
  v_pk_max_u16 v193, v193, s45
  v_pk_max_u16 v194, v194, s45
  v_pk_max_u16 v195, v195, s45
  v_mfma_f32_4x4x4_16b_bf16 a[224:227], a[232:233], v[192:193], a[224:227]
  s_nop 0
  v_mfma_f32_4x4x4_16b_bf16 a[228:231], a[232:233], v[194:195], a[228:231]
  v_mfma_f32_32x32x16_bf16 a[32:47], a[0:3], v[192:195], a[32:47]
  ds_read_b64_tr_b16 a[28:29], v4 offset:1792
  ds_read_b64_tr_b16 a[30:31], v4 offset:5888
  v_fma_f32 v200, v200, v5, v7
  v_fma_f32 v201, v201, v5, v7
  v_fma_f32 v202, v202, v5, v7
  v_fma_f32 v203, v203, v5, v7
  v_mfma_f32_32x32x16_bf16 a[48:63], a[4:7], v[192:195], a[48:63]
  ds_read_b64_tr_b16 a[0:1], v4 offset:8192
  ds_read_b64_tr_b16 a[2:3], v4 offset:12288
  v_fma_f32 v204, v204, v5, v7
  v_fma_f32 v205, v205, v5, v7
  v_fma_f32 v206, v206, v5, v7
  v_fma_f32 v207, v207, v5, v7
  v_mfma_f32_32x32x16_bf16 a[64:79], a[8:11], v[192:195], a[64:79]
  ds_read_b64_tr_b16 a[4:5], v4 offset:8448
  ds_read_b64_tr_b16 a[6:7], v4 offset:12544
  v_exp_f32 v200, v200
  v_exp_f32 v201, v201
  s_waitcnt lgkmcnt(6)
  v_mfma_f32_32x32x16_bf16 a[80:95], a[12:15], v[192:195], a[80:95]
  ds_read_b64_tr_b16 a[8:9], v4 offset:8704
  ds_read_b64_tr_b16 a[10:11], v4 offset:12800
  buffer_load_dwordx4 v2, s[56:59], s16 offen offset:2048 lds
  v_mfma_f32_32x32x16_bf16 a[96:111], a[16:19], v[192:195], a[96:111]
  ds_read_b64_tr_b16 a[12:13], v4 offset:8960
  ds_read_b64_tr_b16 a[14:15], v4 offset:13056
  v_exp_f32 v202, v202
  v_exp_f32 v203, v203
  v_mfma_f32_32x32x16_bf16 a[112:127], a[20:23], v[192:195], a[112:127]
  ds_read_b64_tr_b16 a[16:17], v4 offset:9216
  ds_read_b64_tr_b16 a[18:19], v4 offset:13312
  v_exp_f32 v204, v204
  v_exp_f32 v205, v205
  v_mfma_f32_32x32x16_bf16 a[128:143], a[24:27], v[192:195], a[128:143]
  ds_read_b64_tr_b16 a[20:21], v4 offset:9472
  ds_read_b64_tr_b16 a[22:23], v4 offset:13568
  v_exp_f32 v206, v206
  v_exp_f32 v207, v207
  s_waitcnt lgkmcnt(6)
  v_mfma_f32_32x32x16_bf16 a[144:159], a[28:31], v[192:195], a[144:159]
  ds_read_b64_tr_b16 a[24:25], v4 offset:9728
  ds_read_b64_tr_b16 a[26:27], v4 offset:13824
  buffer_load_dwordx4 v2, s[60:63], s16 offen offset:3072 lds
  v_cvt_pk_bf16_f32 v196, v200, v201
  v_cvt_pk_bf16_f32 v197, v202, v203
  v_cvt_pk_bf16_f32 v198, v204, v205
  v_cvt_pk_bf16_f32 v199, v206, v207
  v_pk_max_u16 v196, v196, s45
  v_pk_max_u16 v197, v197, s45
  v_pk_max_u16 v198, v198, s45
  v_pk_max_u16 v199, v199, s45
  v_mfma_f32_4x4x4_16b_bf16 a[224:227], a[232:233], v[196:197], a[224:227]
  s_nop 0
  v_mfma_f32_4x4x4_16b_bf16 a[228:231], a[232:233], v[198:199], a[228:231]
  v_mfma_f32_32x32x16_bf16 a[32:47], a[0:3], v[196:199], a[32:47]
  ds_read_b64_tr_b16 a[28:29], v4 offset:9984
  ds_read_b64_tr_b16 a[30:31], v4 offset:14080
  v_fma_f32 v208, v208, v5, v7
  v_fma_f32 v209, v209, v5, v7
  v_fma_f32 v210, v210, v5, v7
  v_fma_f32 v211, v211, v5, v7
  v_mfma_f32_32x32x16_bf16 a[48:63], a[4:7], v[196:199], a[48:63]
  s_waitcnt vmcnt(20)
  s_barrier
  ds_read_b64_tr_b16 a[0:1], v4 offset:16384
  ds_read_b64_tr_b16 a[2:3], v4 offset:20480
  v_fma_f32 v212, v212, v5, v7
  v_fma_f32 v213, v213, v5, v7
  v_mfma_f32_32x32x16_bf16 a[64:79], a[8:11], v[196:199], a[64:79]
  ds_read_b64_tr_b16 a[4:5], v4 offset:16640
  ds_read_b64_tr_b16 a[6:7], v4 offset:20736
  v_fma_f32 v214, v214, v5, v7
  v_fma_f32 v215, v215, v5, v7
  v_exp_f32 v208, v208
  s_waitcnt lgkmcnt(6)
  v_mfma_f32_32x32x16_bf16 a[80:95], a[12:15], v[196:199], a[80:95]
  s_add_u32 m0, s31, 32768
  s_add_u32 s6, s16, 114688
  ds_read_b64_tr_b16 a[8:9], v4 offset:16896
  ds_read_b64_tr_b16 a[10:11], v4 offset:20992
  buffer_load_dwordx4 v2, s[48:51], s6 offen offset:0 lds
  v_mfma_f32_32x32x16_bf16 a[96:111], a[16:19], v[196:199], a[96:111]
  ds_read_b64_tr_b16 a[12:13], v4 offset:17152
  ds_read_b64_tr_b16 a[14:15], v4 offset:21248
  v_exp_f32 v209, v209
  v_exp_f32 v210, v210
  v_mfma_f32_32x32x16_bf16 a[112:127], a[20:23], v[196:199], a[112:127]
  ds_read_b64_tr_b16 a[16:17], v4 offset:17408
  ds_read_b64_tr_b16 a[18:19], v4 offset:21504
  v_exp_f32 v211, v211
  v_exp_f32 v212, v212
  v_mfma_f32_32x32x16_bf16 a[128:143], a[24:27], v[196:199], a[128:143]
  ds_read_b64_tr_b16 a[20:21], v4 offset:17664
  ds_read_b64_tr_b16 a[22:23], v4 offset:21760
  v_exp_f32 v213, v213
  v_exp_f32 v214, v214
  s_waitcnt lgkmcnt(6)
  v_mfma_f32_32x32x16_bf16 a[144:159], a[28:31], v[196:199], a[144:159]
  ds_read_b64_tr_b16 a[24:25], v4 offset:17920
  ds_read_b64_tr_b16 a[26:27], v4 offset:22016
  buffer_load_dwordx4 v2, s[52:55], s6 offen offset:1024 lds
  v_exp_f32 v215, v215
  v_cvt_pk_bf16_f32 v208, v208, v209
  v_cvt_pk_bf16_f32 v209, v210, v211
  v_cvt_pk_bf16_f32 v210, v212, v213
  v_cvt_pk_bf16_f32 v211, v214, v215
  v_pk_max_u16 v208, v208, s45
  v_pk_max_u16 v209, v209, s45
  v_pk_max_u16 v210, v210, s45
  v_pk_max_u16 v211, v211, s45
  v_mfma_f32_4x4x4_16b_bf16 a[224:227], a[232:233], v[208:209], a[224:227]
  s_nop 0
  v_mfma_f32_4x4x4_16b_bf16 a[228:231], a[232:233], v[210:211], a[228:231]
  v_mfma_f32_32x32x16_bf16 a[32:47], a[0:3], v[208:211], a[32:47]
  ds_read_b64_tr_b16 a[28:29], v4 offset:18176
  ds_read_b64_tr_b16 a[30:31], v4 offset:22272
  v_fma_f32 v216, v216, v5, v7
  v_fma_f32 v217, v217, v5, v7
  v_fma_f32 v218, v218, v5, v7
  v_fma_f32 v219, v219, v5, v7
  v_mfma_f32_32x32x16_bf16 a[48:63], a[4:7], v[208:211], a[48:63]
  ds_read_b64_tr_b16 a[0:1], v4 offset:24576
  ds_read_b64_tr_b16 a[2:3], v4 offset:28672
  v_fma_f32 v220, v220, v5, v7
  v_fma_f32 v221, v221, v5, v7
  v_fma_f32 v222, v222, v5, v7
  v_fma_f32 v223, v223, v5, v7
  v_mfma_f32_32x32x16_bf16 a[64:79], a[8:11], v[208:211], a[64:79]
  ds_read_b64_tr_b16 a[4:5], v4 offset:24832
  ds_read_b64_tr_b16 a[6:7], v4 offset:28928
  v_exp_f32 v216, v216
  v_exp_f32 v217, v217
  s_waitcnt lgkmcnt(6)
  v_mfma_f32_32x32x16_bf16 a[80:95], a[12:15], v[208:211], a[80:95]
  ds_read_b64_tr_b16 a[8:9], v4 offset:25088
  ds_read_b64_tr_b16 a[10:11], v4 offset:29184
  buffer_load_dwordx4 v2, s[56:59], s6 offen offset:2048 lds
  v_mfma_f32_32x32x16_bf16 a[96:111], a[16:19], v[208:211], a[96:111]
  ds_read_b64_tr_b16 a[12:13], v4 offset:25344
  ds_read_b64_tr_b16 a[14:15], v4 offset:29440
  v_exp_f32 v218, v218
  v_exp_f32 v219, v219
  v_mfma_f32_32x32x16_bf16 a[112:127], a[20:23], v[208:211], a[112:127]
  ds_read_b64_tr_b16 a[16:17], v4 offset:25600
  ds_read_b64_tr_b16 a[18:19], v4 offset:29696
  v_exp_f32 v220, v220
  v_exp_f32 v221, v221
  v_mfma_f32_32x32x16_bf16 a[128:143], a[24:27], v[208:211], a[128:143]
  ds_read_b64_tr_b16 a[20:21], v4 offset:25856
  ds_read_b64_tr_b16 a[22:23], v4 offset:29952
  v_exp_f32 v222, v222
  v_exp_f32 v223, v223
  s_waitcnt lgkmcnt(6)
  v_mfma_f32_32x32x16_bf16 a[144:159], a[28:31], v[208:211], a[144:159]
  ds_read_b64_tr_b16 a[24:25], v4 offset:26112
  ds_read_b64_tr_b16 a[26:27], v4 offset:30208
  buffer_load_dwordx4 v2, s[60:63], s6 offen offset:3072 lds
  v_cvt_pk_bf16_f32 v212, v216, v217
  v_cvt_pk_bf16_f32 v213, v218, v219
  v_cvt_pk_bf16_f32 v214, v220, v221
  v_cvt_pk_bf16_f32 v215, v222, v223
  v_pk_max_u16 v212, v212, s45
  v_pk_max_u16 v213, v213, s45
  v_pk_max_u16 v214, v214, s45
  v_pk_max_u16 v215, v215, s45
  v_mfma_f32_4x4x4_16b_bf16 a[224:227], a[232:233], v[212:213], a[224:227]
  s_nop 0
  v_mfma_f32_4x4x4_16b_bf16 a[228:231], a[232:233], v[214:215], a[228:231]
  v_mfma_f32_32x32x16_bf16 a[32:47], a[0:3], v[212:215], a[32:47]
  ds_read_b64_tr_b16 a[28:29], v4 offset:26368
  ds_read_b64_tr_b16 a[30:31], v4 offset:30464
  v_fma_f32 v224, v224, v5, v7
  v_fma_f32 v225, v225, v5, v7
  v_fma_f32 v226, v226, v5, v7
  v_fma_f32 v227, v227, v5, v7
  v_mfma_f32_32x32x16_bf16 a[48:63], a[4:7], v[212:215], a[48:63]
  ds_read_b64_tr_b16 a[0:1], v4 offset:32768
  ds_read_b64_tr_b16 a[2:3], v4 offset:36864
  v_fma_f32 v228, v228, v5, v7
  v_fma_f32 v229, v229, v5, v7
  v_fma_f32 v230, v230, v5, v7
  v_fma_f32 v231, v231, v5, v7
  v_mfma_f32_32x32x16_bf16 a[64:79], a[8:11], v[212:215], a[64:79]
  ds_read_b64_tr_b16 a[4:5], v4 offset:33024
  ds_read_b64_tr_b16 a[6:7], v4 offset:37120
  v_exp_f32 v224, v224
  v_exp_f32 v225, v225
  s_waitcnt lgkmcnt(6)
  v_mfma_f32_32x32x16_bf16 a[80:95], a[12:15], v[212:215], a[80:95]
  s_add_u32 m0, s31, 49152
  ds_read_b64_tr_b16 a[8:9], v4 offset:33280
  ds_read_b64_tr_b16 a[10:11], v4 offset:37376
  buffer_load_dwordx4 v2, s[48:51], s17 offen offset:0 lds
  v_mfma_f32_32x32x16_bf16 a[96:111], a[16:19], v[212:215], a[96:111]
  ds_read_b64_tr_b16 a[12:13], v4 offset:33536
  ds_read_b64_tr_b16 a[14:15], v4 offset:37632
  v_exp_f32 v226, v226
  v_exp_f32 v227, v227
  v_mfma_f32_32x32x16_bf16 a[112:127], a[20:23], v[212:215], a[112:127]
  ds_read_b64_tr_b16 a[16:17], v4 offset:33792
  ds_read_b64_tr_b16 a[18:19], v4 offset:37888
  v_exp_f32 v228, v228
  v_exp_f32 v229, v229
  v_mfma_f32_32x32x16_bf16 a[128:143], a[24:27], v[212:215], a[128:143]
  ds_read_b64_tr_b16 a[20:21], v4 offset:34048
  ds_read_b64_tr_b16 a[22:23], v4 offset:38144
  v_exp_f32 v230, v230
  v_exp_f32 v231, v231
  s_waitcnt lgkmcnt(6)
  v_mfma_f32_32x32x16_bf16 a[144:159], a[28:31], v[212:215], a[144:159]
  ds_read_b64_tr_b16 a[24:25], v4 offset:34304
  ds_read_b64_tr_b16 a[26:27], v4 offset:38400
  buffer_load_dwordx4 v2, s[52:55], s17 offen offset:1024 lds
  v_cvt_pk_bf16_f32 v224, v224, v225
  v_cvt_pk_bf16_f32 v225, v226, v227
  v_cvt_pk_bf16_f32 v226, v228, v229
  v_cvt_pk_bf16_f32 v227, v230, v231
  v_pk_max_u16 v224, v224, s45
  v_pk_max_u16 v225, v225, s45
  v_pk_max_u16 v226, v226, s45
  v_pk_max_u16 v227, v227, s45
  v_mfma_f32_4x4x4_16b_bf16 a[224:227], a[232:233], v[224:225], a[224:227]
  s_nop 0
  v_mfma_f32_4x4x4_16b_bf16 a[228:231], a[232:233], v[226:227], a[228:231]
  v_mfma_f32_32x32x16_bf16 a[32:47], a[0:3], v[224:227], a[32:47]
  ds_read_b64_tr_b16 a[28:29], v4 offset:34560
  ds_read_b64_tr_b16 a[30:31], v4 offset:38656
  v_fma_f32 v232, v232, v5, v7
  v_fma_f32 v233, v233, v5, v7
  v_fma_f32 v234, v234, v5, v7
  v_fma_f32 v235, v235, v5, v7
  v_mfma_f32_32x32x16_bf16 a[48:63], a[4:7], v[224:227], a[48:63]
  ds_read_b64_tr_b16 a[0:1], v4 offset:40960
  ds_read_b64_tr_b16 a[2:3], v4 offset:45056
  v_fma_f32 v236, v236, v5, v7
  v_fma_f32 v237, v237, v5, v7
  v_fma_f32 v238, v238, v5, v7
  v_fma_f32 v239, v239, v5, v7
  v_mfma_f32_32x32x16_bf16 a[64:79], a[8:11], v[224:227], a[64:79]
  ds_read_b64_tr_b16 a[4:5], v4 offset:41216
  ds_read_b64_tr_b16 a[6:7], v4 offset:45312
  v_exp_f32 v232, v232
  v_exp_f32 v233, v233
  s_waitcnt lgkmcnt(6)
  v_mfma_f32_32x32x16_bf16 a[80:95], a[12:15], v[224:227], a[80:95]
  ds_read_b64_tr_b16 a[8:9], v4 offset:41472
  ds_read_b64_tr_b16 a[10:11], v4 offset:45568
  buffer_load_dwordx4 v2, s[56:59], s17 offen offset:2048 lds
  v_mfma_f32_32x32x16_bf16 a[96:111], a[16:19], v[224:227], a[96:111]
  ds_read_b64_tr_b16 a[12:13], v4 offset:41728
  ds_read_b64_tr_b16 a[14:15], v4 offset:45824
  v_exp_f32 v234, v234
  v_exp_f32 v235, v235
  v_mfma_f32_32x32x16_bf16 a[112:127], a[20:23], v[224:227], a[112:127]
  ds_read_b64_tr_b16 a[16:17], v4 offset:41984
  ds_read_b64_tr_b16 a[18:19], v4 offset:46080
  v_exp_f32 v236, v236
  v_exp_f32 v237, v237
  v_mfma_f32_32x32x16_bf16 a[128:143], a[24:27], v[224:227], a[128:143]
  ds_read_b64_tr_b16 a[20:21], v4 offset:42240
  ds_read_b64_tr_b16 a[22:23], v4 offset:46336
  v_exp_f32 v238, v238
  v_exp_f32 v239, v239
  s_waitcnt lgkmcnt(6)
  v_mfma_f32_32x32x16_bf16 a[144:159], a[28:31], v[224:227], a[144:159]
  ds_read_b64_tr_b16 a[24:25], v4 offset:42496
  ds_read_b64_tr_b16 a[26:27], v4 offset:46592
  buffer_load_dwordx4 v2, s[60:63], s17 offen offset:3072 lds
  v_cvt_pk_bf16_f32 v228, v232, v233
  v_cvt_pk_bf16_f32 v229, v234, v235
  v_cvt_pk_bf16_f32 v230, v236, v237
  v_cvt_pk_bf16_f32 v231, v238, v239
  v_pk_max_u16 v228, v228, s45
  v_pk_max_u16 v229, v229, s45
  v_pk_max_u16 v230, v230, s45
  v_pk_max_u16 v231, v231, s45
  v_mfma_f32_4x4x4_16b_bf16 a[224:227], a[232:233], v[228:229], a[224:227]
  s_nop 0
  v_mfma_f32_4x4x4_16b_bf16 a[228:231], a[232:233], v[230:231], a[228:231]
  v_mfma_f32_32x32x16_bf16 a[32:47], a[0:3], v[228:231], a[32:47]
  ds_read_b64_tr_b16 a[28:29], v4 offset:42752
  ds_read_b64_tr_b16 a[30:31], v4 offset:46848
  v_accvgpr_read_b32 v10, a224
  s_nop 0
  v_accvgpr_read_b32 v11, a228
  v_add_f32 v10, v10, v11
  v_add_u32 v3, 0x00010000, v3
  v_mfma_f32_32x32x16_bf16 a[48:63], a[4:7], v[228:231], a[48:63]
  s_waitcnt vmcnt(20)
  s_barrier
  ds_read_b64_tr_b16 a[0:1], v3 offset:49152
  ds_read_b64_tr_b16 a[2:3], v3 offset:49664
  v_mov_b32 v11, v10
  s_nop 1
  v_permlane32_swap_b32 v10, v11
  v_mfma_f32_32x32x16_bf16 a[64:79], a[8:11], v[228:231], a[64:79]
  ds_read_b64_tr_b16 a[4:5], v3 offset:49408
  ds_read_b64_tr_b16 a[6:7], v3 offset:49920
  v_add_f32 v10, v10, v11
  v_rcp_f32 v10, v10
  v_add_u32 v3, 0x00010000, v3
  s_waitcnt lgkmcnt(6)
  v_mfma_f32_32x32x16_bf16 a[80:95], a[12:15], v[228:231], a[80:95]
  s_add_u32 m0, s31, 65536
  s_add_u32 s6, s17, 114688
  ds_read_b64_tr_b16 a[8:9], v3 offset:0
  ds_read_b64_tr_b16 a[10:11], v3 offset:512
  buffer_load_dwordx4 v2, s[48:51], s6 offen offset:0 lds
  v_mfma_f32_32x32x16_bf16 a[96:111], a[16:19], v[228:231], a[96:111]
  ds_read_b64_tr_b16 a[12:13], v3 offset:256
  ds_read_b64_tr_b16 a[14:15], v3 offset:768
  v_accvgpr_read_b32 v80, a32
  v_accvgpr_read_b32 v81, a33
  v_accvgpr_read_b32 v82, a34
  v_add_u32 v3, 0xffff0000, v3
  v_mfma_f32_32x32x16_bf16 a[112:127], a[20:23], v[228:231], a[112:127]
  ds_read_b64_tr_b16 a[16:17], v3 offset:51200
  ds_read_b64_tr_b16 a[18:19], v3 offset:51712
  v_accvgpr_read_b32 v83, a35
  v_accvgpr_read_b32 v84, a36
  v_accvgpr_read_b32 v85, a37
  v_accvgpr_read_b32 v86, a38
  v_mfma_f32_32x32x16_bf16 a[128:143], a[24:27], v[228:231], a[128:143]
  ds_read_b64_tr_b16 a[20:21], v3 offset:51456
L_padl8:
  s_cbranch_execz L_walk_done
  ds_read_b64_tr_b16 a[22:23], v3 offset:51968
  v_accvgpr_read_b32 v87, a39
  v_mul_f32 v80, v10, v80
  v_mul_f32 v81, v10, v81
  v_add_u32 v3, 0x00010000, v3
  s_waitcnt lgkmcnt(6)
  v_mfma_f32_32x32x16_bf16 a[144:159], a[28:31], v[228:231], a[144:159]
  ds_read_b64_tr_b16 a[24:25], v3 offset:2048
  ds_read_b64_tr_b16 a[26:27], v3 offset:2560
  buffer_load_dwordx4 v2, s[52:55], s6 offen offset:1024 lds
  v_mul_f32 v82, v10, v82
  v_mul_f32 v83, v10, v83
  v_mul_f32 v84, v10, v84
  v_mul_f32 v85, v10, v85
  v_mul_f32 v86, v10, v86
  v_mul_f32 v87, v10, v87
  v_cvt_pk_bf16_f32 v128, v80, v81
  v_cvt_pk_bf16_f32 v129, v82, v83
  v_cvt_pk_bf16_f32 v130, v84, v85
  v_cvt_pk_bf16_f32 v131, v86, v87
  v_accvgpr_read_b32 v88, a40
  v_accvgpr_read_b32 v89, a41
  v_accvgpr_read_b32 v90, a42
  v_accvgpr_read_b32 v91, a43
  v_accvgpr_read_b32 v92, a44
  v_accvgpr_read_b32 v93, a45
  v_accvgpr_read_b32 v94, a46
  v_accvgpr_read_b32 v95, a47
  v_mul_f32 v88, v10, v88
  v_mul_f32 v89, v10, v89
  v_mul_f32 v90, v10, v90
  v_mul_f32 v91, v10, v91
  v_mul_f32 v92, v10, v92
  v_mul_f32 v93, v10, v93
  v_mul_f32 v94, v10, v94
  v_mul_f32 v95, v10, v95
  v_cvt_pk_bf16_f32 v132, v88, v89
  v_cvt_pk_bf16_f32 v133, v90, v91
  v_cvt_pk_bf16_f32 v134, v92, v93
  v_cvt_pk_bf16_f32 v135, v94, v95
  v_mfma_f32_32x32x16_bf16 v[16:31], a[0:3], v[128:131], 0
  ds_read_b64_tr_b16 a[28:29], v3 offset:2304
  ds_read_b64_tr_b16 a[30:31], v3 offset:2816
  v_accvgpr_read_b32 v80, a48
  v_accvgpr_read_b32 v81, a49
  v_accvgpr_read_b32 v82, a50
  v_add_u32 v3, 0xffff0000, v3
  v_mfma_f32_32x32x16_bf16 v[32:47], a[4:7], v[128:131], 0
  ds_read_b64_tr_b16 a[0:1], v3 offset:53248
  ds_read_b64_tr_b16 a[2:3], v3 offset:53760
  buffer_load_dwordx4 v2, s[56:59], s6 offen offset:2048 lds
  v_accvgpr_read_b32 v83, a51
  v_mfma_f32_32x32x16_bf16 v[48:63], a[8:11], v[128:131], 0
  ds_read_b64_tr_b16 a[4:5], v3 offset:53504
  ds_read_b64_tr_b16 a[6:7], v3 offset:54016
  v_accvgpr_read_b32 v84, a52
  v_accvgpr_read_b32 v85, a53
  v_accvgpr_read_b32 v86, a54
  v_add_u32 v3, 0x00010000, v3
  s_waitcnt lgkmcnt(6)
  v_mfma_f32_32x32x16_bf16 v[64:79], a[12:15], v[128:131], 0
  ds_read_b64_tr_b16 a[8:9], v3 offset:4096
  ds_read_b64_tr_b16 a[10:11], v3 offset:4608
  buffer_load_dwordx4 v2, s[60:63], s6 offen offset:3072 lds
  v_accvgpr_read_b32 v87, a55
  v_mfma_f32_32x32x16_bf16 v[16:31], a[16:19], v[132:135], v[16:31]
  ds_read_b64_tr_b16 a[12:13], v3 offset:4352
  ds_read_b64_tr_b16 a[14:15], v3 offset:4864
  v_mul_f32 v80, v10, v80
  v_mul_f32 v81, v10, v81
  v_mul_f32 v82, v10, v82
  v_add_u32 v3, 0xffff0000, v3
  v_mfma_f32_32x32x16_bf16 v[32:47], a[20:23], v[132:135], v[32:47]
  s_add_u32 m0, s31, 81920
  ds_read_b64_tr_b16 a[16:17], v3 offset:55296
  ds_read_b64_tr_b16 a[18:19], v3 offset:55808
  buffer_load_dwordx4 v2, s[48:51], s18 offen offset:0 lds
  v_mfma_f32_32x32x16_bf16 v[48:63], a[24:27], v[132:135], v[48:63]
  ds_read_b64_tr_b16 a[20:21], v3 offset:55552
  ds_read_b64_tr_b16 a[22:23], v3 offset:56064
  v_mul_f32 v83, v10, v83
  v_mul_f32 v84, v10, v84
  v_mul_f32 v85, v10, v85
  v_add_u32 v3, 0x00010000, v3
  s_waitcnt lgkmcnt(6)
  v_mfma_f32_32x32x16_bf16 v[64:79], a[28:31], v[132:135], v[64:79]
  ds_read_b64_tr_b16 a[24:25], v3 offset:6144
  ds_read_b64_tr_b16 a[26:27], v3 offset:6656
  buffer_load_dwordx4 v2, s[52:55], s18 offen offset:1024 lds
  v_mul_f32 v86, v10, v86
  v_mul_f32 v87, v10, v87
  v_cvt_pk_bf16_f32 v136, v80, v81
  v_cvt_pk_bf16_f32 v137, v82, v83
  v_cvt_pk_bf16_f32 v138, v84, v85
  v_cvt_pk_bf16_f32 v139, v86, v87
  v_accvgpr_read_b32 v88, a56
  v_accvgpr_read_b32 v89, a57
  v_accvgpr_read_b32 v90, a58
  v_accvgpr_read_b32 v91, a59
  v_accvgpr_read_b32 v92, a60
  v_accvgpr_read_b32 v93, a61
  v_accvgpr_read_b32 v94, a62
  v_accvgpr_read_b32 v95, a63
  v_mul_f32 v88, v10, v88
  v_mul_f32 v89, v10, v89
  v_mul_f32 v90, v10, v90
  v_mul_f32 v91, v10, v91
  v_mul_f32 v92, v10, v92
  v_mul_f32 v93, v10, v93
  v_mul_f32 v94, v10, v94
  v_mul_f32 v95, v10, v95
  v_cvt_pk_bf16_f32 v140, v88, v89
  v_cvt_pk_bf16_f32 v141, v90, v91
  v_cvt_pk_bf16_f32 v142, v92, v93
  v_cvt_pk_bf16_f32 v143, v94, v95
  v_mfma_f32_32x32x16_bf16 v[16:31], a[0:3], v[136:139], v[16:31]
  ds_read_b64_tr_b16 a[28:29], v3 offset:6400
  ds_read_b64_tr_b16 a[30:31], v3 offset:6912
  v_accvgpr_read_b32 v80, a64
  v_accvgpr_read_b32 v81, a65
  v_accvgpr_read_b32 v82, a66
  v_add_u32 v3, 0xffff0000, v3
  v_mfma_f32_32x32x16_bf16 v[32:47], a[4:7], v[136:139], v[32:47]
  ds_read_b64_tr_b16 a[0:1], v3 offset:57344
  ds_read_b64_tr_b16 a[2:3], v3 offset:57856
  buffer_load_dwordx4 v2, s[56:59], s18 offen offset:2048 lds
  v_accvgpr_read_b32 v83, a67
  v_mfma_f32_32x32x16_bf16 v[48:63], a[8:11], v[136:139], v[48:63]
  ds_read_b64_tr_b16 a[4:5], v3 offset:57600
  ds_read_b64_tr_b16 a[6:7], v3 offset:58112
  v_accvgpr_read_b32 v84, a68
  v_accvgpr_read_b32 v85, a69
  v_accvgpr_read_b32 v86, a70
  v_add_u32 v3, 0x00010000, v3
  s_waitcnt lgkmcnt(6)
  v_mfma_f32_32x32x16_bf16 v[64:79], a[12:15], v[136:139], v[64:79]
  ds_read_b64_tr_b16 a[8:9], v3 offset:8192
  ds_read_b64_tr_b16 a[10:11], v3 offset:8704
  buffer_load_dwordx4 v2, s[60:63], s18 offen offset:3072 lds
  v_accvgpr_read_b32 v87, a71
  v_mfma_f32_32x32x16_bf16 v[16:31], a[16:19], v[140:143], v[16:31]
  ds_read_b64_tr_b16 a[12:13], v3 offset:8448
  ds_read_b64_tr_b16 a[14:15], v3 offset:8960
  v_mul_f32 v80, v10, v80
  v_mul_f32 v81, v10, v81
  v_mul_f32 v82, v10, v82
  v_add_u32 v3, 0xffff0000, v3
  v_mfma_f32_32x32x16_bf16 v[32:47], a[20:23], v[140:143], v[32:47]
  ds_read_b64_tr_b16 a[16:17], v3 offset:59392
  ds_read_b64_tr_b16 a[18:19], v3 offset:59904
  v_mul_f32 v83, v10, v83
  v_mul_f32 v84, v10, v84
  v_mul_f32 v85, v10, v85
  v_mul_f32 v86, v10, v86
  v_mfma_f32_32x32x16_bf16 v[48:63], a[24:27], v[140:143], v[48:63]
  ds_read_b64_tr_b16 a[20:21], v3 offset:59648
  ds_read_b64_tr_b16 a[22:23], v3 offset:60160
  v_mul_f32 v87, v10, v87
  v_cvt_pk_bf16_f32 v144, v80, v81
  v_cvt_pk_bf16_f32 v145, v82, v83
  v_add_u32 v3, 0x00010000, v3
  s_waitcnt lgkmcnt(6)
  v_mfma_f32_32x32x16_bf16 v[64:79], a[28:31], v[140:143], v[64:79]
  ds_read_b64_tr_b16 a[24:25], v3 offset:10240
  ds_read_b64_tr_b16 a[26:27], v3 offset:10752
  v_cvt_pk_bf16_f32 v146, v84, v85
  v_cvt_pk_bf16_f32 v147, v86, v87
  v_accvgpr_read_b32 v88, a72
  v_accvgpr_read_b32 v89, a73
  v_accvgpr_read_b32 v90, a74
  v_accvgpr_read_b32 v91, a75
  v_accvgpr_read_b32 v92, a76
  v_accvgpr_read_b32 v93, a77
  v_accvgpr_read_b32 v94, a78
  v_accvgpr_read_b32 v95, a79
  v_mul_f32 v88, v10, v88
  v_mul_f32 v89, v10, v89
  v_mul_f32 v90, v10, v90
  v_mul_f32 v91, v10, v91
  v_mul_f32 v92, v10, v92
  v_mul_f32 v93, v10, v93
  v_mul_f32 v94, v10, v94
  v_mul_f32 v95, v10, v95
  v_cvt_pk_bf16_f32 v148, v88, v89
  v_cvt_pk_bf16_f32 v149, v90, v91
  v_cvt_pk_bf16_f32 v150, v92, v93
  v_cvt_pk_bf16_f32 v151, v94, v95
  v_mfma_f32_32x32x16_bf16 v[16:31], a[0:3], v[144:147], v[16:31]
  ds_read_b64_tr_b16 a[28:29], v3 offset:10496
  ds_read_b64_tr_b16 a[30:31], v3 offset:11008
  v_accvgpr_read_b32 v80, a80
  v_accvgpr_read_b32 v81, a81
  v_accvgpr_read_b32 v82, a82
  v_add_u32 v3, 0xffff0000, v3
  v_mfma_f32_32x32x16_bf16 v[32:47], a[4:7], v[144:147], v[32:47]
  ds_read_b64_tr_b16 a[0:1], v3 offset:61440
  ds_read_b64_tr_b16 a[2:3], v3 offset:61952
  v_accvgpr_read_b32 v83, a83
  v_accvgpr_read_b32 v84, a84
  v_accvgpr_read_b32 v85, a85
  v_accvgpr_read_b32 v86, a86
  v_mfma_f32_32x32x16_bf16 v[48:63], a[8:11], v[144:147], v[48:63]
  ds_read_b64_tr_b16 a[4:5], v3 offset:61696
  ds_read_b64_tr_b16 a[6:7], v3 offset:62208
  v_accvgpr_read_b32 v87, a87
  v_mul_f32 v80, v10, v80
  v_mul_f32 v81, v10, v81
  v_add_u32 v3, 0x00010000, v3
  s_waitcnt lgkmcnt(6)
  v_mfma_f32_32x32x16_bf16 v[64:79], a[12:15], v[144:147], v[64:79]
  ds_read_b64_tr_b16 a[8:9], v3 offset:12288
  ds_read_b64_tr_b16 a[10:11], v3 offset:12800
  v_mul_f32 v82, v10, v82
  v_mul_f32 v83, v10, v83
  v_mul_f32 v84, v10, v84
  v_mul_f32 v85, v10, v85
  v_mfma_f32_32x32x16_bf16 v[16:31], a[16:19], v[148:151], v[16:31]
  ds_read_b64_tr_b16 a[12:13], v3 offset:12544
  ds_read_b64_tr_b16 a[14:15], v3 offset:13056
  v_mul_f32 v86, v10, v86
  v_mul_f32 v87, v10, v87
  v_cvt_pk_bf16_f32 v152, v80, v81
  v_add_u32 v3, 0xffff0000, v3
  v_mfma_f32_32x32x16_bf16 v[32:47], a[20:23], v[148:151], v[32:47]
  ds_read_b64_tr_b16 a[16:17], v3 offset:63488
  ds_read_b64_tr_b16 a[18:19], v3 offset:64000
  v_cvt_pk_bf16_f32 v153, v82, v83
  v_cvt_pk_bf16_f32 v154, v84, v85
  v_cvt_pk_bf16_f32 v155, v86, v87
  v_accvgpr_read_b32 v88, a88
  v_mfma_f32_32x32x16_bf16 v[48:63], a[24:27], v[148:151], v[48:63]
  ds_read_b64_tr_b16 a[20:21], v3 offset:63744
  ds_read_b64_tr_b16 a[22:23], v3 offset:64256
  v_accvgpr_read_b32 v89, a89
  v_accvgpr_read_b32 v90, a90
  v_accvgpr_read_b32 v91, a91
  v_add_u32 v3, 0x00010000, v3
  s_waitcnt lgkmcnt(6)
  v_mfma_f32_32x32x16_bf16 v[64:79], a[28:31], v[148:151], v[64:79]
  ds_read_b64_tr_b16 a[24:25], v3 offset:14336
  ds_read_b64_tr_b16 a[26:27], v3 offset:14848
  v_accvgpr_read_b32 v92, a92
  v_accvgpr_read_b32 v93, a93
  v_accvgpr_read_b32 v94, a94
  v_accvgpr_read_b32 v95, a95
  v_mul_f32 v88, v10, v88
  v_mul_f32 v89, v10, v89
  v_mul_f32 v90, v10, v90
  v_mul_f32 v91, v10, v91
  v_mul_f32 v92, v10, v92
  v_mul_f32 v93, v10, v93
  v_mul_f32 v94, v10, v94
  v_mul_f32 v95, v10, v95
  v_cvt_pk_bf16_f32 v156, v88, v89
  v_cvt_pk_bf16_f32 v157, v90, v91
  v_cvt_pk_bf16_f32 v158, v92, v93
  v_cvt_pk_bf16_f32 v159, v94, v95
  v_mfma_f32_32x32x16_bf16 v[16:31], a[0:3], v[152:155], v[16:31]
  ds_read_b64_tr_b16 a[28:29], v3 offset:14592
  ds_read_b64_tr_b16 a[30:31], v3 offset:15104
  v_accvgpr_read_b32 v80, a96
  v_accvgpr_read_b32 v81, a97
  v_accvgpr_read_b32 v82, a98
  v_accvgpr_read_b32 v83, a99
  v_mfma_f32_32x32x16_bf16 v[32:47], a[4:7], v[152:155], v[32:47]
  s_add_u32 m0, s31, 98304
  s_add_u32 s6, s18, 114688
  s_waitcnt vmcnt(20)
  s_barrier
  ds_read_b64_tr_b16 a[0:1], v3 offset:16384
  ds_read_b64_tr_b16 a[2:3], v3 offset:16896
  buffer_load_dwordx4 v2, s[48:51], s6 offen offset:0 lds
  v_mfma_f32_32x32x16_bf16 v[48:63], a[8:11], v[152:155], v[48:63]
  ds_read_b64_tr_b16 a[4:5], v3 offset:16640
  ds_read_b64_tr_b16 a[6:7], v3 offset:17152
  v_accvgpr_read_b32 v84, a100
  v_accvgpr_read_b32 v85, a101
  v_accvgpr_read_b32 v86, a102
  v_add_u32 v3, 0xfffe0000, v3
  s_waitcnt lgkmcnt(6)
  v_mfma_f32_32x32x16_bf16 v[64:79], a[12:15], v[152:155], v[64:79]
  ds_read_b64_tr_b16 a[8:9], v3 offset:0
  ds_read_b64_tr_b16 a[10:11], v3 offset:512
  buffer_load_dwordx4 v2, s[52:55], s6 offen offset:1024 lds
  v_accvgpr_read_b32 v87, a103
  v_mfma_f32_32x32x16_bf16 v[16:31], a[16:19], v[156:159], v[16:31]
  ds_read_b64_tr_b16 a[12:13], v3 offset:256
  ds_read_b64_tr_b16 a[14:15], v3 offset:768
  v_mul_f32 v80, v10, v80
  v_mul_f32 v81, v10, v81
  v_mul_f32 v82, v10, v82
  v_add_u32 v3, 0x00020000, v3
  v_mfma_f32_32x32x16_bf16 v[32:47], a[20:23], v[156:159], v[32:47]
  ds_read_b64_tr_b16 a[16:17], v3 offset:18432
  ds_read_b64_tr_b16 a[18:19], v3 offset:18944
  buffer_load_dwordx4 v2, s[56:59], s6 offen offset:2048 lds
  v_mul_f32 v83, v10, v83
  v_mfma_f32_32x32x16_bf16 v[48:63], a[24:27], v[156:159], v[48:63]
  ds_read_b64_tr_b16 a[20:21], v3 offset:18688
  ds_read_b64_tr_b16 a[22:23], v3 offset:19200
  v_mul_f32 v84, v10, v84
  v_mul_f32 v85, v10, v85
  v_mul_f32 v86, v10, v86
  v_add_u32 v3, 0xfffe0000, v3
  s_waitcnt lgkmcnt(6)
  v_mfma_f32_32x32x16_bf16 v[64:79], a[28:31], v[156:159], v[64:79]
  ds_read_b64_tr_b16 a[24:25], v3 offset:2048
  ds_read_b64_tr_b16 a[26:27], v3 offset:2560
  buffer_load_dwordx4 v2, s[60:63], s6 offen offset:3072 lds
  v_mul_f32 v87, v10, v87
  v_cvt_pk_bf16_f32 v160, v80, v81
  v_cvt_pk_bf16_f32 v161, v82, v83
  v_cvt_pk_bf16_f32 v162, v84, v85
  v_cvt_pk_bf16_f32 v163, v86, v87
  v_accvgpr_read_b32 v88, a104
  v_accvgpr_read_b32 v89, a105
  v_accvgpr_read_b32 v90, a106
  v_accvgpr_read_b32 v91, a107
  v_accvgpr_read_b32 v92, a108
  v_accvgpr_read_b32 v93, a109
  v_accvgpr_read_b32 v94, a110
  v_accvgpr_read_b32 v95, a111
  v_mul_f32 v88, v10, v88
  v_mul_f32 v89, v10, v89
  v_mul_f32 v90, v10, v90
  v_mul_f32 v91, v10, v91
  v_mul_f32 v92, v10, v92
  v_mul_f32 v93, v10, v93
  v_mul_f32 v94, v10, v94
  v_mul_f32 v95, v10, v95
  v_cvt_pk_bf16_f32 v164, v88, v89
  v_cvt_pk_bf16_f32 v165, v90, v91
  v_cvt_pk_bf16_f32 v166, v92, v93
  v_cvt_pk_bf16_f32 v167, v94, v95
  v_mfma_f32_32x32x16_bf16 v[16:31], a[0:3], v[160:163], v[16:31]
  ds_read_b64_tr_b16 a[28:29], v3 offset:2304
  ds_read_b64_tr_b16 a[30:31], v3 offset:2816
  v_accvgpr_read_b32 v80, a112
  v_accvgpr_read_b32 v81, a113
  v_accvgpr_read_b32 v82, a114
  v_add_u32 v3, 0x00020000, v3
  v_mfma_f32_32x32x16_bf16 v[32:47], a[4:7], v[160:163], v[32:47]
  ds_read_b64_tr_b16 a[0:1], v3 offset:20480
  ds_read_b64_tr_b16 a[2:3], v3 offset:20992
  v_accvgpr_read_b32 v83, a115
  v_accvgpr_read_b32 v84, a116
  v_accvgpr_read_b32 v85, a117
  v_accvgpr_read_b32 v86, a118
  v_mfma_f32_32x32x16_bf16 v[48:63], a[8:11], v[160:163], v[48:63]
  ds_read_b64_tr_b16 a[4:5], v3 offset:20736
  ds_read_b64_tr_b16 a[6:7], v3 offset:21248
  v_accvgpr_read_b32 v87, a119
  v_mul_f32 v80, v10, v80
  v_mul_f32 v81, v10, v81
  v_add_u32 v3, 0xfffe0000, v3
  s_waitcnt lgkmcnt(6)
  v_mfma_f32_32x32x16_bf16 v[64:79], a[12:15], v[160:163], v[64:79]
  ds_read_b64_tr_b16 a[8:9], v3 offset:4096
  ds_read_b64_tr_b16 a[10:11], v3 offset:4608
  v_mul_f32 v82, v10, v82
  v_mul_f32 v83, v10, v83
  v_mul_f32 v84, v10, v84
  v_mul_f32 v85, v10, v85
  v_mfma_f32_32x32x16_bf16 v[16:31], a[16:19], v[164:167], v[16:31]
  ds_read_b64_tr_b16 a[12:13], v3 offset:4352
  ds_read_b64_tr_b16 a[14:15], v3 offset:4864
  v_mul_f32 v86, v10, v86
  v_mul_f32 v87, v10, v87
  v_cvt_pk_bf16_f32 v168, v80, v81
  v_add_u32 v3, 0x00020000, v3
  v_mfma_f32_32x32x16_bf16 v[32:47], a[20:23], v[164:167], v[32:47]
  ds_read_b64_tr_b16 a[16:17], v3 offset:22528
  ds_read_b64_tr_b16 a[18:19], v3 offset:23040
  v_cvt_pk_bf16_f32 v169, v82, v83
  v_cvt_pk_bf16_f32 v170, v84, v85
  v_cvt_pk_bf16_f32 v171, v86, v87
  v_accvgpr_read_b32 v88, a120
  v_mfma_f32_32x32x16_bf16 v[48:63], a[24:27], v[164:167], v[48:63]
  ds_read_b64_tr_b16 a[20:21], v3 offset:22784
  ds_read_b64_tr_b16 a[22:23], v3 offset:23296
  v_accvgpr_read_b32 v89, a121
  v_accvgpr_read_b32 v90, a122
  v_accvgpr_read_b32 v91, a123
  v_add_u32 v3, 0xfffe0000, v3
  s_waitcnt lgkmcnt(6)
  v_mfma_f32_32x32x16_bf16 v[64:79], a[28:31], v[164:167], v[64:79]
  ds_read_b64_tr_b16 a[24:25], v3 offset:6144
  ds_read_b64_tr_b16 a[26:27], v3 offset:6656
  v_accvgpr_read_b32 v92, a124
  v_accvgpr_read_b32 v93, a125
  v_accvgpr_read_b32 v94, a126
  v_accvgpr_read_b32 v95, a127
  v_mul_f32 v88, v10, v88
  v_mul_f32 v89, v10, v89
  v_mul_f32 v90, v10, v90
  v_mul_f32 v91, v10, v91
  v_mul_f32 v92, v10, v92
  v_mul_f32 v93, v10, v93
  v_mul_f32 v94, v10, v94
  v_mul_f32 v95, v10, v95
  v_cvt_pk_bf16_f32 v172, v88, v89
  v_cvt_pk_bf16_f32 v173, v90, v91
  v_cvt_pk_bf16_f32 v174, v92, v93
  v_cvt_pk_bf16_f32 v175, v94, v95
  v_mfma_f32_32x32x16_bf16 v[16:31], a[0:3], v[168:171], v[16:31]
  ds_read_b64_tr_b16 a[28:29], v3 offset:6400
  ds_read_b64_tr_b16 a[30:31], v3 offset:6912
  v_accvgpr_read_b32 v80, a128
  v_accvgpr_read_b32 v81, a129
  v_accvgpr_read_b32 v82, a130
  v_add_u32 v3, 0x00020000, v3
  v_mfma_f32_32x32x16_bf16 v[32:47], a[4:7], v[168:171], v[32:47]
  ds_read_b64_tr_b16 a[0:1], v3 offset:24576
  ds_read_b64_tr_b16 a[2:3], v3 offset:25088
  v_accvgpr_read_b32 v83, a131
  v_accvgpr_read_b32 v84, a132
  v_accvgpr_read_b32 v85, a133
  v_accvgpr_read_b32 v86, a134
  v_mfma_f32_32x32x16_bf16 v[48:63], a[8:11], v[168:171], v[48:63]
  ds_read_b64_tr_b16 a[4:5], v3 offset:24832
  ds_read_b64_tr_b16 a[6:7], v3 offset:25344
  v_accvgpr_read_b32 v87, a135
  v_mul_f32 v80, v10, v80
  v_mul_f32 v81, v10, v81
  v_add_u32 v3, 0xfffe0000, v3
  s_waitcnt lgkmcnt(6)
  v_mfma_f32_32x32x16_bf16 v[64:79], a[12:15], v[168:171], v[64:79]
  ds_read_b64_tr_b16 a[8:9], v3 offset:8192
  ds_read_b64_tr_b16 a[10:11], v3 offset:8704
  v_mul_f32 v82, v10, v82
  v_mul_f32 v83, v10, v83
  v_mul_f32 v84, v10, v84
  v_mul_f32 v85, v10, v85
  v_mfma_f32_32x32x16_bf16 v[16:31], a[16:19], v[172:175], v[16:31]
  ds_read_b64_tr_b16 a[12:13], v3 offset:8448
  ds_read_b64_tr_b16 a[14:15], v3 offset:8960
  v_mul_f32 v86, v10, v86
  v_mul_f32 v87, v10, v87
  v_cvt_pk_bf16_f32 v176, v80, v81
  v_add_u32 v3, 0x00020000, v3
  v_mfma_f32_32x32x16_bf16 v[32:47], a[20:23], v[172:175], v[32:47]
  ds_read_b64_tr_b16 a[16:17], v3 offset:26624
  ds_read_b64_tr_b16 a[18:19], v3 offset:27136
  v_cvt_pk_bf16_f32 v177, v82, v83
  v_cvt_pk_bf16_f32 v178, v84, v85
  v_cvt_pk_bf16_f32 v179, v86, v87
  v_accvgpr_read_b32 v88, a136
  v_mfma_f32_32x32x16_bf16 v[48:63], a[24:27], v[172:175], v[48:63]
  ds_read_b64_tr_b16 a[20:21], v3 offset:26880
  ds_read_b64_tr_b16 a[22:23], v3 offset:27392
  v_accvgpr_read_b32 v89, a137
  v_accvgpr_read_b32 v90, a138
  v_accvgpr_read_b32 v91, a139
  v_add_u32 v3, 0xfffe0000, v3
  s_waitcnt lgkmcnt(6)
  v_mfma_f32_32x32x16_bf16 v[64:79], a[28:31], v[172:175], v[64:79]
  ds_read_b64_tr_b16 a[24:25], v3 offset:10240
  ds_read_b64_tr_b16 a[26:27], v3 offset:10752
  v_accvgpr_read_b32 v92, a140
  v_accvgpr_read_b32 v93, a141
  v_accvgpr_read_b32 v94, a142
  v_accvgpr_read_b32 v95, a143
  v_mul_f32 v88, v10, v88
  v_mul_f32 v89, v10, v89
  v_mul_f32 v90, v10, v90
  v_mul_f32 v91, v10, v91
  v_mul_f32 v92, v10, v92
  v_mul_f32 v93, v10, v93
  v_mul_f32 v94, v10, v94
  v_mul_f32 v95, v10, v95
  v_cvt_pk_bf16_f32 v180, v88, v89
  v_cvt_pk_bf16_f32 v181, v90, v91
  v_cvt_pk_bf16_f32 v182, v92, v93
  v_cvt_pk_bf16_f32 v183, v94, v95
  v_mfma_f32_32x32x16_bf16 v[16:31], a[0:3], v[176:179], v[16:31]
  ds_read_b64_tr_b16 a[28:29], v3 offset:10496
  ds_read_b64_tr_b16 a[30:31], v3 offset:11008
  v_accvgpr_read_b32 v80, a144
  v_accvgpr_read_b32 v81, a145
  v_accvgpr_read_b32 v82, a146
  v_add_u32 v3, 0x00020000, v3
  v_mfma_f32_32x32x16_bf16 v[32:47], a[4:7], v[176:179], v[32:47]
  ds_read_b64_tr_b16 a[0:1], v3 offset:28672
  ds_read_b64_tr_b16 a[2:3], v3 offset:29184
  v_accvgpr_read_b32 v83, a147
  v_accvgpr_read_b32 v84, a148
  v_accvgpr_read_b32 v85, a149
  v_accvgpr_read_b32 v86, a150
  v_mfma_f32_32x32x16_bf16 v[48:63], a[8:11], v[176:179], v[48:63]
  ds_read_b64_tr_b16 a[4:5], v3 offset:28928
  ds_read_b64_tr_b16 a[6:7], v3 offset:29440
  v_accvgpr_read_b32 v87, a151
  v_mul_f32 v80, v10, v80
  v_mul_f32 v81, v10, v81
  v_add_u32 v3, 0xfffe0000, v3
  s_waitcnt lgkmcnt(6)
  v_mfma_f32_32x32x16_bf16 v[64:79], a[12:15], v[176:179], v[64:79]
  ds_read_b64_tr_b16 a[8:9], v3 offset:12288
  ds_read_b64_tr_b16 a[10:11], v3 offset:12800
  v_mul_f32 v82, v10, v82
  v_mul_f32 v83, v10, v83
  v_mul_f32 v84, v10, v84
  v_mul_f32 v85, v10, v85
  v_mfma_f32_32x32x16_bf16 v[16:31], a[16:19], v[180:183], v[16:31]
  ds_read_b64_tr_b16 a[12:13], v3 offset:12544
  ds_read_b64_tr_b16 a[14:15], v3 offset:13056
  v_mul_f32 v86, v10, v86
  v_mul_f32 v87, v10, v87
  v_cvt_pk_bf16_f32 v184, v80, v81
  v_add_u32 v3, 0x00020000, v3
  v_mfma_f32_32x32x16_bf16 v[32:47], a[20:23], v[180:183], v[32:47]
  ds_read_b64_tr_b16 a[16:17], v3 offset:30720
  ds_read_b64_tr_b16 a[18:19], v3 offset:31232
  v_cvt_pk_bf16_f32 v185, v82, v83
  v_cvt_pk_bf16_f32 v186, v84, v85
  v_cvt_pk_bf16_f32 v187, v86, v87
  v_accvgpr_read_b32 v88, a152
  v_mfma_f32_32x32x16_bf16 v[48:63], a[24:27], v[180:183], v[48:63]
  ds_read_b64_tr_b16 a[20:21], v3 offset:30976
  ds_read_b64_tr_b16 a[22:23], v3 offset:31488
  v_accvgpr_read_b32 v89, a153
  v_accvgpr_read_b32 v90, a154
  v_accvgpr_read_b32 v91, a155
  v_add_u32 v3, 0xfffe0000, v3
  s_waitcnt lgkmcnt(6)
  v_mfma_f32_32x32x16_bf16 v[64:79], a[28:31], v[180:183], v[64:79]
  ds_read_b64_tr_b16 a[24:25], v3 offset:14336
  ds_read_b64_tr_b16 a[26:27], v3 offset:14848
  v_accvgpr_read_b32 v92, a156
  v_accvgpr_read_b32 v93, a157
  v_accvgpr_read_b32 v94, a158
  v_accvgpr_read_b32 v95, a159
  v_mul_f32 v88, v10, v88
  v_mul_f32 v89, v10, v89
  v_mul_f32 v90, v10, v90
  v_mul_f32 v91, v10, v91
  v_mul_f32 v92, v10, v92
  v_mul_f32 v93, v10, v93
  v_mul_f32 v94, v10, v94
  v_mul_f32 v95, v10, v95
  v_cvt_pk_bf16_f32 v188, v88, v89
  v_cvt_pk_bf16_f32 v189, v90, v91
  v_cvt_pk_bf16_f32 v190, v92, v93
  v_cvt_pk_bf16_f32 v191, v94, v95
  v_mfma_f32_32x32x16_bf16 v[16:31], a[0:3], v[184:187], v[16:31]
  ds_read_b64_tr_b16 a[28:29], v3 offset:14592
  ds_read_b64_tr_b16 a[30:31], v3 offset:15104
  v_mfma_f32_32x32x16_bf16 v[32:47], a[4:7], v[184:187], v[32:47]
  s_add_u32 m0, s31, 114688
  s_waitcnt vmcnt(16)
  s_barrier
  ds_read_b64_tr_b16 a[0:1], v3 offset:16384
  ds_read_b64_tr_b16 a[2:3], v3 offset:16896
  buffer_load_dwordx4 v2, s[48:51], s19 offen offset:0 lds
  v_mfma_f32_32x32x16_bf16 v[48:63], a[8:11], v[184:187], v[48:63]
  ds_read_b64_tr_b16 a[4:5], v3 offset:18432
  ds_read_b64_tr_b16 a[6:7], v3 offset:18944
  s_waitcnt lgkmcnt(6)
  v_mfma_f32_32x32x16_bf16 v[64:79], a[12:15], v[184:187], v[64:79]
  ds_read_b64_tr_b16 a[8:9], v3 offset:20480
  ds_read_b64_tr_b16 a[10:11], v3 offset:20992
  buffer_load_dwordx4 v2, s[52:55], s19 offen offset:1024 lds
  v_mfma_f32_32x32x16_bf16 v[16:31], a[16:19], v[188:191], v[16:31]
  ds_read_b64_tr_b16 a[12:13], v3 offset:22528
  ds_read_b64_tr_b16 a[14:15], v3 offset:23040
  v_mfma_f32_32x32x16_bf16 v[32:47], a[20:23], v[188:191], v[32:47]
  ds_read_b64_tr_b16 a[16:17], v3 offset:24576
  ds_read_b64_tr_b16 a[18:19], v3 offset:25088
  buffer_load_dwordx4 v2, s[56:59], s19 offen offset:2048 lds
  v_mfma_f32_32x32x16_bf16 v[48:63], a[24:27], v[188:191], v[48:63]
  ds_read_b64_tr_b16 a[20:21], v3 offset:26624
  ds_read_b64_tr_b16 a[22:23], v3 offset:27136
  s_waitcnt lgkmcnt(6)
  v_mfma_f32_32x32x16_bf16 v[64:79], a[28:31], v[188:191], v[64:79]
  ds_read_b64_tr_b16 a[24:25], v3 offset:28672
  ds_read_b64_tr_b16 a[26:27], v3 offset:29184
  buffer_load_dwordx4 v2, s[60:63], s19 offen offset:3072 lds
  s_mul_i32 s7, s14, 65536
  v_mfma_f32_32x32x16_bf16 v[224:239], a[0:3], v[128:131], 0
  ds_read_b64_tr_b16 a[28:29], v3 offset:30720
  ds_read_b64_tr_b16 a[30:31], v3 offset:31232
  s_add_u32 s7, s7, s9
  v_cvt_pk_bf16_f32 v16, v16, v17
  v_cvt_pk_bf16_f32 v17, v18, v19
  v_cvt_pk_bf16_f32 v18, v20, v21
  v_mfma_f32_32x32x16_bf16 v[224:239], a[4:7], v[132:135], v[224:239]
L_padl9:
  s_cbranch_execz L_walk_done
  s_add_u32 m0, s31, 131072
  s_add_u32 s6, s19, 114688
  ds_read_b64_tr_b16 a[0:1], v3 offset:16640
  ds_read_b64_tr_b16 a[2:3], v3 offset:17152
  buffer_load_dwordx4 v2, s[48:51], s6 offen offset:0 lds
  v_mfma_f32_32x32x16_bf16 v[224:239], a[8:11], v[136:139], v[224:239]
  ds_read_b64_tr_b16 a[4:5], v3 offset:18688
  ds_read_b64_tr_b16 a[6:7], v3 offset:19200
  v_cvt_pk_bf16_f32 v19, v22, v23
  v_cvt_pk_bf16_f32 v20, v24, v25
  v_cvt_pk_bf16_f32 v21, v26, v27
  v_cvt_pk_bf16_f32 v22, v28, v29
  s_waitcnt lgkmcnt(6)
  v_mfma_f32_32x32x16_bf16 v[224:239], a[12:15], v[140:143], v[224:239]
  ds_read_b64_tr_b16 a[8:9], v3 offset:20736
  ds_read_b64_tr_b16 a[10:11], v3 offset:21248
  buffer_load_dwordx4 v2, s[52:55], s6 offen offset:1024 lds
  v_cvt_pk_bf16_f32 v23, v30, v31
  v_mfma_f32_32x32x16_bf16 v[224:239], a[16:19], v[144:147], v[224:239]
  ds_read_b64_tr_b16 a[12:13], v3 offset:22784
  ds_read_b64_tr_b16 a[14:15], v3 offset:23296
  buffer_store_dwordx4 v[16:19], v12, s[88:91], s7 offen offset:0 sc1
  v_mfma_f32_32x32x16_bf16 v[224:239], a[20:23], v[148:151], v[224:239]
  ds_read_b64_tr_b16 a[16:17], v3 offset:24832
  ds_read_b64_tr_b16 a[18:19], v3 offset:25344
  buffer_load_dwordx4 v2, s[56:59], s6 offen offset:2048 lds
  v_mfma_f32_32x32x16_bf16 v[224:239], a[24:27], v[152:155], v[224:239]
  ds_read_b64_tr_b16 a[20:21], v3 offset:26880
  ds_read_b64_tr_b16 a[22:23], v3 offset:27392
  buffer_store_dwordx4 v[20:23], v12, s[88:91], s7 offen offset:1024 sc1
  s_mul_i32 s8, s14, 65536
  s_add_u32 s8, s8, s10
  s_waitcnt lgkmcnt(6)
  v_mfma_f32_32x32x16_bf16 v[224:239], a[28:31], v[156:159], v[224:239]
  ds_read_b64_tr_b16 a[24:25], v3 offset:28928
  ds_read_b64_tr_b16 a[26:27], v3 offset:29440
  buffer_load_dwordx4 v2, s[60:63], s6 offen offset:3072 lds
  v_cvt_pk_bf16_f32 v32, v32, v33
  v_mfma_f32_32x32x16_bf16 v[80:95], a[0:3], v[128:131], 0
  ds_read_b64_tr_b16 a[28:29], v3 offset:30976
  ds_read_b64_tr_b16 a[30:31], v3 offset:31488
  v_cvt_pk_bf16_f32 v33, v34, v35
  v_cvt_pk_bf16_f32 v34, v36, v37
  v_cvt_pk_bf16_f32 v35, v38, v39
  v_cvt_pk_bf16_f32 v36, v40, v41
  v_mfma_f32_32x32x16_bf16 v[80:95], a[4:7], v[132:135], v[80:95]
  ds_read_b64_tr_b16 a[0:1], v3 offset:32768
  ds_read_b64_tr_b16 a[2:3], v3 offset:33280
  v_cvt_pk_bf16_f32 v37, v42, v43
  v_cvt_pk_bf16_f32 v38, v44, v45
  v_cvt_pk_bf16_f32 v39, v46, v47
  v_mfma_f32_32x32x16_bf16 v[80:95], a[8:11], v[136:139], v[80:95]
  ds_read_b64_tr_b16 a[4:5], v3 offset:34816
  ds_read_b64_tr_b16 a[6:7], v3 offset:35328
  buffer_store_dwordx4 v[32:35], v12, s[88:91], s8 offen offset:0 sc1
  buffer_store_dwordx4 v[36:39], v12, s[88:91], s8 offen offset:1024 sc1
  s_waitcnt lgkmcnt(6)
  v_mfma_f32_32x32x16_bf16 v[80:95], a[12:15], v[140:143], v[80:95]
  ds_read_b64_tr_b16 a[8:9], v3 offset:36864
  ds_read_b64_tr_b16 a[10:11], v3 offset:37376
  s_mul_i32 s7, s15, 65536
  s_add_u32 s7, s7, s9
  v_cvt_pk_bf16_f32 v48, v48, v49
  v_cvt_pk_bf16_f32 v49, v50, v51
  v_mfma_f32_32x32x16_bf16 v[80:95], a[16:19], v[144:147], v[80:95]
  ds_read_b64_tr_b16 a[12:13], v3 offset:38912
  ds_read_b64_tr_b16 a[14:15], v3 offset:39424
  v_cvt_pk_bf16_f32 v50, v52, v53
  v_cvt_pk_bf16_f32 v51, v54, v55
  v_cvt_pk_bf16_f32 v52, v56, v57
  v_cvt_pk_bf16_f32 v53, v58, v59
  v_mfma_f32_32x32x16_bf16 v[80:95], a[20:23], v[148:151], v[80:95]
  ds_read_b64_tr_b16 a[16:17], v3 offset:40960
  ds_read_b64_tr_b16 a[18:19], v3 offset:41472
  v_cvt_pk_bf16_f32 v54, v60, v61
  v_cvt_pk_bf16_f32 v55, v62, v63
  v_mfma_f32_32x32x16_bf16 v[80:95], a[24:27], v[152:155], v[80:95]
  ds_read_b64_tr_b16 a[20:21], v3 offset:43008
  ds_read_b64_tr_b16 a[22:23], v3 offset:43520
  buffer_store_dwordx4 v[48:51], v12, s[88:91], s7 offen offset:0 sc1
  buffer_store_dwordx4 v[52:55], v12, s[88:91], s7 offen offset:1024 sc1
  s_waitcnt lgkmcnt(6)
  v_mfma_f32_32x32x16_bf16 v[80:95], a[28:31], v[156:159], v[80:95]
  ds_read_b64_tr_b16 a[24:25], v3 offset:45056
  ds_read_b64_tr_b16 a[26:27], v3 offset:45568
  s_mul_i32 s8, s15, 65536
  s_add_u32 s8, s8, s10
  v_cvt_pk_bf16_f32 v64, v64, v65
  v_cvt_pk_bf16_f32 v65, v66, v67
  v_mfma_f32_32x32x16_bf16 v[224:239], a[0:3], v[160:163], v[224:239]
  ds_read_b64_tr_b16 a[28:29], v3 offset:47104
  ds_read_b64_tr_b16 a[30:31], v3 offset:47616
  v_cvt_pk_bf16_f32 v66, v68, v69
  v_cvt_pk_bf16_f32 v67, v70, v71
  v_cvt_pk_bf16_f32 v68, v72, v73
  v_cvt_pk_bf16_f32 v69, v74, v75
  v_mfma_f32_32x32x16_bf16 v[224:239], a[4:7], v[164:167], v[224:239]
  ds_read_b64_tr_b16 a[0:1], v3 offset:33024
  ds_read_b64_tr_b16 a[2:3], v3 offset:33536
  v_cvt_pk_bf16_f32 v70, v76, v77
  v_cvt_pk_bf16_f32 v71, v78, v79
  v_mfma_f32_32x32x16_bf16 v[224:239], a[8:11], v[168:171], v[224:239]
  ds_read_b64_tr_b16 a[4:5], v3 offset:35072
  ds_read_b64_tr_b16 a[6:7], v3 offset:35584
  buffer_store_dwordx4 v[64:67], v12, s[88:91], s8 offen offset:0 sc1
  buffer_store_dwordx4 v[68:71], v12, s[88:91], s8 offen offset:1024 sc1
  s_waitcnt lgkmcnt(6)
  v_mfma_f32_32x32x16_bf16 v[224:239], a[12:15], v[172:175], v[224:239]
  ds_read_b64_tr_b16 a[8:9], v3 offset:37120
  ds_read_b64_tr_b16 a[10:11], v3 offset:37632
  v_mfma_f32_32x32x16_bf16 v[224:239], a[16:19], v[176:179], v[224:239]
  ds_read_b64_tr_b16 a[12:13], v3 offset:39168
  ds_read_b64_tr_b16 a[14:15], v3 offset:39680
  v_mfma_f32_32x32x16_bf16 v[224:239], a[20:23], v[180:183], v[224:239]
  ds_read_b64_tr_b16 a[16:17], v3 offset:41216
  ds_read_b64_tr_b16 a[18:19], v3 offset:41728
  v_mfma_f32_32x32x16_bf16 v[224:239], a[24:27], v[184:187], v[224:239]
  ds_read_b64_tr_b16 a[20:21], v3 offset:43264
  ds_read_b64_tr_b16 a[22:23], v3 offset:43776
  s_waitcnt lgkmcnt(6)
  v_mfma_f32_32x32x16_bf16 v[224:239], a[28:31], v[188:191], v[224:239]
  ds_read_b64_tr_b16 a[24:25], v3 offset:45312
  ds_read_b64_tr_b16 a[26:27], v3 offset:45824
  v_mfma_f32_32x32x16_bf16 v[80:95], a[0:3], v[160:163], v[80:95]
  ds_read_b64_tr_b16 a[28:29], v3 offset:47360
  ds_read_b64_tr_b16 a[30:31], v3 offset:47872
  v_mfma_f32_32x32x16_bf16 v[80:95], a[4:7], v[164:167], v[80:95]
  s_add_u32 m0, s31, 147456
  s_waitcnt vmcnt(24)
  s_barrier
  ds_read_b64_tr_b16 a[0:1], v3 offset:49152
  ds_read_b64_tr_b16 a[2:3], v3 offset:49664
  buffer_load_dwordx4 v2, s[48:51], s20 offen offset:0 lds
  v_mfma_f32_32x32x16_bf16 v[80:95], a[8:11], v[168:171], v[80:95]
  ds_read_b64_tr_b16 a[4:5], v3 offset:51200
  ds_read_b64_tr_b16 a[6:7], v3 offset:51712
  s_mul_i32 s7, s16, 65536
  s_add_u32 s7, s7, s9
  v_cvt_pk_bf16_f32 v224, v224, v225
  v_cvt_pk_bf16_f32 v225, v226, v227
  s_waitcnt lgkmcnt(6)
  v_mfma_f32_32x32x16_bf16 v[80:95], a[12:15], v[172:175], v[80:95]
  ds_read_b64_tr_b16 a[8:9], v3 offset:53248
  ds_read_b64_tr_b16 a[10:11], v3 offset:53760
  buffer_load_dwordx4 v2, s[52:55], s20 offen offset:1024 lds
  v_cvt_pk_bf16_f32 v226, v228, v229
  v_mfma_f32_32x32x16_bf16 v[80:95], a[16:19], v[176:179], v[80:95]
  ds_read_b64_tr_b16 a[12:13], v3 offset:55296
  ds_read_b64_tr_b16 a[14:15], v3 offset:55808
  v_cvt_pk_bf16_f32 v227, v230, v231
  v_cvt_pk_bf16_f32 v228, v232, v233
  v_cvt_pk_bf16_f32 v229, v234, v235
  v_cvt_pk_bf16_f32 v230, v236, v237
  v_mfma_f32_32x32x16_bf16 v[80:95], a[20:23], v[180:183], v[80:95]
  ds_read_b64_tr_b16 a[16:17], v3 offset:57344
  ds_read_b64_tr_b16 a[18:19], v3 offset:57856
  buffer_load_dwordx4 v2, s[56:59], s20 offen offset:2048 lds
  s_lshl_b32 s99, s14, 3
  v_mfma_f32_32x32x16_bf16 v[80:95], a[24:27], v[184:187], v[80:95]
  ds_read_b64_tr_b16 a[20:21], v3 offset:59392
  ds_read_b64_tr_b16 a[22:23], v3 offset:59904
  s_lshl2_add_u32 s99, s96, s99
  s_add_u32 s99, s99, s28
  s_waitcnt vmcnt(7)
  s_waitcnt lgkmcnt(6)
  v_mfma_f32_32x32x16_bf16 v[80:95], a[28:31], v[188:191], v[80:95]
  ds_read_b64_tr_b16 a[24:25], v3 offset:61440
  ds_read_b64_tr_b16 a[26:27], v3 offset:61952
  buffer_load_dwordx4 v2, s[60:63], s20 offen offset:3072 lds
  v_cvt_pk_bf16_f32 v231, v238, v239
  v_mfma_f32_32x32x16_bf16 v[16:31], a[0:3], v[128:131], 0
  ds_read_b64_tr_b16 a[28:29], v3 offset:63488
  ds_read_b64_tr_b16 a[30:31], v3 offset:64000
  buffer_store_dword v0, off, s[88:91], s99 sc1
  v_mfma_f32_32x32x16_bf16 v[16:31], a[4:7], v[132:135], v[16:31]
  s_add_u32 m0, s31, 0
  s_add_u32 s6, s20, 114688
  ds_read_b64_tr_b16 a[0:1], v3 offset:49408
  ds_read_b64_tr_b16 a[2:3], v3 offset:49920
  buffer_load_dwordx4 v2, s[48:51], s6 offen offset:0 lds
  buffer_store_dwordx4 v[224:227], v12, s[88:91], s7 offen offset:0 sc1
  buffer_store_dwordx4 v[228:231], v12, s[88:91], s7 offen offset:1024 sc1
  v_mfma_f32_32x32x16_bf16 v[16:31], a[8:11], v[136:139], v[16:31]
  ds_read_b64_tr_b16 a[4:5], v3 offset:51456
  ds_read_b64_tr_b16 a[6:7], v3 offset:51968
  s_mul_i32 s8, s16, 65536
  s_add_u32 s8, s8, s10
  v_cvt_pk_bf16_f32 v80, v80, v81
  v_cvt_pk_bf16_f32 v81, v82, v83
  s_waitcnt lgkmcnt(6)
  v_mfma_f32_32x32x16_bf16 v[16:31], a[12:15], v[140:143], v[16:31]
  ds_read_b64_tr_b16 a[8:9], v3 offset:53504
  ds_read_b64_tr_b16 a[10:11], v3 offset:54016
  buffer_load_dwordx4 v2, s[52:55], s6 offen offset:1024 lds
  v_cvt_pk_bf16_f32 v82, v84, v85
  v_mfma_f32_32x32x16_bf16 v[16:31], a[16:19], v[144:147], v[16:31]
  ds_read_b64_tr_b16 a[12:13], v3 offset:55552
  ds_read_b64_tr_b16 a[14:15], v3 offset:56064
  v_cvt_pk_bf16_f32 v83, v86, v87
  v_cvt_pk_bf16_f32 v84, v88, v89
  v_cvt_pk_bf16_f32 v85, v90, v91
  v_cvt_pk_bf16_f32 v86, v92, v93
  v_mfma_f32_32x32x16_bf16 v[16:31], a[20:23], v[148:151], v[16:31]
  ds_read_b64_tr_b16 a[16:17], v3 offset:57600
  ds_read_b64_tr_b16 a[18:19], v3 offset:58112
  buffer_load_dwordx4 v2, s[56:59], s6 offen offset:2048 lds
  s_lshl_b32 s99, s15, 3
  v_mfma_f32_32x32x16_bf16 v[16:31], a[24:27], v[152:155], v[16:31]
  ds_read_b64_tr_b16 a[20:21], v3 offset:59648
  ds_read_b64_tr_b16 a[22:23], v3 offset:60160
  s_lshl2_add_u32 s99, s96, s99
  s_add_u32 s99, s99, s28
  s_waitcnt vmcnt(10)
  s_waitcnt lgkmcnt(6)
  v_mfma_f32_32x32x16_bf16 v[16:31], a[28:31], v[156:159], v[16:31]
  ds_read_b64_tr_b16 a[24:25], v3 offset:61696
  ds_read_b64_tr_b16 a[26:27], v3 offset:62208
  buffer_load_dwordx4 v2, s[60:63], s6 offen offset:3072 lds
  v_cvt_pk_bf16_f32 v87, v94, v95
  v_mfma_f32_32x32x16_bf16 v[32:47], a[0:3], v[128:131], 0
  ds_read_b64_tr_b16 a[28:29], v3 offset:63744
  ds_read_b64_tr_b16 a[30:31], v3 offset:64256
  buffer_store_dword v0, off, s[88:91], s99 sc1
  v_add_u32 v3, 0x00010000, v3
  v_mfma_f32_32x32x16_bf16 v[32:47], a[4:7], v[132:135], v[32:47]
  ds_read_b64_tr_b16 a[0:1], v3 offset:0
  ds_read_b64_tr_b16 a[2:3], v3 offset:512
  buffer_store_dwordx4 v[80:83], v12, s[88:91], s8 offen offset:0 sc1
  buffer_store_dwordx4 v[84:87], v12, s[88:91], s8 offen offset:1024 sc1
  v_mfma_f32_32x32x16_bf16 v[32:47], a[8:11], v[136:139], v[32:47]
  ds_read_b64_tr_b16 a[4:5], v3 offset:2048
  ds_read_b64_tr_b16 a[6:7], v3 offset:2560
  s_waitcnt lgkmcnt(6)
  v_mfma_f32_32x32x16_bf16 v[32:47], a[12:15], v[140:143], v[32:47]
  ds_read_b64_tr_b16 a[8:9], v3 offset:4096
  ds_read_b64_tr_b16 a[10:11], v3 offset:4608
  v_mfma_f32_32x32x16_bf16 v[32:47], a[16:19], v[144:147], v[32:47]
  ds_read_b64_tr_b16 a[12:13], v3 offset:6144
  ds_read_b64_tr_b16 a[14:15], v3 offset:6656
  v_mfma_f32_32x32x16_bf16 v[32:47], a[20:23], v[148:151], v[32:47]
  ds_read_b64_tr_b16 a[16:17], v3 offset:8192
  ds_read_b64_tr_b16 a[18:19], v3 offset:8704
  v_mfma_f32_32x32x16_bf16 v[32:47], a[24:27], v[152:155], v[32:47]
  ds_read_b64_tr_b16 a[20:21], v3 offset:10240
  ds_read_b64_tr_b16 a[22:23], v3 offset:10752
  s_waitcnt lgkmcnt(6)
  v_mfma_f32_32x32x16_bf16 v[32:47], a[28:31], v[156:159], v[32:47]
  ds_read_b64_tr_b16 a[24:25], v3 offset:12288
  ds_read_b64_tr_b16 a[26:27], v3 offset:12800
  v_mfma_f32_32x32x16_bf16 v[16:31], a[0:3], v[160:163], v[16:31]
  ds_read_b64_tr_b16 a[28:29], v3 offset:14336
  ds_read_b64_tr_b16 a[30:31], v3 offset:14848
  v_mfma_f32_32x32x16_bf16 v[16:31], a[4:7], v[164:167], v[16:31]
  ds_read_b64_tr_b16 a[0:1], v3 offset:256
  ds_read_b64_tr_b16 a[2:3], v3 offset:768
  v_mfma_f32_32x32x16_bf16 v[16:31], a[8:11], v[168:171], v[16:31]
  ds_read_b64_tr_b16 a[4:5], v3 offset:2304
  ds_read_b64_tr_b16 a[6:7], v3 offset:2816
  s_waitcnt lgkmcnt(6)
  v_mfma_f32_32x32x16_bf16 v[16:31], a[12:15], v[172:175], v[16:31]
  ds_read_b64_tr_b16 a[8:9], v3 offset:4352
  ds_read_b64_tr_b16 a[10:11], v3 offset:4864
  v_mfma_f32_32x32x16_bf16 v[16:31], a[16:19], v[176:179], v[16:31]
  ds_read_b64_tr_b16 a[12:13], v3 offset:6400
  ds_read_b64_tr_b16 a[14:15], v3 offset:6912
  v_mfma_f32_32x32x16_bf16 v[16:31], a[20:23], v[180:183], v[16:31]
  ds_read_b64_tr_b16 a[16:17], v3 offset:8448
  ds_read_b64_tr_b16 a[18:19], v3 offset:8960
  v_mfma_f32_32x32x16_bf16 v[16:31], a[24:27], v[184:187], v[16:31]
  ds_read_b64_tr_b16 a[20:21], v3 offset:10496
  ds_read_b64_tr_b16 a[22:23], v3 offset:11008
  s_waitcnt lgkmcnt(6)
  v_mfma_f32_32x32x16_bf16 v[16:31], a[28:31], v[188:191], v[16:31]
  ds_read_b64_tr_b16 a[24:25], v3 offset:12544
  ds_read_b64_tr_b16 a[26:27], v3 offset:13056
  v_mfma_f32_32x32x16_bf16 v[32:47], a[0:3], v[160:163], v[32:47]
  ds_read_b64_tr_b16 a[28:29], v3 offset:14592
  ds_read_b64_tr_b16 a[30:31], v3 offset:15104
  v_mfma_f32_32x32x16_bf16 v[32:47], a[4:7], v[164:167], v[32:47]
  s_barrier
  ds_read_b64_tr_b16 a[0:1], v3 offset:16384
  ds_read_b64_tr_b16 a[2:3], v3 offset:16896
  v_mfma_f32_32x32x16_bf16 v[32:47], a[8:11], v[168:171], v[32:47]
  ds_read_b64_tr_b16 a[4:5], v3 offset:18432
  ds_read_b64_tr_b16 a[6:7], v3 offset:18944
  s_mul_i32 s7, s17, 65536
  s_add_u32 s7, s7, s9
  v_cvt_pk_bf16_f32 v16, v16, v17
  v_cvt_pk_bf16_f32 v17, v18, v19
  s_waitcnt lgkmcnt(6)
  v_mfma_f32_32x32x16_bf16 v[32:47], a[12:15], v[172:175], v[32:47]
  ds_read_b64_tr_b16 a[8:9], v3 offset:20480
  ds_read_b64_tr_b16 a[10:11], v3 offset:20992
  v_cvt_pk_bf16_f32 v18, v20, v21
  v_cvt_pk_bf16_f32 v19, v22, v23
  v_cvt_pk_bf16_f32 v20, v24, v25
  v_cvt_pk_bf16_f32 v21, v26, v27
  v_mfma_f32_32x32x16_bf16 v[32:47], a[16:19], v[176:179], v[32:47]
  ds_read_b64_tr_b16 a[12:13], v3 offset:22528
  ds_read_b64_tr_b16 a[14:15], v3 offset:23040
  s_lshl_b32 s99, s16, 3
  s_lshl2_add_u32 s99, s96, s99
  s_add_u32 s99, s99, s28
  v_cvt_pk_bf16_f32 v22, v28, v29
  v_mfma_f32_32x32x16_bf16 v[32:47], a[20:23], v[180:183], v[32:47]
  ds_read_b64_tr_b16 a[16:17], v3 offset:24576
  ds_read_b64_tr_b16 a[18:19], v3 offset:25088
  s_waitcnt vmcnt(0)
  v_cvt_pk_bf16_f32 v23, v30, v31
  v_mfma_f32_32x32x16_bf16 v[32:47], a[24:27], v[184:187], v[32:47]
  ds_read_b64_tr_b16 a[20:21], v3 offset:26624
  ds_read_b64_tr_b16 a[22:23], v3 offset:27136
  buffer_store_dword v0, off, s[88:91], s99 sc1
  s_waitcnt lgkmcnt(6)
  v_mfma_f32_32x32x16_bf16 v[32:47], a[28:31], v[188:191], v[32:47]
  ds_read_b64_tr_b16 a[24:25], v3 offset:28672
  ds_read_b64_tr_b16 a[26:27], v3 offset:29184
  buffer_store_dwordx4 v[16:19], v12, s[88:91], s7 offen offset:0 sc1
  v_mfma_f32_32x32x16_bf16 v[48:63], a[0:3], v[128:131], 0
  ds_read_b64_tr_b16 a[28:29], v3 offset:30720
  ds_read_b64_tr_b16 a[30:31], v3 offset:31232
  buffer_store_dwordx4 v[20:23], v12, s[88:91], s7 offen offset:1024 sc1
  v_mfma_f32_32x32x16_bf16 v[48:63], a[4:7], v[132:135], v[48:63]
  ds_read_b64_tr_b16 a[0:1], v3 offset:16640
  ds_read_b64_tr_b16 a[2:3], v3 offset:17152
  v_mfma_f32_32x32x16_bf16 v[48:63], a[8:11], v[136:139], v[48:63]
  ds_read_b64_tr_b16 a[4:5], v3 offset:18688
  ds_read_b64_tr_b16 a[6:7], v3 offset:19200
  s_mul_i32 s8, s17, 65536
  s_add_u32 s8, s8, s10
  v_cvt_pk_bf16_f32 v32, v32, v33
  v_cvt_pk_bf16_f32 v33, v34, v35
  s_waitcnt lgkmcnt(6)
  v_mfma_f32_32x32x16_bf16 v[48:63], a[12:15], v[140:143], v[48:63]
  ds_read_b64_tr_b16 a[8:9], v3 offset:20736
  ds_read_b64_tr_b16 a[10:11], v3 offset:21248
  v_cvt_pk_bf16_f32 v34, v36, v37
  v_cvt_pk_bf16_f32 v35, v38, v39
  v_cvt_pk_bf16_f32 v36, v40, v41
  v_cvt_pk_bf16_f32 v37, v42, v43
  v_mfma_f32_32x32x16_bf16 v[48:63], a[16:19], v[144:147], v[48:63]
  ds_read_b64_tr_b16 a[12:13], v3 offset:22784
  ds_read_b64_tr_b16 a[14:15], v3 offset:23296
  v_cvt_pk_bf16_f32 v38, v44, v45
  v_cvt_pk_bf16_f32 v39, v46, v47
  v_mfma_f32_32x32x16_bf16 v[48:63], a[20:23], v[148:151], v[48:63]
  ds_read_b64_tr_b16 a[16:17], v3 offset:24832
  ds_read_b64_tr_b16 a[18:19], v3 offset:25344
  buffer_store_dwordx4 v[32:35], v12, s[88:91], s8 offen offset:0 sc1
  v_mfma_f32_32x32x16_bf16 v[48:63], a[24:27], v[152:155], v[48:63]
  ds_read_b64_tr_b16 a[20:21], v3 offset:26880
  ds_read_b64_tr_b16 a[22:23], v3 offset:27392
  buffer_store_dwordx4 v[36:39], v12, s[88:91], s8 offen offset:1024 sc1
  s_waitcnt lgkmcnt(6)
  v_mfma_f32_32x32x16_bf16 v[48:63], a[28:31], v[156:159], v[48:63]
  ds_read_b64_tr_b16 a[24:25], v3 offset:28928
  ds_read_b64_tr_b16 a[26:27], v3 offset:29440
  v_mfma_f32_32x32x16_bf16 v[64:79], a[0:3], v[128:131], 0
  ds_read_b64_tr_b16 a[28:29], v3 offset:30976
  ds_read_b64_tr_b16 a[30:31], v3 offset:31488
  v_mfma_f32_32x32x16_bf16 v[64:79], a[4:7], v[132:135], v[64:79]
  ds_read_b64_tr_b16 a[0:1], v3 offset:32768
  ds_read_b64_tr_b16 a[2:3], v3 offset:33280
  v_mfma_f32_32x32x16_bf16 v[64:79], a[8:11], v[136:139], v[64:79]
  ds_read_b64_tr_b16 a[4:5], v3 offset:34816
  ds_read_b64_tr_b16 a[6:7], v3 offset:35328
  s_waitcnt lgkmcnt(6)
  v_mfma_f32_32x32x16_bf16 v[64:79], a[12:15], v[140:143], v[64:79]
  ds_read_b64_tr_b16 a[8:9], v3 offset:36864
  ds_read_b64_tr_b16 a[10:11], v3 offset:37376
  v_mfma_f32_32x32x16_bf16 v[64:79], a[16:19], v[144:147], v[64:79]
  ds_read_b64_tr_b16 a[12:13], v3 offset:38912
  ds_read_b64_tr_b16 a[14:15], v3 offset:39424
  v_mfma_f32_32x32x16_bf16 v[64:79], a[20:23], v[148:151], v[64:79]
  ds_read_b64_tr_b16 a[16:17], v3 offset:40960
  ds_read_b64_tr_b16 a[18:19], v3 offset:41472
  v_mfma_f32_32x32x16_bf16 v[64:79], a[24:27], v[152:155], v[64:79]
  ds_read_b64_tr_b16 a[20:21], v3 offset:43008
  ds_read_b64_tr_b16 a[22:23], v3 offset:43520
  s_waitcnt lgkmcnt(6)
  v_mfma_f32_32x32x16_bf16 v[64:79], a[28:31], v[156:159], v[64:79]
  ds_read_b64_tr_b16 a[24:25], v3 offset:45056
  ds_read_b64_tr_b16 a[26:27], v3 offset:45568
  v_mfma_f32_32x32x16_bf16 v[48:63], a[0:3], v[160:163], v[48:63]
  ds_read_b64_tr_b16 a[28:29], v3 offset:47104
  ds_read_b64_tr_b16 a[30:31], v3 offset:47616
  v_mfma_f32_32x32x16_bf16 v[48:63], a[4:7], v[164:167], v[48:63]
  ds_read_b64_tr_b16 a[0:1], v3 offset:33024
  ds_read_b64_tr_b16 a[2:3], v3 offset:33536
  v_mfma_f32_32x32x16_bf16 v[48:63], a[8:11], v[168:171], v[48:63]
  ds_read_b64_tr_b16 a[4:5], v3 offset:35072
  ds_read_b64_tr_b16 a[6:7], v3 offset:35584
  s_waitcnt lgkmcnt(6)
  v_mfma_f32_32x32x16_bf16 v[48:63], a[12:15], v[172:175], v[48:63]
  ds_read_b64_tr_b16 a[8:9], v3 offset:37120
  ds_read_b64_tr_b16 a[10:11], v3 offset:37632
  v_mfma_f32_32x32x16_bf16 v[48:63], a[16:19], v[176:179], v[48:63]
  ds_read_b64_tr_b16 a[12:13], v3 offset:39168
  ds_read_b64_tr_b16 a[14:15], v3 offset:39680
  v_mfma_f32_32x32x16_bf16 v[48:63], a[20:23], v[180:183], v[48:63]
  ds_read_b64_tr_b16 a[16:17], v3 offset:41216
  ds_read_b64_tr_b16 a[18:19], v3 offset:41728
  v_mfma_f32_32x32x16_bf16 v[48:63], a[24:27], v[184:187], v[48:63]
  ds_read_b64_tr_b16 a[20:21], v3 offset:43264
  ds_read_b64_tr_b16 a[22:23], v3 offset:43776
  s_waitcnt lgkmcnt(6)
  v_mfma_f32_32x32x16_bf16 v[48:63], a[28:31], v[188:191], v[48:63]
  ds_read_b64_tr_b16 a[24:25], v3 offset:45312
  ds_read_b64_tr_b16 a[26:27], v3 offset:45824
  v_mfma_f32_32x32x16_bf16 v[64:79], a[0:3], v[160:163], v[64:79]
  ds_read_b64_tr_b16 a[28:29], v3 offset:47360
  ds_read_b64_tr_b16 a[30:31], v3 offset:47872
  v_mfma_f32_32x32x16_bf16 v[64:79], a[4:7], v[164:167], v[64:79]
  s_barrier
  ds_read_b64_tr_b16 a[0:1], v3 offset:49152
  ds_read_b64_tr_b16 a[2:3], v3 offset:49664
  v_mfma_f32_32x32x16_bf16 v[64:79], a[8:11], v[168:171], v[64:79]
  ds_read_b64_tr_b16 a[4:5], v3 offset:51200
  ds_read_b64_tr_b16 a[6:7], v3 offset:51712
  s_mul_i32 s7, s18, 65536
  s_add_u32 s7, s7, s9
  v_cvt_pk_bf16_f32 v48, v48, v49
  v_cvt_pk_bf16_f32 v49, v50, v51
  s_waitcnt lgkmcnt(6)
  v_mfma_f32_32x32x16_bf16 v[64:79], a[12:15], v[172:175], v[64:79]
  ds_read_b64_tr_b16 a[8:9], v3 offset:53248
  ds_read_b64_tr_b16 a[10:11], v3 offset:53760
  v_cvt_pk_bf16_f32 v50, v52, v53
  v_cvt_pk_bf16_f32 v51, v54, v55
  v_cvt_pk_bf16_f32 v52, v56, v57
  v_cvt_pk_bf16_f32 v53, v58, v59
  v_mfma_f32_32x32x16_bf16 v[64:79], a[16:19], v[176:179], v[64:79]
  ds_read_b64_tr_b16 a[12:13], v3 offset:55296
  ds_read_b64_tr_b16 a[14:15], v3 offset:55808
  s_lshl_b32 s99, s17, 3
  s_lshl2_add_u32 s99, s96, s99
  s_add_u32 s99, s99, s28
  v_cvt_pk_bf16_f32 v54, v60, v61
  v_mfma_f32_32x32x16_bf16 v[64:79], a[20:23], v[180:183], v[64:79]
  ds_read_b64_tr_b16 a[16:17], v3 offset:57344
  ds_read_b64_tr_b16 a[18:19], v3 offset:57856
  s_waitcnt vmcnt(0)
  v_cvt_pk_bf16_f32 v55, v62, v63
  v_mfma_f32_32x32x16_bf16 v[64:79], a[24:27], v[184:187], v[64:79]
  ds_read_b64_tr_b16 a[20:21], v3 offset:59392
  ds_read_b64_tr_b16 a[22:23], v3 offset:59904
  buffer_store_dword v0, off, s[88:91], s99 sc1
  s_waitcnt lgkmcnt(6)
  v_mfma_f32_32x32x16_bf16 v[64:79], a[28:31], v[188:191], v[64:79]
  ds_read_b64_tr_b16 a[24:25], v3 offset:61440
  ds_read_b64_tr_b16 a[26:27], v3 offset:61952
  buffer_store_dwordx4 v[48:51], v12, s[88:91], s7 offen offset:0 sc1
  v_mfma_f32_32x32x16_bf16 v[224:239], a[0:3], v[128:131], 0
  ds_read_b64_tr_b16 a[28:29], v3 offset:63488
  ds_read_b64_tr_b16 a[30:31], v3 offset:64000
  buffer_store_dwordx4 v[52:55], v12, s[88:91], s7 offen offset:1024 sc1
  v_mfma_f32_32x32x16_bf16 v[224:239], a[4:7], v[132:135], v[224:239]
  ds_read_b64_tr_b16 a[0:1], v3 offset:49408
  ds_read_b64_tr_b16 a[2:3], v3 offset:49920
  v_mfma_f32_32x32x16_bf16 v[224:239], a[8:11], v[136:139], v[224:239]
  ds_read_b64_tr_b16 a[4:5], v3 offset:51456
  ds_read_b64_tr_b16 a[6:7], v3 offset:51968
  s_mul_i32 s8, s18, 65536
  s_add_u32 s8, s8, s10
  v_cvt_pk_bf16_f32 v64, v64, v65
  v_cvt_pk_bf16_f32 v65, v66, v67
  s_waitcnt lgkmcnt(6)
  v_mfma_f32_32x32x16_bf16 v[224:239], a[12:15], v[140:143], v[224:239]
  ds_read_b64_tr_b16 a[8:9], v3 offset:53504
  ds_read_b64_tr_b16 a[10:11], v3 offset:54016
  v_cvt_pk_bf16_f32 v66, v68, v69
  v_cvt_pk_bf16_f32 v67, v70, v71
  v_cvt_pk_bf16_f32 v68, v72, v73
  v_cvt_pk_bf16_f32 v69, v74, v75
  v_mfma_f32_32x32x16_bf16 v[224:239], a[16:19], v[144:147], v[224:239]
  ds_read_b64_tr_b16 a[12:13], v3 offset:55552
  ds_read_b64_tr_b16 a[14:15], v3 offset:56064
  v_cvt_pk_bf16_f32 v70, v76, v77
  v_cvt_pk_bf16_f32 v71, v78, v79
  v_mfma_f32_32x32x16_bf16 v[224:239], a[20:23], v[148:151], v[224:239]
  ds_read_b64_tr_b16 a[16:17], v3 offset:57600
  ds_read_b64_tr_b16 a[18:19], v3 offset:58112
  buffer_store_dwordx4 v[64:67], v12, s[88:91], s8 offen offset:0 sc1
  v_mfma_f32_32x32x16_bf16 v[224:239], a[24:27], v[152:155], v[224:239]
  ds_read_b64_tr_b16 a[20:21], v3 offset:59648
  ds_read_b64_tr_b16 a[22:23], v3 offset:60160
  buffer_store_dwordx4 v[68:71], v12, s[88:91], s8 offen offset:1024 sc1
  s_waitcnt lgkmcnt(6)
  v_mfma_f32_32x32x16_bf16 v[224:239], a[28:31], v[156:159], v[224:239]
  ds_read_b64_tr_b16 a[24:25], v3 offset:61696
  ds_read_b64_tr_b16 a[26:27], v3 offset:62208
  v_mfma_f32_32x32x16_bf16 v[80:95], a[0:3], v[128:131], 0
  ds_read_b64_tr_b16 a[28:29], v3 offset:63744
  ds_read_b64_tr_b16 a[30:31], v3 offset:64256
  v_add_u32 v3, 0x00010000, v3
  v_mfma_f32_32x32x16_bf16 v[80:95], a[4:7], v[132:135], v[80:95]
  ds_read_b64_tr_b16 a[0:1], v3 offset:0
  ds_read_b64_tr_b16 a[2:3], v3 offset:512
  v_mfma_f32_32x32x16_bf16 v[80:95], a[8:11], v[136:139], v[80:95]
  ds_read_b64_tr_b16 a[4:5], v3 offset:2048
  ds_read_b64_tr_b16 a[6:7], v3 offset:2560
  s_waitcnt lgkmcnt(6)
  v_mfma_f32_32x32x16_bf16 v[80:95], a[12:15], v[140:143], v[80:95]
  ds_read_b64_tr_b16 a[8:9], v3 offset:4096
  ds_read_b64_tr_b16 a[10:11], v3 offset:4608
  v_mfma_f32_32x32x16_bf16 v[80:95], a[16:19], v[144:147], v[80:95]
  ds_read_b64_tr_b16 a[12:13], v3 offset:6144
  ds_read_b64_tr_b16 a[14:15], v3 offset:6656
  v_mfma_f32_32x32x16_bf16 v[80:95], a[20:23], v[148:151], v[80:95]
  ds_read_b64_tr_b16 a[16:17], v3 offset:8192
  ds_read_b64_tr_b16 a[18:19], v3 offset:8704
  v_mfma_f32_32x32x16_bf16 v[80:95], a[24:27], v[152:155], v[80:95]
  ds_read_b64_tr_b16 a[20:21], v3 offset:10240
  ds_read_b64_tr_b16 a[22:23], v3 offset:10752
  s_waitcnt lgkmcnt(6)
  v_mfma_f32_32x32x16_bf16 v[80:95], a[28:31], v[156:159], v[80:95]
  ds_read_b64_tr_b16 a[24:25], v3 offset:12288
  ds_read_b64_tr_b16 a[26:27], v3 offset:12800
  v_mfma_f32_32x32x16_bf16 v[224:239], a[0:3], v[160:163], v[224:239]
  ds_read_b64_tr_b16 a[28:29], v3 offset:14336
  ds_read_b64_tr_b16 a[30:31], v3 offset:14848
  v_mfma_f32_32x32x16_bf16 v[224:239], a[4:7], v[164:167], v[224:239]
  ds_read_b64_tr_b16 a[0:1], v3 offset:256
  ds_read_b64_tr_b16 a[2:3], v3 offset:768
  v_mfma_f32_32x32x16_bf16 v[224:239], a[8:11], v[168:171], v[224:239]
  ds_read_b64_tr_b16 a[4:5], v3 offset:2304
  ds_read_b64_tr_b16 a[6:7], v3 offset:2816
  s_waitcnt lgkmcnt(6)
  v_mfma_f32_32x32x16_bf16 v[224:239], a[12:15], v[172:175], v[224:239]
  ds_read_b64_tr_b16 a[8:9], v3 offset:4352
  ds_read_b64_tr_b16 a[10:11], v3 offset:4864
  v_mfma_f32_32x32x16_bf16 v[224:239], a[16:19], v[176:179], v[224:239]
  ds_read_b64_tr_b16 a[12:13], v3 offset:6400
  ds_read_b64_tr_b16 a[14:15], v3 offset:6912
  v_mfma_f32_32x32x16_bf16 v[224:239], a[20:23], v[180:183], v[224:239]
  ds_read_b64_tr_b16 a[16:17], v3 offset:8448
  ds_read_b64_tr_b16 a[18:19], v3 offset:8960
  v_mfma_f32_32x32x16_bf16 v[224:239], a[24:27], v[184:187], v[224:239]
  ds_read_b64_tr_b16 a[20:21], v3 offset:10496
  ds_read_b64_tr_b16 a[22:23], v3 offset:11008
  s_waitcnt lgkmcnt(6)
  v_mfma_f32_32x32x16_bf16 v[224:239], a[28:31], v[188:191], v[224:239]
L_padl10:
  s_cbranch_execz L_walk_done
  ds_read_b64_tr_b16 a[24:25], v3 offset:12544
  ds_read_b64_tr_b16 a[26:27], v3 offset:13056
  v_mfma_f32_32x32x16_bf16 v[80:95], a[0:3], v[160:163], v[80:95]
  ds_read_b64_tr_b16 a[28:29], v3 offset:14592
  ds_read_b64_tr_b16 a[30:31], v3 offset:15104
  v_mfma_f32_32x32x16_bf16 v[80:95], a[4:7], v[164:167], v[80:95]
  s_barrier
  ds_read_b64_tr_b16 a[0:1], v3 offset:16384
  ds_read_b64_tr_b16 a[2:3], v3 offset:16896
  v_mfma_f32_32x32x16_bf16 v[80:95], a[8:11], v[168:171], v[80:95]
  ds_read_b64_tr_b16 a[4:5], v3 offset:18432
  ds_read_b64_tr_b16 a[6:7], v3 offset:18944
  s_mul_i32 s7, s19, 65536
  s_add_u32 s7, s7, s9
  v_cvt_pk_bf16_f32 v224, v224, v225
  v_cvt_pk_bf16_f32 v225, v226, v227
  s_waitcnt lgkmcnt(6)
  v_mfma_f32_32x32x16_bf16 v[80:95], a[12:15], v[172:175], v[80:95]
  ds_read_b64_tr_b16 a[8:9], v3 offset:20480
  ds_read_b64_tr_b16 a[10:11], v3 offset:20992
  v_cvt_pk_bf16_f32 v226, v228, v229
  v_cvt_pk_bf16_f32 v227, v230, v231
  v_cvt_pk_bf16_f32 v228, v232, v233
  v_cvt_pk_bf16_f32 v229, v234, v235
  v_mfma_f32_32x32x16_bf16 v[80:95], a[16:19], v[176:179], v[80:95]
  ds_read_b64_tr_b16 a[12:13], v3 offset:22528
  ds_read_b64_tr_b16 a[14:15], v3 offset:23040
  v_cvt_pk_bf16_f32 v230, v236, v237
  v_cvt_pk_bf16_f32 v231, v238, v239
  s_lshl_b32 s99, s18, 3
  s_lshl2_add_u32 s99, s96, s99
  v_mfma_f32_32x32x16_bf16 v[80:95], a[20:23], v[180:183], v[80:95]
  ds_read_b64_tr_b16 a[16:17], v3 offset:24576
  ds_read_b64_tr_b16 a[18:19], v3 offset:25088
  buffer_store_dwordx4 v[224:227], v12, s[88:91], s7 offen offset:0 sc1
  s_add_u32 s99, s99, s28
  v_mfma_f32_32x32x16_bf16 v[80:95], a[24:27], v[184:187], v[80:95]
  ds_read_b64_tr_b16 a[20:21], v3 offset:26624
  ds_read_b64_tr_b16 a[22:23], v3 offset:27136
  buffer_store_dwordx4 v[228:231], v12, s[88:91], s7 offen offset:1024 sc1
  s_waitcnt vmcnt(2)
  s_waitcnt lgkmcnt(6)
  v_mfma_f32_32x32x16_bf16 v[80:95], a[28:31], v[188:191], v[80:95]
  ds_read_b64_tr_b16 a[24:25], v3 offset:28672
  ds_read_b64_tr_b16 a[26:27], v3 offset:29184
  buffer_store_dword v0, off, s[88:91], s99 sc1
  v_mfma_f32_32x32x16_bf16 v[16:31], a[0:3], v[128:131], 0
  ds_read_b64_tr_b16 a[28:29], v3 offset:30720
  ds_read_b64_tr_b16 a[30:31], v3 offset:31232
  v_add_u32 v3, 0xfffe0000, v3
  v_mfma_f32_32x32x16_bf16 v[16:31], a[4:7], v[132:135], v[16:31]
  ds_read_b64_tr_b16 a[0:1], v3 offset:0
  ds_read_b64_tr_b16 a[2:3], v3 offset:512
  v_mfma_f32_32x32x16_bf16 v[16:31], a[8:11], v[136:139], v[16:31]
  ds_read_b64_tr_b16 a[4:5], v3 offset:2048
  ds_read_b64_tr_b16 a[6:7], v3 offset:2560
  s_mul_i32 s8, s19, 65536
  s_add_u32 s8, s8, s10
  v_cvt_pk_bf16_f32 v80, v80, v81
  v_cvt_pk_bf16_f32 v81, v82, v83
  s_waitcnt lgkmcnt(6)
  v_mfma_f32_32x32x16_bf16 v[16:31], a[12:15], v[140:143], v[16:31]
  ds_read_b64_tr_b16 a[8:9], v3 offset:4096
  ds_read_b64_tr_b16 a[10:11], v3 offset:4608
  v_cvt_pk_bf16_f32 v82, v84, v85
  v_cvt_pk_bf16_f32 v83, v86, v87
  v_cvt_pk_bf16_f32 v84, v88, v89
  v_cvt_pk_bf16_f32 v85, v90, v91
  v_mfma_f32_32x32x16_bf16 v[16:31], a[16:19], v[144:147], v[16:31]
  ds_read_b64_tr_b16 a[12:13], v3 offset:6144
  ds_read_b64_tr_b16 a[14:15], v3 offset:6656
  v_cvt_pk_bf16_f32 v86, v92, v93
  v_cvt_pk_bf16_f32 v87, v94, v95
  v_mfma_f32_32x32x16_bf16 v[16:31], a[20:23], v[148:151], v[16:31]
  ds_read_b64_tr_b16 a[16:17], v3 offset:8192
  ds_read_b64_tr_b16 a[18:19], v3 offset:8704
  buffer_store_dwordx4 v[80:83], v12, s[88:91], s8 offen offset:0 sc1
  v_mfma_f32_32x32x16_bf16 v[16:31], a[24:27], v[152:155], v[16:31]
  ds_read_b64_tr_b16 a[20:21], v3 offset:10240
  ds_read_b64_tr_b16 a[22:23], v3 offset:10752
  buffer_store_dwordx4 v[84:87], v12, s[88:91], s8 offen offset:1024 sc1
  s_waitcnt lgkmcnt(6)
  v_mfma_f32_32x32x16_bf16 v[16:31], a[28:31], v[156:159], v[16:31]
  ds_read_b64_tr_b16 a[24:25], v3 offset:12288
  ds_read_b64_tr_b16 a[26:27], v3 offset:12800
  v_mfma_f32_32x32x16_bf16 v[16:31], a[0:3], v[160:163], v[16:31]
  ds_read_b64_tr_b16 a[28:29], v3 offset:14336
  ds_read_b64_tr_b16 a[30:31], v3 offset:14848
  v_add_u32 v3, 0x00020000, v3
  v_mfma_f32_32x32x16_bf16 v[16:31], a[4:7], v[164:167], v[16:31]
  ds_read_b64_tr_b16 a[0:1], v3 offset:16640
  ds_read_b64_tr_b16 a[2:3], v3 offset:17152
  v_mfma_f32_32x32x16_bf16 v[16:31], a[8:11], v[168:171], v[16:31]
  ds_read_b64_tr_b16 a[4:5], v3 offset:18688
  ds_read_b64_tr_b16 a[6:7], v3 offset:19200
  s_waitcnt lgkmcnt(6)
  v_mfma_f32_32x32x16_bf16 v[16:31], a[12:15], v[172:175], v[16:31]
  ds_read_b64_tr_b16 a[8:9], v3 offset:20736
  ds_read_b64_tr_b16 a[10:11], v3 offset:21248
  v_mfma_f32_32x32x16_bf16 v[16:31], a[16:19], v[176:179], v[16:31]
  ds_read_b64_tr_b16 a[12:13], v3 offset:22784
  ds_read_b64_tr_b16 a[14:15], v3 offset:23296
  v_mfma_f32_32x32x16_bf16 v[16:31], a[20:23], v[180:183], v[16:31]
  ds_read_b64_tr_b16 a[16:17], v3 offset:24832
  ds_read_b64_tr_b16 a[18:19], v3 offset:25344
  v_mfma_f32_32x32x16_bf16 v[16:31], a[24:27], v[184:187], v[16:31]
  ds_read_b64_tr_b16 a[20:21], v3 offset:26880
  ds_read_b64_tr_b16 a[22:23], v3 offset:27392
  s_waitcnt lgkmcnt(6)
  v_mfma_f32_32x32x16_bf16 v[16:31], a[28:31], v[188:191], v[16:31]
  ds_read_b64_tr_b16 a[24:25], v3 offset:28928
  ds_read_b64_tr_b16 a[26:27], v3 offset:29440
  v_mfma_f32_32x32x16_bf16 v[32:47], a[0:3], v[128:131], 0
  ds_read_b64_tr_b16 a[28:29], v3 offset:30976
  ds_read_b64_tr_b16 a[30:31], v3 offset:31488
  v_add_u32 v3, 0xfffe0000, v3
  v_mfma_f32_32x32x16_bf16 v[32:47], a[4:7], v[132:135], v[32:47]
  ds_read_b64_tr_b16 a[0:1], v3 offset:256
  ds_read_b64_tr_b16 a[2:3], v3 offset:768
  v_mfma_f32_32x32x16_bf16 v[32:47], a[8:11], v[136:139], v[32:47]
  ds_read_b64_tr_b16 a[4:5], v3 offset:2304
  ds_read_b64_tr_b16 a[6:7], v3 offset:2816
  s_mul_i32 s7, s20, 65536
  s_add_u32 s7, s7, s9
  v_cvt_pk_bf16_f32 v16, v16, v17
  v_cvt_pk_bf16_f32 v17, v18, v19
  s_waitcnt lgkmcnt(6)
  v_mfma_f32_32x32x16_bf16 v[32:47], a[12:15], v[140:143], v[32:47]
  ds_read_b64_tr_b16 a[8:9], v3 offset:4352
  ds_read_b64_tr_b16 a[10:11], v3 offset:4864
  v_cvt_pk_bf16_f32 v18, v20, v21
  v_cvt_pk_bf16_f32 v19, v22, v23
  v_cvt_pk_bf16_f32 v20, v24, v25
  v_cvt_pk_bf16_f32 v21, v26, v27
  v_mfma_f32_32x32x16_bf16 v[32:47], a[16:19], v[144:147], v[32:47]
  ds_read_b64_tr_b16 a[12:13], v3 offset:6400
  ds_read_b64_tr_b16 a[14:15], v3 offset:6912
  v_cvt_pk_bf16_f32 v22, v28, v29
  v_cvt_pk_bf16_f32 v23, v30, v31
  v_mfma_f32_32x32x16_bf16 v[32:47], a[20:23], v[148:151], v[32:47]
  ds_read_b64_tr_b16 a[16:17], v3 offset:8448
  ds_read_b64_tr_b16 a[18:19], v3 offset:8960
  buffer_store_dwordx4 v[16:19], v12, s[88:91], s7 offen offset:0 sc1
  v_mfma_f32_32x32x16_bf16 v[32:47], a[24:27], v[152:155], v[32:47]
  ds_read_b64_tr_b16 a[20:21], v3 offset:10496
  ds_read_b64_tr_b16 a[22:23], v3 offset:11008
  buffer_store_dwordx4 v[20:23], v12, s[88:91], s7 offen offset:1024 sc1
  s_lshl_b32 s99, s19, 3
  s_lshl2_add_u32 s99, s96, s99
  s_waitcnt lgkmcnt(6)
  v_mfma_f32_32x32x16_bf16 v[32:47], a[28:31], v[156:159], v[32:47]
  ds_read_b64_tr_b16 a[24:25], v3 offset:12544
  ds_read_b64_tr_b16 a[26:27], v3 offset:13056
  s_add_u32 s99, s99, s28
  s_waitcnt vmcnt(2)
  v_mfma_f32_32x32x16_bf16 v[32:47], a[0:3], v[160:163], v[32:47]
  ds_read_b64_tr_b16 a[28:29], v3 offset:14592
  ds_read_b64_tr_b16 a[30:31], v3 offset:15104
  buffer_store_dword v0, off, s[88:91], s99 sc1
  v_mfma_f32_32x32x16_bf16 v[32:47], a[4:7], v[164:167], v[32:47]
  v_mfma_f32_32x32x16_bf16 v[32:47], a[8:11], v[168:171], v[32:47]
  s_waitcnt lgkmcnt(2)
  v_mfma_f32_32x32x16_bf16 v[32:47], a[12:15], v[172:175], v[32:47]
  v_mfma_f32_32x32x16_bf16 v[32:47], a[16:19], v[176:179], v[32:47]
  v_mfma_f32_32x32x16_bf16 v[32:47], a[20:23], v[180:183], v[32:47]
  v_mfma_f32_32x32x16_bf16 v[32:47], a[24:27], v[184:187], v[32:47]
  s_waitcnt lgkmcnt(0)
  v_mfma_f32_32x32x16_bf16 v[32:47], a[28:31], v[188:191], v[32:47]
  s_mul_i32 s8, s20, 65536
  s_add_u32 s8, s8, s10
  s_nop 9
  v_cvt_pk_bf16_f32 v32, v32, v33
  v_cvt_pk_bf16_f32 v33, v34, v35
  v_cvt_pk_bf16_f32 v34, v36, v37
  v_cvt_pk_bf16_f32 v35, v38, v39
  v_cvt_pk_bf16_f32 v36, v40, v41
  v_cvt_pk_bf16_f32 v37, v42, v43
  v_cvt_pk_bf16_f32 v38, v44, v45
  v_cvt_pk_bf16_f32 v39, v46, v47
  buffer_store_dwordx4 v[32:35], v12, s[88:91], s8 offen offset:0 sc1
  buffer_store_dwordx4 v[36:39], v12, s[88:91], s8 offen offset:1024 sc1
  s_lshl_b32 s99, s20, 3
  s_lshl2_add_u32 s99, s96, s99
  s_add_u32 s99, s99, s28
  s_waitcnt vmcnt(0)
  buffer_store_dword v0, off, s[88:91], s99 sc1
  s_endpgm
L_spinNl:
  s_mov_b32 s0, 0x40000
L_loopNl:
  s_sleep 1
  buffer_load_dwordx2 v[14:15], off, s[92:95], s26 sc1
  s_waitcnt vmcnt(0)
  v_and_b32 v0, -7, v15
  v_cmp_ne_u32 vcc, v0, v14
  v_cmp_eq_u32 s[44:45], 0, v14
  s_nop 1
  s_or_b64 vcc, vcc, s[44:45]
  s_cbranch_vccz L_backNl
  s_sub_u32 s0, s0, 1
  s_cmp_lg_u32 s0, 0
  s_cbranch_scc1 L_loopNl
  s_branch L_backNl
L_code_end:
  s_endpgm
.section .rodata,"a"
.p2align 6
.amdhsa_kernel recurrent_scan__sliding_block_cached__dense_activation_gelu__prompt_kernel
  .amdhsa_next_free_vgpr 512
  .amdhsa_next_free_sgpr 102
  .amdhsa_accum_offset 256
  .amdhsa_group_segment_fixed_size 0
  .amdhsa_kernarg_size 104
  .amdhsa_user_sgpr_count 2
  .amdhsa_user_sgpr_kernarg_segment_ptr 1
  .amdhsa_system_sgpr_workgroup_id_x 1
.end_amdhsa_kernel
```
